```python
import torch

def _softmax(x, axis=-1):
    return torch.softmax(x, dim=axis)
def _gelu(x):
    return torch.nn.functional.gelu(x, approximate="tanh")
def _silu(x):
    return torch.nn.functional.silu(x)
def _sigmoid(x):
    return torch.sigmoid(x)
def _layernorm(x, axis=-1, eps=1e-5):
    m = x.mean(dim=axis, keepdim=True)
    v = x.var(dim=axis, keepdim=True, unbiased=False)
    return (x - m) / torch.sqrt(v + eps)
def _scatter_add(tgt, idx, src, axis=0):
    return tgt.clone().index_add_(axis, idx, src)
def _segment_sum(src, seg, n):
    out = torch.zeros((n,) + src.shape[1:], dtype=src.dtype)
    return out.index_add_(0, seg, src)
def _pad(x, pw):
    flat = tuple(v for pair in reversed(pw) for v in pair)
    return torch.nn.functional.pad(x, flat)

kernel_name = 'recurrent_scan__spectral_fnet__glu_gated_glu__prompt'

def setup_inputs():

    _w = (lambda a: (lambda t: t.to(torch.bfloat16) if t.is_floating_point() else t)(torch.as_tensor(a)))
    def _A_setup():
        B, S, D = 1, 2048, 576
        ns = torch.arange(S)[:, None] * torch.arange(S)[None, :]
        nd = torch.arange(D)[:, None] * torch.arange(D)[None, :]
        Ws_re = torch.cos(-2.0 * torch.pi * ns / S).to(float)
        Ws_im = torch.sin(-2.0 * torch.pi * ns / S).to(float)
        Wd_re = torch.cos(-2.0 * torch.pi * nd / D).to(float)
        Wd_im = torch.sin(-2.0 * torch.pi * nd / D).to(float)
        return {
            "x": _w((lambda *s: torch.randn(*s, dtype=torch.bfloat16) * 0.05)(B, S, D)),
            "dft_seq_re": _w(Ws_re),
            "dft_seq_im": _w(Ws_im),
            "dft_hid_re": _w(Wd_re),
            "dft_hid_im": _w(Wd_im),
        }
    _A_in = _A_setup()

    def _B_setup():
        B, S, D, F = 1, 2048, 576, 4608
        return {
            "x": _w((lambda *s: torch.randn(*s, dtype=torch.bfloat16) * 0.05)(B, S, D)),
            "w_gate": _w((lambda *s: torch.randn(*s, dtype=torch.bfloat16) * 0.05)(D, F)),
            "w_up": _w((lambda *s: torch.randn(*s, dtype=torch.bfloat16) * 0.05)(D, F)),
            "w_down": _w((lambda *s: torch.randn(*s, dtype=torch.bfloat16) * 0.05)(F, D)),
        }
    _B_in = _B_setup()

    return {
        "A_x": _A_in["x"],
        "A_dft_seq_re": _A_in["dft_seq_re"],
        "A_dft_seq_im": _A_in["dft_seq_im"],
        "A_dft_hid_re": _A_in["dft_hid_re"],
        "A_dft_hid_im": _A_in["dft_hid_im"],
        "B_x": _B_in["x"],
        "B_w_gate": _B_in["w_gate"],
        "B_w_up": _B_in["w_up"],
        "B_w_down": _B_in["w_down"],
    }

def reference(A_x, A_dft_seq_re, A_dft_seq_im, A_dft_hid_re, A_dft_hid_im, B_x, B_w_gate, B_w_up, B_w_down):
    def _A_ref(x, dft_seq_re, dft_seq_im, dft_hid_re, dft_hid_im):
        a = torch.einsum("bsd,ed->bse", x, dft_hid_re)
        b = torch.einsum("bsd,ed->bse", x, dft_hid_im)
        y = torch.einsum("ts,bse->bte", dft_seq_re, a) - torch.einsum("ts,bse->bte", dft_seq_im, b)
        return y

    def _B_ref(x, w_gate, w_up, w_down):
        g = torch.einsum("bsd,df->bsf", x, w_gate)
        u = torch.einsum("bsd,df->bsf", x, w_up)
        h = _sigmoid(g) * u
        return torch.einsum("bsf,fd->bsd", h, w_down)

    x = A_x
    xn = _layernorm(x, axis=-1)
    s = _A_ref(xn, A_dft_seq_re, A_dft_seq_im, A_dft_hid_re, A_dft_hid_im)
    g = _silu(_B_ref(xn, B_w_gate, B_w_up, B_w_down))
    return x + s * g
```

```asm
; @launch kernel=ln_kernel grid=(512,1,1) block=(256,1,1) lds=0
; @launch kernel=stagea_kernel grid=(672,1,1) block=(256,1,1) lds=147456
; @launch kernel=stageb_kernel grid=(256,1,1) block=(256,1,1) lds=147456
; @launch kernel=final_kernel grid=(1152,1,1) block=(256,1,1) lds=0
.amdgcn_target "amdgcn-amd-amdhsa--gfx950"
.text
.globl ln_kernel
.p2align 8
.type ln_kernel,@function
ln_kernel:
    s_cmp_ge_u32 s2, 512
    s_cbranch_scc1 K0_END
    s_load_dwordx2 s[4:5], s[0:1], 0
    s_load_dwordx2 s[6:7], s[0:1], 88
    v_lshrrev_b32 v1, 6, v0
    v_and_b32 v10, 63, v0
    s_lshl_b32 s3, s2, 2
    v_add_u32 v1, s3, v1
    s_movk_i32 s3, 1152
    v_mul_lo_u32 v1, v1, s3
    v_lshlrev_b32 v11, 4, v10
    v_add_u32 v1, v1, v11
    s_waitcnt lgkmcnt(0)
    s_mov_b32 s8, s4
    s_mov_b32 s9, s5
    s_mov_b32 s10, 0x240000
    s_mov_b32 s11, 0x00020000
    s_mov_b32 s12, s6
    s_mov_b32 s13, s7
    s_mov_b32 s14, 0x240000
    s_mov_b32 s15, 0x00020000
    v_mov_b32 v6, 0
    v_mov_b32 v7, 0
    v_mov_b32 v8, 0
    v_mov_b32 v9, 0
    buffer_load_dwordx4 v[2:5], v1, s[8:11], 0 offen
    v_cmp_gt_u32 vcc, 8, v10
    s_and_saveexec_b64 s[16:17], vcc
    buffer_load_dwordx4 v[6:9], v1, s[8:11], 0 offen offset:1024
    s_mov_b64 exec, s[16:17]
    s_waitcnt vmcnt(0)
    v_lshlrev_b32 v20, 16, v2
    v_and_b32 v21, 0xffff0000, v2
    v_lshlrev_b32 v22, 16, v3
    v_and_b32 v23, 0xffff0000, v3
    v_lshlrev_b32 v24, 16, v4
    v_and_b32 v25, 0xffff0000, v4
    v_lshlrev_b32 v26, 16, v5
    v_and_b32 v27, 0xffff0000, v5
    v_lshlrev_b32 v28, 16, v6
    v_and_b32 v29, 0xffff0000, v6
    v_lshlrev_b32 v30, 16, v7
    v_and_b32 v31, 0xffff0000, v7
    v_lshlrev_b32 v32, 16, v8
    v_and_b32 v33, 0xffff0000, v8
    v_lshlrev_b32 v34, 16, v9
    v_and_b32 v35, 0xffff0000, v9
    v_add_f32 v12, v20, v21
    v_add_f32 v12, v12, v22
    v_add_f32 v12, v12, v23
    v_add_f32 v12, v12, v24
    v_add_f32 v12, v12, v25
    v_add_f32 v12, v12, v26
    v_add_f32 v12, v12, v27
    v_add_f32 v12, v12, v28
    v_add_f32 v12, v12, v29
    v_add_f32 v12, v12, v30
    v_add_f32 v12, v12, v31
    v_add_f32 v12, v12, v32
    v_add_f32 v12, v12, v33
    v_add_f32 v12, v12, v34
    v_add_f32 v12, v12, v35
    v_xor_b32 v13, 1, v10
    v_lshlrev_b32 v13, 2, v13
    ds_bpermute_b32 v14, v13, v12
    s_waitcnt lgkmcnt(0)
    v_add_f32 v12, v12, v14
    v_xor_b32 v13, 2, v10
    v_lshlrev_b32 v13, 2, v13
    ds_bpermute_b32 v14, v13, v12
    s_waitcnt lgkmcnt(0)
    v_add_f32 v12, v12, v14
    v_xor_b32 v13, 4, v10
    v_lshlrev_b32 v13, 2, v13
    ds_bpermute_b32 v14, v13, v12
    s_waitcnt lgkmcnt(0)
    v_add_f32 v12, v12, v14
    v_xor_b32 v13, 8, v10
    v_lshlrev_b32 v13, 2, v13
    ds_bpermute_b32 v14, v13, v12
    s_waitcnt lgkmcnt(0)
    v_add_f32 v12, v12, v14
    v_xor_b32 v13, 16, v10
    v_lshlrev_b32 v13, 2, v13
    ds_bpermute_b32 v14, v13, v12
    s_waitcnt lgkmcnt(0)
    v_add_f32 v12, v12, v14
    v_xor_b32 v13, 32, v10
    v_lshlrev_b32 v13, 2, v13
    ds_bpermute_b32 v14, v13, v12
    s_waitcnt lgkmcnt(0)
    v_add_f32 v12, v12, v14
    s_mov_b32 s3, 0x3ae38e39
    v_mul_f32 v12, s3, v12
    v_mov_b32 v15, 0
    v_sub_f32 v16, v20, v12
    v_fmac_f32 v15, v16, v16
    v_sub_f32 v16, v21, v12
    v_fmac_f32 v15, v16, v16
    v_sub_f32 v16, v22, v12
    v_fmac_f32 v15, v16, v16
    v_sub_f32 v16, v23, v12
    v_fmac_f32 v15, v16, v16
    v_sub_f32 v16, v24, v12
    v_fmac_f32 v15, v16, v16
    v_sub_f32 v16, v25, v12
    v_fmac_f32 v15, v16, v16
    v_sub_f32 v16, v26, v12
    v_fmac_f32 v15, v16, v16
    v_sub_f32 v16, v27, v12
    v_fmac_f32 v15, v16, v16
    s_and_saveexec_b64 s[16:17], vcc
    v_sub_f32 v16, v28, v12
    v_fmac_f32 v15, v16, v16
    v_sub_f32 v16, v29, v12
    v_fmac_f32 v15, v16, v16
    v_sub_f32 v16, v30, v12
    v_fmac_f32 v15, v16, v16
    v_sub_f32 v16, v31, v12
    v_fmac_f32 v15, v16, v16
    v_sub_f32 v16, v32, v12
    v_fmac_f32 v15, v16, v16
    v_sub_f32 v16, v33, v12
    v_fmac_f32 v15, v16, v16
    v_sub_f32 v16, v34, v12
    v_fmac_f32 v15, v16, v16
    v_sub_f32 v16, v35, v12
    v_fmac_f32 v15, v16, v16
    s_mov_b64 exec, s[16:17]
    v_xor_b32 v13, 1, v10
    v_lshlrev_b32 v13, 2, v13
    ds_bpermute_b32 v14, v13, v15
    s_waitcnt lgkmcnt(0)
    v_add_f32 v15, v15, v14
    v_xor_b32 v13, 2, v10
    v_lshlrev_b32 v13, 2, v13
    ds_bpermute_b32 v14, v13, v15
    s_waitcnt lgkmcnt(0)
    v_add_f32 v15, v15, v14
    v_xor_b32 v13, 4, v10
    v_lshlrev_b32 v13, 2, v13
    ds_bpermute_b32 v14, v13, v15
    s_waitcnt lgkmcnt(0)
    v_add_f32 v15, v15, v14
    v_xor_b32 v13, 8, v10
    v_lshlrev_b32 v13, 2, v13
    ds_bpermute_b32 v14, v13, v15
    s_waitcnt lgkmcnt(0)
    v_add_f32 v15, v15, v14
    v_xor_b32 v13, 16, v10
    v_lshlrev_b32 v13, 2, v13
    ds_bpermute_b32 v14, v13, v15
    s_waitcnt lgkmcnt(0)
    v_add_f32 v15, v15, v14
    v_xor_b32 v13, 32, v10
    v_lshlrev_b32 v13, 2, v13
    ds_bpermute_b32 v14, v13, v15
    s_waitcnt lgkmcnt(0)
    v_add_f32 v15, v15, v14
    v_mul_f32 v15, s3, v15
    v_cvt_pk_bf16_f32 v16, v12, v12
    v_lshlrev_b32 v12, 16, v16
    v_cvt_pk_bf16_f32 v16, v15, v15
    v_lshlrev_b32 v15, 16, v16
    v_add_f32 v15, 0x3727c5ac, v15
    v_cvt_pk_bf16_f32 v16, v15, v15
    v_lshlrev_b32 v15, 16, v16
    v_sqrt_f32 v15, v15
    s_nop 0
    v_cvt_pk_bf16_f32 v16, v15, v15
    v_lshlrev_b32 v15, 16, v16
    v_rcp_f32 v17, v15
    s_nop 0
    v_sub_f32 v20, v20, v12
    v_cvt_pk_bf16_f32 v16, v20, v20
    v_lshlrev_b32 v20, 16, v16
    v_mul_f32 v18, v20, v17
    v_fma_f32 v19, -v18, v15, v20
    v_fma_f32 v20, v19, v17, v18
    v_sub_f32 v21, v21, v12
    v_cvt_pk_bf16_f32 v16, v21, v21
    v_lshlrev_b32 v21, 16, v16
    v_mul_f32 v18, v21, v17
    v_fma_f32 v19, -v18, v15, v21
    v_fma_f32 v21, v19, v17, v18
    v_sub_f32 v22, v22, v12
    v_cvt_pk_bf16_f32 v16, v22, v22
    v_lshlrev_b32 v22, 16, v16
    v_mul_f32 v18, v22, v17
    v_fma_f32 v19, -v18, v15, v22
    v_fma_f32 v22, v19, v17, v18
    v_sub_f32 v23, v23, v12
    v_cvt_pk_bf16_f32 v16, v23, v23
    v_lshlrev_b32 v23, 16, v16
    v_mul_f32 v18, v23, v17
    v_fma_f32 v19, -v18, v15, v23
    v_fma_f32 v23, v19, v17, v18
    v_sub_f32 v24, v24, v12
    v_cvt_pk_bf16_f32 v16, v24, v24
    v_lshlrev_b32 v24, 16, v16
    v_mul_f32 v18, v24, v17
    v_fma_f32 v19, -v18, v15, v24
    v_fma_f32 v24, v19, v17, v18
    v_sub_f32 v25, v25, v12
    v_cvt_pk_bf16_f32 v16, v25, v25
    v_lshlrev_b32 v25, 16, v16
    v_mul_f32 v18, v25, v17
    v_fma_f32 v19, -v18, v15, v25
    v_fma_f32 v25, v19, v17, v18
    v_sub_f32 v26, v26, v12
    v_cvt_pk_bf16_f32 v16, v26, v26
    v_lshlrev_b32 v26, 16, v16
    v_mul_f32 v18, v26, v17
    v_fma_f32 v19, -v18, v15, v26
    v_fma_f32 v26, v19, v17, v18
    v_sub_f32 v27, v27, v12
    v_cvt_pk_bf16_f32 v16, v27, v27
    v_lshlrev_b32 v27, 16, v16
    v_mul_f32 v18, v27, v17
    v_fma_f32 v19, -v18, v15, v27
    v_fma_f32 v27, v19, v17, v18
    v_sub_f32 v28, v28, v12
    v_cvt_pk_bf16_f32 v16, v28, v28
    v_lshlrev_b32 v28, 16, v16
    v_mul_f32 v18, v28, v17
    v_fma_f32 v19, -v18, v15, v28
    v_fma_f32 v28, v19, v17, v18
    v_sub_f32 v29, v29, v12
    v_cvt_pk_bf16_f32 v16, v29, v29
    v_lshlrev_b32 v29, 16, v16
    v_mul_f32 v18, v29, v17
    v_fma_f32 v19, -v18, v15, v29
    v_fma_f32 v29, v19, v17, v18
    v_sub_f32 v30, v30, v12
    v_cvt_pk_bf16_f32 v16, v30, v30
    v_lshlrev_b32 v30, 16, v16
    v_mul_f32 v18, v30, v17
    v_fma_f32 v19, -v18, v15, v30
    v_fma_f32 v30, v19, v17, v18
    v_sub_f32 v31, v31, v12
    v_cvt_pk_bf16_f32 v16, v31, v31
    v_lshlrev_b32 v31, 16, v16
    v_mul_f32 v18, v31, v17
    v_fma_f32 v19, -v18, v15, v31
    v_fma_f32 v31, v19, v17, v18
    v_sub_f32 v32, v32, v12
    v_cvt_pk_bf16_f32 v16, v32, v32
    v_lshlrev_b32 v32, 16, v16
    v_mul_f32 v18, v32, v17
    v_fma_f32 v19, -v18, v15, v32
    v_fma_f32 v32, v19, v17, v18
    v_sub_f32 v33, v33, v12
    v_cvt_pk_bf16_f32 v16, v33, v33
    v_lshlrev_b32 v33, 16, v16
    v_mul_f32 v18, v33, v17
    v_fma_f32 v19, -v18, v15, v33
    v_fma_f32 v33, v19, v17, v18
    v_sub_f32 v34, v34, v12
    v_cvt_pk_bf16_f32 v16, v34, v34
    v_lshlrev_b32 v34, 16, v16
    v_mul_f32 v18, v34, v17
    v_fma_f32 v19, -v18, v15, v34
    v_fma_f32 v34, v19, v17, v18
    v_sub_f32 v35, v35, v12
    v_cvt_pk_bf16_f32 v16, v35, v35
    v_lshlrev_b32 v35, 16, v16
    v_mul_f32 v18, v35, v17
    v_fma_f32 v19, -v18, v15, v35
    v_fma_f32 v35, v19, v17, v18
    v_cvt_pk_bf16_f32 v2, v20, v21
    v_cvt_pk_bf16_f32 v3, v22, v23
    v_cvt_pk_bf16_f32 v4, v24, v25
    v_cvt_pk_bf16_f32 v5, v26, v27
    v_cvt_pk_bf16_f32 v6, v28, v29
    v_cvt_pk_bf16_f32 v7, v30, v31
    v_cvt_pk_bf16_f32 v8, v32, v33
    v_cvt_pk_bf16_f32 v9, v34, v35
    buffer_store_dwordx4 v[2:5], v1, s[12:15], 0 offen
    s_and_saveexec_b64 s[16:17], vcc
    buffer_store_dwordx4 v[6:9], v1, s[12:15], 0 offen offset:1024
    s_mov_b64 exec, s[16:17]
K0_END:
    s_endpgm
.globl stagea_kernel
.p2align 8
.type stagea_kernel,@function
stagea_kernel:
    s_cmp_ge_u32 s2, 672
    s_cbranch_scc1 K1_END
    s_load_dwordx4 s[4:7], s[0:1], 24
    s_load_dwordx4 s[8:11], s[0:1], 48
    s_load_dwordx2 s[12:13], s[0:1], 88
    v_and_b32 v250, 63, v0
    v_lshrrev_b32 v251, 6, v0
    s_nop 0
    v_readfirstlane_b32 s40, v251
    s_lshl_b32 s41, s40, 10
    s_lshr_b32 s42, s40, 1
    s_and_b32 s43, s40, 1
    s_waitcnt lgkmcnt(0)
    s_mov_b32 s16, s12
    s_mov_b32 s17, s13
    s_mov_b32 s18, 0x240000
    s_mov_b32 s19, 0x00020000
    s_cmp_ge_u32 s2, 576
    s_cbranch_scc1 K1_DFT
    s_lshr_b32 s44, s2, 4
    s_and_b32 s45, s2, 15
    s_mov_b32 s20, s8
    s_mov_b32 s21, s9
    s_mov_b32 s22, 0x510000
    s_mov_b32 s23, 0x00020000
    s_mov_b32 s24, s10
    s_mov_b32 s25, s11
    s_mov_b32 s26, 0x510000
    s_mov_b32 s27, 0x00020000
    s_add_u32 s28, s12, 0x800000
    s_addc_u32 s29, s13, 0
    s_mov_b32 s30, 0x1200000
    s_mov_b32 s31, 0x00020000
    s_mov_b32 s46, 0
    s_mov_b32 s47, 0
    s_mov_b32 s48, 0
    s_lshl_b32 s50, s45, 7
    v_lshrrev_b32 v249, 3, v250
    v_lshl_add_u32 v0, v251, 3, v249
    v_add_u32 v0, s50, v0
    s_mov_b32 s51, 1152
    v_mul_lo_u32 v0, v0, s51
    v_and_b32 v248, 7, v250
    v_xor_b32 v248, v248, v249
    v_lshl_add_u32 v0, v248, 4, v0
    s_lshl_b32 s52, s44, 7
    v_lshrrev_b32 v249, 4, v250
    v_mul_u32_u24 v248, 4, v251
    v_add_u32 v249, v249, v248
    v_and_b32 v248, 3, v249
    v_bfe_u32 v247, v249, 3, 1
    v_lshl_or_b32 v248, v247, 2, v248
    v_bfe_u32 v247, v250, 1, 3
    v_xor_b32 v248, v247, v248
    s_mov_b32 s51, 9216
    v_mul_lo_u32 v1, v249, s51
    v_lshl_add_u32 v1, v248, 5, v1
    v_and_b32 v247, 1, v250
    v_lshl_add_u32 v1, v247, 4, v1
    s_lshl_b32 s51, s52, 1
    v_add_u32 v1, s51, v1
    s_lshl_b32 s53, s42, 2
    s_lshl_b32 s54, s43, 2
    v_mov_b32 v4, 0
    v_mov_b32 v5, 0
    v_mov_b32 v6, 0
    v_mov_b32 v7, 0
    v_mov_b32 v8, 0
    v_mov_b32 v9, 0
    v_mov_b32 v10, 0
    v_mov_b32 v11, 0
    v_mov_b32 v12, 0
    v_mov_b32 v13, 0
    v_mov_b32 v14, 0
    v_mov_b32 v15, 0
    v_mov_b32 v16, 0
    v_mov_b32 v17, 0
    v_mov_b32 v18, 0
    v_mov_b32 v19, 0
    v_mov_b32 v20, 0
    v_mov_b32 v21, 0
    v_mov_b32 v22, 0
    v_mov_b32 v23, 0
    v_mov_b32 v24, 0
    v_mov_b32 v25, 0
    v_mov_b32 v26, 0
    v_mov_b32 v27, 0
    v_mov_b32 v28, 0
    v_mov_b32 v29, 0
    v_mov_b32 v30, 0
    v_mov_b32 v31, 0
    v_mov_b32 v32, 0
    v_mov_b32 v33, 0
    v_mov_b32 v34, 0
    v_mov_b32 v35, 0
    v_mov_b32 v36, 0
    v_mov_b32 v37, 0
    v_mov_b32 v38, 0
    v_mov_b32 v39, 0
    v_mov_b32 v40, 0
    v_mov_b32 v41, 0
    v_mov_b32 v42, 0
    v_mov_b32 v43, 0
    v_mov_b32 v44, 0
    v_mov_b32 v45, 0
    v_mov_b32 v46, 0
    v_mov_b32 v47, 0
    v_mov_b32 v48, 0
    v_mov_b32 v49, 0
    v_mov_b32 v50, 0
    v_mov_b32 v51, 0
    v_mov_b32 v52, 0
    v_mov_b32 v53, 0
    v_mov_b32 v54, 0
    v_mov_b32 v55, 0
    v_mov_b32 v56, 0
    v_mov_b32 v57, 0
    v_mov_b32 v58, 0
    v_mov_b32 v59, 0
    v_mov_b32 v60, 0
    v_mov_b32 v61, 0
    v_mov_b32 v62, 0
    v_mov_b32 v63, 0
    v_mov_b32 v64, 0
    v_mov_b32 v65, 0
    v_mov_b32 v66, 0
    v_mov_b32 v67, 0
    v_mov_b32 v68, 0
    v_mov_b32 v69, 0
    v_mov_b32 v70, 0
    v_mov_b32 v71, 0
    v_mov_b32 v72, 0
    v_mov_b32 v73, 0
    v_mov_b32 v74, 0
    v_mov_b32 v75, 0
    v_mov_b32 v76, 0
    v_mov_b32 v77, 0
    v_mov_b32 v78, 0
    v_mov_b32 v79, 0
    v_mov_b32 v80, 0
    v_mov_b32 v81, 0
    v_mov_b32 v82, 0
    v_mov_b32 v83, 0
    v_mov_b32 v84, 0
    v_mov_b32 v85, 0
    v_mov_b32 v86, 0
    v_mov_b32 v87, 0
    v_mov_b32 v88, 0
    v_mov_b32 v89, 0
    v_mov_b32 v90, 0
    v_mov_b32 v91, 0
    v_mov_b32 v92, 0
    v_mov_b32 v93, 0
    v_mov_b32 v94, 0
    v_mov_b32 v95, 0
    v_mov_b32 v96, 0
    v_mov_b32 v97, 0
    v_mov_b32 v98, 0
    v_mov_b32 v99, 0
    v_mov_b32 v100, 0
    v_mov_b32 v101, 0
    v_mov_b32 v102, 0
    v_mov_b32 v103, 0
    v_mov_b32 v104, 0
    v_mov_b32 v105, 0
    v_mov_b32 v106, 0
    v_mov_b32 v107, 0
    v_mov_b32 v108, 0
    v_mov_b32 v109, 0
    v_mov_b32 v110, 0
    v_mov_b32 v111, 0
    v_mov_b32 v112, 0
    v_mov_b32 v113, 0
    v_mov_b32 v114, 0
    v_mov_b32 v115, 0
    v_mov_b32 v116, 0
    v_mov_b32 v117, 0
    v_mov_b32 v118, 0
    v_mov_b32 v119, 0
    v_mov_b32 v120, 0
    v_mov_b32 v121, 0
    v_mov_b32 v122, 0
    v_mov_b32 v123, 0
    v_mov_b32 v124, 0
    v_mov_b32 v125, 0
    v_mov_b32 v126, 0
    v_mov_b32 v127, 0
    v_mov_b32 v128, 0
    v_mov_b32 v129, 0
    v_mov_b32 v130, 0
    v_mov_b32 v131, 0
    v_lshrrev_b32 v249, 4, v250
    v_bfe_u32 v248, v250, 2, 2
    v_lshl_add_u32 v228, v249, 3, v248
    s_movk_i32 s51, 256
    v_mul_lo_u32 v228, v228, s51
    v_and_b32 v249, 1, v249
    v_lshl_or_b32 v248, v249, 2, v248
    s_add_u32 s51, s53, 0
    v_xor_b32 v248, s51, v248
    v_lshl_add_u32 v228, v248, 5, v228
    v_and_b32 v248, 3, v250
    v_lshl_add_u32 v228, v248, 3, v228
    v_lshrrev_b32 v249, 4, v250
    v_bfe_u32 v248, v250, 2, 2
    v_lshl_add_u32 v229, v249, 3, v248
    s_movk_i32 s51, 256
    v_mul_lo_u32 v229, v229, s51
    v_and_b32 v249, 1, v249
    v_lshl_or_b32 v248, v249, 2, v248
    s_add_u32 s51, s53, 1
    v_xor_b32 v248, s51, v248
    v_lshl_add_u32 v229, v248, 5, v229
    v_and_b32 v248, 3, v250
    v_lshl_add_u32 v229, v248, 3, v229
    v_lshrrev_b32 v249, 4, v250
    v_bfe_u32 v248, v250, 2, 2
    v_lshl_add_u32 v230, v249, 3, v248
    s_movk_i32 s51, 256
    v_mul_lo_u32 v230, v230, s51
    v_and_b32 v249, 1, v249
    v_lshl_or_b32 v248, v249, 2, v248
    s_add_u32 s51, s53, 2
    v_xor_b32 v248, s51, v248
    v_lshl_add_u32 v230, v248, 5, v230
    v_and_b32 v248, 3, v250
    v_lshl_add_u32 v230, v248, 3, v230
    v_lshrrev_b32 v249, 4, v250
    v_bfe_u32 v248, v250, 2, 2
    v_lshl_add_u32 v231, v249, 3, v248
    s_movk_i32 s51, 256
    v_mul_lo_u32 v231, v231, s51
    v_and_b32 v249, 1, v249
    v_lshl_or_b32 v248, v249, 2, v248
    s_add_u32 s51, s53, 3
    v_xor_b32 v248, s51, v248
    v_lshl_add_u32 v231, v248, 5, v231
    v_and_b32 v248, 3, v250
    v_lshl_add_u32 v231, v248, 3, v231
    v_lshrrev_b32 v249, 4, v250
    v_bfe_u32 v248, v250, 2, 2
    v_lshl_add_u32 v232, v249, 3, v248
    s_movk_i32 s51, 256
    v_mul_lo_u32 v232, v232, s51
    v_and_b32 v249, 1, v249
    v_lshl_or_b32 v248, v249, 2, v248
    s_add_u32 s51, s53, 0
    v_xor_b32 v248, s51, v248
    v_lshl_add_u32 v232, v248, 5, v232
    v_and_b32 v248, 3, v250
    v_lshl_add_u32 v232, v248, 3, v232
    v_lshrrev_b32 v249, 4, v250
    v_bfe_u32 v248, v250, 2, 2
    v_lshl_add_u32 v233, v249, 3, v248
    s_movk_i32 s51, 256
    v_mul_lo_u32 v233, v233, s51
    v_and_b32 v249, 1, v249
    v_lshl_or_b32 v248, v249, 2, v248
    s_add_u32 s51, s53, 1
    v_xor_b32 v248, s51, v248
    v_lshl_add_u32 v233, v248, 5, v233
    v_and_b32 v248, 3, v250
    v_lshl_add_u32 v233, v248, 3, v233
    v_lshrrev_b32 v249, 4, v250
    v_bfe_u32 v248, v250, 2, 2
    v_lshl_add_u32 v234, v249, 3, v248
    s_movk_i32 s51, 256
    v_mul_lo_u32 v234, v234, s51
    v_and_b32 v249, 1, v249
    v_lshl_or_b32 v248, v249, 2, v248
    s_add_u32 s51, s53, 2
    v_xor_b32 v248, s51, v248
    v_lshl_add_u32 v234, v248, 5, v234
    v_and_b32 v248, 3, v250
    v_lshl_add_u32 v234, v248, 3, v234
    v_lshrrev_b32 v249, 4, v250
    v_bfe_u32 v248, v250, 2, 2
    v_lshl_add_u32 v235, v249, 3, v248
    s_movk_i32 s51, 256
    v_mul_lo_u32 v235, v235, s51
    v_and_b32 v249, 1, v249
    v_lshl_or_b32 v248, v249, 2, v248
    s_add_u32 s51, s53, 3
    v_xor_b32 v248, s51, v248
    v_lshl_add_u32 v235, v248, 5, v235
    v_and_b32 v248, 3, v250
    v_lshl_add_u32 v235, v248, 3, v235
    v_and_b32 v236, 15, v250
    s_lshl_b32 s51, s54, 4
    v_add_u32 v236, s51, v236
    v_lshlrev_b32 v236, 7, v236
    v_lshrrev_b32 v249, 4, v250
    v_add_u32 v249, 0, v249
    v_and_b32 v248, 7, v250
    v_xor_b32 v249, v249, v248
    v_lshlrev_b32 v249, 4, v249
    v_add_u32 v236, v236, v249
    v_and_b32 v237, 15, v250
    s_lshl_b32 s51, s54, 4
    v_add_u32 v237, s51, v237
    v_lshlrev_b32 v237, 7, v237
    v_lshrrev_b32 v249, 4, v250
    v_add_u32 v249, 4, v249
    v_and_b32 v248, 7, v250
    v_xor_b32 v249, v249, v248
    v_lshlrev_b32 v249, 4, v249
    v_add_u32 v237, v237, v249
    s_add_u32 m0, s41, 0
    s_add_u32 s51, s46, 0
    buffer_load_dwordx4 v0, s[16:19], s51 offen lds
    s_add_u32 m0, s41, 4096
    s_add_u32 s51, s46, 36864
    buffer_load_dwordx4 v0, s[16:19], s51 offen lds
    s_add_u32 m0, s41, 8192
    s_add_u32 s51, s46, 73728
    buffer_load_dwordx4 v0, s[16:19], s51 offen lds
    s_add_u32 m0, s41, 12288
    s_add_u32 s51, s46, 110592
    buffer_load_dwordx4 v0, s[16:19], s51 offen lds
    s_add_u32 m0, s41, 16384
    s_add_u32 s51, s47, 0
    buffer_load_dwordx4 v1, s[20:23], s51 offen lds
    s_add_u32 m0, s41, 20480
    s_add_u32 s51, s47, 147456
    buffer_load_dwordx4 v1, s[20:23], s51 offen lds
    s_add_u32 m0, s41, 24576
    s_add_u32 s51, s47, 294912
    buffer_load_dwordx4 v1, s[20:23], s51 offen lds
    s_add_u32 m0, s41, 28672
    s_add_u32 s51, s47, 442368
    buffer_load_dwordx4 v1, s[20:23], s51 offen lds
    s_add_u32 m0, s41, 32768
    s_add_u32 s51, s48, 0
    buffer_load_dwordx4 v1, s[24:27], s51 offen lds
    s_add_u32 m0, s41, 36864
    s_add_u32 s51, s48, 147456
    buffer_load_dwordx4 v1, s[24:27], s51 offen lds
    s_add_u32 m0, s41, 40960
    s_add_u32 s51, s48, 294912
    buffer_load_dwordx4 v1, s[24:27], s51 offen lds
    s_add_u32 m0, s41, 45056
    s_add_u32 s51, s48, 442368
    buffer_load_dwordx4 v1, s[24:27], s51 offen lds
    s_add_u32 s46, s46, 128
    s_add_u32 s47, s47, 589824
    s_add_u32 s48, s48, 589824
    s_add_u32 m0, s41, 49152
    s_add_u32 s51, s46, 0
    buffer_load_dwordx4 v0, s[16:19], s51 offen lds
    s_add_u32 m0, s41, 53248
    s_add_u32 s51, s46, 36864
    buffer_load_dwordx4 v0, s[16:19], s51 offen lds
    s_add_u32 m0, s41, 57344
    s_add_u32 s51, s46, 73728
    buffer_load_dwordx4 v0, s[16:19], s51 offen lds
    s_add_u32 m0, s41, 61440
    s_add_u32 s51, s46, 110592
    buffer_load_dwordx4 v0, s[16:19], s51 offen lds
    s_add_u32 m0, s41, 65536
    s_add_u32 s51, s47, 0
    buffer_load_dwordx4 v1, s[20:23], s51 offen lds
    s_add_u32 m0, s41, 69632
    s_add_u32 s51, s47, 147456
    buffer_load_dwordx4 v1, s[20:23], s51 offen lds
    s_add_u32 m0, s41, 73728
    s_add_u32 s51, s47, 294912
    buffer_load_dwordx4 v1, s[20:23], s51 offen lds
    s_add_u32 m0, s41, 77824
    s_add_u32 s51, s47, 442368
    buffer_load_dwordx4 v1, s[20:23], s51 offen lds
    s_add_u32 m0, s41, 81920
    s_add_u32 s51, s48, 0
    buffer_load_dwordx4 v1, s[24:27], s51 offen lds
    s_add_u32 m0, s41, 86016
    s_add_u32 s51, s48, 147456
    buffer_load_dwordx4 v1, s[24:27], s51 offen lds
    s_add_u32 m0, s41, 90112
    s_add_u32 s51, s48, 294912
    buffer_load_dwordx4 v1, s[24:27], s51 offen lds
    s_add_u32 m0, s41, 94208
    s_add_u32 s51, s48, 442368
    buffer_load_dwordx4 v1, s[24:27], s51 offen lds
    s_waitcnt vmcnt(12)
    s_barrier
    ds_read_b128 v[164:167], v236 offset:0
    ds_read_b128 v[168:171], v236 offset:2048
    ds_read_b128 v[172:175], v236 offset:4096
    ds_read_b128 v[176:179], v236 offset:6144
    ds_read_b64_tr_b16 v[132:133], v228 offset:16384
    ds_read_b64_tr_b16 v[134:135], v228 offset:17408
    ds_read_b64_tr_b16 v[136:137], v229 offset:16384
    ds_read_b64_tr_b16 v[138:139], v229 offset:17408
    ds_read_b64_tr_b16 v[140:141], v230 offset:16384
    ds_read_b64_tr_b16 v[142:143], v230 offset:17408
    ds_read_b64_tr_b16 v[144:145], v231 offset:16384
    ds_read_b64_tr_b16 v[146:147], v231 offset:17408
    ds_read_b64_tr_b16 v[148:149], v232 offset:32768
    ds_read_b64_tr_b16 v[150:151], v232 offset:33792
    ds_read_b64_tr_b16 v[152:153], v233 offset:32768
    ds_read_b64_tr_b16 v[154:155], v233 offset:33792
    ds_read_b64_tr_b16 v[156:157], v234 offset:32768
    ds_read_b64_tr_b16 v[158:159], v234 offset:33792
    ds_read_b64_tr_b16 v[160:161], v235 offset:32768
    ds_read_b64_tr_b16 v[162:163], v235 offset:33792
    s_waitcnt lgkmcnt(0)
    v_mfma_f32_16x16x32_bf16 v[4:7], v[132:135], v[164:167], v[4:7]
    v_mfma_f32_16x16x32_bf16 v[8:11], v[132:135], v[168:171], v[8:11]
    ds_read_b128 v[212:215], v237 offset:0
    v_mfma_f32_16x16x32_bf16 v[12:15], v[132:135], v[172:175], v[12:15]
    ds_read_b128 v[216:219], v237 offset:2048
    v_mfma_f32_16x16x32_bf16 v[16:19], v[132:135], v[176:179], v[16:19]
    ds_read_b128 v[220:223], v237 offset:4096
    v_mfma_f32_16x16x32_bf16 v[20:23], v[136:139], v[164:167], v[20:23]
    ds_read_b128 v[224:227], v237 offset:6144
    v_mfma_f32_16x16x32_bf16 v[24:27], v[136:139], v[168:171], v[24:27]
    v_mfma_f32_16x16x32_bf16 v[28:31], v[136:139], v[172:175], v[28:31]
    ds_read_b64_tr_b16 v[180:181], v228 offset:24576
    v_mfma_f32_16x16x32_bf16 v[32:35], v[136:139], v[176:179], v[32:35]
    ds_read_b64_tr_b16 v[182:183], v228 offset:25600
    v_mfma_f32_16x16x32_bf16 v[36:39], v[140:143], v[164:167], v[36:39]
    ds_read_b64_tr_b16 v[184:185], v229 offset:24576
    v_mfma_f32_16x16x32_bf16 v[40:43], v[140:143], v[168:171], v[40:43]
    ds_read_b64_tr_b16 v[186:187], v229 offset:25600
    v_mfma_f32_16x16x32_bf16 v[44:47], v[140:143], v[172:175], v[44:47]
    v_mfma_f32_16x16x32_bf16 v[48:51], v[140:143], v[176:179], v[48:51]
    ds_read_b64_tr_b16 v[188:189], v230 offset:24576
    v_mfma_f32_16x16x32_bf16 v[52:55], v[144:147], v[164:167], v[52:55]
    ds_read_b64_tr_b16 v[190:191], v230 offset:25600
    v_mfma_f32_16x16x32_bf16 v[56:59], v[144:147], v[168:171], v[56:59]
    ds_read_b64_tr_b16 v[192:193], v231 offset:24576
    v_mfma_f32_16x16x32_bf16 v[60:63], v[144:147], v[172:175], v[60:63]
    ds_read_b64_tr_b16 v[194:195], v231 offset:25600
    v_mfma_f32_16x16x32_bf16 v[64:67], v[144:147], v[176:179], v[64:67]
    ds_read_b64_tr_b16 v[196:197], v232 offset:40960
    v_mfma_f32_16x16x32_bf16 v[68:71], v[148:151], v[164:167], v[68:71]
    v_mfma_f32_16x16x32_bf16 v[72:75], v[148:151], v[168:171], v[72:75]
    ds_read_b64_tr_b16 v[198:199], v232 offset:41984
    v_mfma_f32_16x16x32_bf16 v[76:79], v[148:151], v[172:175], v[76:79]
    ds_read_b64_tr_b16 v[200:201], v233 offset:40960
    v_mfma_f32_16x16x32_bf16 v[80:83], v[148:151], v[176:179], v[80:83]
    ds_read_b64_tr_b16 v[202:203], v233 offset:41984
    v_mfma_f32_16x16x32_bf16 v[84:87], v[152:155], v[164:167], v[84:87]
    ds_read_b64_tr_b16 v[204:205], v234 offset:40960
    v_mfma_f32_16x16x32_bf16 v[88:91], v[152:155], v[168:171], v[88:91]
    v_mfma_f32_16x16x32_bf16 v[92:95], v[152:155], v[172:175], v[92:95]
    ds_read_b64_tr_b16 v[206:207], v234 offset:41984
    v_mfma_f32_16x16x32_bf16 v[96:99], v[152:155], v[176:179], v[96:99]
    ds_read_b64_tr_b16 v[208:209], v235 offset:40960
    v_mfma_f32_16x16x32_bf16 v[100:103], v[156:159], v[164:167], v[100:103]
    ds_read_b64_tr_b16 v[210:211], v235 offset:41984
    v_mfma_f32_16x16x32_bf16 v[104:107], v[156:159], v[168:171], v[104:107]
    s_add_u32 s46, s46, 128
    s_add_u32 s47, s47, 589824
    s_add_u32 s48, s48, 589824
    v_mfma_f32_16x16x32_bf16 v[108:111], v[156:159], v[172:175], v[108:111]
    v_mfma_f32_16x16x32_bf16 v[112:115], v[156:159], v[176:179], v[112:115]
    s_add_u32 m0, s41, 98304
    s_add_u32 s51, s46, 0
    buffer_load_dwordx4 v0, s[16:19], s51 offen lds
    v_mfma_f32_16x16x32_bf16 v[116:119], v[160:163], v[164:167], v[116:119]
    s_add_u32 m0, s41, 102400
    s_add_u32 s51, s46, 36864
    buffer_load_dwordx4 v0, s[16:19], s51 offen lds
    v_mfma_f32_16x16x32_bf16 v[120:123], v[160:163], v[168:171], v[120:123]
    s_add_u32 m0, s41, 106496
    s_add_u32 s51, s46, 73728
    buffer_load_dwordx4 v0, s[16:19], s51 offen lds
    v_mfma_f32_16x16x32_bf16 v[124:127], v[160:163], v[172:175], v[124:127]
    s_add_u32 m0, s41, 110592
    s_add_u32 s51, s46, 110592
    buffer_load_dwordx4 v0, s[16:19], s51 offen lds
    v_mfma_f32_16x16x32_bf16 v[128:131], v[160:163], v[176:179], v[128:131]
    s_add_u32 m0, s41, 114688
    s_add_u32 s51, s47, 0
    buffer_load_dwordx4 v1, s[20:23], s51 offen lds
    s_waitcnt lgkmcnt(0)
    v_mfma_f32_16x16x32_bf16 v[4:7], v[180:183], v[212:215], v[4:7]
    v_mfma_f32_16x16x32_bf16 v[8:11], v[180:183], v[216:219], v[8:11]
    v_mfma_f32_16x16x32_bf16 v[12:15], v[180:183], v[220:223], v[12:15]
    v_mfma_f32_16x16x32_bf16 v[16:19], v[180:183], v[224:227], v[16:19]
    v_mfma_f32_16x16x32_bf16 v[20:23], v[184:187], v[212:215], v[20:23]
    s_add_u32 m0, s41, 118784
    s_add_u32 s51, s47, 147456
    buffer_load_dwordx4 v1, s[20:23], s51 offen lds
    v_mfma_f32_16x16x32_bf16 v[24:27], v[184:187], v[216:219], v[24:27]
    v_mfma_f32_16x16x32_bf16 v[28:31], v[184:187], v[220:223], v[28:31]
    v_mfma_f32_16x16x32_bf16 v[32:35], v[184:187], v[224:227], v[32:35]
    v_mfma_f32_16x16x32_bf16 v[36:39], v[188:191], v[212:215], v[36:39]
    v_mfma_f32_16x16x32_bf16 v[40:43], v[188:191], v[216:219], v[40:43]
    s_add_u32 m0, s41, 122880
    s_add_u32 s51, s47, 294912
    buffer_load_dwordx4 v1, s[20:23], s51 offen lds
    v_mfma_f32_16x16x32_bf16 v[44:47], v[188:191], v[220:223], v[44:47]
    v_mfma_f32_16x16x32_bf16 v[48:51], v[188:191], v[224:227], v[48:51]
    v_mfma_f32_16x16x32_bf16 v[52:55], v[192:195], v[212:215], v[52:55]
    v_mfma_f32_16x16x32_bf16 v[56:59], v[192:195], v[216:219], v[56:59]
    s_add_u32 m0, s41, 126976
    s_add_u32 s51, s47, 442368
    buffer_load_dwordx4 v1, s[20:23], s51 offen lds
    v_mfma_f32_16x16x32_bf16 v[60:63], v[192:195], v[220:223], v[60:63]
    v_mfma_f32_16x16x32_bf16 v[64:67], v[192:195], v[224:227], v[64:67]
    v_mfma_f32_16x16x32_bf16 v[68:71], v[196:199], v[212:215], v[68:71]
    v_mfma_f32_16x16x32_bf16 v[72:75], v[196:199], v[216:219], v[72:75]
    v_mfma_f32_16x16x32_bf16 v[76:79], v[196:199], v[220:223], v[76:79]
    s_add_u32 m0, s41, 131072
    s_add_u32 s51, s48, 0
    buffer_load_dwordx4 v1, s[24:27], s51 offen lds
    v_mfma_f32_16x16x32_bf16 v[80:83], v[196:199], v[224:227], v[80:83]
    v_mfma_f32_16x16x32_bf16 v[84:87], v[200:203], v[212:215], v[84:87]
    v_mfma_f32_16x16x32_bf16 v[88:91], v[200:203], v[216:219], v[88:91]
    v_mfma_f32_16x16x32_bf16 v[92:95], v[200:203], v[220:223], v[92:95]
    s_add_u32 m0, s41, 135168
    s_add_u32 s51, s48, 147456
    buffer_load_dwordx4 v1, s[24:27], s51 offen lds
    v_mfma_f32_16x16x32_bf16 v[96:99], v[200:203], v[224:227], v[96:99]
    v_mfma_f32_16x16x32_bf16 v[100:103], v[204:207], v[212:215], v[100:103]
    v_mfma_f32_16x16x32_bf16 v[104:107], v[204:207], v[216:219], v[104:107]
    v_mfma_f32_16x16x32_bf16 v[108:111], v[204:207], v[220:223], v[108:111]
    v_mfma_f32_16x16x32_bf16 v[112:115], v[204:207], v[224:227], v[112:115]
    s_add_u32 m0, s41, 139264
    s_add_u32 s51, s48, 294912
    buffer_load_dwordx4 v1, s[24:27], s51 offen lds
    v_mfma_f32_16x16x32_bf16 v[116:119], v[208:211], v[212:215], v[116:119]
    v_mfma_f32_16x16x32_bf16 v[120:123], v[208:211], v[216:219], v[120:123]
    v_mfma_f32_16x16x32_bf16 v[124:127], v[208:211], v[220:223], v[124:127]
    v_mfma_f32_16x16x32_bf16 v[128:131], v[208:211], v[224:227], v[128:131]
    s_add_u32 m0, s41, 143360
    s_add_u32 s51, s48, 442368
    buffer_load_dwordx4 v1, s[24:27], s51 offen lds
    s_waitcnt vmcnt(12)
    s_barrier
    v_add_u32 v228, 49152, v228
    v_add_u32 v229, 49152, v229
    v_add_u32 v230, 49152, v230
    v_add_u32 v231, 49152, v231
    v_add_u32 v232, 49152, v232
    v_add_u32 v233, 49152, v233
    v_add_u32 v234, 49152, v234
    v_add_u32 v235, 49152, v235
    v_add_u32 v236, 49152, v236
    v_add_u32 v237, 49152, v237
    ds_read_b128 v[164:167], v236 offset:0
    ds_read_b128 v[168:171], v236 offset:2048
    ds_read_b128 v[172:175], v236 offset:4096
    ds_read_b128 v[176:179], v236 offset:6144
    ds_read_b64_tr_b16 v[132:133], v228 offset:16384
    ds_read_b64_tr_b16 v[134:135], v228 offset:17408
    ds_read_b64_tr_b16 v[136:137], v229 offset:16384
    ds_read_b64_tr_b16 v[138:139], v229 offset:17408
    ds_read_b64_tr_b16 v[140:141], v230 offset:16384
    ds_read_b64_tr_b16 v[142:143], v230 offset:17408
    ds_read_b64_tr_b16 v[144:145], v231 offset:16384
    ds_read_b64_tr_b16 v[146:147], v231 offset:17408
    ds_read_b64_tr_b16 v[148:149], v232 offset:32768
    ds_read_b64_tr_b16 v[150:151], v232 offset:33792
    ds_read_b64_tr_b16 v[152:153], v233 offset:32768
    ds_read_b64_tr_b16 v[154:155], v233 offset:33792
    ds_read_b64_tr_b16 v[156:157], v234 offset:32768
    ds_read_b64_tr_b16 v[158:159], v234 offset:33792
    ds_read_b64_tr_b16 v[160:161], v235 offset:32768
    ds_read_b64_tr_b16 v[162:163], v235 offset:33792
    s_waitcnt lgkmcnt(0)
    v_mfma_f32_16x16x32_bf16 v[4:7], v[132:135], v[164:167], v[4:7]
    v_mfma_f32_16x16x32_bf16 v[8:11], v[132:135], v[168:171], v[8:11]
    ds_read_b128 v[212:215], v237 offset:0
    v_mfma_f32_16x16x32_bf16 v[12:15], v[132:135], v[172:175], v[12:15]
    ds_read_b128 v[216:219], v237 offset:2048
    v_mfma_f32_16x16x32_bf16 v[16:19], v[132:135], v[176:179], v[16:19]
    ds_read_b128 v[220:223], v237 offset:4096
    v_mfma_f32_16x16x32_bf16 v[20:23], v[136:139], v[164:167], v[20:23]
    ds_read_b128 v[224:227], v237 offset:6144
    v_mfma_f32_16x16x32_bf16 v[24:27], v[136:139], v[168:171], v[24:27]
    v_mfma_f32_16x16x32_bf16 v[28:31], v[136:139], v[172:175], v[28:31]
    ds_read_b64_tr_b16 v[180:181], v228 offset:24576
    v_mfma_f32_16x16x32_bf16 v[32:35], v[136:139], v[176:179], v[32:35]
    ds_read_b64_tr_b16 v[182:183], v228 offset:25600
    v_mfma_f32_16x16x32_bf16 v[36:39], v[140:143], v[164:167], v[36:39]
    ds_read_b64_tr_b16 v[184:185], v229 offset:24576
    v_mfma_f32_16x16x32_bf16 v[40:43], v[140:143], v[168:171], v[40:43]
    ds_read_b64_tr_b16 v[186:187], v229 offset:25600
    v_mfma_f32_16x16x32_bf16 v[44:47], v[140:143], v[172:175], v[44:47]
    v_mfma_f32_16x16x32_bf16 v[48:51], v[140:143], v[176:179], v[48:51]
    ds_read_b64_tr_b16 v[188:189], v230 offset:24576
    v_mfma_f32_16x16x32_bf16 v[52:55], v[144:147], v[164:167], v[52:55]
    ds_read_b64_tr_b16 v[190:191], v230 offset:25600
    v_mfma_f32_16x16x32_bf16 v[56:59], v[144:147], v[168:171], v[56:59]
    ds_read_b64_tr_b16 v[192:193], v231 offset:24576
    v_mfma_f32_16x16x32_bf16 v[60:63], v[144:147], v[172:175], v[60:63]
    ds_read_b64_tr_b16 v[194:195], v231 offset:25600
    v_mfma_f32_16x16x32_bf16 v[64:67], v[144:147], v[176:179], v[64:67]
    ds_read_b64_tr_b16 v[196:197], v232 offset:40960
    v_mfma_f32_16x16x32_bf16 v[68:71], v[148:151], v[164:167], v[68:71]
    v_mfma_f32_16x16x32_bf16 v[72:75], v[148:151], v[168:171], v[72:75]
    ds_read_b64_tr_b16 v[198:199], v232 offset:41984
    v_mfma_f32_16x16x32_bf16 v[76:79], v[148:151], v[172:175], v[76:79]
    ds_read_b64_tr_b16 v[200:201], v233 offset:40960
    v_mfma_f32_16x16x32_bf16 v[80:83], v[148:151], v[176:179], v[80:83]
    ds_read_b64_tr_b16 v[202:203], v233 offset:41984
    v_mfma_f32_16x16x32_bf16 v[84:87], v[152:155], v[164:167], v[84:87]
    ds_read_b64_tr_b16 v[204:205], v234 offset:40960
    v_mfma_f32_16x16x32_bf16 v[88:91], v[152:155], v[168:171], v[88:91]
    v_mfma_f32_16x16x32_bf16 v[92:95], v[152:155], v[172:175], v[92:95]
    ds_read_b64_tr_b16 v[206:207], v234 offset:41984
    v_mfma_f32_16x16x32_bf16 v[96:99], v[152:155], v[176:179], v[96:99]
    ds_read_b64_tr_b16 v[208:209], v235 offset:40960
    v_mfma_f32_16x16x32_bf16 v[100:103], v[156:159], v[164:167], v[100:103]
    ds_read_b64_tr_b16 v[210:211], v235 offset:41984
    v_mfma_f32_16x16x32_bf16 v[104:107], v[156:159], v[168:171], v[104:107]
    s_add_u32 s46, s46, 128
    s_add_u32 s47, s47, 589824
    s_add_u32 s48, s48, 589824
    v_mfma_f32_16x16x32_bf16 v[108:111], v[156:159], v[172:175], v[108:111]
    v_mfma_f32_16x16x32_bf16 v[112:115], v[156:159], v[176:179], v[112:115]
    s_add_u32 m0, s41, 0
    s_add_u32 s51, s46, 0
    buffer_load_dwordx4 v0, s[16:19], s51 offen lds
    v_mfma_f32_16x16x32_bf16 v[116:119], v[160:163], v[164:167], v[116:119]
    s_add_u32 m0, s41, 4096
    s_add_u32 s51, s46, 36864
    buffer_load_dwordx4 v0, s[16:19], s51 offen lds
    v_mfma_f32_16x16x32_bf16 v[120:123], v[160:163], v[168:171], v[120:123]
    s_add_u32 m0, s41, 8192
    s_add_u32 s51, s46, 73728
    buffer_load_dwordx4 v0, s[16:19], s51 offen lds
    v_mfma_f32_16x16x32_bf16 v[124:127], v[160:163], v[172:175], v[124:127]
    s_add_u32 m0, s41, 12288
    s_add_u32 s51, s46, 110592
    buffer_load_dwordx4 v0, s[16:19], s51 offen lds
    v_mfma_f32_16x16x32_bf16 v[128:131], v[160:163], v[176:179], v[128:131]
    s_add_u32 m0, s41, 16384
    s_add_u32 s51, s47, 0
    buffer_load_dwordx4 v1, s[20:23], s51 offen lds
    s_waitcnt lgkmcnt(0)
    v_mfma_f32_16x16x32_bf16 v[4:7], v[180:183], v[212:215], v[4:7]
    v_mfma_f32_16x16x32_bf16 v[8:11], v[180:183], v[216:219], v[8:11]
    v_mfma_f32_16x16x32_bf16 v[12:15], v[180:183], v[220:223], v[12:15]
    v_mfma_f32_16x16x32_bf16 v[16:19], v[180:183], v[224:227], v[16:19]
    v_mfma_f32_16x16x32_bf16 v[20:23], v[184:187], v[212:215], v[20:23]
    s_add_u32 m0, s41, 20480
    s_add_u32 s51, s47, 147456
    buffer_load_dwordx4 v1, s[20:23], s51 offen lds
    v_mfma_f32_16x16x32_bf16 v[24:27], v[184:187], v[216:219], v[24:27]
    v_mfma_f32_16x16x32_bf16 v[28:31], v[184:187], v[220:223], v[28:31]
    v_mfma_f32_16x16x32_bf16 v[32:35], v[184:187], v[224:227], v[32:35]
    v_mfma_f32_16x16x32_bf16 v[36:39], v[188:191], v[212:215], v[36:39]
    v_mfma_f32_16x16x32_bf16 v[40:43], v[188:191], v[216:219], v[40:43]
    s_add_u32 m0, s41, 24576
    s_add_u32 s51, s47, 294912
    buffer_load_dwordx4 v1, s[20:23], s51 offen lds
    v_mfma_f32_16x16x32_bf16 v[44:47], v[188:191], v[220:223], v[44:47]
    v_mfma_f32_16x16x32_bf16 v[48:51], v[188:191], v[224:227], v[48:51]
    v_mfma_f32_16x16x32_bf16 v[52:55], v[192:195], v[212:215], v[52:55]
    v_mfma_f32_16x16x32_bf16 v[56:59], v[192:195], v[216:219], v[56:59]
    s_add_u32 m0, s41, 28672
    s_add_u32 s51, s47, 442368
    buffer_load_dwordx4 v1, s[20:23], s51 offen lds
    v_mfma_f32_16x16x32_bf16 v[60:63], v[192:195], v[220:223], v[60:63]
    v_mfma_f32_16x16x32_bf16 v[64:67], v[192:195], v[224:227], v[64:67]
    v_mfma_f32_16x16x32_bf16 v[68:71], v[196:199], v[212:215], v[68:71]
    v_mfma_f32_16x16x32_bf16 v[72:75], v[196:199], v[216:219], v[72:75]
    v_mfma_f32_16x16x32_bf16 v[76:79], v[196:199], v[220:223], v[76:79]
    s_add_u32 m0, s41, 32768
    s_add_u32 s51, s48, 0
    buffer_load_dwordx4 v1, s[24:27], s51 offen lds
    v_mfma_f32_16x16x32_bf16 v[80:83], v[196:199], v[224:227], v[80:83]
    v_mfma_f32_16x16x32_bf16 v[84:87], v[200:203], v[212:215], v[84:87]
    v_mfma_f32_16x16x32_bf16 v[88:91], v[200:203], v[216:219], v[88:91]
    v_mfma_f32_16x16x32_bf16 v[92:95], v[200:203], v[220:223], v[92:95]
    s_add_u32 m0, s41, 36864
    s_add_u32 s51, s48, 147456
    buffer_load_dwordx4 v1, s[24:27], s51 offen lds
    v_mfma_f32_16x16x32_bf16 v[96:99], v[200:203], v[224:227], v[96:99]
    v_mfma_f32_16x16x32_bf16 v[100:103], v[204:207], v[212:215], v[100:103]
    v_mfma_f32_16x16x32_bf16 v[104:107], v[204:207], v[216:219], v[104:107]
    v_mfma_f32_16x16x32_bf16 v[108:111], v[204:207], v[220:223], v[108:111]
    v_mfma_f32_16x16x32_bf16 v[112:115], v[204:207], v[224:227], v[112:115]
    s_add_u32 m0, s41, 40960
    s_add_u32 s51, s48, 294912
    buffer_load_dwordx4 v1, s[24:27], s51 offen lds
    v_mfma_f32_16x16x32_bf16 v[116:119], v[208:211], v[212:215], v[116:119]
    v_mfma_f32_16x16x32_bf16 v[120:123], v[208:211], v[216:219], v[120:123]
    v_mfma_f32_16x16x32_bf16 v[124:127], v[208:211], v[220:223], v[124:127]
    v_mfma_f32_16x16x32_bf16 v[128:131], v[208:211], v[224:227], v[128:131]
    s_add_u32 m0, s41, 45056
    s_add_u32 s51, s48, 442368
    buffer_load_dwordx4 v1, s[24:27], s51 offen lds
    s_waitcnt vmcnt(12)
    s_barrier
    v_add_u32 v228, 49152, v228
    v_add_u32 v229, 49152, v229
    v_add_u32 v230, 49152, v230
    v_add_u32 v231, 49152, v231
    v_add_u32 v232, 49152, v232
    v_add_u32 v233, 49152, v233
    v_add_u32 v234, 49152, v234
    v_add_u32 v235, 49152, v235
    v_add_u32 v236, 49152, v236
    v_add_u32 v237, 49152, v237
    ds_read_b128 v[164:167], v236 offset:0
    ds_read_b128 v[168:171], v236 offset:2048
    ds_read_b128 v[172:175], v236 offset:4096
    ds_read_b128 v[176:179], v236 offset:6144
    ds_read_b64_tr_b16 v[132:133], v228 offset:16384
    ds_read_b64_tr_b16 v[134:135], v228 offset:17408
    ds_read_b64_tr_b16 v[136:137], v229 offset:16384
    ds_read_b64_tr_b16 v[138:139], v229 offset:17408
    ds_read_b64_tr_b16 v[140:141], v230 offset:16384
    ds_read_b64_tr_b16 v[142:143], v230 offset:17408
    ds_read_b64_tr_b16 v[144:145], v231 offset:16384
    ds_read_b64_tr_b16 v[146:147], v231 offset:17408
    ds_read_b64_tr_b16 v[148:149], v232 offset:32768
    ds_read_b64_tr_b16 v[150:151], v232 offset:33792
    ds_read_b64_tr_b16 v[152:153], v233 offset:32768
    ds_read_b64_tr_b16 v[154:155], v233 offset:33792
    ds_read_b64_tr_b16 v[156:157], v234 offset:32768
    ds_read_b64_tr_b16 v[158:159], v234 offset:33792
    ds_read_b64_tr_b16 v[160:161], v235 offset:32768
    ds_read_b64_tr_b16 v[162:163], v235 offset:33792
    s_waitcnt lgkmcnt(0)
    v_mfma_f32_16x16x32_bf16 v[4:7], v[132:135], v[164:167], v[4:7]
    v_mfma_f32_16x16x32_bf16 v[8:11], v[132:135], v[168:171], v[8:11]
    ds_read_b128 v[212:215], v237 offset:0
    v_mfma_f32_16x16x32_bf16 v[12:15], v[132:135], v[172:175], v[12:15]
    ds_read_b128 v[216:219], v237 offset:2048
    v_mfma_f32_16x16x32_bf16 v[16:19], v[132:135], v[176:179], v[16:19]
    ds_read_b128 v[220:223], v237 offset:4096
    v_mfma_f32_16x16x32_bf16 v[20:23], v[136:139], v[164:167], v[20:23]
    ds_read_b128 v[224:227], v237 offset:6144
    v_mfma_f32_16x16x32_bf16 v[24:27], v[136:139], v[168:171], v[24:27]
    v_mfma_f32_16x16x32_bf16 v[28:31], v[136:139], v[172:175], v[28:31]
    ds_read_b64_tr_b16 v[180:181], v228 offset:24576
    v_mfma_f32_16x16x32_bf16 v[32:35], v[136:139], v[176:179], v[32:35]
    ds_read_b64_tr_b16 v[182:183], v228 offset:25600
    v_mfma_f32_16x16x32_bf16 v[36:39], v[140:143], v[164:167], v[36:39]
    ds_read_b64_tr_b16 v[184:185], v229 offset:24576
    v_mfma_f32_16x16x32_bf16 v[40:43], v[140:143], v[168:171], v[40:43]
    ds_read_b64_tr_b16 v[186:187], v229 offset:25600
    v_mfma_f32_16x16x32_bf16 v[44:47], v[140:143], v[172:175], v[44:47]
    v_mfma_f32_16x16x32_bf16 v[48:51], v[140:143], v[176:179], v[48:51]
    ds_read_b64_tr_b16 v[188:189], v230 offset:24576
    v_mfma_f32_16x16x32_bf16 v[52:55], v[144:147], v[164:167], v[52:55]
    ds_read_b64_tr_b16 v[190:191], v230 offset:25600
    v_mfma_f32_16x16x32_bf16 v[56:59], v[144:147], v[168:171], v[56:59]
    ds_read_b64_tr_b16 v[192:193], v231 offset:24576
    v_mfma_f32_16x16x32_bf16 v[60:63], v[144:147], v[172:175], v[60:63]
    ds_read_b64_tr_b16 v[194:195], v231 offset:25600
    v_mfma_f32_16x16x32_bf16 v[64:67], v[144:147], v[176:179], v[64:67]
    ds_read_b64_tr_b16 v[196:197], v232 offset:40960
    v_mfma_f32_16x16x32_bf16 v[68:71], v[148:151], v[164:167], v[68:71]
    v_mfma_f32_16x16x32_bf16 v[72:75], v[148:151], v[168:171], v[72:75]
    ds_read_b64_tr_b16 v[198:199], v232 offset:41984
    v_mfma_f32_16x16x32_bf16 v[76:79], v[148:151], v[172:175], v[76:79]
    ds_read_b64_tr_b16 v[200:201], v233 offset:40960
    v_mfma_f32_16x16x32_bf16 v[80:83], v[148:151], v[176:179], v[80:83]
    ds_read_b64_tr_b16 v[202:203], v233 offset:41984
    v_mfma_f32_16x16x32_bf16 v[84:87], v[152:155], v[164:167], v[84:87]
    ds_read_b64_tr_b16 v[204:205], v234 offset:40960
    v_mfma_f32_16x16x32_bf16 v[88:91], v[152:155], v[168:171], v[88:91]
    v_mfma_f32_16x16x32_bf16 v[92:95], v[152:155], v[172:175], v[92:95]
    ds_read_b64_tr_b16 v[206:207], v234 offset:41984
    v_mfma_f32_16x16x32_bf16 v[96:99], v[152:155], v[176:179], v[96:99]
    ds_read_b64_tr_b16 v[208:209], v235 offset:40960
    v_mfma_f32_16x16x32_bf16 v[100:103], v[156:159], v[164:167], v[100:103]
    ds_read_b64_tr_b16 v[210:211], v235 offset:41984
    v_mfma_f32_16x16x32_bf16 v[104:107], v[156:159], v[168:171], v[104:107]
    s_add_u32 s46, s46, 128
    s_add_u32 s47, s47, 589824
    s_add_u32 s48, s48, 589824
    v_mfma_f32_16x16x32_bf16 v[108:111], v[156:159], v[172:175], v[108:111]
    v_mfma_f32_16x16x32_bf16 v[112:115], v[156:159], v[176:179], v[112:115]
    s_add_u32 m0, s41, 49152
    s_add_u32 s51, s46, 0
    buffer_load_dwordx4 v0, s[16:19], s51 offen lds
    v_mfma_f32_16x16x32_bf16 v[116:119], v[160:163], v[164:167], v[116:119]
    s_add_u32 m0, s41, 53248
    s_add_u32 s51, s46, 36864
    buffer_load_dwordx4 v0, s[16:19], s51 offen lds
    v_mfma_f32_16x16x32_bf16 v[120:123], v[160:163], v[168:171], v[120:123]
    s_add_u32 m0, s41, 57344
    s_add_u32 s51, s46, 73728
    buffer_load_dwordx4 v0, s[16:19], s51 offen lds
    v_mfma_f32_16x16x32_bf16 v[124:127], v[160:163], v[172:175], v[124:127]
    s_add_u32 m0, s41, 61440
    s_add_u32 s51, s46, 110592
    buffer_load_dwordx4 v0, s[16:19], s51 offen lds
    v_mfma_f32_16x16x32_bf16 v[128:131], v[160:163], v[176:179], v[128:131]
    s_add_u32 m0, s41, 65536
    s_add_u32 s51, s47, 0
    buffer_load_dwordx4 v1, s[20:23], s51 offen lds
    s_waitcnt lgkmcnt(0)
    v_mfma_f32_16x16x32_bf16 v[4:7], v[180:183], v[212:215], v[4:7]
    v_mfma_f32_16x16x32_bf16 v[8:11], v[180:183], v[216:219], v[8:11]
    v_mfma_f32_16x16x32_bf16 v[12:15], v[180:183], v[220:223], v[12:15]
    v_mfma_f32_16x16x32_bf16 v[16:19], v[180:183], v[224:227], v[16:19]
    v_mfma_f32_16x16x32_bf16 v[20:23], v[184:187], v[212:215], v[20:23]
    s_add_u32 m0, s41, 69632
    s_add_u32 s51, s47, 147456
    buffer_load_dwordx4 v1, s[20:23], s51 offen lds
    v_mfma_f32_16x16x32_bf16 v[24:27], v[184:187], v[216:219], v[24:27]
    v_mfma_f32_16x16x32_bf16 v[28:31], v[184:187], v[220:223], v[28:31]
    v_mfma_f32_16x16x32_bf16 v[32:35], v[184:187], v[224:227], v[32:35]
    v_mfma_f32_16x16x32_bf16 v[36:39], v[188:191], v[212:215], v[36:39]
    v_mfma_f32_16x16x32_bf16 v[40:43], v[188:191], v[216:219], v[40:43]
    s_add_u32 m0, s41, 73728
    s_add_u32 s51, s47, 294912
    buffer_load_dwordx4 v1, s[20:23], s51 offen lds
    v_mfma_f32_16x16x32_bf16 v[44:47], v[188:191], v[220:223], v[44:47]
    v_mfma_f32_16x16x32_bf16 v[48:51], v[188:191], v[224:227], v[48:51]
    v_mfma_f32_16x16x32_bf16 v[52:55], v[192:195], v[212:215], v[52:55]
    v_mfma_f32_16x16x32_bf16 v[56:59], v[192:195], v[216:219], v[56:59]
    s_add_u32 m0, s41, 77824
    s_add_u32 s51, s47, 442368
    buffer_load_dwordx4 v1, s[20:23], s51 offen lds
    v_mfma_f32_16x16x32_bf16 v[60:63], v[192:195], v[220:223], v[60:63]
    v_mfma_f32_16x16x32_bf16 v[64:67], v[192:195], v[224:227], v[64:67]
    v_mfma_f32_16x16x32_bf16 v[68:71], v[196:199], v[212:215], v[68:71]
    v_mfma_f32_16x16x32_bf16 v[72:75], v[196:199], v[216:219], v[72:75]
    v_mfma_f32_16x16x32_bf16 v[76:79], v[196:199], v[220:223], v[76:79]
    s_add_u32 m0, s41, 81920
    s_add_u32 s51, s48, 0
    buffer_load_dwordx4 v1, s[24:27], s51 offen lds
    v_mfma_f32_16x16x32_bf16 v[80:83], v[196:199], v[224:227], v[80:83]
    v_mfma_f32_16x16x32_bf16 v[84:87], v[200:203], v[212:215], v[84:87]
    v_mfma_f32_16x16x32_bf16 v[88:91], v[200:203], v[216:219], v[88:91]
    v_mfma_f32_16x16x32_bf16 v[92:95], v[200:203], v[220:223], v[92:95]
    s_add_u32 m0, s41, 86016
    s_add_u32 s51, s48, 147456
    buffer_load_dwordx4 v1, s[24:27], s51 offen lds
    v_mfma_f32_16x16x32_bf16 v[96:99], v[200:203], v[224:227], v[96:99]
    v_mfma_f32_16x16x32_bf16 v[100:103], v[204:207], v[212:215], v[100:103]
    v_mfma_f32_16x16x32_bf16 v[104:107], v[204:207], v[216:219], v[104:107]
    v_mfma_f32_16x16x32_bf16 v[108:111], v[204:207], v[220:223], v[108:111]
    v_mfma_f32_16x16x32_bf16 v[112:115], v[204:207], v[224:227], v[112:115]
    s_add_u32 m0, s41, 90112
    s_add_u32 s51, s48, 294912
    buffer_load_dwordx4 v1, s[24:27], s51 offen lds
    v_mfma_f32_16x16x32_bf16 v[116:119], v[208:211], v[212:215], v[116:119]
    v_mfma_f32_16x16x32_bf16 v[120:123], v[208:211], v[216:219], v[120:123]
    v_mfma_f32_16x16x32_bf16 v[124:127], v[208:211], v[220:223], v[124:127]
    v_mfma_f32_16x16x32_bf16 v[128:131], v[208:211], v[224:227], v[128:131]
    s_add_u32 m0, s41, 94208
    s_add_u32 s51, s48, 442368
    buffer_load_dwordx4 v1, s[24:27], s51 offen lds
    s_waitcnt vmcnt(12)
    s_barrier
    v_subrev_u32 v228, 98304, v228
    v_subrev_u32 v229, 98304, v229
    v_subrev_u32 v230, 98304, v230
    v_subrev_u32 v231, 98304, v231
    v_subrev_u32 v232, 98304, v232
    v_subrev_u32 v233, 98304, v233
    v_subrev_u32 v234, 98304, v234
    v_subrev_u32 v235, 98304, v235
    v_subrev_u32 v236, 98304, v236
    v_subrev_u32 v237, 98304, v237
    ds_read_b128 v[164:167], v236 offset:0
    ds_read_b128 v[168:171], v236 offset:2048
    ds_read_b128 v[172:175], v236 offset:4096
    ds_read_b128 v[176:179], v236 offset:6144
    ds_read_b64_tr_b16 v[132:133], v228 offset:16384
    ds_read_b64_tr_b16 v[134:135], v228 offset:17408
    ds_read_b64_tr_b16 v[136:137], v229 offset:16384
    ds_read_b64_tr_b16 v[138:139], v229 offset:17408
    ds_read_b64_tr_b16 v[140:141], v230 offset:16384
    ds_read_b64_tr_b16 v[142:143], v230 offset:17408
    ds_read_b64_tr_b16 v[144:145], v231 offset:16384
    ds_read_b64_tr_b16 v[146:147], v231 offset:17408
    ds_read_b64_tr_b16 v[148:149], v232 offset:32768
    ds_read_b64_tr_b16 v[150:151], v232 offset:33792
    ds_read_b64_tr_b16 v[152:153], v233 offset:32768
    ds_read_b64_tr_b16 v[154:155], v233 offset:33792
    ds_read_b64_tr_b16 v[156:157], v234 offset:32768
    ds_read_b64_tr_b16 v[158:159], v234 offset:33792
    ds_read_b64_tr_b16 v[160:161], v235 offset:32768
    ds_read_b64_tr_b16 v[162:163], v235 offset:33792
    s_waitcnt lgkmcnt(0)
    v_mfma_f32_16x16x32_bf16 v[4:7], v[132:135], v[164:167], v[4:7]
    v_mfma_f32_16x16x32_bf16 v[8:11], v[132:135], v[168:171], v[8:11]
    ds_read_b128 v[212:215], v237 offset:0
    v_mfma_f32_16x16x32_bf16 v[12:15], v[132:135], v[172:175], v[12:15]
    ds_read_b128 v[216:219], v237 offset:2048
    v_mfma_f32_16x16x32_bf16 v[16:19], v[132:135], v[176:179], v[16:19]
    ds_read_b128 v[220:223], v237 offset:4096
    v_mfma_f32_16x16x32_bf16 v[20:23], v[136:139], v[164:167], v[20:23]
    ds_read_b128 v[224:227], v237 offset:6144
    v_mfma_f32_16x16x32_bf16 v[24:27], v[136:139], v[168:171], v[24:27]
    v_mfma_f32_16x16x32_bf16 v[28:31], v[136:139], v[172:175], v[28:31]
    ds_read_b64_tr_b16 v[180:181], v228 offset:24576
    v_mfma_f32_16x16x32_bf16 v[32:35], v[136:139], v[176:179], v[32:35]
    ds_read_b64_tr_b16 v[182:183], v228 offset:25600
    v_mfma_f32_16x16x32_bf16 v[36:39], v[140:143], v[164:167], v[36:39]
    ds_read_b64_tr_b16 v[184:185], v229 offset:24576
    v_mfma_f32_16x16x32_bf16 v[40:43], v[140:143], v[168:171], v[40:43]
    ds_read_b64_tr_b16 v[186:187], v229 offset:25600
    v_mfma_f32_16x16x32_bf16 v[44:47], v[140:143], v[172:175], v[44:47]
    v_mfma_f32_16x16x32_bf16 v[48:51], v[140:143], v[176:179], v[48:51]
    ds_read_b64_tr_b16 v[188:189], v230 offset:24576
    v_mfma_f32_16x16x32_bf16 v[52:55], v[144:147], v[164:167], v[52:55]
    ds_read_b64_tr_b16 v[190:191], v230 offset:25600
    v_mfma_f32_16x16x32_bf16 v[56:59], v[144:147], v[168:171], v[56:59]
    ds_read_b64_tr_b16 v[192:193], v231 offset:24576
    v_mfma_f32_16x16x32_bf16 v[60:63], v[144:147], v[172:175], v[60:63]
    ds_read_b64_tr_b16 v[194:195], v231 offset:25600
    v_mfma_f32_16x16x32_bf16 v[64:67], v[144:147], v[176:179], v[64:67]
    ds_read_b64_tr_b16 v[196:197], v232 offset:40960
    v_mfma_f32_16x16x32_bf16 v[68:71], v[148:151], v[164:167], v[68:71]
    v_mfma_f32_16x16x32_bf16 v[72:75], v[148:151], v[168:171], v[72:75]
    ds_read_b64_tr_b16 v[198:199], v232 offset:41984
    v_mfma_f32_16x16x32_bf16 v[76:79], v[148:151], v[172:175], v[76:79]
    ds_read_b64_tr_b16 v[200:201], v233 offset:40960
    v_mfma_f32_16x16x32_bf16 v[80:83], v[148:151], v[176:179], v[80:83]
    ds_read_b64_tr_b16 v[202:203], v233 offset:41984
    v_mfma_f32_16x16x32_bf16 v[84:87], v[152:155], v[164:167], v[84:87]
    ds_read_b64_tr_b16 v[204:205], v234 offset:40960
    v_mfma_f32_16x16x32_bf16 v[88:91], v[152:155], v[168:171], v[88:91]
    v_mfma_f32_16x16x32_bf16 v[92:95], v[152:155], v[172:175], v[92:95]
    ds_read_b64_tr_b16 v[206:207], v234 offset:41984
    v_mfma_f32_16x16x32_bf16 v[96:99], v[152:155], v[176:179], v[96:99]
    ds_read_b64_tr_b16 v[208:209], v235 offset:40960
    v_mfma_f32_16x16x32_bf16 v[100:103], v[156:159], v[164:167], v[100:103]
    ds_read_b64_tr_b16 v[210:211], v235 offset:41984
    v_mfma_f32_16x16x32_bf16 v[104:107], v[156:159], v[168:171], v[104:107]
    s_add_u32 s46, s46, 128
    s_add_u32 s47, s47, 589824
    s_add_u32 s48, s48, 589824
    v_mfma_f32_16x16x32_bf16 v[108:111], v[156:159], v[172:175], v[108:111]
    v_mfma_f32_16x16x32_bf16 v[112:115], v[156:159], v[176:179], v[112:115]
    s_add_u32 m0, s41, 98304
    s_add_u32 s51, s46, 0
    buffer_load_dwordx4 v0, s[16:19], s51 offen lds
    v_mfma_f32_16x16x32_bf16 v[116:119], v[160:163], v[164:167], v[116:119]
    s_add_u32 m0, s41, 102400
    s_add_u32 s51, s46, 36864
    buffer_load_dwordx4 v0, s[16:19], s51 offen lds
    v_mfma_f32_16x16x32_bf16 v[120:123], v[160:163], v[168:171], v[120:123]
    s_add_u32 m0, s41, 106496
    s_add_u32 s51, s46, 73728
    buffer_load_dwordx4 v0, s[16:19], s51 offen lds
    v_mfma_f32_16x16x32_bf16 v[124:127], v[160:163], v[172:175], v[124:127]
    s_add_u32 m0, s41, 110592
    s_add_u32 s51, s46, 110592
    buffer_load_dwordx4 v0, s[16:19], s51 offen lds
    v_mfma_f32_16x16x32_bf16 v[128:131], v[160:163], v[176:179], v[128:131]
    s_add_u32 m0, s41, 114688
    s_add_u32 s51, s47, 0
    buffer_load_dwordx4 v1, s[20:23], s51 offen lds
    s_waitcnt lgkmcnt(0)
    v_mfma_f32_16x16x32_bf16 v[4:7], v[180:183], v[212:215], v[4:7]
    v_mfma_f32_16x16x32_bf16 v[8:11], v[180:183], v[216:219], v[8:11]
    v_mfma_f32_16x16x32_bf16 v[12:15], v[180:183], v[220:223], v[12:15]
    v_mfma_f32_16x16x32_bf16 v[16:19], v[180:183], v[224:227], v[16:19]
    v_mfma_f32_16x16x32_bf16 v[20:23], v[184:187], v[212:215], v[20:23]
    s_add_u32 m0, s41, 118784
    s_add_u32 s51, s47, 147456
    buffer_load_dwordx4 v1, s[20:23], s51 offen lds
    v_mfma_f32_16x16x32_bf16 v[24:27], v[184:187], v[216:219], v[24:27]
    v_mfma_f32_16x16x32_bf16 v[28:31], v[184:187], v[220:223], v[28:31]
    v_mfma_f32_16x16x32_bf16 v[32:35], v[184:187], v[224:227], v[32:35]
    v_mfma_f32_16x16x32_bf16 v[36:39], v[188:191], v[212:215], v[36:39]
    v_mfma_f32_16x16x32_bf16 v[40:43], v[188:191], v[216:219], v[40:43]
    s_add_u32 m0, s41, 122880
    s_add_u32 s51, s47, 294912
    buffer_load_dwordx4 v1, s[20:23], s51 offen lds
    v_mfma_f32_16x16x32_bf16 v[44:47], v[188:191], v[220:223], v[44:47]
    v_mfma_f32_16x16x32_bf16 v[48:51], v[188:191], v[224:227], v[48:51]
    v_mfma_f32_16x16x32_bf16 v[52:55], v[192:195], v[212:215], v[52:55]
    v_mfma_f32_16x16x32_bf16 v[56:59], v[192:195], v[216:219], v[56:59]
    s_add_u32 m0, s41, 126976
    s_add_u32 s51, s47, 442368
    buffer_load_dwordx4 v1, s[20:23], s51 offen lds
    v_mfma_f32_16x16x32_bf16 v[60:63], v[192:195], v[220:223], v[60:63]
    v_mfma_f32_16x16x32_bf16 v[64:67], v[192:195], v[224:227], v[64:67]
    v_mfma_f32_16x16x32_bf16 v[68:71], v[196:199], v[212:215], v[68:71]
    v_mfma_f32_16x16x32_bf16 v[72:75], v[196:199], v[216:219], v[72:75]
    v_mfma_f32_16x16x32_bf16 v[76:79], v[196:199], v[220:223], v[76:79]
    s_add_u32 m0, s41, 131072
    s_add_u32 s51, s48, 0
    buffer_load_dwordx4 v1, s[24:27], s51 offen lds
    v_mfma_f32_16x16x32_bf16 v[80:83], v[196:199], v[224:227], v[80:83]
    v_mfma_f32_16x16x32_bf16 v[84:87], v[200:203], v[212:215], v[84:87]
    v_mfma_f32_16x16x32_bf16 v[88:91], v[200:203], v[216:219], v[88:91]
    v_mfma_f32_16x16x32_bf16 v[92:95], v[200:203], v[220:223], v[92:95]
    s_add_u32 m0, s41, 135168
    s_add_u32 s51, s48, 147456
    buffer_load_dwordx4 v1, s[24:27], s51 offen lds
    v_mfma_f32_16x16x32_bf16 v[96:99], v[200:203], v[224:227], v[96:99]
    v_mfma_f32_16x16x32_bf16 v[100:103], v[204:207], v[212:215], v[100:103]
    v_mfma_f32_16x16x32_bf16 v[104:107], v[204:207], v[216:219], v[104:107]
    v_mfma_f32_16x16x32_bf16 v[108:111], v[204:207], v[220:223], v[108:111]
    v_mfma_f32_16x16x32_bf16 v[112:115], v[204:207], v[224:227], v[112:115]
    s_add_u32 m0, s41, 139264
    s_add_u32 s51, s48, 294912
    buffer_load_dwordx4 v1, s[24:27], s51 offen lds
    v_mfma_f32_16x16x32_bf16 v[116:119], v[208:211], v[212:215], v[116:119]
    v_mfma_f32_16x16x32_bf16 v[120:123], v[208:211], v[216:219], v[120:123]
    v_mfma_f32_16x16x32_bf16 v[124:127], v[208:211], v[220:223], v[124:127]
    v_mfma_f32_16x16x32_bf16 v[128:131], v[208:211], v[224:227], v[128:131]
    s_add_u32 m0, s41, 143360
    s_add_u32 s51, s48, 442368
    buffer_load_dwordx4 v1, s[24:27], s51 offen lds
    s_waitcnt vmcnt(12)
    s_barrier
    v_add_u32 v228, 49152, v228
    v_add_u32 v229, 49152, v229
    v_add_u32 v230, 49152, v230
    v_add_u32 v231, 49152, v231
    v_add_u32 v232, 49152, v232
    v_add_u32 v233, 49152, v233
    v_add_u32 v234, 49152, v234
    v_add_u32 v235, 49152, v235
    v_add_u32 v236, 49152, v236
    v_add_u32 v237, 49152, v237
    ds_read_b128 v[164:167], v236 offset:0
    ds_read_b128 v[168:171], v236 offset:2048
    ds_read_b128 v[172:175], v236 offset:4096
    ds_read_b128 v[176:179], v236 offset:6144
    ds_read_b64_tr_b16 v[132:133], v228 offset:16384
    ds_read_b64_tr_b16 v[134:135], v228 offset:17408
    ds_read_b64_tr_b16 v[136:137], v229 offset:16384
    ds_read_b64_tr_b16 v[138:139], v229 offset:17408
    ds_read_b64_tr_b16 v[140:141], v230 offset:16384
    ds_read_b64_tr_b16 v[142:143], v230 offset:17408
    ds_read_b64_tr_b16 v[144:145], v231 offset:16384
    ds_read_b64_tr_b16 v[146:147], v231 offset:17408
    ds_read_b64_tr_b16 v[148:149], v232 offset:32768
    ds_read_b64_tr_b16 v[150:151], v232 offset:33792
    ds_read_b64_tr_b16 v[152:153], v233 offset:32768
    ds_read_b64_tr_b16 v[154:155], v233 offset:33792
    ds_read_b64_tr_b16 v[156:157], v234 offset:32768
    ds_read_b64_tr_b16 v[158:159], v234 offset:33792
    ds_read_b64_tr_b16 v[160:161], v235 offset:32768
    ds_read_b64_tr_b16 v[162:163], v235 offset:33792
    s_waitcnt lgkmcnt(0)
    v_mfma_f32_16x16x32_bf16 v[4:7], v[132:135], v[164:167], v[4:7]
    v_mfma_f32_16x16x32_bf16 v[8:11], v[132:135], v[168:171], v[8:11]
    ds_read_b128 v[212:215], v237 offset:0
    v_mfma_f32_16x16x32_bf16 v[12:15], v[132:135], v[172:175], v[12:15]
    ds_read_b128 v[216:219], v237 offset:2048
    v_mfma_f32_16x16x32_bf16 v[16:19], v[132:135], v[176:179], v[16:19]
    ds_read_b128 v[220:223], v237 offset:4096
    v_mfma_f32_16x16x32_bf16 v[20:23], v[136:139], v[164:167], v[20:23]
    ds_read_b128 v[224:227], v237 offset:6144
    v_mfma_f32_16x16x32_bf16 v[24:27], v[136:139], v[168:171], v[24:27]
    v_mfma_f32_16x16x32_bf16 v[28:31], v[136:139], v[172:175], v[28:31]
    ds_read_b64_tr_b16 v[180:181], v228 offset:24576
    v_mfma_f32_16x16x32_bf16 v[32:35], v[136:139], v[176:179], v[32:35]
    ds_read_b64_tr_b16 v[182:183], v228 offset:25600
    v_mfma_f32_16x16x32_bf16 v[36:39], v[140:143], v[164:167], v[36:39]
    ds_read_b64_tr_b16 v[184:185], v229 offset:24576
    v_mfma_f32_16x16x32_bf16 v[40:43], v[140:143], v[168:171], v[40:43]
    ds_read_b64_tr_b16 v[186:187], v229 offset:25600
    v_mfma_f32_16x16x32_bf16 v[44:47], v[140:143], v[172:175], v[44:47]
    v_mfma_f32_16x16x32_bf16 v[48:51], v[140:143], v[176:179], v[48:51]
    ds_read_b64_tr_b16 v[188:189], v230 offset:24576
    v_mfma_f32_16x16x32_bf16 v[52:55], v[144:147], v[164:167], v[52:55]
    ds_read_b64_tr_b16 v[190:191], v230 offset:25600
    v_mfma_f32_16x16x32_bf16 v[56:59], v[144:147], v[168:171], v[56:59]
    ds_read_b64_tr_b16 v[192:193], v231 offset:24576
    v_mfma_f32_16x16x32_bf16 v[60:63], v[144:147], v[172:175], v[60:63]
    ds_read_b64_tr_b16 v[194:195], v231 offset:25600
    v_mfma_f32_16x16x32_bf16 v[64:67], v[144:147], v[176:179], v[64:67]
    ds_read_b64_tr_b16 v[196:197], v232 offset:40960
    v_mfma_f32_16x16x32_bf16 v[68:71], v[148:151], v[164:167], v[68:71]
    v_mfma_f32_16x16x32_bf16 v[72:75], v[148:151], v[168:171], v[72:75]
    ds_read_b64_tr_b16 v[198:199], v232 offset:41984
    v_mfma_f32_16x16x32_bf16 v[76:79], v[148:151], v[172:175], v[76:79]
    ds_read_b64_tr_b16 v[200:201], v233 offset:40960
    v_mfma_f32_16x16x32_bf16 v[80:83], v[148:151], v[176:179], v[80:83]
    ds_read_b64_tr_b16 v[202:203], v233 offset:41984
    v_mfma_f32_16x16x32_bf16 v[84:87], v[152:155], v[164:167], v[84:87]
    ds_read_b64_tr_b16 v[204:205], v234 offset:40960
    v_mfma_f32_16x16x32_bf16 v[88:91], v[152:155], v[168:171], v[88:91]
    v_mfma_f32_16x16x32_bf16 v[92:95], v[152:155], v[172:175], v[92:95]
    ds_read_b64_tr_b16 v[206:207], v234 offset:41984
    v_mfma_f32_16x16x32_bf16 v[96:99], v[152:155], v[176:179], v[96:99]
    ds_read_b64_tr_b16 v[208:209], v235 offset:40960
    v_mfma_f32_16x16x32_bf16 v[100:103], v[156:159], v[164:167], v[100:103]
    ds_read_b64_tr_b16 v[210:211], v235 offset:41984
    v_mfma_f32_16x16x32_bf16 v[104:107], v[156:159], v[168:171], v[104:107]
    s_add_u32 s46, s46, 128
    s_add_u32 s47, s47, 589824
    s_add_u32 s48, s48, 589824
    v_mfma_f32_16x16x32_bf16 v[108:111], v[156:159], v[172:175], v[108:111]
    v_mfma_f32_16x16x32_bf16 v[112:115], v[156:159], v[176:179], v[112:115]
    s_add_u32 m0, s41, 0
    s_add_u32 s51, s46, 0
    buffer_load_dwordx4 v0, s[16:19], s51 offen lds
    v_mfma_f32_16x16x32_bf16 v[116:119], v[160:163], v[164:167], v[116:119]
    s_add_u32 m0, s41, 4096
    s_add_u32 s51, s46, 36864
    buffer_load_dwordx4 v0, s[16:19], s51 offen lds
    v_mfma_f32_16x16x32_bf16 v[120:123], v[160:163], v[168:171], v[120:123]
    s_add_u32 m0, s41, 8192
    s_add_u32 s51, s46, 73728
    buffer_load_dwordx4 v0, s[16:19], s51 offen lds
    v_mfma_f32_16x16x32_bf16 v[124:127], v[160:163], v[172:175], v[124:127]
    s_add_u32 m0, s41, 12288
    s_add_u32 s51, s46, 110592
    buffer_load_dwordx4 v0, s[16:19], s51 offen lds
    v_mfma_f32_16x16x32_bf16 v[128:131], v[160:163], v[176:179], v[128:131]
    s_add_u32 m0, s41, 16384
    s_add_u32 s51, s47, 0
    buffer_load_dwordx4 v1, s[20:23], s51 offen lds
    s_waitcnt lgkmcnt(0)
    v_mfma_f32_16x16x32_bf16 v[4:7], v[180:183], v[212:215], v[4:7]
    v_mfma_f32_16x16x32_bf16 v[8:11], v[180:183], v[216:219], v[8:11]
    v_mfma_f32_16x16x32_bf16 v[12:15], v[180:183], v[220:223], v[12:15]
    v_mfma_f32_16x16x32_bf16 v[16:19], v[180:183], v[224:227], v[16:19]
    v_mfma_f32_16x16x32_bf16 v[20:23], v[184:187], v[212:215], v[20:23]
    s_add_u32 m0, s41, 20480
    s_add_u32 s51, s47, 147456
    buffer_load_dwordx4 v1, s[20:23], s51 offen lds
    v_mfma_f32_16x16x32_bf16 v[24:27], v[184:187], v[216:219], v[24:27]
    v_mfma_f32_16x16x32_bf16 v[28:31], v[184:187], v[220:223], v[28:31]
    v_mfma_f32_16x16x32_bf16 v[32:35], v[184:187], v[224:227], v[32:35]
    v_mfma_f32_16x16x32_bf16 v[36:39], v[188:191], v[212:215], v[36:39]
    v_mfma_f32_16x16x32_bf16 v[40:43], v[188:191], v[216:219], v[40:43]
    s_add_u32 m0, s41, 24576
    s_add_u32 s51, s47, 294912
    buffer_load_dwordx4 v1, s[20:23], s51 offen lds
    v_mfma_f32_16x16x32_bf16 v[44:47], v[188:191], v[220:223], v[44:47]
    v_mfma_f32_16x16x32_bf16 v[48:51], v[188:191], v[224:227], v[48:51]
    v_mfma_f32_16x16x32_bf16 v[52:55], v[192:195], v[212:215], v[52:55]
    v_mfma_f32_16x16x32_bf16 v[56:59], v[192:195], v[216:219], v[56:59]
    s_add_u32 m0, s41, 28672
    s_add_u32 s51, s47, 442368
    buffer_load_dwordx4 v1, s[20:23], s51 offen lds
    v_mfma_f32_16x16x32_bf16 v[60:63], v[192:195], v[220:223], v[60:63]
    v_mfma_f32_16x16x32_bf16 v[64:67], v[192:195], v[224:227], v[64:67]
    v_mfma_f32_16x16x32_bf16 v[68:71], v[196:199], v[212:215], v[68:71]
    v_mfma_f32_16x16x32_bf16 v[72:75], v[196:199], v[216:219], v[72:75]
    v_mfma_f32_16x16x32_bf16 v[76:79], v[196:199], v[220:223], v[76:79]
    s_add_u32 m0, s41, 32768
    s_add_u32 s51, s48, 0
    buffer_load_dwordx4 v1, s[24:27], s51 offen lds
    v_mfma_f32_16x16x32_bf16 v[80:83], v[196:199], v[224:227], v[80:83]
    v_mfma_f32_16x16x32_bf16 v[84:87], v[200:203], v[212:215], v[84:87]
    v_mfma_f32_16x16x32_bf16 v[88:91], v[200:203], v[216:219], v[88:91]
    v_mfma_f32_16x16x32_bf16 v[92:95], v[200:203], v[220:223], v[92:95]
    s_add_u32 m0, s41, 36864
    s_add_u32 s51, s48, 147456
    buffer_load_dwordx4 v1, s[24:27], s51 offen lds
    v_mfma_f32_16x16x32_bf16 v[96:99], v[200:203], v[224:227], v[96:99]
    v_mfma_f32_16x16x32_bf16 v[100:103], v[204:207], v[212:215], v[100:103]
    v_mfma_f32_16x16x32_bf16 v[104:107], v[204:207], v[216:219], v[104:107]
    v_mfma_f32_16x16x32_bf16 v[108:111], v[204:207], v[220:223], v[108:111]
    v_mfma_f32_16x16x32_bf16 v[112:115], v[204:207], v[224:227], v[112:115]
    s_add_u32 m0, s41, 40960
    s_add_u32 s51, s48, 294912
    buffer_load_dwordx4 v1, s[24:27], s51 offen lds
    v_mfma_f32_16x16x32_bf16 v[116:119], v[208:211], v[212:215], v[116:119]
    v_mfma_f32_16x16x32_bf16 v[120:123], v[208:211], v[216:219], v[120:123]
    v_mfma_f32_16x16x32_bf16 v[124:127], v[208:211], v[220:223], v[124:127]
    v_mfma_f32_16x16x32_bf16 v[128:131], v[208:211], v[224:227], v[128:131]
    s_add_u32 m0, s41, 45056
    s_add_u32 s51, s48, 442368
    buffer_load_dwordx4 v1, s[24:27], s51 offen lds
    s_waitcnt vmcnt(12)
    s_barrier
    v_add_u32 v228, 49152, v228
    v_add_u32 v229, 49152, v229
    v_add_u32 v230, 49152, v230
    v_add_u32 v231, 49152, v231
    v_add_u32 v232, 49152, v232
    v_add_u32 v233, 49152, v233
    v_add_u32 v234, 49152, v234
    v_add_u32 v235, 49152, v235
    v_add_u32 v236, 49152, v236
    v_add_u32 v237, 49152, v237
    ds_read_b128 v[164:167], v236 offset:0
    ds_read_b128 v[168:171], v236 offset:2048
    ds_read_b128 v[172:175], v236 offset:4096
    ds_read_b128 v[176:179], v236 offset:6144
    ds_read_b64_tr_b16 v[132:133], v228 offset:16384
    ds_read_b64_tr_b16 v[134:135], v228 offset:17408
    ds_read_b64_tr_b16 v[136:137], v229 offset:16384
    ds_read_b64_tr_b16 v[138:139], v229 offset:17408
    ds_read_b64_tr_b16 v[140:141], v230 offset:16384
    ds_read_b64_tr_b16 v[142:143], v230 offset:17408
    ds_read_b64_tr_b16 v[144:145], v231 offset:16384
    ds_read_b64_tr_b16 v[146:147], v231 offset:17408
    ds_read_b64_tr_b16 v[148:149], v232 offset:32768
    ds_read_b64_tr_b16 v[150:151], v232 offset:33792
    ds_read_b64_tr_b16 v[152:153], v233 offset:32768
    ds_read_b64_tr_b16 v[154:155], v233 offset:33792
    ds_read_b64_tr_b16 v[156:157], v234 offset:32768
    ds_read_b64_tr_b16 v[158:159], v234 offset:33792
    ds_read_b64_tr_b16 v[160:161], v235 offset:32768
    ds_read_b64_tr_b16 v[162:163], v235 offset:33792
    s_waitcnt lgkmcnt(0)
    v_mfma_f32_16x16x32_bf16 v[4:7], v[132:135], v[164:167], v[4:7]
    v_mfma_f32_16x16x32_bf16 v[8:11], v[132:135], v[168:171], v[8:11]
    ds_read_b128 v[212:215], v237 offset:0
    v_mfma_f32_16x16x32_bf16 v[12:15], v[132:135], v[172:175], v[12:15]
    ds_read_b128 v[216:219], v237 offset:2048
    v_mfma_f32_16x16x32_bf16 v[16:19], v[132:135], v[176:179], v[16:19]
    ds_read_b128 v[220:223], v237 offset:4096
    v_mfma_f32_16x16x32_bf16 v[20:23], v[136:139], v[164:167], v[20:23]
    ds_read_b128 v[224:227], v237 offset:6144
    v_mfma_f32_16x16x32_bf16 v[24:27], v[136:139], v[168:171], v[24:27]
    v_mfma_f32_16x16x32_bf16 v[28:31], v[136:139], v[172:175], v[28:31]
    ds_read_b64_tr_b16 v[180:181], v228 offset:24576
    v_mfma_f32_16x16x32_bf16 v[32:35], v[136:139], v[176:179], v[32:35]
    ds_read_b64_tr_b16 v[182:183], v228 offset:25600
    v_mfma_f32_16x16x32_bf16 v[36:39], v[140:143], v[164:167], v[36:39]
    ds_read_b64_tr_b16 v[184:185], v229 offset:24576
    v_mfma_f32_16x16x32_bf16 v[40:43], v[140:143], v[168:171], v[40:43]
    ds_read_b64_tr_b16 v[186:187], v229 offset:25600
    v_mfma_f32_16x16x32_bf16 v[44:47], v[140:143], v[172:175], v[44:47]
    v_mfma_f32_16x16x32_bf16 v[48:51], v[140:143], v[176:179], v[48:51]
    ds_read_b64_tr_b16 v[188:189], v230 offset:24576
    v_mfma_f32_16x16x32_bf16 v[52:55], v[144:147], v[164:167], v[52:55]
    ds_read_b64_tr_b16 v[190:191], v230 offset:25600
    v_mfma_f32_16x16x32_bf16 v[56:59], v[144:147], v[168:171], v[56:59]
    ds_read_b64_tr_b16 v[192:193], v231 offset:24576
    v_mfma_f32_16x16x32_bf16 v[60:63], v[144:147], v[172:175], v[60:63]
    ds_read_b64_tr_b16 v[194:195], v231 offset:25600
    v_mfma_f32_16x16x32_bf16 v[64:67], v[144:147], v[176:179], v[64:67]
    ds_read_b64_tr_b16 v[196:197], v232 offset:40960
    v_mfma_f32_16x16x32_bf16 v[68:71], v[148:151], v[164:167], v[68:71]
    v_mfma_f32_16x16x32_bf16 v[72:75], v[148:151], v[168:171], v[72:75]
    ds_read_b64_tr_b16 v[198:199], v232 offset:41984
    v_mfma_f32_16x16x32_bf16 v[76:79], v[148:151], v[172:175], v[76:79]
    ds_read_b64_tr_b16 v[200:201], v233 offset:40960
    v_mfma_f32_16x16x32_bf16 v[80:83], v[148:151], v[176:179], v[80:83]
    ds_read_b64_tr_b16 v[202:203], v233 offset:41984
    v_mfma_f32_16x16x32_bf16 v[84:87], v[152:155], v[164:167], v[84:87]
    ds_read_b64_tr_b16 v[204:205], v234 offset:40960
    v_mfma_f32_16x16x32_bf16 v[88:91], v[152:155], v[168:171], v[88:91]
    v_mfma_f32_16x16x32_bf16 v[92:95], v[152:155], v[172:175], v[92:95]
    ds_read_b64_tr_b16 v[206:207], v234 offset:41984
    v_mfma_f32_16x16x32_bf16 v[96:99], v[152:155], v[176:179], v[96:99]
    ds_read_b64_tr_b16 v[208:209], v235 offset:40960
    v_mfma_f32_16x16x32_bf16 v[100:103], v[156:159], v[164:167], v[100:103]
    ds_read_b64_tr_b16 v[210:211], v235 offset:41984
    v_mfma_f32_16x16x32_bf16 v[104:107], v[156:159], v[168:171], v[104:107]
    s_add_u32 s46, s46, 128
    s_add_u32 s47, s47, 589824
    s_add_u32 s48, s48, 589824
    v_mfma_f32_16x16x32_bf16 v[108:111], v[156:159], v[172:175], v[108:111]
    v_mfma_f32_16x16x32_bf16 v[112:115], v[156:159], v[176:179], v[112:115]
    s_add_u32 m0, s41, 49152
    s_add_u32 s51, s46, 0
    buffer_load_dwordx4 v0, s[16:19], s51 offen lds
    v_mfma_f32_16x16x32_bf16 v[116:119], v[160:163], v[164:167], v[116:119]
    s_add_u32 m0, s41, 53248
    s_add_u32 s51, s46, 36864
    buffer_load_dwordx4 v0, s[16:19], s51 offen lds
    v_mfma_f32_16x16x32_bf16 v[120:123], v[160:163], v[168:171], v[120:123]
    s_add_u32 m0, s41, 57344
    s_add_u32 s51, s46, 73728
    buffer_load_dwordx4 v0, s[16:19], s51 offen lds
    v_mfma_f32_16x16x32_bf16 v[124:127], v[160:163], v[172:175], v[124:127]
    s_add_u32 m0, s41, 61440
    s_add_u32 s51, s46, 110592
    buffer_load_dwordx4 v0, s[16:19], s51 offen lds
    v_mfma_f32_16x16x32_bf16 v[128:131], v[160:163], v[176:179], v[128:131]
    s_add_u32 m0, s41, 65536
    s_add_u32 s51, s47, 0
    buffer_load_dwordx4 v1, s[20:23], s51 offen lds
    s_waitcnt lgkmcnt(0)
    v_mfma_f32_16x16x32_bf16 v[4:7], v[180:183], v[212:215], v[4:7]
    v_mfma_f32_16x16x32_bf16 v[8:11], v[180:183], v[216:219], v[8:11]
    v_mfma_f32_16x16x32_bf16 v[12:15], v[180:183], v[220:223], v[12:15]
    v_mfma_f32_16x16x32_bf16 v[16:19], v[180:183], v[224:227], v[16:19]
    v_mfma_f32_16x16x32_bf16 v[20:23], v[184:187], v[212:215], v[20:23]
    s_add_u32 m0, s41, 69632
    s_add_u32 s51, s47, 147456
    buffer_load_dwordx4 v1, s[20:23], s51 offen lds
    v_mfma_f32_16x16x32_bf16 v[24:27], v[184:187], v[216:219], v[24:27]
    v_mfma_f32_16x16x32_bf16 v[28:31], v[184:187], v[220:223], v[28:31]
    v_mfma_f32_16x16x32_bf16 v[32:35], v[184:187], v[224:227], v[32:35]
    v_mfma_f32_16x16x32_bf16 v[36:39], v[188:191], v[212:215], v[36:39]
    v_mfma_f32_16x16x32_bf16 v[40:43], v[188:191], v[216:219], v[40:43]
    s_add_u32 m0, s41, 73728
    s_add_u32 s51, s47, 294912
    buffer_load_dwordx4 v1, s[20:23], s51 offen lds
    v_mfma_f32_16x16x32_bf16 v[44:47], v[188:191], v[220:223], v[44:47]
    v_mfma_f32_16x16x32_bf16 v[48:51], v[188:191], v[224:227], v[48:51]
    v_mfma_f32_16x16x32_bf16 v[52:55], v[192:195], v[212:215], v[52:55]
    v_mfma_f32_16x16x32_bf16 v[56:59], v[192:195], v[216:219], v[56:59]
    s_add_u32 m0, s41, 77824
    s_add_u32 s51, s47, 442368
    buffer_load_dwordx4 v1, s[20:23], s51 offen lds
    v_mfma_f32_16x16x32_bf16 v[60:63], v[192:195], v[220:223], v[60:63]
    v_mfma_f32_16x16x32_bf16 v[64:67], v[192:195], v[224:227], v[64:67]
    v_mfma_f32_16x16x32_bf16 v[68:71], v[196:199], v[212:215], v[68:71]
    v_mfma_f32_16x16x32_bf16 v[72:75], v[196:199], v[216:219], v[72:75]
    v_mfma_f32_16x16x32_bf16 v[76:79], v[196:199], v[220:223], v[76:79]
    s_add_u32 m0, s41, 81920
    s_add_u32 s51, s48, 0
    buffer_load_dwordx4 v1, s[24:27], s51 offen lds
    v_mfma_f32_16x16x32_bf16 v[80:83], v[196:199], v[224:227], v[80:83]
    v_mfma_f32_16x16x32_bf16 v[84:87], v[200:203], v[212:215], v[84:87]
    v_mfma_f32_16x16x32_bf16 v[88:91], v[200:203], v[216:219], v[88:91]
    v_mfma_f32_16x16x32_bf16 v[92:95], v[200:203], v[220:223], v[92:95]
    s_add_u32 m0, s41, 86016
    s_add_u32 s51, s48, 147456
    buffer_load_dwordx4 v1, s[24:27], s51 offen lds
    v_mfma_f32_16x16x32_bf16 v[96:99], v[200:203], v[224:227], v[96:99]
    v_mfma_f32_16x16x32_bf16 v[100:103], v[204:207], v[212:215], v[100:103]
    v_mfma_f32_16x16x32_bf16 v[104:107], v[204:207], v[216:219], v[104:107]
    v_mfma_f32_16x16x32_bf16 v[108:111], v[204:207], v[220:223], v[108:111]
    v_mfma_f32_16x16x32_bf16 v[112:115], v[204:207], v[224:227], v[112:115]
    s_add_u32 m0, s41, 90112
    s_add_u32 s51, s48, 294912
    buffer_load_dwordx4 v1, s[24:27], s51 offen lds
    v_mfma_f32_16x16x32_bf16 v[116:119], v[208:211], v[212:215], v[116:119]
    v_mfma_f32_16x16x32_bf16 v[120:123], v[208:211], v[216:219], v[120:123]
    v_mfma_f32_16x16x32_bf16 v[124:127], v[208:211], v[220:223], v[124:127]
    v_mfma_f32_16x16x32_bf16 v[128:131], v[208:211], v[224:227], v[128:131]
    s_add_u32 m0, s41, 94208
    s_add_u32 s51, s48, 442368
    buffer_load_dwordx4 v1, s[24:27], s51 offen lds
    s_waitcnt vmcnt(12)
    s_barrier
    v_subrev_u32 v228, 98304, v228
    v_subrev_u32 v229, 98304, v229
    v_subrev_u32 v230, 98304, v230
    v_subrev_u32 v231, 98304, v231
    v_subrev_u32 v232, 98304, v232
    v_subrev_u32 v233, 98304, v233
    v_subrev_u32 v234, 98304, v234
    v_subrev_u32 v235, 98304, v235
    v_subrev_u32 v236, 98304, v236
    v_subrev_u32 v237, 98304, v237
    ds_read_b128 v[164:167], v236 offset:0
    ds_read_b128 v[168:171], v236 offset:2048
    ds_read_b128 v[172:175], v236 offset:4096
    ds_read_b128 v[176:179], v236 offset:6144
    ds_read_b64_tr_b16 v[132:133], v228 offset:16384
    ds_read_b64_tr_b16 v[134:135], v228 offset:17408
    ds_read_b64_tr_b16 v[136:137], v229 offset:16384
    ds_read_b64_tr_b16 v[138:139], v229 offset:17408
    ds_read_b64_tr_b16 v[140:141], v230 offset:16384
    ds_read_b64_tr_b16 v[142:143], v230 offset:17408
    ds_read_b64_tr_b16 v[144:145], v231 offset:16384
    ds_read_b64_tr_b16 v[146:147], v231 offset:17408
    ds_read_b64_tr_b16 v[148:149], v232 offset:32768
    ds_read_b64_tr_b16 v[150:151], v232 offset:33792
    ds_read_b64_tr_b16 v[152:153], v233 offset:32768
    ds_read_b64_tr_b16 v[154:155], v233 offset:33792
    ds_read_b64_tr_b16 v[156:157], v234 offset:32768
    ds_read_b64_tr_b16 v[158:159], v234 offset:33792
    ds_read_b64_tr_b16 v[160:161], v235 offset:32768
    ds_read_b64_tr_b16 v[162:163], v235 offset:33792
    s_waitcnt lgkmcnt(0)
    v_mfma_f32_16x16x32_bf16 v[4:7], v[132:135], v[164:167], v[4:7]
    v_mfma_f32_16x16x32_bf16 v[8:11], v[132:135], v[168:171], v[8:11]
    ds_read_b128 v[212:215], v237 offset:0
    v_mfma_f32_16x16x32_bf16 v[12:15], v[132:135], v[172:175], v[12:15]
    ds_read_b128 v[216:219], v237 offset:2048
    v_mfma_f32_16x16x32_bf16 v[16:19], v[132:135], v[176:179], v[16:19]
    ds_read_b128 v[220:223], v237 offset:4096
    v_mfma_f32_16x16x32_bf16 v[20:23], v[136:139], v[164:167], v[20:23]
    ds_read_b128 v[224:227], v237 offset:6144
    v_mfma_f32_16x16x32_bf16 v[24:27], v[136:139], v[168:171], v[24:27]
    v_mfma_f32_16x16x32_bf16 v[28:31], v[136:139], v[172:175], v[28:31]
    ds_read_b64_tr_b16 v[180:181], v228 offset:24576
    v_mfma_f32_16x16x32_bf16 v[32:35], v[136:139], v[176:179], v[32:35]
    ds_read_b64_tr_b16 v[182:183], v228 offset:25600
    v_mfma_f32_16x16x32_bf16 v[36:39], v[140:143], v[164:167], v[36:39]
    ds_read_b64_tr_b16 v[184:185], v229 offset:24576
    v_mfma_f32_16x16x32_bf16 v[40:43], v[140:143], v[168:171], v[40:43]
    ds_read_b64_tr_b16 v[186:187], v229 offset:25600
    v_mfma_f32_16x16x32_bf16 v[44:47], v[140:143], v[172:175], v[44:47]
    v_mfma_f32_16x16x32_bf16 v[48:51], v[140:143], v[176:179], v[48:51]
    ds_read_b64_tr_b16 v[188:189], v230 offset:24576
    v_mfma_f32_16x16x32_bf16 v[52:55], v[144:147], v[164:167], v[52:55]
    ds_read_b64_tr_b16 v[190:191], v230 offset:25600
    v_mfma_f32_16x16x32_bf16 v[56:59], v[144:147], v[168:171], v[56:59]
    ds_read_b64_tr_b16 v[192:193], v231 offset:24576
    v_mfma_f32_16x16x32_bf16 v[60:63], v[144:147], v[172:175], v[60:63]
    ds_read_b64_tr_b16 v[194:195], v231 offset:25600
    v_mfma_f32_16x16x32_bf16 v[64:67], v[144:147], v[176:179], v[64:67]
    ds_read_b64_tr_b16 v[196:197], v232 offset:40960
    v_mfma_f32_16x16x32_bf16 v[68:71], v[148:151], v[164:167], v[68:71]
    v_mfma_f32_16x16x32_bf16 v[72:75], v[148:151], v[168:171], v[72:75]
    ds_read_b64_tr_b16 v[198:199], v232 offset:41984
    v_mfma_f32_16x16x32_bf16 v[76:79], v[148:151], v[172:175], v[76:79]
    ds_read_b64_tr_b16 v[200:201], v233 offset:40960
    v_mfma_f32_16x16x32_bf16 v[80:83], v[148:151], v[176:179], v[80:83]
    ds_read_b64_tr_b16 v[202:203], v233 offset:41984
    v_mfma_f32_16x16x32_bf16 v[84:87], v[152:155], v[164:167], v[84:87]
    ds_read_b64_tr_b16 v[204:205], v234 offset:40960
    v_mfma_f32_16x16x32_bf16 v[88:91], v[152:155], v[168:171], v[88:91]
    v_mfma_f32_16x16x32_bf16 v[92:95], v[152:155], v[172:175], v[92:95]
    ds_read_b64_tr_b16 v[206:207], v234 offset:41984
    v_mfma_f32_16x16x32_bf16 v[96:99], v[152:155], v[176:179], v[96:99]
    ds_read_b64_tr_b16 v[208:209], v235 offset:40960
    v_mfma_f32_16x16x32_bf16 v[100:103], v[156:159], v[164:167], v[100:103]
    ds_read_b64_tr_b16 v[210:211], v235 offset:41984
    v_mfma_f32_16x16x32_bf16 v[104:107], v[156:159], v[168:171], v[104:107]
    s_add_u32 s46, s46, 128
    s_add_u32 s47, s47, 589824
    s_add_u32 s48, s48, 589824
    v_mfma_f32_16x16x32_bf16 v[108:111], v[156:159], v[172:175], v[108:111]
    v_mfma_f32_16x16x32_bf16 v[112:115], v[156:159], v[176:179], v[112:115]
    s_add_u32 m0, s41, 98304
    s_add_u32 s51, s46, 0
    buffer_load_dwordx4 v0, s[16:19], s51 offen lds
    v_mfma_f32_16x16x32_bf16 v[116:119], v[160:163], v[164:167], v[116:119]
    s_add_u32 m0, s41, 102400
    s_add_u32 s51, s46, 36864
    buffer_load_dwordx4 v0, s[16:19], s51 offen lds
    v_mfma_f32_16x16x32_bf16 v[120:123], v[160:163], v[168:171], v[120:123]
    s_add_u32 m0, s41, 106496
    s_add_u32 s51, s46, 73728
    buffer_load_dwordx4 v0, s[16:19], s51 offen lds
    v_mfma_f32_16x16x32_bf16 v[124:127], v[160:163], v[172:175], v[124:127]
    s_add_u32 m0, s41, 110592
    s_add_u32 s51, s46, 110592
    buffer_load_dwordx4 v0, s[16:19], s51 offen lds
    v_mfma_f32_16x16x32_bf16 v[128:131], v[160:163], v[176:179], v[128:131]
    s_add_u32 m0, s41, 114688
    s_add_u32 s51, s47, 0
    buffer_load_dwordx4 v1, s[20:23], s51 offen lds
    s_waitcnt lgkmcnt(0)
    v_mfma_f32_16x16x32_bf16 v[4:7], v[180:183], v[212:215], v[4:7]
    v_mfma_f32_16x16x32_bf16 v[8:11], v[180:183], v[216:219], v[8:11]
    v_mfma_f32_16x16x32_bf16 v[12:15], v[180:183], v[220:223], v[12:15]
    v_mfma_f32_16x16x32_bf16 v[16:19], v[180:183], v[224:227], v[16:19]
    v_mfma_f32_16x16x32_bf16 v[20:23], v[184:187], v[212:215], v[20:23]
    s_add_u32 m0, s41, 118784
    s_add_u32 s51, s47, 147456
    buffer_load_dwordx4 v1, s[20:23], s51 offen lds
    v_mfma_f32_16x16x32_bf16 v[24:27], v[184:187], v[216:219], v[24:27]
    v_mfma_f32_16x16x32_bf16 v[28:31], v[184:187], v[220:223], v[28:31]
    v_mfma_f32_16x16x32_bf16 v[32:35], v[184:187], v[224:227], v[32:35]
    v_mfma_f32_16x16x32_bf16 v[36:39], v[188:191], v[212:215], v[36:39]
    v_mfma_f32_16x16x32_bf16 v[40:43], v[188:191], v[216:219], v[40:43]
    s_add_u32 m0, s41, 122880
    s_add_u32 s51, s47, 294912
    buffer_load_dwordx4 v1, s[20:23], s51 offen lds
    v_mfma_f32_16x16x32_bf16 v[44:47], v[188:191], v[220:223], v[44:47]
    v_mfma_f32_16x16x32_bf16 v[48:51], v[188:191], v[224:227], v[48:51]
    v_mfma_f32_16x16x32_bf16 v[52:55], v[192:195], v[212:215], v[52:55]
    v_mfma_f32_16x16x32_bf16 v[56:59], v[192:195], v[216:219], v[56:59]
    s_add_u32 m0, s41, 126976
    s_add_u32 s51, s47, 442368
    buffer_load_dwordx4 v1, s[20:23], s51 offen lds
    v_mfma_f32_16x16x32_bf16 v[60:63], v[192:195], v[220:223], v[60:63]
    v_mfma_f32_16x16x32_bf16 v[64:67], v[192:195], v[224:227], v[64:67]
    v_mfma_f32_16x16x32_bf16 v[68:71], v[196:199], v[212:215], v[68:71]
    v_mfma_f32_16x16x32_bf16 v[72:75], v[196:199], v[216:219], v[72:75]
    v_mfma_f32_16x16x32_bf16 v[76:79], v[196:199], v[220:223], v[76:79]
    s_add_u32 m0, s41, 131072
    s_add_u32 s51, s48, 0
    buffer_load_dwordx4 v1, s[24:27], s51 offen lds
    v_mfma_f32_16x16x32_bf16 v[80:83], v[196:199], v[224:227], v[80:83]
    v_mfma_f32_16x16x32_bf16 v[84:87], v[200:203], v[212:215], v[84:87]
    v_mfma_f32_16x16x32_bf16 v[88:91], v[200:203], v[216:219], v[88:91]
    v_mfma_f32_16x16x32_bf16 v[92:95], v[200:203], v[220:223], v[92:95]
    s_add_u32 m0, s41, 135168
    s_add_u32 s51, s48, 147456
    buffer_load_dwordx4 v1, s[24:27], s51 offen lds
    v_mfma_f32_16x16x32_bf16 v[96:99], v[200:203], v[224:227], v[96:99]
    v_mfma_f32_16x16x32_bf16 v[100:103], v[204:207], v[212:215], v[100:103]
    v_mfma_f32_16x16x32_bf16 v[104:107], v[204:207], v[216:219], v[104:107]
    v_mfma_f32_16x16x32_bf16 v[108:111], v[204:207], v[220:223], v[108:111]
    v_mfma_f32_16x16x32_bf16 v[112:115], v[204:207], v[224:227], v[112:115]
    s_add_u32 m0, s41, 139264
    s_add_u32 s51, s48, 294912
    buffer_load_dwordx4 v1, s[24:27], s51 offen lds
    v_mfma_f32_16x16x32_bf16 v[116:119], v[208:211], v[212:215], v[116:119]
    v_mfma_f32_16x16x32_bf16 v[120:123], v[208:211], v[216:219], v[120:123]
    v_mfma_f32_16x16x32_bf16 v[124:127], v[208:211], v[220:223], v[124:127]
    v_mfma_f32_16x16x32_bf16 v[128:131], v[208:211], v[224:227], v[128:131]
    s_add_u32 m0, s41, 143360
    s_add_u32 s51, s48, 442368
    buffer_load_dwordx4 v1, s[24:27], s51 offen lds
    s_waitcnt vmcnt(12)
    s_barrier
    v_add_u32 v228, 49152, v228
    v_add_u32 v229, 49152, v229
    v_add_u32 v230, 49152, v230
    v_add_u32 v231, 49152, v231
    v_add_u32 v232, 49152, v232
    v_add_u32 v233, 49152, v233
    v_add_u32 v234, 49152, v234
    v_add_u32 v235, 49152, v235
    v_add_u32 v236, 49152, v236
    v_add_u32 v237, 49152, v237
    ds_read_b128 v[164:167], v236 offset:0
    ds_read_b128 v[168:171], v236 offset:2048
    ds_read_b128 v[172:175], v236 offset:4096
    ds_read_b128 v[176:179], v236 offset:6144
    ds_read_b64_tr_b16 v[132:133], v228 offset:16384
    ds_read_b64_tr_b16 v[134:135], v228 offset:17408
    ds_read_b64_tr_b16 v[136:137], v229 offset:16384
    ds_read_b64_tr_b16 v[138:139], v229 offset:17408
    ds_read_b64_tr_b16 v[140:141], v230 offset:16384
    ds_read_b64_tr_b16 v[142:143], v230 offset:17408
    ds_read_b64_tr_b16 v[144:145], v231 offset:16384
    ds_read_b64_tr_b16 v[146:147], v231 offset:17408
    ds_read_b64_tr_b16 v[148:149], v232 offset:32768
    ds_read_b64_tr_b16 v[150:151], v232 offset:33792
    ds_read_b64_tr_b16 v[152:153], v233 offset:32768
    ds_read_b64_tr_b16 v[154:155], v233 offset:33792
    ds_read_b64_tr_b16 v[156:157], v234 offset:32768
    ds_read_b64_tr_b16 v[158:159], v234 offset:33792
    ds_read_b64_tr_b16 v[160:161], v235 offset:32768
    ds_read_b64_tr_b16 v[162:163], v235 offset:33792
    s_waitcnt lgkmcnt(0)
    v_mfma_f32_16x16x32_bf16 v[4:7], v[132:135], v[164:167], v[4:7]
    v_mfma_f32_16x16x32_bf16 v[8:11], v[132:135], v[168:171], v[8:11]
    ds_read_b128 v[212:215], v237 offset:0
    v_mfma_f32_16x16x32_bf16 v[12:15], v[132:135], v[172:175], v[12:15]
    v_mfma_f32_16x16x32_bf16 v[16:19], v[132:135], v[176:179], v[16:19]
    ds_read_b128 v[216:219], v237 offset:2048
    v_mfma_f32_16x16x32_bf16 v[20:23], v[136:139], v[164:167], v[20:23]
    ds_read_b128 v[220:223], v237 offset:4096
    v_mfma_f32_16x16x32_bf16 v[24:27], v[136:139], v[168:171], v[24:27]
    v_mfma_f32_16x16x32_bf16 v[28:31], v[136:139], v[172:175], v[28:31]
    ds_read_b128 v[224:227], v237 offset:6144
    v_mfma_f32_16x16x32_bf16 v[32:35], v[136:139], v[176:179], v[32:35]
    ds_read_b64_tr_b16 v[180:181], v228 offset:24576
    v_mfma_f32_16x16x32_bf16 v[36:39], v[140:143], v[164:167], v[36:39]
    v_mfma_f32_16x16x32_bf16 v[40:43], v[140:143], v[168:171], v[40:43]
    ds_read_b64_tr_b16 v[182:183], v228 offset:25600
    v_mfma_f32_16x16x32_bf16 v[44:47], v[140:143], v[172:175], v[44:47]
    v_mfma_f32_16x16x32_bf16 v[48:51], v[140:143], v[176:179], v[48:51]
    ds_read_b64_tr_b16 v[184:185], v229 offset:24576
    v_mfma_f32_16x16x32_bf16 v[52:55], v[144:147], v[164:167], v[52:55]
    ds_read_b64_tr_b16 v[186:187], v229 offset:25600
    v_mfma_f32_16x16x32_bf16 v[56:59], v[144:147], v[168:171], v[56:59]
    v_mfma_f32_16x16x32_bf16 v[60:63], v[144:147], v[172:175], v[60:63]
    ds_read_b64_tr_b16 v[188:189], v230 offset:24576
    v_mfma_f32_16x16x32_bf16 v[64:67], v[144:147], v[176:179], v[64:67]
    ds_read_b64_tr_b16 v[190:191], v230 offset:25600
    v_mfma_f32_16x16x32_bf16 v[68:71], v[148:151], v[164:167], v[68:71]
    v_mfma_f32_16x16x32_bf16 v[72:75], v[148:151], v[168:171], v[72:75]
    ds_read_b64_tr_b16 v[192:193], v231 offset:24576
    v_mfma_f32_16x16x32_bf16 v[76:79], v[148:151], v[172:175], v[76:79]
    v_mfma_f32_16x16x32_bf16 v[80:83], v[148:151], v[176:179], v[80:83]
    ds_read_b64_tr_b16 v[194:195], v231 offset:25600
    v_mfma_f32_16x16x32_bf16 v[84:87], v[152:155], v[164:167], v[84:87]
    ds_read_b64_tr_b16 v[196:197], v232 offset:40960
    v_mfma_f32_16x16x32_bf16 v[88:91], v[152:155], v[168:171], v[88:91]
    v_mfma_f32_16x16x32_bf16 v[92:95], v[152:155], v[172:175], v[92:95]
    ds_read_b64_tr_b16 v[198:199], v232 offset:41984
    v_mfma_f32_16x16x32_bf16 v[96:99], v[152:155], v[176:179], v[96:99]
    ds_read_b64_tr_b16 v[200:201], v233 offset:40960
    v_mfma_f32_16x16x32_bf16 v[100:103], v[156:159], v[164:167], v[100:103]
    v_mfma_f32_16x16x32_bf16 v[104:107], v[156:159], v[168:171], v[104:107]
    ds_read_b64_tr_b16 v[202:203], v233 offset:41984
    v_mfma_f32_16x16x32_bf16 v[108:111], v[156:159], v[172:175], v[108:111]
    v_mfma_f32_16x16x32_bf16 v[112:115], v[156:159], v[176:179], v[112:115]
    ds_read_b64_tr_b16 v[204:205], v234 offset:40960
    v_mfma_f32_16x16x32_bf16 v[116:119], v[160:163], v[164:167], v[116:119]
    ds_read_b64_tr_b16 v[206:207], v234 offset:41984
    v_mfma_f32_16x16x32_bf16 v[120:123], v[160:163], v[168:171], v[120:123]
    v_mfma_f32_16x16x32_bf16 v[124:127], v[160:163], v[172:175], v[124:127]
    ds_read_b64_tr_b16 v[208:209], v235 offset:40960
    v_mfma_f32_16x16x32_bf16 v[128:131], v[160:163], v[176:179], v[128:131]
    ds_read_b64_tr_b16 v[210:211], v235 offset:41984
    s_waitcnt lgkmcnt(0)
    v_mfma_f32_16x16x32_bf16 v[4:7], v[180:183], v[212:215], v[4:7]
    v_mfma_f32_16x16x32_bf16 v[8:11], v[180:183], v[216:219], v[8:11]
    v_mfma_f32_16x16x32_bf16 v[12:15], v[180:183], v[220:223], v[12:15]
    v_mfma_f32_16x16x32_bf16 v[16:19], v[180:183], v[224:227], v[16:19]
    v_mfma_f32_16x16x32_bf16 v[20:23], v[184:187], v[212:215], v[20:23]
    v_mfma_f32_16x16x32_bf16 v[24:27], v[184:187], v[216:219], v[24:27]
    v_mfma_f32_16x16x32_bf16 v[28:31], v[184:187], v[220:223], v[28:31]
    v_mfma_f32_16x16x32_bf16 v[32:35], v[184:187], v[224:227], v[32:35]
    v_mfma_f32_16x16x32_bf16 v[36:39], v[188:191], v[212:215], v[36:39]
    v_mfma_f32_16x16x32_bf16 v[40:43], v[188:191], v[216:219], v[40:43]
    v_mfma_f32_16x16x32_bf16 v[44:47], v[188:191], v[220:223], v[44:47]
    v_mfma_f32_16x16x32_bf16 v[48:51], v[188:191], v[224:227], v[48:51]
    v_mfma_f32_16x16x32_bf16 v[52:55], v[192:195], v[212:215], v[52:55]
    v_mfma_f32_16x16x32_bf16 v[56:59], v[192:195], v[216:219], v[56:59]
    v_mfma_f32_16x16x32_bf16 v[60:63], v[192:195], v[220:223], v[60:63]
    v_mfma_f32_16x16x32_bf16 v[64:67], v[192:195], v[224:227], v[64:67]
    v_mfma_f32_16x16x32_bf16 v[68:71], v[196:199], v[212:215], v[68:71]
    v_mfma_f32_16x16x32_bf16 v[72:75], v[196:199], v[216:219], v[72:75]
    v_mfma_f32_16x16x32_bf16 v[76:79], v[196:199], v[220:223], v[76:79]
    v_mfma_f32_16x16x32_bf16 v[80:83], v[196:199], v[224:227], v[80:83]
    v_mfma_f32_16x16x32_bf16 v[84:87], v[200:203], v[212:215], v[84:87]
    v_mfma_f32_16x16x32_bf16 v[88:91], v[200:203], v[216:219], v[88:91]
    v_mfma_f32_16x16x32_bf16 v[92:95], v[200:203], v[220:223], v[92:95]
    v_mfma_f32_16x16x32_bf16 v[96:99], v[200:203], v[224:227], v[96:99]
    v_mfma_f32_16x16x32_bf16 v[100:103], v[204:207], v[212:215], v[100:103]
    v_mfma_f32_16x16x32_bf16 v[104:107], v[204:207], v[216:219], v[104:107]
    v_mfma_f32_16x16x32_bf16 v[108:111], v[204:207], v[220:223], v[108:111]
    v_mfma_f32_16x16x32_bf16 v[112:115], v[204:207], v[224:227], v[112:115]
    v_mfma_f32_16x16x32_bf16 v[116:119], v[208:211], v[212:215], v[116:119]
    v_mfma_f32_16x16x32_bf16 v[120:123], v[208:211], v[216:219], v[120:123]
    v_mfma_f32_16x16x32_bf16 v[124:127], v[208:211], v[220:223], v[124:127]
    v_mfma_f32_16x16x32_bf16 v[128:131], v[208:211], v[224:227], v[128:131]
    s_waitcnt vmcnt(0)
    s_barrier
    v_add_u32 v228, 49152, v228
    v_add_u32 v229, 49152, v229
    v_add_u32 v230, 49152, v230
    v_add_u32 v231, 49152, v231
    v_add_u32 v232, 49152, v232
    v_add_u32 v233, 49152, v233
    v_add_u32 v234, 49152, v234
    v_add_u32 v235, 49152, v235
    v_add_u32 v236, 49152, v236
    v_add_u32 v237, 49152, v237
    ds_read_b128 v[164:167], v236 offset:0
    ds_read_b128 v[168:171], v236 offset:2048
    ds_read_b128 v[172:175], v236 offset:4096
    ds_read_b128 v[176:179], v236 offset:6144
    ds_read_b64_tr_b16 v[132:133], v228 offset:16384
    ds_read_b64_tr_b16 v[134:135], v228 offset:17408
    ds_read_b64_tr_b16 v[136:137], v229 offset:16384
    ds_read_b64_tr_b16 v[138:139], v229 offset:17408
    ds_read_b64_tr_b16 v[140:141], v230 offset:16384
    ds_read_b64_tr_b16 v[142:143], v230 offset:17408
    ds_read_b64_tr_b16 v[144:145], v231 offset:16384
    ds_read_b64_tr_b16 v[146:147], v231 offset:17408
    ds_read_b64_tr_b16 v[148:149], v232 offset:32768
    ds_read_b64_tr_b16 v[150:151], v232 offset:33792
    ds_read_b64_tr_b16 v[152:153], v233 offset:32768
    ds_read_b64_tr_b16 v[154:155], v233 offset:33792
    ds_read_b64_tr_b16 v[156:157], v234 offset:32768
    ds_read_b64_tr_b16 v[158:159], v234 offset:33792
    ds_read_b64_tr_b16 v[160:161], v235 offset:32768
    ds_read_b64_tr_b16 v[162:163], v235 offset:33792
    s_waitcnt lgkmcnt(0)
    v_mfma_f32_16x16x32_bf16 v[4:7], v[132:135], v[164:167], v[4:7]
    v_mfma_f32_16x16x32_bf16 v[8:11], v[132:135], v[168:171], v[8:11]
    ds_read_b128 v[212:215], v237 offset:0
    v_mfma_f32_16x16x32_bf16 v[12:15], v[132:135], v[172:175], v[12:15]
    v_mfma_f32_16x16x32_bf16 v[16:19], v[132:135], v[176:179], v[16:19]
    ds_read_b128 v[216:219], v237 offset:2048
    v_mfma_f32_16x16x32_bf16 v[20:23], v[136:139], v[164:167], v[20:23]
    ds_read_b128 v[220:223], v237 offset:4096
    v_mfma_f32_16x16x32_bf16 v[24:27], v[136:139], v[168:171], v[24:27]
    v_mfma_f32_16x16x32_bf16 v[28:31], v[136:139], v[172:175], v[28:31]
    ds_read_b128 v[224:227], v237 offset:6144
    v_mfma_f32_16x16x32_bf16 v[32:35], v[136:139], v[176:179], v[32:35]
    ds_read_b64_tr_b16 v[180:181], v228 offset:24576
    v_mfma_f32_16x16x32_bf16 v[36:39], v[140:143], v[164:167], v[36:39]
    v_mfma_f32_16x16x32_bf16 v[40:43], v[140:143], v[168:171], v[40:43]
    ds_read_b64_tr_b16 v[182:183], v228 offset:25600
    v_mfma_f32_16x16x32_bf16 v[44:47], v[140:143], v[172:175], v[44:47]
    v_mfma_f32_16x16x32_bf16 v[48:51], v[140:143], v[176:179], v[48:51]
    ds_read_b64_tr_b16 v[184:185], v229 offset:24576
    v_mfma_f32_16x16x32_bf16 v[52:55], v[144:147], v[164:167], v[52:55]
    ds_read_b64_tr_b16 v[186:187], v229 offset:25600
    v_mfma_f32_16x16x32_bf16 v[56:59], v[144:147], v[168:171], v[56:59]
    v_mfma_f32_16x16x32_bf16 v[60:63], v[144:147], v[172:175], v[60:63]
    ds_read_b64_tr_b16 v[188:189], v230 offset:24576
    v_mfma_f32_16x16x32_bf16 v[64:67], v[144:147], v[176:179], v[64:67]
    ds_read_b64_tr_b16 v[190:191], v230 offset:25600
    v_mfma_f32_16x16x32_bf16 v[68:71], v[148:151], v[164:167], v[68:71]
    v_mfma_f32_16x16x32_bf16 v[72:75], v[148:151], v[168:171], v[72:75]
    ds_read_b64_tr_b16 v[192:193], v231 offset:24576
    v_mfma_f32_16x16x32_bf16 v[76:79], v[148:151], v[172:175], v[76:79]
    v_mfma_f32_16x16x32_bf16 v[80:83], v[148:151], v[176:179], v[80:83]
    ds_read_b64_tr_b16 v[194:195], v231 offset:25600
    v_mfma_f32_16x16x32_bf16 v[84:87], v[152:155], v[164:167], v[84:87]
    ds_read_b64_tr_b16 v[196:197], v232 offset:40960
    v_mfma_f32_16x16x32_bf16 v[88:91], v[152:155], v[168:171], v[88:91]
    v_mfma_f32_16x16x32_bf16 v[92:95], v[152:155], v[172:175], v[92:95]
    ds_read_b64_tr_b16 v[198:199], v232 offset:41984
    v_mfma_f32_16x16x32_bf16 v[96:99], v[152:155], v[176:179], v[96:99]
    ds_read_b64_tr_b16 v[200:201], v233 offset:40960
    v_mfma_f32_16x16x32_bf16 v[100:103], v[156:159], v[164:167], v[100:103]
    v_mfma_f32_16x16x32_bf16 v[104:107], v[156:159], v[168:171], v[104:107]
    ds_read_b64_tr_b16 v[202:203], v233 offset:41984
    v_mfma_f32_16x16x32_bf16 v[108:111], v[156:159], v[172:175], v[108:111]
    v_mfma_f32_16x16x32_bf16 v[112:115], v[156:159], v[176:179], v[112:115]
    ds_read_b64_tr_b16 v[204:205], v234 offset:40960
    v_mfma_f32_16x16x32_bf16 v[116:119], v[160:163], v[164:167], v[116:119]
    ds_read_b64_tr_b16 v[206:207], v234 offset:41984
    v_mfma_f32_16x16x32_bf16 v[120:123], v[160:163], v[168:171], v[120:123]
    v_mfma_f32_16x16x32_bf16 v[124:127], v[160:163], v[172:175], v[124:127]
    ds_read_b64_tr_b16 v[208:209], v235 offset:40960
    v_mfma_f32_16x16x32_bf16 v[128:131], v[160:163], v[176:179], v[128:131]
    ds_read_b64_tr_b16 v[210:211], v235 offset:41984
    s_waitcnt lgkmcnt(0)
    v_mfma_f32_16x16x32_bf16 v[4:7], v[180:183], v[212:215], v[4:7]
    v_mfma_f32_16x16x32_bf16 v[8:11], v[180:183], v[216:219], v[8:11]
    v_mfma_f32_16x16x32_bf16 v[12:15], v[180:183], v[220:223], v[12:15]
    v_mfma_f32_16x16x32_bf16 v[16:19], v[180:183], v[224:227], v[16:19]
    v_mfma_f32_16x16x32_bf16 v[20:23], v[184:187], v[212:215], v[20:23]
    v_mfma_f32_16x16x32_bf16 v[24:27], v[184:187], v[216:219], v[24:27]
    v_mfma_f32_16x16x32_bf16 v[28:31], v[184:187], v[220:223], v[28:31]
    v_mfma_f32_16x16x32_bf16 v[32:35], v[184:187], v[224:227], v[32:35]
    v_mfma_f32_16x16x32_bf16 v[36:39], v[188:191], v[212:215], v[36:39]
    v_mfma_f32_16x16x32_bf16 v[40:43], v[188:191], v[216:219], v[40:43]
    v_mfma_f32_16x16x32_bf16 v[44:47], v[188:191], v[220:223], v[44:47]
    v_mfma_f32_16x16x32_bf16 v[48:51], v[188:191], v[224:227], v[48:51]
    v_mfma_f32_16x16x32_bf16 v[52:55], v[192:195], v[212:215], v[52:55]
    v_mfma_f32_16x16x32_bf16 v[56:59], v[192:195], v[216:219], v[56:59]
    v_mfma_f32_16x16x32_bf16 v[60:63], v[192:195], v[220:223], v[60:63]
    v_mfma_f32_16x16x32_bf16 v[64:67], v[192:195], v[224:227], v[64:67]
    v_mfma_f32_16x16x32_bf16 v[68:71], v[196:199], v[212:215], v[68:71]
    v_mfma_f32_16x16x32_bf16 v[72:75], v[196:199], v[216:219], v[72:75]
    v_mfma_f32_16x16x32_bf16 v[76:79], v[196:199], v[220:223], v[76:79]
    v_mfma_f32_16x16x32_bf16 v[80:83], v[196:199], v[224:227], v[80:83]
    v_mfma_f32_16x16x32_bf16 v[84:87], v[200:203], v[212:215], v[84:87]
    v_mfma_f32_16x16x32_bf16 v[88:91], v[200:203], v[216:219], v[88:91]
    v_mfma_f32_16x16x32_bf16 v[92:95], v[200:203], v[220:223], v[92:95]
    v_mfma_f32_16x16x32_bf16 v[96:99], v[200:203], v[224:227], v[96:99]
    v_mfma_f32_16x16x32_bf16 v[100:103], v[204:207], v[212:215], v[100:103]
    v_mfma_f32_16x16x32_bf16 v[104:107], v[204:207], v[216:219], v[104:107]
    v_mfma_f32_16x16x32_bf16 v[108:111], v[204:207], v[220:223], v[108:111]
    v_mfma_f32_16x16x32_bf16 v[112:115], v[204:207], v[224:227], v[112:115]
    v_mfma_f32_16x16x32_bf16 v[116:119], v[208:211], v[212:215], v[116:119]
    v_mfma_f32_16x16x32_bf16 v[120:123], v[208:211], v[216:219], v[120:123]
    v_mfma_f32_16x16x32_bf16 v[124:127], v[208:211], v[220:223], v[124:127]
    v_mfma_f32_16x16x32_bf16 v[128:131], v[208:211], v[224:227], v[128:131]
    s_waitcnt vmcnt(0)
    s_barrier
    s_nop 7
    s_nop 7
    v_and_b32 v249, 15, v250
    s_lshl_b32 s55, s45, 7
    s_lshl_b32 s56, s43, 6
    s_add_u32 s55, s55, s56
    v_add_u32 v249, s55, v249
    s_movk_i32 s56, 9216
    v_mul_lo_u32 v249, v249, s56
    v_lshrrev_b32 v248, 4, v250
    v_lshlrev_b32 v248, 3, v248
    v_add_u32 v249, v249, v248
    s_lshl_b32 s55, s44, 8
    s_lshl_b32 s56, s42, 7
    s_add_u32 s55, s55, s56
    v_add_u32 v249, s55, v249
    v_cvt_pk_bf16_f32 v137, v4, v4
    v_lshlrev_b32 v136, 16, v137
    v_mul_f32 v137, 0xbfb8aa3b, v136
    v_exp_f32 v137, v137
    s_nop 0
    v_add_f32 v137, 1.0, v137
    v_rcp_f32 v136, v137
    s_nop 0
    v_cvt_pk_bf16_f32 v137, v136, v136
    v_lshlrev_b32 v136, 16, v137
    v_cvt_pk_bf16_f32 v137, v68, v68
    v_lshlrev_b32 v138, 16, v137
    v_mul_f32 v140, v136, v138
    v_cvt_pk_bf16_f32 v137, v5, v5
    v_lshlrev_b32 v136, 16, v137
    v_mul_f32 v137, 0xbfb8aa3b, v136
    v_exp_f32 v137, v137
    s_nop 0
    v_add_f32 v137, 1.0, v137
    v_rcp_f32 v136, v137
    s_nop 0
    v_cvt_pk_bf16_f32 v137, v136, v136
    v_lshlrev_b32 v136, 16, v137
    v_cvt_pk_bf16_f32 v137, v69, v69
    v_lshlrev_b32 v138, 16, v137
    v_mul_f32 v141, v136, v138
    v_cvt_pk_bf16_f32 v137, v6, v6
    v_lshlrev_b32 v136, 16, v137
    v_mul_f32 v137, 0xbfb8aa3b, v136
    v_exp_f32 v137, v137
    s_nop 0
    v_add_f32 v137, 1.0, v137
    v_rcp_f32 v136, v137
    s_nop 0
    v_cvt_pk_bf16_f32 v137, v136, v136
    v_lshlrev_b32 v136, 16, v137
    v_cvt_pk_bf16_f32 v137, v70, v70
    v_lshlrev_b32 v138, 16, v137
    v_mul_f32 v142, v136, v138
    v_cvt_pk_bf16_f32 v137, v7, v7
    v_lshlrev_b32 v136, 16, v137
    v_mul_f32 v137, 0xbfb8aa3b, v136
    v_exp_f32 v137, v137
    s_nop 0
    v_add_f32 v137, 1.0, v137
    v_rcp_f32 v136, v137
    s_nop 0
    v_cvt_pk_bf16_f32 v137, v136, v136
    v_lshlrev_b32 v136, 16, v137
    v_cvt_pk_bf16_f32 v137, v71, v71
    v_lshlrev_b32 v138, 16, v137
    v_mul_f32 v143, v136, v138
    v_cvt_pk_bf16_f32 v132, v140, v141
    v_cvt_pk_bf16_f32 v133, v142, v143
    s_mov_b32 s55, 0
    buffer_store_dwordx2 v[132:133], v249, s[28:31], s55 offen offset:0
    s_nop 1
    v_cvt_pk_bf16_f32 v137, v8, v8
    v_lshlrev_b32 v136, 16, v137
    v_mul_f32 v137, 0xbfb8aa3b, v136
    v_exp_f32 v137, v137
    s_nop 0
    v_add_f32 v137, 1.0, v137
    v_rcp_f32 v136, v137
    s_nop 0
    v_cvt_pk_bf16_f32 v137, v136, v136
    v_lshlrev_b32 v136, 16, v137
    v_cvt_pk_bf16_f32 v137, v72, v72
    v_lshlrev_b32 v138, 16, v137
    v_mul_f32 v140, v136, v138
    v_cvt_pk_bf16_f32 v137, v9, v9
    v_lshlrev_b32 v136, 16, v137
    v_mul_f32 v137, 0xbfb8aa3b, v136
    v_exp_f32 v137, v137
    s_nop 0
    v_add_f32 v137, 1.0, v137
    v_rcp_f32 v136, v137
    s_nop 0
    v_cvt_pk_bf16_f32 v137, v136, v136
    v_lshlrev_b32 v136, 16, v137
    v_cvt_pk_bf16_f32 v137, v73, v73
    v_lshlrev_b32 v138, 16, v137
    v_mul_f32 v141, v136, v138
    v_cvt_pk_bf16_f32 v137, v10, v10
    v_lshlrev_b32 v136, 16, v137
    v_mul_f32 v137, 0xbfb8aa3b, v136
    v_exp_f32 v137, v137
    s_nop 0
    v_add_f32 v137, 1.0, v137
    v_rcp_f32 v136, v137
    s_nop 0
    v_cvt_pk_bf16_f32 v137, v136, v136
    v_lshlrev_b32 v136, 16, v137
    v_cvt_pk_bf16_f32 v137, v74, v74
    v_lshlrev_b32 v138, 16, v137
    v_mul_f32 v142, v136, v138
    v_cvt_pk_bf16_f32 v137, v11, v11
    v_lshlrev_b32 v136, 16, v137
    v_mul_f32 v137, 0xbfb8aa3b, v136
    v_exp_f32 v137, v137
    s_nop 0
    v_add_f32 v137, 1.0, v137
    v_rcp_f32 v136, v137
    s_nop 0
    v_cvt_pk_bf16_f32 v137, v136, v136
    v_lshlrev_b32 v136, 16, v137
    v_cvt_pk_bf16_f32 v137, v75, v75
    v_lshlrev_b32 v138, 16, v137
    v_mul_f32 v143, v136, v138
    v_cvt_pk_bf16_f32 v132, v140, v141
    v_cvt_pk_bf16_f32 v133, v142, v143
    s_mov_b32 s55, 147456
    buffer_store_dwordx2 v[132:133], v249, s[28:31], s55 offen offset:0
    s_nop 1
    v_cvt_pk_bf16_f32 v137, v12, v12
    v_lshlrev_b32 v136, 16, v137
    v_mul_f32 v137, 0xbfb8aa3b, v136
    v_exp_f32 v137, v137
    s_nop 0
    v_add_f32 v137, 1.0, v137
    v_rcp_f32 v136, v137
    s_nop 0
    v_cvt_pk_bf16_f32 v137, v136, v136
    v_lshlrev_b32 v136, 16, v137
    v_cvt_pk_bf16_f32 v137, v76, v76
    v_lshlrev_b32 v138, 16, v137
    v_mul_f32 v140, v136, v138
    v_cvt_pk_bf16_f32 v137, v13, v13
    v_lshlrev_b32 v136, 16, v137
    v_mul_f32 v137, 0xbfb8aa3b, v136
    v_exp_f32 v137, v137
    s_nop 0
    v_add_f32 v137, 1.0, v137
    v_rcp_f32 v136, v137
    s_nop 0
    v_cvt_pk_bf16_f32 v137, v136, v136
    v_lshlrev_b32 v136, 16, v137
    v_cvt_pk_bf16_f32 v137, v77, v77
    v_lshlrev_b32 v138, 16, v137
    v_mul_f32 v141, v136, v138
    v_cvt_pk_bf16_f32 v137, v14, v14
    v_lshlrev_b32 v136, 16, v137
    v_mul_f32 v137, 0xbfb8aa3b, v136
    v_exp_f32 v137, v137
    s_nop 0
    v_add_f32 v137, 1.0, v137
    v_rcp_f32 v136, v137
    s_nop 0
    v_cvt_pk_bf16_f32 v137, v136, v136
    v_lshlrev_b32 v136, 16, v137
    v_cvt_pk_bf16_f32 v137, v78, v78
    v_lshlrev_b32 v138, 16, v137
    v_mul_f32 v142, v136, v138
    v_cvt_pk_bf16_f32 v137, v15, v15
    v_lshlrev_b32 v136, 16, v137
    v_mul_f32 v137, 0xbfb8aa3b, v136
    v_exp_f32 v137, v137
    s_nop 0
    v_add_f32 v137, 1.0, v137
    v_rcp_f32 v136, v137
    s_nop 0
    v_cvt_pk_bf16_f32 v137, v136, v136
    v_lshlrev_b32 v136, 16, v137
    v_cvt_pk_bf16_f32 v137, v79, v79
    v_lshlrev_b32 v138, 16, v137
    v_mul_f32 v143, v136, v138
    v_cvt_pk_bf16_f32 v132, v140, v141
    v_cvt_pk_bf16_f32 v133, v142, v143
    s_mov_b32 s55, 294912
    buffer_store_dwordx2 v[132:133], v249, s[28:31], s55 offen offset:0
    s_nop 1
    v_cvt_pk_bf16_f32 v137, v16, v16
    v_lshlrev_b32 v136, 16, v137
    v_mul_f32 v137, 0xbfb8aa3b, v136
    v_exp_f32 v137, v137
    s_nop 0
    v_add_f32 v137, 1.0, v137
    v_rcp_f32 v136, v137
    s_nop 0
    v_cvt_pk_bf16_f32 v137, v136, v136
    v_lshlrev_b32 v136, 16, v137
    v_cvt_pk_bf16_f32 v137, v80, v80
    v_lshlrev_b32 v138, 16, v137
    v_mul_f32 v140, v136, v138
    v_cvt_pk_bf16_f32 v137, v17, v17
    v_lshlrev_b32 v136, 16, v137
    v_mul_f32 v137, 0xbfb8aa3b, v136
    v_exp_f32 v137, v137
    s_nop 0
    v_add_f32 v137, 1.0, v137
    v_rcp_f32 v136, v137
    s_nop 0
    v_cvt_pk_bf16_f32 v137, v136, v136
    v_lshlrev_b32 v136, 16, v137
    v_cvt_pk_bf16_f32 v137, v81, v81
    v_lshlrev_b32 v138, 16, v137
    v_mul_f32 v141, v136, v138
    v_cvt_pk_bf16_f32 v137, v18, v18
    v_lshlrev_b32 v136, 16, v137
    v_mul_f32 v137, 0xbfb8aa3b, v136
    v_exp_f32 v137, v137
    s_nop 0
    v_add_f32 v137, 1.0, v137
    v_rcp_f32 v136, v137
    s_nop 0
    v_cvt_pk_bf16_f32 v137, v136, v136
    v_lshlrev_b32 v136, 16, v137
    v_cvt_pk_bf16_f32 v137, v82, v82
    v_lshlrev_b32 v138, 16, v137
    v_mul_f32 v142, v136, v138
    v_cvt_pk_bf16_f32 v137, v19, v19
    v_lshlrev_b32 v136, 16, v137
    v_mul_f32 v137, 0xbfb8aa3b, v136
    v_exp_f32 v137, v137
    s_nop 0
    v_add_f32 v137, 1.0, v137
    v_rcp_f32 v136, v137
    s_nop 0
    v_cvt_pk_bf16_f32 v137, v136, v136
    v_lshlrev_b32 v136, 16, v137
    v_cvt_pk_bf16_f32 v137, v83, v83
    v_lshlrev_b32 v138, 16, v137
    v_mul_f32 v143, v136, v138
    v_cvt_pk_bf16_f32 v132, v140, v141
    v_cvt_pk_bf16_f32 v133, v142, v143
    s_mov_b32 s55, 442368
    buffer_store_dwordx2 v[132:133], v249, s[28:31], s55 offen offset:0
    s_nop 1
    v_cvt_pk_bf16_f32 v137, v20, v20
    v_lshlrev_b32 v136, 16, v137
    v_mul_f32 v137, 0xbfb8aa3b, v136
    v_exp_f32 v137, v137
    s_nop 0
    v_add_f32 v137, 1.0, v137
    v_rcp_f32 v136, v137
    s_nop 0
    v_cvt_pk_bf16_f32 v137, v136, v136
    v_lshlrev_b32 v136, 16, v137
    v_cvt_pk_bf16_f32 v137, v84, v84
    v_lshlrev_b32 v138, 16, v137
    v_mul_f32 v140, v136, v138
    v_cvt_pk_bf16_f32 v137, v21, v21
    v_lshlrev_b32 v136, 16, v137
    v_mul_f32 v137, 0xbfb8aa3b, v136
    v_exp_f32 v137, v137
    s_nop 0
    v_add_f32 v137, 1.0, v137
    v_rcp_f32 v136, v137
    s_nop 0
    v_cvt_pk_bf16_f32 v137, v136, v136
    v_lshlrev_b32 v136, 16, v137
    v_cvt_pk_bf16_f32 v137, v85, v85
    v_lshlrev_b32 v138, 16, v137
    v_mul_f32 v141, v136, v138
    v_cvt_pk_bf16_f32 v137, v22, v22
    v_lshlrev_b32 v136, 16, v137
    v_mul_f32 v137, 0xbfb8aa3b, v136
    v_exp_f32 v137, v137
    s_nop 0
    v_add_f32 v137, 1.0, v137
    v_rcp_f32 v136, v137
    s_nop 0
    v_cvt_pk_bf16_f32 v137, v136, v136
    v_lshlrev_b32 v136, 16, v137
    v_cvt_pk_bf16_f32 v137, v86, v86
    v_lshlrev_b32 v138, 16, v137
    v_mul_f32 v142, v136, v138
    v_cvt_pk_bf16_f32 v137, v23, v23
    v_lshlrev_b32 v136, 16, v137
    v_mul_f32 v137, 0xbfb8aa3b, v136
    v_exp_f32 v137, v137
    s_nop 0
    v_add_f32 v137, 1.0, v137
    v_rcp_f32 v136, v137
    s_nop 0
    v_cvt_pk_bf16_f32 v137, v136, v136
    v_lshlrev_b32 v136, 16, v137
    v_cvt_pk_bf16_f32 v137, v87, v87
    v_lshlrev_b32 v138, 16, v137
    v_mul_f32 v143, v136, v138
    v_cvt_pk_bf16_f32 v132, v140, v141
    v_cvt_pk_bf16_f32 v133, v142, v143
    s_mov_b32 s55, 0
    buffer_store_dwordx2 v[132:133], v249, s[28:31], s55 offen offset:32
    s_nop 1
    v_cvt_pk_bf16_f32 v137, v24, v24
    v_lshlrev_b32 v136, 16, v137
    v_mul_f32 v137, 0xbfb8aa3b, v136
    v_exp_f32 v137, v137
    s_nop 0
    v_add_f32 v137, 1.0, v137
    v_rcp_f32 v136, v137
    s_nop 0
    v_cvt_pk_bf16_f32 v137, v136, v136
    v_lshlrev_b32 v136, 16, v137
    v_cvt_pk_bf16_f32 v137, v88, v88
    v_lshlrev_b32 v138, 16, v137
    v_mul_f32 v140, v136, v138
    v_cvt_pk_bf16_f32 v137, v25, v25
    v_lshlrev_b32 v136, 16, v137
    v_mul_f32 v137, 0xbfb8aa3b, v136
    v_exp_f32 v137, v137
    s_nop 0
    v_add_f32 v137, 1.0, v137
    v_rcp_f32 v136, v137
    s_nop 0
    v_cvt_pk_bf16_f32 v137, v136, v136
    v_lshlrev_b32 v136, 16, v137
    v_cvt_pk_bf16_f32 v137, v89, v89
    v_lshlrev_b32 v138, 16, v137
    v_mul_f32 v141, v136, v138
    v_cvt_pk_bf16_f32 v137, v26, v26
    v_lshlrev_b32 v136, 16, v137
    v_mul_f32 v137, 0xbfb8aa3b, v136
    v_exp_f32 v137, v137
    s_nop 0
    v_add_f32 v137, 1.0, v137
    v_rcp_f32 v136, v137
    s_nop 0
    v_cvt_pk_bf16_f32 v137, v136, v136
    v_lshlrev_b32 v136, 16, v137
    v_cvt_pk_bf16_f32 v137, v90, v90
    v_lshlrev_b32 v138, 16, v137
    v_mul_f32 v142, v136, v138
    v_cvt_pk_bf16_f32 v137, v27, v27
    v_lshlrev_b32 v136, 16, v137
    v_mul_f32 v137, 0xbfb8aa3b, v136
    v_exp_f32 v137, v137
    s_nop 0
    v_add_f32 v137, 1.0, v137
    v_rcp_f32 v136, v137
    s_nop 0
    v_cvt_pk_bf16_f32 v137, v136, v136
    v_lshlrev_b32 v136, 16, v137
    v_cvt_pk_bf16_f32 v137, v91, v91
    v_lshlrev_b32 v138, 16, v137
    v_mul_f32 v143, v136, v138
    v_cvt_pk_bf16_f32 v132, v140, v141
    v_cvt_pk_bf16_f32 v133, v142, v143
    s_mov_b32 s55, 147456
    buffer_store_dwordx2 v[132:133], v249, s[28:31], s55 offen offset:32
    s_nop 1
    v_cvt_pk_bf16_f32 v137, v28, v28
    v_lshlrev_b32 v136, 16, v137
    v_mul_f32 v137, 0xbfb8aa3b, v136
    v_exp_f32 v137, v137
    s_nop 0
    v_add_f32 v137, 1.0, v137
    v_rcp_f32 v136, v137
    s_nop 0
    v_cvt_pk_bf16_f32 v137, v136, v136
    v_lshlrev_b32 v136, 16, v137
    v_cvt_pk_bf16_f32 v137, v92, v92
    v_lshlrev_b32 v138, 16, v137
    v_mul_f32 v140, v136, v138
    v_cvt_pk_bf16_f32 v137, v29, v29
    v_lshlrev_b32 v136, 16, v137
    v_mul_f32 v137, 0xbfb8aa3b, v136
    v_exp_f32 v137, v137
    s_nop 0
    v_add_f32 v137, 1.0, v137
    v_rcp_f32 v136, v137
    s_nop 0
    v_cvt_pk_bf16_f32 v137, v136, v136
    v_lshlrev_b32 v136, 16, v137
    v_cvt_pk_bf16_f32 v137, v93, v93
    v_lshlrev_b32 v138, 16, v137
    v_mul_f32 v141, v136, v138
    v_cvt_pk_bf16_f32 v137, v30, v30
    v_lshlrev_b32 v136, 16, v137
    v_mul_f32 v137, 0xbfb8aa3b, v136
    v_exp_f32 v137, v137
    s_nop 0
    v_add_f32 v137, 1.0, v137
    v_rcp_f32 v136, v137
    s_nop 0
    v_cvt_pk_bf16_f32 v137, v136, v136
    v_lshlrev_b32 v136, 16, v137
    v_cvt_pk_bf16_f32 v137, v94, v94
    v_lshlrev_b32 v138, 16, v137
    v_mul_f32 v142, v136, v138
    v_cvt_pk_bf16_f32 v137, v31, v31
    v_lshlrev_b32 v136, 16, v137
    v_mul_f32 v137, 0xbfb8aa3b, v136
    v_exp_f32 v137, v137
    s_nop 0
    v_add_f32 v137, 1.0, v137
    v_rcp_f32 v136, v137
    s_nop 0
    v_cvt_pk_bf16_f32 v137, v136, v136
    v_lshlrev_b32 v136, 16, v137
    v_cvt_pk_bf16_f32 v137, v95, v95
    v_lshlrev_b32 v138, 16, v137
    v_mul_f32 v143, v136, v138
    v_cvt_pk_bf16_f32 v132, v140, v141
    v_cvt_pk_bf16_f32 v133, v142, v143
    s_mov_b32 s55, 294912
    buffer_store_dwordx2 v[132:133], v249, s[28:31], s55 offen offset:32
    s_nop 1
    v_cvt_pk_bf16_f32 v137, v32, v32
    v_lshlrev_b32 v136, 16, v137
    v_mul_f32 v137, 0xbfb8aa3b, v136
    v_exp_f32 v137, v137
    s_nop 0
    v_add_f32 v137, 1.0, v137
    v_rcp_f32 v136, v137
    s_nop 0
    v_cvt_pk_bf16_f32 v137, v136, v136
    v_lshlrev_b32 v136, 16, v137
    v_cvt_pk_bf16_f32 v137, v96, v96
    v_lshlrev_b32 v138, 16, v137
    v_mul_f32 v140, v136, v138
    v_cvt_pk_bf16_f32 v137, v33, v33
    v_lshlrev_b32 v136, 16, v137
    v_mul_f32 v137, 0xbfb8aa3b, v136
    v_exp_f32 v137, v137
    s_nop 0
    v_add_f32 v137, 1.0, v137
    v_rcp_f32 v136, v137
    s_nop 0
    v_cvt_pk_bf16_f32 v137, v136, v136
    v_lshlrev_b32 v136, 16, v137
    v_cvt_pk_bf16_f32 v137, v97, v97
    v_lshlrev_b32 v138, 16, v137
    v_mul_f32 v141, v136, v138
    v_cvt_pk_bf16_f32 v137, v34, v34
    v_lshlrev_b32 v136, 16, v137
    v_mul_f32 v137, 0xbfb8aa3b, v136
    v_exp_f32 v137, v137
    s_nop 0
    v_add_f32 v137, 1.0, v137
    v_rcp_f32 v136, v137
    s_nop 0
    v_cvt_pk_bf16_f32 v137, v136, v136
    v_lshlrev_b32 v136, 16, v137
    v_cvt_pk_bf16_f32 v137, v98, v98
    v_lshlrev_b32 v138, 16, v137
    v_mul_f32 v142, v136, v138
    v_cvt_pk_bf16_f32 v137, v35, v35
    v_lshlrev_b32 v136, 16, v137
    v_mul_f32 v137, 0xbfb8aa3b, v136
    v_exp_f32 v137, v137
    s_nop 0
    v_add_f32 v137, 1.0, v137
    v_rcp_f32 v136, v137
    s_nop 0
    v_cvt_pk_bf16_f32 v137, v136, v136
    v_lshlrev_b32 v136, 16, v137
    v_cvt_pk_bf16_f32 v137, v99, v99
    v_lshlrev_b32 v138, 16, v137
    v_mul_f32 v143, v136, v138
    v_cvt_pk_bf16_f32 v132, v140, v141
    v_cvt_pk_bf16_f32 v133, v142, v143
    s_mov_b32 s55, 442368
    buffer_store_dwordx2 v[132:133], v249, s[28:31], s55 offen offset:32
    s_nop 1
    v_cvt_pk_bf16_f32 v137, v36, v36
    v_lshlrev_b32 v136, 16, v137
    v_mul_f32 v137, 0xbfb8aa3b, v136
    v_exp_f32 v137, v137
    s_nop 0
    v_add_f32 v137, 1.0, v137
    v_rcp_f32 v136, v137
    s_nop 0
    v_cvt_pk_bf16_f32 v137, v136, v136
    v_lshlrev_b32 v136, 16, v137
    v_cvt_pk_bf16_f32 v137, v100, v100
    v_lshlrev_b32 v138, 16, v137
    v_mul_f32 v140, v136, v138
    v_cvt_pk_bf16_f32 v137, v37, v37
    v_lshlrev_b32 v136, 16, v137
    v_mul_f32 v137, 0xbfb8aa3b, v136
    v_exp_f32 v137, v137
    s_nop 0
    v_add_f32 v137, 1.0, v137
    v_rcp_f32 v136, v137
    s_nop 0
    v_cvt_pk_bf16_f32 v137, v136, v136
    v_lshlrev_b32 v136, 16, v137
    v_cvt_pk_bf16_f32 v137, v101, v101
    v_lshlrev_b32 v138, 16, v137
    v_mul_f32 v141, v136, v138
    v_cvt_pk_bf16_f32 v137, v38, v38
    v_lshlrev_b32 v136, 16, v137
    v_mul_f32 v137, 0xbfb8aa3b, v136
    v_exp_f32 v137, v137
    s_nop 0
    v_add_f32 v137, 1.0, v137
    v_rcp_f32 v136, v137
    s_nop 0
    v_cvt_pk_bf16_f32 v137, v136, v136
    v_lshlrev_b32 v136, 16, v137
    v_cvt_pk_bf16_f32 v137, v102, v102
    v_lshlrev_b32 v138, 16, v137
    v_mul_f32 v142, v136, v138
    v_cvt_pk_bf16_f32 v137, v39, v39
    v_lshlrev_b32 v136, 16, v137
    v_mul_f32 v137, 0xbfb8aa3b, v136
    v_exp_f32 v137, v137
    s_nop 0
    v_add_f32 v137, 1.0, v137
    v_rcp_f32 v136, v137
    s_nop 0
    v_cvt_pk_bf16_f32 v137, v136, v136
    v_lshlrev_b32 v136, 16, v137
    v_cvt_pk_bf16_f32 v137, v103, v103
    v_lshlrev_b32 v138, 16, v137
    v_mul_f32 v143, v136, v138
    v_cvt_pk_bf16_f32 v132, v140, v141
    v_cvt_pk_bf16_f32 v133, v142, v143
    s_mov_b32 s55, 0
    buffer_store_dwordx2 v[132:133], v249, s[28:31], s55 offen offset:64
    s_nop 1
    v_cvt_pk_bf16_f32 v137, v40, v40
    v_lshlrev_b32 v136, 16, v137
    v_mul_f32 v137, 0xbfb8aa3b, v136
    v_exp_f32 v137, v137
    s_nop 0
    v_add_f32 v137, 1.0, v137
    v_rcp_f32 v136, v137
    s_nop 0
    v_cvt_pk_bf16_f32 v137, v136, v136
    v_lshlrev_b32 v136, 16, v137
    v_cvt_pk_bf16_f32 v137, v104, v104
    v_lshlrev_b32 v138, 16, v137
    v_mul_f32 v140, v136, v138
    v_cvt_pk_bf16_f32 v137, v41, v41
    v_lshlrev_b32 v136, 16, v137
    v_mul_f32 v137, 0xbfb8aa3b, v136
    v_exp_f32 v137, v137
    s_nop 0
    v_add_f32 v137, 1.0, v137
    v_rcp_f32 v136, v137
    s_nop 0
    v_cvt_pk_bf16_f32 v137, v136, v136
    v_lshlrev_b32 v136, 16, v137
    v_cvt_pk_bf16_f32 v137, v105, v105
    v_lshlrev_b32 v138, 16, v137
    v_mul_f32 v141, v136, v138
    v_cvt_pk_bf16_f32 v137, v42, v42
    v_lshlrev_b32 v136, 16, v137
    v_mul_f32 v137, 0xbfb8aa3b, v136
    v_exp_f32 v137, v137
    s_nop 0
    v_add_f32 v137, 1.0, v137
    v_rcp_f32 v136, v137
    s_nop 0
    v_cvt_pk_bf16_f32 v137, v136, v136
    v_lshlrev_b32 v136, 16, v137
    v_cvt_pk_bf16_f32 v137, v106, v106
    v_lshlrev_b32 v138, 16, v137
    v_mul_f32 v142, v136, v138
    v_cvt_pk_bf16_f32 v137, v43, v43
    v_lshlrev_b32 v136, 16, v137
    v_mul_f32 v137, 0xbfb8aa3b, v136
    v_exp_f32 v137, v137
    s_nop 0
    v_add_f32 v137, 1.0, v137
    v_rcp_f32 v136, v137
    s_nop 0
    v_cvt_pk_bf16_f32 v137, v136, v136
    v_lshlrev_b32 v136, 16, v137
    v_cvt_pk_bf16_f32 v137, v107, v107
    v_lshlrev_b32 v138, 16, v137
    v_mul_f32 v143, v136, v138
    v_cvt_pk_bf16_f32 v132, v140, v141
    v_cvt_pk_bf16_f32 v133, v142, v143
    s_mov_b32 s55, 147456
    buffer_store_dwordx2 v[132:133], v249, s[28:31], s55 offen offset:64
    s_nop 1
    v_cvt_pk_bf16_f32 v137, v44, v44
    v_lshlrev_b32 v136, 16, v137
    v_mul_f32 v137, 0xbfb8aa3b, v136
    v_exp_f32 v137, v137
    s_nop 0
    v_add_f32 v137, 1.0, v137
    v_rcp_f32 v136, v137
    s_nop 0
    v_cvt_pk_bf16_f32 v137, v136, v136
    v_lshlrev_b32 v136, 16, v137
    v_cvt_pk_bf16_f32 v137, v108, v108
    v_lshlrev_b32 v138, 16, v137
    v_mul_f32 v140, v136, v138
    v_cvt_pk_bf16_f32 v137, v45, v45
    v_lshlrev_b32 v136, 16, v137
    v_mul_f32 v137, 0xbfb8aa3b, v136
    v_exp_f32 v137, v137
    s_nop 0
    v_add_f32 v137, 1.0, v137
    v_rcp_f32 v136, v137
    s_nop 0
    v_cvt_pk_bf16_f32 v137, v136, v136
    v_lshlrev_b32 v136, 16, v137
    v_cvt_pk_bf16_f32 v137, v109, v109
    v_lshlrev_b32 v138, 16, v137
    v_mul_f32 v141, v136, v138
    v_cvt_pk_bf16_f32 v137, v46, v46
    v_lshlrev_b32 v136, 16, v137
    v_mul_f32 v137, 0xbfb8aa3b, v136
    v_exp_f32 v137, v137
    s_nop 0
    v_add_f32 v137, 1.0, v137
    v_rcp_f32 v136, v137
    s_nop 0
    v_cvt_pk_bf16_f32 v137, v136, v136
    v_lshlrev_b32 v136, 16, v137
    v_cvt_pk_bf16_f32 v137, v110, v110
    v_lshlrev_b32 v138, 16, v137
    v_mul_f32 v142, v136, v138
    v_cvt_pk_bf16_f32 v137, v47, v47
    v_lshlrev_b32 v136, 16, v137
    v_mul_f32 v137, 0xbfb8aa3b, v136
    v_exp_f32 v137, v137
    s_nop 0
    v_add_f32 v137, 1.0, v137
    v_rcp_f32 v136, v137
    s_nop 0
    v_cvt_pk_bf16_f32 v137, v136, v136
    v_lshlrev_b32 v136, 16, v137
    v_cvt_pk_bf16_f32 v137, v111, v111
    v_lshlrev_b32 v138, 16, v137
    v_mul_f32 v143, v136, v138
    v_cvt_pk_bf16_f32 v132, v140, v141
    v_cvt_pk_bf16_f32 v133, v142, v143
    s_mov_b32 s55, 294912
    buffer_store_dwordx2 v[132:133], v249, s[28:31], s55 offen offset:64
    s_nop 1
    v_cvt_pk_bf16_f32 v137, v48, v48
    v_lshlrev_b32 v136, 16, v137
    v_mul_f32 v137, 0xbfb8aa3b, v136
    v_exp_f32 v137, v137
    s_nop 0
    v_add_f32 v137, 1.0, v137
    v_rcp_f32 v136, v137
    s_nop 0
    v_cvt_pk_bf16_f32 v137, v136, v136
    v_lshlrev_b32 v136, 16, v137
    v_cvt_pk_bf16_f32 v137, v112, v112
    v_lshlrev_b32 v138, 16, v137
    v_mul_f32 v140, v136, v138
    v_cvt_pk_bf16_f32 v137, v49, v49
    v_lshlrev_b32 v136, 16, v137
    v_mul_f32 v137, 0xbfb8aa3b, v136
    v_exp_f32 v137, v137
    s_nop 0
    v_add_f32 v137, 1.0, v137
    v_rcp_f32 v136, v137
    s_nop 0
    v_cvt_pk_bf16_f32 v137, v136, v136
    v_lshlrev_b32 v136, 16, v137
    v_cvt_pk_bf16_f32 v137, v113, v113
    v_lshlrev_b32 v138, 16, v137
    v_mul_f32 v141, v136, v138
    v_cvt_pk_bf16_f32 v137, v50, v50
    v_lshlrev_b32 v136, 16, v137
    v_mul_f32 v137, 0xbfb8aa3b, v136
    v_exp_f32 v137, v137
    s_nop 0
    v_add_f32 v137, 1.0, v137
    v_rcp_f32 v136, v137
    s_nop 0
    v_cvt_pk_bf16_f32 v137, v136, v136
    v_lshlrev_b32 v136, 16, v137
    v_cvt_pk_bf16_f32 v137, v114, v114
    v_lshlrev_b32 v138, 16, v137
    v_mul_f32 v142, v136, v138
    v_cvt_pk_bf16_f32 v137, v51, v51
    v_lshlrev_b32 v136, 16, v137
    v_mul_f32 v137, 0xbfb8aa3b, v136
    v_exp_f32 v137, v137
    s_nop 0
    v_add_f32 v137, 1.0, v137
    v_rcp_f32 v136, v137
    s_nop 0
    v_cvt_pk_bf16_f32 v137, v136, v136
    v_lshlrev_b32 v136, 16, v137
    v_cvt_pk_bf16_f32 v137, v115, v115
    v_lshlrev_b32 v138, 16, v137
    v_mul_f32 v143, v136, v138
    v_cvt_pk_bf16_f32 v132, v140, v141
    v_cvt_pk_bf16_f32 v133, v142, v143
    s_mov_b32 s55, 442368
    buffer_store_dwordx2 v[132:133], v249, s[28:31], s55 offen offset:64
    s_nop 1
    v_cvt_pk_bf16_f32 v137, v52, v52
    v_lshlrev_b32 v136, 16, v137
    v_mul_f32 v137, 0xbfb8aa3b, v136
    v_exp_f32 v137, v137
    s_nop 0
    v_add_f32 v137, 1.0, v137
    v_rcp_f32 v136, v137
    s_nop 0
    v_cvt_pk_bf16_f32 v137, v136, v136
    v_lshlrev_b32 v136, 16, v137
    v_cvt_pk_bf16_f32 v137, v116, v116
    v_lshlrev_b32 v138, 16, v137
    v_mul_f32 v140, v136, v138
    v_cvt_pk_bf16_f32 v137, v53, v53
    v_lshlrev_b32 v136, 16, v137
    v_mul_f32 v137, 0xbfb8aa3b, v136
    v_exp_f32 v137, v137
    s_nop 0
    v_add_f32 v137, 1.0, v137
    v_rcp_f32 v136, v137
    s_nop 0
    v_cvt_pk_bf16_f32 v137, v136, v136
    v_lshlrev_b32 v136, 16, v137
    v_cvt_pk_bf16_f32 v137, v117, v117
    v_lshlrev_b32 v138, 16, v137
    v_mul_f32 v141, v136, v138
    v_cvt_pk_bf16_f32 v137, v54, v54
    v_lshlrev_b32 v136, 16, v137
    v_mul_f32 v137, 0xbfb8aa3b, v136
    v_exp_f32 v137, v137
    s_nop 0
    v_add_f32 v137, 1.0, v137
    v_rcp_f32 v136, v137
    s_nop 0
    v_cvt_pk_bf16_f32 v137, v136, v136
    v_lshlrev_b32 v136, 16, v137
    v_cvt_pk_bf16_f32 v137, v118, v118
    v_lshlrev_b32 v138, 16, v137
    v_mul_f32 v142, v136, v138
    v_cvt_pk_bf16_f32 v137, v55, v55
    v_lshlrev_b32 v136, 16, v137
    v_mul_f32 v137, 0xbfb8aa3b, v136
    v_exp_f32 v137, v137
    s_nop 0
    v_add_f32 v137, 1.0, v137
    v_rcp_f32 v136, v137
    s_nop 0
    v_cvt_pk_bf16_f32 v137, v136, v136
    v_lshlrev_b32 v136, 16, v137
    v_cvt_pk_bf16_f32 v137, v119, v119
    v_lshlrev_b32 v138, 16, v137
    v_mul_f32 v143, v136, v138
    v_cvt_pk_bf16_f32 v132, v140, v141
    v_cvt_pk_bf16_f32 v133, v142, v143
    s_mov_b32 s55, 0
    buffer_store_dwordx2 v[132:133], v249, s[28:31], s55 offen offset:96
    s_nop 1
    v_cvt_pk_bf16_f32 v137, v56, v56
    v_lshlrev_b32 v136, 16, v137
    v_mul_f32 v137, 0xbfb8aa3b, v136
    v_exp_f32 v137, v137
    s_nop 0
    v_add_f32 v137, 1.0, v137
    v_rcp_f32 v136, v137
    s_nop 0
    v_cvt_pk_bf16_f32 v137, v136, v136
    v_lshlrev_b32 v136, 16, v137
    v_cvt_pk_bf16_f32 v137, v120, v120
    v_lshlrev_b32 v138, 16, v137
    v_mul_f32 v140, v136, v138
    v_cvt_pk_bf16_f32 v137, v57, v57
    v_lshlrev_b32 v136, 16, v137
    v_mul_f32 v137, 0xbfb8aa3b, v136
    v_exp_f32 v137, v137
    s_nop 0
    v_add_f32 v137, 1.0, v137
    v_rcp_f32 v136, v137
    s_nop 0
    v_cvt_pk_bf16_f32 v137, v136, v136
    v_lshlrev_b32 v136, 16, v137
    v_cvt_pk_bf16_f32 v137, v121, v121
    v_lshlrev_b32 v138, 16, v137
    v_mul_f32 v141, v136, v138
    v_cvt_pk_bf16_f32 v137, v58, v58
    v_lshlrev_b32 v136, 16, v137
    v_mul_f32 v137, 0xbfb8aa3b, v136
    v_exp_f32 v137, v137
    s_nop 0
    v_add_f32 v137, 1.0, v137
    v_rcp_f32 v136, v137
    s_nop 0
    v_cvt_pk_bf16_f32 v137, v136, v136
    v_lshlrev_b32 v136, 16, v137
    v_cvt_pk_bf16_f32 v137, v122, v122
    v_lshlrev_b32 v138, 16, v137
    v_mul_f32 v142, v136, v138
    v_cvt_pk_bf16_f32 v137, v59, v59
    v_lshlrev_b32 v136, 16, v137
    v_mul_f32 v137, 0xbfb8aa3b, v136
    v_exp_f32 v137, v137
    s_nop 0
    v_add_f32 v137, 1.0, v137
    v_rcp_f32 v136, v137
    s_nop 0
    v_cvt_pk_bf16_f32 v137, v136, v136
    v_lshlrev_b32 v136, 16, v137
    v_cvt_pk_bf16_f32 v137, v123, v123
    v_lshlrev_b32 v138, 16, v137
    v_mul_f32 v143, v136, v138
    v_cvt_pk_bf16_f32 v132, v140, v141
    v_cvt_pk_bf16_f32 v133, v142, v143
    s_mov_b32 s55, 147456
    buffer_store_dwordx2 v[132:133], v249, s[28:31], s55 offen offset:96
    s_nop 1
    v_cvt_pk_bf16_f32 v137, v60, v60
    v_lshlrev_b32 v136, 16, v137
    v_mul_f32 v137, 0xbfb8aa3b, v136
    v_exp_f32 v137, v137
    s_nop 0
    v_add_f32 v137, 1.0, v137
    v_rcp_f32 v136, v137
    s_nop 0
    v_cvt_pk_bf16_f32 v137, v136, v136
    v_lshlrev_b32 v136, 16, v137
    v_cvt_pk_bf16_f32 v137, v124, v124
    v_lshlrev_b32 v138, 16, v137
    v_mul_f32 v140, v136, v138
    v_cvt_pk_bf16_f32 v137, v61, v61
    v_lshlrev_b32 v136, 16, v137
    v_mul_f32 v137, 0xbfb8aa3b, v136
    v_exp_f32 v137, v137
    s_nop 0
    v_add_f32 v137, 1.0, v137
    v_rcp_f32 v136, v137
    s_nop 0
    v_cvt_pk_bf16_f32 v137, v136, v136
    v_lshlrev_b32 v136, 16, v137
    v_cvt_pk_bf16_f32 v137, v125, v125
    v_lshlrev_b32 v138, 16, v137
    v_mul_f32 v141, v136, v138
    v_cvt_pk_bf16_f32 v137, v62, v62
    v_lshlrev_b32 v136, 16, v137
    v_mul_f32 v137, 0xbfb8aa3b, v136
    v_exp_f32 v137, v137
    s_nop 0
    v_add_f32 v137, 1.0, v137
    v_rcp_f32 v136, v137
    s_nop 0
    v_cvt_pk_bf16_f32 v137, v136, v136
    v_lshlrev_b32 v136, 16, v137
    v_cvt_pk_bf16_f32 v137, v126, v126
    v_lshlrev_b32 v138, 16, v137
    v_mul_f32 v142, v136, v138
    v_cvt_pk_bf16_f32 v137, v63, v63
    v_lshlrev_b32 v136, 16, v137
    v_mul_f32 v137, 0xbfb8aa3b, v136
    v_exp_f32 v137, v137
    s_nop 0
    v_add_f32 v137, 1.0, v137
    v_rcp_f32 v136, v137
    s_nop 0
    v_cvt_pk_bf16_f32 v137, v136, v136
    v_lshlrev_b32 v136, 16, v137
    v_cvt_pk_bf16_f32 v137, v127, v127
    v_lshlrev_b32 v138, 16, v137
    v_mul_f32 v143, v136, v138
    v_cvt_pk_bf16_f32 v132, v140, v141
    v_cvt_pk_bf16_f32 v133, v142, v143
    s_mov_b32 s55, 294912
    buffer_store_dwordx2 v[132:133], v249, s[28:31], s55 offen offset:96
    s_nop 1
    v_cvt_pk_bf16_f32 v137, v64, v64
    v_lshlrev_b32 v136, 16, v137
    v_mul_f32 v137, 0xbfb8aa3b, v136
    v_exp_f32 v137, v137
    s_nop 0
    v_add_f32 v137, 1.0, v137
    v_rcp_f32 v136, v137
    s_nop 0
    v_cvt_pk_bf16_f32 v137, v136, v136
    v_lshlrev_b32 v136, 16, v137
    v_cvt_pk_bf16_f32 v137, v128, v128
    v_lshlrev_b32 v138, 16, v137
    v_mul_f32 v140, v136, v138
    v_cvt_pk_bf16_f32 v137, v65, v65
    v_lshlrev_b32 v136, 16, v137
    v_mul_f32 v137, 0xbfb8aa3b, v136
    v_exp_f32 v137, v137
    s_nop 0
    v_add_f32 v137, 1.0, v137
    v_rcp_f32 v136, v137
    s_nop 0
    v_cvt_pk_bf16_f32 v137, v136, v136
    v_lshlrev_b32 v136, 16, v137
    v_cvt_pk_bf16_f32 v137, v129, v129
    v_lshlrev_b32 v138, 16, v137
    v_mul_f32 v141, v136, v138
    v_cvt_pk_bf16_f32 v137, v66, v66
    v_lshlrev_b32 v136, 16, v137
    v_mul_f32 v137, 0xbfb8aa3b, v136
    v_exp_f32 v137, v137
    s_nop 0
    v_add_f32 v137, 1.0, v137
    v_rcp_f32 v136, v137
    s_nop 0
    v_cvt_pk_bf16_f32 v137, v136, v136
    v_lshlrev_b32 v136, 16, v137
    v_cvt_pk_bf16_f32 v137, v130, v130
    v_lshlrev_b32 v138, 16, v137
    v_mul_f32 v142, v136, v138
    v_cvt_pk_bf16_f32 v137, v67, v67
    v_lshlrev_b32 v136, 16, v137
    v_mul_f32 v137, 0xbfb8aa3b, v136
    v_exp_f32 v137, v137
    s_nop 0
    v_add_f32 v137, 1.0, v137
    v_rcp_f32 v136, v137
    s_nop 0
    v_cvt_pk_bf16_f32 v137, v136, v136
    v_lshlrev_b32 v136, 16, v137
    v_cvt_pk_bf16_f32 v137, v131, v131
    v_lshlrev_b32 v138, 16, v137
    v_mul_f32 v143, v136, v138
    v_cvt_pk_bf16_f32 v132, v140, v141
    v_cvt_pk_bf16_f32 v133, v142, v143
    s_mov_b32 s55, 442368
    buffer_store_dwordx2 v[132:133], v249, s[28:31], s55 offen offset:96
    s_nop 1
    s_branch K1_END
K1_DFT:
    s_sub_u32 s44, s2, 576
    s_and_b32 s45, s44, 15
    s_lshr_b32 s44, s44, 4
    s_cmp_ge_u32 s44, 3
    s_cselect_b32 s20, s6, s4
    s_cselect_b32 s21, s7, s5
    s_mov_b32 s22, 0xa2000
    s_mov_b32 s23, 0x00020000
    s_cselect_b32 s57, 3, 0
    s_sub_u32 s57, s44, s57
    s_add_u32 s28, s12, 0x300000
    s_addc_u32 s29, s13, 0
    s_mov_b32 s30, 0x480000
    s_mov_b32 s31, 0x00020000
    s_mov_b32 s46, 0
    s_mov_b32 s47, 0
    s_lshl_b32 s50, s45, 7
    v_lshrrev_b32 v249, 3, v250
    v_lshl_add_u32 v0, v251, 3, v249
    v_add_u32 v0, s50, v0
    s_mov_b32 s51, 1152
    v_mul_lo_u32 v0, v0, s51
    v_and_b32 v248, 7, v250
    v_xor_b32 v248, v248, v249
    v_lshl_add_u32 v0, v248, 4, v0
    s_mul_i32 s52, s57, 192
    v_lshrrev_b32 v249, 3, v250
    v_lshl_add_u32 v1, v251, 3, v249
    v_add_u32 v1, s52, v1
    s_mov_b32 s51, 1152
    v_mul_lo_u32 v1, v1, s51
    v_and_b32 v248, 7, v250
    v_xor_b32 v248, v248, v249
    v_lshl_add_u32 v1, v248, 4, v1
    s_lshl_b32 s53, s42, 2
    s_mul_i32 s54, s43, 6
    v_mov_b32 v4, 0
    v_mov_b32 v5, 0
    v_mov_b32 v6, 0
    v_mov_b32 v7, 0
    v_mov_b32 v8, 0
    v_mov_b32 v9, 0
    v_mov_b32 v10, 0
    v_mov_b32 v11, 0
    v_mov_b32 v12, 0
    v_mov_b32 v13, 0
    v_mov_b32 v14, 0
    v_mov_b32 v15, 0
    v_mov_b32 v16, 0
    v_mov_b32 v17, 0
    v_mov_b32 v18, 0
    v_mov_b32 v19, 0
    v_mov_b32 v20, 0
    v_mov_b32 v21, 0
    v_mov_b32 v22, 0
    v_mov_b32 v23, 0
    v_mov_b32 v24, 0
    v_mov_b32 v25, 0
    v_mov_b32 v26, 0
    v_mov_b32 v27, 0
    v_mov_b32 v28, 0
    v_mov_b32 v29, 0
    v_mov_b32 v30, 0
    v_mov_b32 v31, 0
    v_mov_b32 v32, 0
    v_mov_b32 v33, 0
    v_mov_b32 v34, 0
    v_mov_b32 v35, 0
    v_mov_b32 v36, 0
    v_mov_b32 v37, 0
    v_mov_b32 v38, 0
    v_mov_b32 v39, 0
    v_mov_b32 v40, 0
    v_mov_b32 v41, 0
    v_mov_b32 v42, 0
    v_mov_b32 v43, 0
    v_mov_b32 v44, 0
    v_mov_b32 v45, 0
    v_mov_b32 v46, 0
    v_mov_b32 v47, 0
    v_mov_b32 v48, 0
    v_mov_b32 v49, 0
    v_mov_b32 v50, 0
    v_mov_b32 v51, 0
    v_mov_b32 v52, 0
    v_mov_b32 v53, 0
    v_mov_b32 v54, 0
    v_mov_b32 v55, 0
    v_mov_b32 v56, 0
    v_mov_b32 v57, 0
    v_mov_b32 v58, 0
    v_mov_b32 v59, 0
    v_mov_b32 v60, 0
    v_mov_b32 v61, 0
    v_mov_b32 v62, 0
    v_mov_b32 v63, 0
    v_mov_b32 v64, 0
    v_mov_b32 v65, 0
    v_mov_b32 v66, 0
    v_mov_b32 v67, 0
    v_mov_b32 v68, 0
    v_mov_b32 v69, 0
    v_mov_b32 v70, 0
    v_mov_b32 v71, 0
    v_mov_b32 v72, 0
    v_mov_b32 v73, 0
    v_mov_b32 v74, 0
    v_mov_b32 v75, 0
    v_mov_b32 v76, 0
    v_mov_b32 v77, 0
    v_mov_b32 v78, 0
    v_mov_b32 v79, 0
    v_mov_b32 v80, 0
    v_mov_b32 v81, 0
    v_mov_b32 v82, 0
    v_mov_b32 v83, 0
    v_mov_b32 v84, 0
    v_mov_b32 v85, 0
    v_mov_b32 v86, 0
    v_mov_b32 v87, 0
    v_mov_b32 v88, 0
    v_mov_b32 v89, 0
    v_mov_b32 v90, 0
    v_mov_b32 v91, 0
    v_mov_b32 v92, 0
    v_mov_b32 v93, 0
    v_mov_b32 v94, 0
    v_mov_b32 v95, 0
    v_mov_b32 v96, 0
    v_mov_b32 v97, 0
    v_mov_b32 v98, 0
    v_mov_b32 v99, 0
    v_and_b32 v180, 15, v250
    s_lshl_b32 s51, s53, 4
    v_add_u32 v180, s51, v180
    v_lshlrev_b32 v180, 7, v180
    v_lshrrev_b32 v249, 4, v250
    v_add_u32 v249, 0, v249
    v_and_b32 v248, 7, v250
    v_xor_b32 v249, v249, v248
    v_lshlrev_b32 v249, 4, v249
    v_add_u32 v180, v180, v249
    v_and_b32 v181, 15, v250
    s_lshl_b32 s51, s53, 4
    v_add_u32 v181, s51, v181
    v_lshlrev_b32 v181, 7, v181
    v_lshrrev_b32 v249, 4, v250
    v_add_u32 v249, 4, v249
    v_and_b32 v248, 7, v250
    v_xor_b32 v249, v249, v248
    v_lshlrev_b32 v249, 4, v249
    v_add_u32 v181, v181, v249
    v_and_b32 v182, 15, v250
    s_lshl_b32 s51, s54, 4
    v_add_u32 v182, s51, v182
    v_lshlrev_b32 v182, 7, v182
    v_lshrrev_b32 v249, 4, v250
    v_add_u32 v249, 0, v249
    v_and_b32 v248, 7, v250
    v_xor_b32 v249, v249, v248
    v_lshlrev_b32 v249, 4, v249
    v_add_u32 v182, v182, v249
    v_and_b32 v183, 15, v250
    s_lshl_b32 s51, s54, 4
    v_add_u32 v183, s51, v183
    v_lshlrev_b32 v183, 7, v183
    v_lshrrev_b32 v249, 4, v250
    v_add_u32 v249, 4, v249
    v_and_b32 v248, 7, v250
    v_xor_b32 v249, v249, v248
    v_lshlrev_b32 v249, 4, v249
    v_add_u32 v183, v183, v249
    s_add_u32 m0, s41, 0
    s_add_u32 s51, s46, 0
    buffer_load_dwordx4 v0, s[16:19], s51 offen lds
    s_add_u32 m0, s41, 4096
    s_add_u32 s51, s46, 36864
    buffer_load_dwordx4 v0, s[16:19], s51 offen lds
    s_add_u32 m0, s41, 8192
    s_add_u32 s51, s46, 73728
    buffer_load_dwordx4 v0, s[16:19], s51 offen lds
    s_add_u32 m0, s41, 12288
    s_add_u32 s51, s46, 110592
    buffer_load_dwordx4 v0, s[16:19], s51 offen lds
    s_add_u32 m0, s41, 16384
    s_add_u32 s51, s47, 0
    buffer_load_dwordx4 v1, s[20:23], s51 offen lds
    s_add_u32 m0, s41, 20480
    s_add_u32 s51, s47, 36864
    buffer_load_dwordx4 v1, s[20:23], s51 offen lds
    s_add_u32 m0, s41, 24576
    s_add_u32 s51, s47, 73728
    buffer_load_dwordx4 v1, s[20:23], s51 offen lds
    s_add_u32 m0, s41, 28672
    s_add_u32 s51, s47, 110592
    buffer_load_dwordx4 v1, s[20:23], s51 offen lds
    s_add_u32 m0, s41, 32768
    s_add_u32 s51, s47, 147456
    buffer_load_dwordx4 v1, s[20:23], s51 offen lds
    s_add_u32 m0, s41, 36864
    s_add_u32 s51, s47, 184320
    buffer_load_dwordx4 v1, s[20:23], s51 offen lds
    s_add_u32 s46, s46, 128
    s_add_u32 s47, s47, 128
    s_add_u32 m0, s41, 40960
    s_add_u32 s51, s46, 0
    buffer_load_dwordx4 v0, s[16:19], s51 offen lds
    s_add_u32 m0, s41, 45056
    s_add_u32 s51, s46, 36864
    buffer_load_dwordx4 v0, s[16:19], s51 offen lds
    s_add_u32 m0, s41, 49152
    s_add_u32 s51, s46, 73728
    buffer_load_dwordx4 v0, s[16:19], s51 offen lds
    s_add_u32 m0, s41, 53248
    s_add_u32 s51, s46, 110592
    buffer_load_dwordx4 v0, s[16:19], s51 offen lds
    s_add_u32 m0, s41, 57344
    s_add_u32 s51, s47, 0
    buffer_load_dwordx4 v1, s[20:23], s51 offen lds
    s_add_u32 m0, s41, 61440
    s_add_u32 s51, s47, 36864
    buffer_load_dwordx4 v1, s[20:23], s51 offen lds
    s_add_u32 m0, s41, 65536
    s_add_u32 s51, s47, 73728
    buffer_load_dwordx4 v1, s[20:23], s51 offen lds
    s_add_u32 m0, s41, 69632
    s_add_u32 s51, s47, 110592
    buffer_load_dwordx4 v1, s[20:23], s51 offen lds
    s_add_u32 m0, s41, 73728
    s_add_u32 s51, s47, 147456
    buffer_load_dwordx4 v1, s[20:23], s51 offen lds
    s_add_u32 m0, s41, 77824
    s_add_u32 s51, s47, 184320
    buffer_load_dwordx4 v1, s[20:23], s51 offen lds
    s_waitcnt vmcnt(10)
    s_barrier
    ds_read_b128 v[116:119], v182 offset:16384
    ds_read_b128 v[120:123], v182 offset:18432
    ds_read_b128 v[124:127], v182 offset:20480
    ds_read_b128 v[128:131], v182 offset:22528
    ds_read_b128 v[132:135], v182 offset:24576
    ds_read_b128 v[136:139], v182 offset:26624
    ds_read_b128 v[100:103], v180 offset:0
    ds_read_b128 v[104:107], v180 offset:2048
    ds_read_b128 v[108:111], v180 offset:4096
    ds_read_b128 v[112:115], v180 offset:6144
    s_waitcnt lgkmcnt(0)
    v_mfma_f32_16x16x32_bf16 v[4:7], v[100:103], v[116:119], v[4:7]
    v_mfma_f32_16x16x32_bf16 v[8:11], v[100:103], v[120:123], v[8:11]
    ds_read_b128 v[156:159], v183 offset:16384
    v_mfma_f32_16x16x32_bf16 v[12:15], v[100:103], v[124:127], v[12:15]
    v_mfma_f32_16x16x32_bf16 v[16:19], v[100:103], v[128:131], v[16:19]
    ds_read_b128 v[160:163], v183 offset:18432
    v_mfma_f32_16x16x32_bf16 v[20:23], v[100:103], v[132:135], v[20:23]
    ds_read_b128 v[164:167], v183 offset:20480
    v_mfma_f32_16x16x32_bf16 v[24:27], v[100:103], v[136:139], v[24:27]
    v_mfma_f32_16x16x32_bf16 v[28:31], v[104:107], v[116:119], v[28:31]
    ds_read_b128 v[168:171], v183 offset:22528
    v_mfma_f32_16x16x32_bf16 v[32:35], v[104:107], v[120:123], v[32:35]
    ds_read_b128 v[172:175], v183 offset:24576
    v_mfma_f32_16x16x32_bf16 v[36:39], v[104:107], v[124:127], v[36:39]
    v_mfma_f32_16x16x32_bf16 v[40:43], v[104:107], v[128:131], v[40:43]
    ds_read_b128 v[176:179], v183 offset:26624
    v_mfma_f32_16x16x32_bf16 v[44:47], v[104:107], v[132:135], v[44:47]
    v_mfma_f32_16x16x32_bf16 v[48:51], v[104:107], v[136:139], v[48:51]
    ds_read_b128 v[140:143], v181 offset:0
    v_mfma_f32_16x16x32_bf16 v[52:55], v[108:111], v[116:119], v[52:55]
    ds_read_b128 v[144:147], v181 offset:2048
    v_mfma_f32_16x16x32_bf16 v[56:59], v[108:111], v[120:123], v[56:59]
    v_mfma_f32_16x16x32_bf16 v[60:63], v[108:111], v[124:127], v[60:63]
    ds_read_b128 v[148:151], v181 offset:4096
    v_mfma_f32_16x16x32_bf16 v[64:67], v[108:111], v[128:131], v[64:67]
    ds_read_b128 v[152:155], v181 offset:6144
    v_mfma_f32_16x16x32_bf16 v[68:71], v[108:111], v[132:135], v[68:71]
    v_mfma_f32_16x16x32_bf16 v[72:75], v[108:111], v[136:139], v[72:75]
    s_add_u32 s46, s46, 128
    s_add_u32 s47, s47, 128
    v_mfma_f32_16x16x32_bf16 v[76:79], v[112:115], v[116:119], v[76:79]
    v_mfma_f32_16x16x32_bf16 v[80:83], v[112:115], v[120:123], v[80:83]
    s_add_u32 m0, s41, 81920
    s_add_u32 s51, s46, 0
    buffer_load_dwordx4 v0, s[16:19], s51 offen lds
    v_mfma_f32_16x16x32_bf16 v[84:87], v[112:115], v[124:127], v[84:87]
    s_add_u32 m0, s41, 86016
    s_add_u32 s51, s46, 36864
    buffer_load_dwordx4 v0, s[16:19], s51 offen lds
    v_mfma_f32_16x16x32_bf16 v[88:91], v[112:115], v[128:131], v[88:91]
    v_mfma_f32_16x16x32_bf16 v[92:95], v[112:115], v[132:135], v[92:95]
    s_add_u32 m0, s41, 90112
    s_add_u32 s51, s46, 73728
    buffer_load_dwordx4 v0, s[16:19], s51 offen lds
    v_mfma_f32_16x16x32_bf16 v[96:99], v[112:115], v[136:139], v[96:99]
    s_add_u32 m0, s41, 94208
    s_add_u32 s51, s46, 110592
    buffer_load_dwordx4 v0, s[16:19], s51 offen lds
    s_waitcnt lgkmcnt(0)
    v_mfma_f32_16x16x32_bf16 v[4:7], v[140:143], v[156:159], v[4:7]
    v_mfma_f32_16x16x32_bf16 v[8:11], v[140:143], v[160:163], v[8:11]
    v_mfma_f32_16x16x32_bf16 v[12:15], v[140:143], v[164:167], v[12:15]
    v_mfma_f32_16x16x32_bf16 v[16:19], v[140:143], v[168:171], v[16:19]
    s_add_u32 m0, s41, 98304
    s_add_u32 s51, s47, 0
    buffer_load_dwordx4 v1, s[20:23], s51 offen lds
    v_mfma_f32_16x16x32_bf16 v[20:23], v[140:143], v[172:175], v[20:23]
    v_mfma_f32_16x16x32_bf16 v[24:27], v[140:143], v[176:179], v[24:27]
    v_mfma_f32_16x16x32_bf16 v[28:31], v[144:147], v[156:159], v[28:31]
    v_mfma_f32_16x16x32_bf16 v[32:35], v[144:147], v[160:163], v[32:35]
    s_add_u32 m0, s41, 102400
    s_add_u32 s51, s47, 36864
    buffer_load_dwordx4 v1, s[20:23], s51 offen lds
    v_mfma_f32_16x16x32_bf16 v[36:39], v[144:147], v[164:167], v[36:39]
    v_mfma_f32_16x16x32_bf16 v[40:43], v[144:147], v[168:171], v[40:43]
    v_mfma_f32_16x16x32_bf16 v[44:47], v[144:147], v[172:175], v[44:47]
    v_mfma_f32_16x16x32_bf16 v[48:51], v[144:147], v[176:179], v[48:51]
    s_add_u32 m0, s41, 106496
    s_add_u32 s51, s47, 73728
    buffer_load_dwordx4 v1, s[20:23], s51 offen lds
    v_mfma_f32_16x16x32_bf16 v[52:55], v[148:151], v[156:159], v[52:55]
    v_mfma_f32_16x16x32_bf16 v[56:59], v[148:151], v[160:163], v[56:59]
    v_mfma_f32_16x16x32_bf16 v[60:63], v[148:151], v[164:167], v[60:63]
    v_mfma_f32_16x16x32_bf16 v[64:67], v[148:151], v[168:171], v[64:67]
    s_add_u32 m0, s41, 110592
    s_add_u32 s51, s47, 110592
    buffer_load_dwordx4 v1, s[20:23], s51 offen lds
    v_mfma_f32_16x16x32_bf16 v[68:71], v[148:151], v[172:175], v[68:71]
    v_mfma_f32_16x16x32_bf16 v[72:75], v[148:151], v[176:179], v[72:75]
    v_mfma_f32_16x16x32_bf16 v[76:79], v[152:155], v[156:159], v[76:79]
    v_mfma_f32_16x16x32_bf16 v[80:83], v[152:155], v[160:163], v[80:83]
    s_add_u32 m0, s41, 114688
    s_add_u32 s51, s47, 147456
    buffer_load_dwordx4 v1, s[20:23], s51 offen lds
    v_mfma_f32_16x16x32_bf16 v[84:87], v[152:155], v[164:167], v[84:87]
    v_mfma_f32_16x16x32_bf16 v[88:91], v[152:155], v[168:171], v[88:91]
    v_mfma_f32_16x16x32_bf16 v[92:95], v[152:155], v[172:175], v[92:95]
    v_mfma_f32_16x16x32_bf16 v[96:99], v[152:155], v[176:179], v[96:99]
    s_add_u32 m0, s41, 118784
    s_add_u32 s51, s47, 184320
    buffer_load_dwordx4 v1, s[20:23], s51 offen lds
    s_waitcnt vmcnt(10)
    s_barrier
    v_add_u32 v180, 40960, v180
    v_add_u32 v181, 40960, v181
    v_add_u32 v182, 40960, v182
    v_add_u32 v183, 40960, v183
    ds_read_b128 v[116:119], v182 offset:16384
    ds_read_b128 v[120:123], v182 offset:18432
    ds_read_b128 v[124:127], v182 offset:20480
    ds_read_b128 v[128:131], v182 offset:22528
    ds_read_b128 v[132:135], v182 offset:24576
    ds_read_b128 v[136:139], v182 offset:26624
    ds_read_b128 v[100:103], v180 offset:0
    ds_read_b128 v[104:107], v180 offset:2048
    ds_read_b128 v[108:111], v180 offset:4096
    ds_read_b128 v[112:115], v180 offset:6144
    s_waitcnt lgkmcnt(0)
    v_mfma_f32_16x16x32_bf16 v[4:7], v[100:103], v[116:119], v[4:7]
    v_mfma_f32_16x16x32_bf16 v[8:11], v[100:103], v[120:123], v[8:11]
    ds_read_b128 v[156:159], v183 offset:16384
    v_mfma_f32_16x16x32_bf16 v[12:15], v[100:103], v[124:127], v[12:15]
    v_mfma_f32_16x16x32_bf16 v[16:19], v[100:103], v[128:131], v[16:19]
    ds_read_b128 v[160:163], v183 offset:18432
    v_mfma_f32_16x16x32_bf16 v[20:23], v[100:103], v[132:135], v[20:23]
    ds_read_b128 v[164:167], v183 offset:20480
    v_mfma_f32_16x16x32_bf16 v[24:27], v[100:103], v[136:139], v[24:27]
    v_mfma_f32_16x16x32_bf16 v[28:31], v[104:107], v[116:119], v[28:31]
    ds_read_b128 v[168:171], v183 offset:22528
    v_mfma_f32_16x16x32_bf16 v[32:35], v[104:107], v[120:123], v[32:35]
    ds_read_b128 v[172:175], v183 offset:24576
    v_mfma_f32_16x16x32_bf16 v[36:39], v[104:107], v[124:127], v[36:39]
    v_mfma_f32_16x16x32_bf16 v[40:43], v[104:107], v[128:131], v[40:43]
    ds_read_b128 v[176:179], v183 offset:26624
    v_mfma_f32_16x16x32_bf16 v[44:47], v[104:107], v[132:135], v[44:47]
    v_mfma_f32_16x16x32_bf16 v[48:51], v[104:107], v[136:139], v[48:51]
    ds_read_b128 v[140:143], v181 offset:0
    v_mfma_f32_16x16x32_bf16 v[52:55], v[108:111], v[116:119], v[52:55]
    ds_read_b128 v[144:147], v181 offset:2048
    v_mfma_f32_16x16x32_bf16 v[56:59], v[108:111], v[120:123], v[56:59]
    v_mfma_f32_16x16x32_bf16 v[60:63], v[108:111], v[124:127], v[60:63]
    ds_read_b128 v[148:151], v181 offset:4096
    v_mfma_f32_16x16x32_bf16 v[64:67], v[108:111], v[128:131], v[64:67]
    ds_read_b128 v[152:155], v181 offset:6144
    v_mfma_f32_16x16x32_bf16 v[68:71], v[108:111], v[132:135], v[68:71]
    v_mfma_f32_16x16x32_bf16 v[72:75], v[108:111], v[136:139], v[72:75]
    s_add_u32 s46, s46, 128
    s_add_u32 s47, s47, 128
    v_mfma_f32_16x16x32_bf16 v[76:79], v[112:115], v[116:119], v[76:79]
    v_mfma_f32_16x16x32_bf16 v[80:83], v[112:115], v[120:123], v[80:83]
    s_add_u32 m0, s41, 0
    s_add_u32 s51, s46, 0
    buffer_load_dwordx4 v0, s[16:19], s51 offen lds
    v_mfma_f32_16x16x32_bf16 v[84:87], v[112:115], v[124:127], v[84:87]
    s_add_u32 m0, s41, 4096
    s_add_u32 s51, s46, 36864
    buffer_load_dwordx4 v0, s[16:19], s51 offen lds
    v_mfma_f32_16x16x32_bf16 v[88:91], v[112:115], v[128:131], v[88:91]
    v_mfma_f32_16x16x32_bf16 v[92:95], v[112:115], v[132:135], v[92:95]
    s_add_u32 m0, s41, 8192
    s_add_u32 s51, s46, 73728
    buffer_load_dwordx4 v0, s[16:19], s51 offen lds
    v_mfma_f32_16x16x32_bf16 v[96:99], v[112:115], v[136:139], v[96:99]
    s_add_u32 m0, s41, 12288
    s_add_u32 s51, s46, 110592
    buffer_load_dwordx4 v0, s[16:19], s51 offen lds
    s_waitcnt lgkmcnt(0)
    v_mfma_f32_16x16x32_bf16 v[4:7], v[140:143], v[156:159], v[4:7]
    v_mfma_f32_16x16x32_bf16 v[8:11], v[140:143], v[160:163], v[8:11]
    v_mfma_f32_16x16x32_bf16 v[12:15], v[140:143], v[164:167], v[12:15]
    v_mfma_f32_16x16x32_bf16 v[16:19], v[140:143], v[168:171], v[16:19]
    s_add_u32 m0, s41, 16384
    s_add_u32 s51, s47, 0
    buffer_load_dwordx4 v1, s[20:23], s51 offen lds
    v_mfma_f32_16x16x32_bf16 v[20:23], v[140:143], v[172:175], v[20:23]
    v_mfma_f32_16x16x32_bf16 v[24:27], v[140:143], v[176:179], v[24:27]
    v_mfma_f32_16x16x32_bf16 v[28:31], v[144:147], v[156:159], v[28:31]
    v_mfma_f32_16x16x32_bf16 v[32:35], v[144:147], v[160:163], v[32:35]
    s_add_u32 m0, s41, 20480
    s_add_u32 s51, s47, 36864
    buffer_load_dwordx4 v1, s[20:23], s51 offen lds
    v_mfma_f32_16x16x32_bf16 v[36:39], v[144:147], v[164:167], v[36:39]
    v_mfma_f32_16x16x32_bf16 v[40:43], v[144:147], v[168:171], v[40:43]
    v_mfma_f32_16x16x32_bf16 v[44:47], v[144:147], v[172:175], v[44:47]
    v_mfma_f32_16x16x32_bf16 v[48:51], v[144:147], v[176:179], v[48:51]
    s_add_u32 m0, s41, 24576
    s_add_u32 s51, s47, 73728
    buffer_load_dwordx4 v1, s[20:23], s51 offen lds
    v_mfma_f32_16x16x32_bf16 v[52:55], v[148:151], v[156:159], v[52:55]
    v_mfma_f32_16x16x32_bf16 v[56:59], v[148:151], v[160:163], v[56:59]
    v_mfma_f32_16x16x32_bf16 v[60:63], v[148:151], v[164:167], v[60:63]
    v_mfma_f32_16x16x32_bf16 v[64:67], v[148:151], v[168:171], v[64:67]
    s_add_u32 m0, s41, 28672
    s_add_u32 s51, s47, 110592
    buffer_load_dwordx4 v1, s[20:23], s51 offen lds
    v_mfma_f32_16x16x32_bf16 v[68:71], v[148:151], v[172:175], v[68:71]
    v_mfma_f32_16x16x32_bf16 v[72:75], v[148:151], v[176:179], v[72:75]
    v_mfma_f32_16x16x32_bf16 v[76:79], v[152:155], v[156:159], v[76:79]
    v_mfma_f32_16x16x32_bf16 v[80:83], v[152:155], v[160:163], v[80:83]
    s_add_u32 m0, s41, 32768
    s_add_u32 s51, s47, 147456
    buffer_load_dwordx4 v1, s[20:23], s51 offen lds
    v_mfma_f32_16x16x32_bf16 v[84:87], v[152:155], v[164:167], v[84:87]
    v_mfma_f32_16x16x32_bf16 v[88:91], v[152:155], v[168:171], v[88:91]
    v_mfma_f32_16x16x32_bf16 v[92:95], v[152:155], v[172:175], v[92:95]
    v_mfma_f32_16x16x32_bf16 v[96:99], v[152:155], v[176:179], v[96:99]
    s_add_u32 m0, s41, 36864
    s_add_u32 s51, s47, 184320
    buffer_load_dwordx4 v1, s[20:23], s51 offen lds
    s_waitcnt vmcnt(10)
    s_barrier
    v_add_u32 v180, 40960, v180
    v_add_u32 v181, 40960, v181
    v_add_u32 v182, 40960, v182
    v_add_u32 v183, 40960, v183
    ds_read_b128 v[116:119], v182 offset:16384
    ds_read_b128 v[120:123], v182 offset:18432
    ds_read_b128 v[124:127], v182 offset:20480
    ds_read_b128 v[128:131], v182 offset:22528
    ds_read_b128 v[132:135], v182 offset:24576
    ds_read_b128 v[136:139], v182 offset:26624
    ds_read_b128 v[100:103], v180 offset:0
    ds_read_b128 v[104:107], v180 offset:2048
    ds_read_b128 v[108:111], v180 offset:4096
    ds_read_b128 v[112:115], v180 offset:6144
    s_waitcnt lgkmcnt(0)
    v_mfma_f32_16x16x32_bf16 v[4:7], v[100:103], v[116:119], v[4:7]
    v_mfma_f32_16x16x32_bf16 v[8:11], v[100:103], v[120:123], v[8:11]
    ds_read_b128 v[156:159], v183 offset:16384
    v_mfma_f32_16x16x32_bf16 v[12:15], v[100:103], v[124:127], v[12:15]
    v_mfma_f32_16x16x32_bf16 v[16:19], v[100:103], v[128:131], v[16:19]
    ds_read_b128 v[160:163], v183 offset:18432
    v_mfma_f32_16x16x32_bf16 v[20:23], v[100:103], v[132:135], v[20:23]
    ds_read_b128 v[164:167], v183 offset:20480
    v_mfma_f32_16x16x32_bf16 v[24:27], v[100:103], v[136:139], v[24:27]
    v_mfma_f32_16x16x32_bf16 v[28:31], v[104:107], v[116:119], v[28:31]
    ds_read_b128 v[168:171], v183 offset:22528
    v_mfma_f32_16x16x32_bf16 v[32:35], v[104:107], v[120:123], v[32:35]
    ds_read_b128 v[172:175], v183 offset:24576
    v_mfma_f32_16x16x32_bf16 v[36:39], v[104:107], v[124:127], v[36:39]
    v_mfma_f32_16x16x32_bf16 v[40:43], v[104:107], v[128:131], v[40:43]
    ds_read_b128 v[176:179], v183 offset:26624
    v_mfma_f32_16x16x32_bf16 v[44:47], v[104:107], v[132:135], v[44:47]
    v_mfma_f32_16x16x32_bf16 v[48:51], v[104:107], v[136:139], v[48:51]
    ds_read_b128 v[140:143], v181 offset:0
    v_mfma_f32_16x16x32_bf16 v[52:55], v[108:111], v[116:119], v[52:55]
    ds_read_b128 v[144:147], v181 offset:2048
    v_mfma_f32_16x16x32_bf16 v[56:59], v[108:111], v[120:123], v[56:59]
    v_mfma_f32_16x16x32_bf16 v[60:63], v[108:111], v[124:127], v[60:63]
    ds_read_b128 v[148:151], v181 offset:4096
    v_mfma_f32_16x16x32_bf16 v[64:67], v[108:111], v[128:131], v[64:67]
    ds_read_b128 v[152:155], v181 offset:6144
    v_mfma_f32_16x16x32_bf16 v[68:71], v[108:111], v[132:135], v[68:71]
    v_mfma_f32_16x16x32_bf16 v[72:75], v[108:111], v[136:139], v[72:75]
    s_add_u32 s46, s46, 128
    s_add_u32 s47, s47, 128
    v_mfma_f32_16x16x32_bf16 v[76:79], v[112:115], v[116:119], v[76:79]
    v_mfma_f32_16x16x32_bf16 v[80:83], v[112:115], v[120:123], v[80:83]
    s_add_u32 m0, s41, 40960
    s_add_u32 s51, s46, 0
    buffer_load_dwordx4 v0, s[16:19], s51 offen lds
    v_mfma_f32_16x16x32_bf16 v[84:87], v[112:115], v[124:127], v[84:87]
    s_add_u32 m0, s41, 45056
    s_add_u32 s51, s46, 36864
    buffer_load_dwordx4 v0, s[16:19], s51 offen lds
    v_mfma_f32_16x16x32_bf16 v[88:91], v[112:115], v[128:131], v[88:91]
    v_mfma_f32_16x16x32_bf16 v[92:95], v[112:115], v[132:135], v[92:95]
    s_add_u32 m0, s41, 49152
    s_add_u32 s51, s46, 73728
    buffer_load_dwordx4 v0, s[16:19], s51 offen lds
    v_mfma_f32_16x16x32_bf16 v[96:99], v[112:115], v[136:139], v[96:99]
    s_add_u32 m0, s41, 53248
    s_add_u32 s51, s46, 110592
    buffer_load_dwordx4 v0, s[16:19], s51 offen lds
    s_waitcnt lgkmcnt(0)
    v_mfma_f32_16x16x32_bf16 v[4:7], v[140:143], v[156:159], v[4:7]
    v_mfma_f32_16x16x32_bf16 v[8:11], v[140:143], v[160:163], v[8:11]
    v_mfma_f32_16x16x32_bf16 v[12:15], v[140:143], v[164:167], v[12:15]
    v_mfma_f32_16x16x32_bf16 v[16:19], v[140:143], v[168:171], v[16:19]
    s_add_u32 m0, s41, 57344
    s_add_u32 s51, s47, 0
    buffer_load_dwordx4 v1, s[20:23], s51 offen lds
    v_mfma_f32_16x16x32_bf16 v[20:23], v[140:143], v[172:175], v[20:23]
    v_mfma_f32_16x16x32_bf16 v[24:27], v[140:143], v[176:179], v[24:27]
    v_mfma_f32_16x16x32_bf16 v[28:31], v[144:147], v[156:159], v[28:31]
    v_mfma_f32_16x16x32_bf16 v[32:35], v[144:147], v[160:163], v[32:35]
    s_add_u32 m0, s41, 61440
    s_add_u32 s51, s47, 36864
    buffer_load_dwordx4 v1, s[20:23], s51 offen lds
    v_mfma_f32_16x16x32_bf16 v[36:39], v[144:147], v[164:167], v[36:39]
    v_mfma_f32_16x16x32_bf16 v[40:43], v[144:147], v[168:171], v[40:43]
    v_mfma_f32_16x16x32_bf16 v[44:47], v[144:147], v[172:175], v[44:47]
    v_mfma_f32_16x16x32_bf16 v[48:51], v[144:147], v[176:179], v[48:51]
    s_add_u32 m0, s41, 65536
    s_add_u32 s51, s47, 73728
    buffer_load_dwordx4 v1, s[20:23], s51 offen lds
    v_mfma_f32_16x16x32_bf16 v[52:55], v[148:151], v[156:159], v[52:55]
    v_mfma_f32_16x16x32_bf16 v[56:59], v[148:151], v[160:163], v[56:59]
    v_mfma_f32_16x16x32_bf16 v[60:63], v[148:151], v[164:167], v[60:63]
    v_mfma_f32_16x16x32_bf16 v[64:67], v[148:151], v[168:171], v[64:67]
    s_add_u32 m0, s41, 69632
    s_add_u32 s51, s47, 110592
    buffer_load_dwordx4 v1, s[20:23], s51 offen lds
    v_mfma_f32_16x16x32_bf16 v[68:71], v[148:151], v[172:175], v[68:71]
    v_mfma_f32_16x16x32_bf16 v[72:75], v[148:151], v[176:179], v[72:75]
    v_mfma_f32_16x16x32_bf16 v[76:79], v[152:155], v[156:159], v[76:79]
    v_mfma_f32_16x16x32_bf16 v[80:83], v[152:155], v[160:163], v[80:83]
    s_add_u32 m0, s41, 73728
    s_add_u32 s51, s47, 147456
    buffer_load_dwordx4 v1, s[20:23], s51 offen lds
    v_mfma_f32_16x16x32_bf16 v[84:87], v[152:155], v[164:167], v[84:87]
    v_mfma_f32_16x16x32_bf16 v[88:91], v[152:155], v[168:171], v[88:91]
    v_mfma_f32_16x16x32_bf16 v[92:95], v[152:155], v[172:175], v[92:95]
    v_mfma_f32_16x16x32_bf16 v[96:99], v[152:155], v[176:179], v[96:99]
    s_add_u32 m0, s41, 77824
    s_add_u32 s51, s47, 184320
    buffer_load_dwordx4 v1, s[20:23], s51 offen lds
    s_waitcnt vmcnt(10)
    s_barrier
    v_subrev_u32 v180, 81920, v180
    v_subrev_u32 v181, 81920, v181
    v_subrev_u32 v182, 81920, v182
    v_subrev_u32 v183, 81920, v183
    ds_read_b128 v[116:119], v182 offset:16384
    ds_read_b128 v[120:123], v182 offset:18432
    ds_read_b128 v[124:127], v182 offset:20480
    ds_read_b128 v[128:131], v182 offset:22528
    ds_read_b128 v[132:135], v182 offset:24576
    ds_read_b128 v[136:139], v182 offset:26624
    ds_read_b128 v[100:103], v180 offset:0
    ds_read_b128 v[104:107], v180 offset:2048
    ds_read_b128 v[108:111], v180 offset:4096
    ds_read_b128 v[112:115], v180 offset:6144
    s_waitcnt lgkmcnt(0)
    v_mfma_f32_16x16x32_bf16 v[4:7], v[100:103], v[116:119], v[4:7]
    v_mfma_f32_16x16x32_bf16 v[8:11], v[100:103], v[120:123], v[8:11]
    ds_read_b128 v[156:159], v183 offset:16384
    v_mfma_f32_16x16x32_bf16 v[12:15], v[100:103], v[124:127], v[12:15]
    v_mfma_f32_16x16x32_bf16 v[16:19], v[100:103], v[128:131], v[16:19]
    ds_read_b128 v[160:163], v183 offset:18432
    v_mfma_f32_16x16x32_bf16 v[20:23], v[100:103], v[132:135], v[20:23]
    ds_read_b128 v[164:167], v183 offset:20480
    v_mfma_f32_16x16x32_bf16 v[24:27], v[100:103], v[136:139], v[24:27]
    v_mfma_f32_16x16x32_bf16 v[28:31], v[104:107], v[116:119], v[28:31]
    ds_read_b128 v[168:171], v183 offset:22528
    v_mfma_f32_16x16x32_bf16 v[32:35], v[104:107], v[120:123], v[32:35]
    ds_read_b128 v[172:175], v183 offset:24576
    v_mfma_f32_16x16x32_bf16 v[36:39], v[104:107], v[124:127], v[36:39]
    v_mfma_f32_16x16x32_bf16 v[40:43], v[104:107], v[128:131], v[40:43]
    ds_read_b128 v[176:179], v183 offset:26624
    v_mfma_f32_16x16x32_bf16 v[44:47], v[104:107], v[132:135], v[44:47]
    v_mfma_f32_16x16x32_bf16 v[48:51], v[104:107], v[136:139], v[48:51]
    ds_read_b128 v[140:143], v181 offset:0
    v_mfma_f32_16x16x32_bf16 v[52:55], v[108:111], v[116:119], v[52:55]
    ds_read_b128 v[144:147], v181 offset:2048
    v_mfma_f32_16x16x32_bf16 v[56:59], v[108:111], v[120:123], v[56:59]
    v_mfma_f32_16x16x32_bf16 v[60:63], v[108:111], v[124:127], v[60:63]
    ds_read_b128 v[148:151], v181 offset:4096
    v_mfma_f32_16x16x32_bf16 v[64:67], v[108:111], v[128:131], v[64:67]
    ds_read_b128 v[152:155], v181 offset:6144
    v_mfma_f32_16x16x32_bf16 v[68:71], v[108:111], v[132:135], v[68:71]
    v_mfma_f32_16x16x32_bf16 v[72:75], v[108:111], v[136:139], v[72:75]
    s_add_u32 s46, s46, 128
    s_add_u32 s47, s47, 128
    v_mfma_f32_16x16x32_bf16 v[76:79], v[112:115], v[116:119], v[76:79]
    v_mfma_f32_16x16x32_bf16 v[80:83], v[112:115], v[120:123], v[80:83]
    s_add_u32 m0, s41, 81920
    s_add_u32 s51, s46, 0
    buffer_load_dwordx4 v0, s[16:19], s51 offen lds
    v_mfma_f32_16x16x32_bf16 v[84:87], v[112:115], v[124:127], v[84:87]
    s_add_u32 m0, s41, 86016
    s_add_u32 s51, s46, 36864
    buffer_load_dwordx4 v0, s[16:19], s51 offen lds
    v_mfma_f32_16x16x32_bf16 v[88:91], v[112:115], v[128:131], v[88:91]
    v_mfma_f32_16x16x32_bf16 v[92:95], v[112:115], v[132:135], v[92:95]
    s_add_u32 m0, s41, 90112
    s_add_u32 s51, s46, 73728
    buffer_load_dwordx4 v0, s[16:19], s51 offen lds
    v_mfma_f32_16x16x32_bf16 v[96:99], v[112:115], v[136:139], v[96:99]
    s_add_u32 m0, s41, 94208
    s_add_u32 s51, s46, 110592
    buffer_load_dwordx4 v0, s[16:19], s51 offen lds
    s_waitcnt lgkmcnt(0)
    v_mfma_f32_16x16x32_bf16 v[4:7], v[140:143], v[156:159], v[4:7]
    v_mfma_f32_16x16x32_bf16 v[8:11], v[140:143], v[160:163], v[8:11]
    v_mfma_f32_16x16x32_bf16 v[12:15], v[140:143], v[164:167], v[12:15]
    v_mfma_f32_16x16x32_bf16 v[16:19], v[140:143], v[168:171], v[16:19]
    s_add_u32 m0, s41, 98304
    s_add_u32 s51, s47, 0
    buffer_load_dwordx4 v1, s[20:23], s51 offen lds
    v_mfma_f32_16x16x32_bf16 v[20:23], v[140:143], v[172:175], v[20:23]
    v_mfma_f32_16x16x32_bf16 v[24:27], v[140:143], v[176:179], v[24:27]
    v_mfma_f32_16x16x32_bf16 v[28:31], v[144:147], v[156:159], v[28:31]
    v_mfma_f32_16x16x32_bf16 v[32:35], v[144:147], v[160:163], v[32:35]
    s_add_u32 m0, s41, 102400
    s_add_u32 s51, s47, 36864
    buffer_load_dwordx4 v1, s[20:23], s51 offen lds
    v_mfma_f32_16x16x32_bf16 v[36:39], v[144:147], v[164:167], v[36:39]
    v_mfma_f32_16x16x32_bf16 v[40:43], v[144:147], v[168:171], v[40:43]
    v_mfma_f32_16x16x32_bf16 v[44:47], v[144:147], v[172:175], v[44:47]
    v_mfma_f32_16x16x32_bf16 v[48:51], v[144:147], v[176:179], v[48:51]
    s_add_u32 m0, s41, 106496
    s_add_u32 s51, s47, 73728
    buffer_load_dwordx4 v1, s[20:23], s51 offen lds
    v_mfma_f32_16x16x32_bf16 v[52:55], v[148:151], v[156:159], v[52:55]
    v_mfma_f32_16x16x32_bf16 v[56:59], v[148:151], v[160:163], v[56:59]
    v_mfma_f32_16x16x32_bf16 v[60:63], v[148:151], v[164:167], v[60:63]
    v_mfma_f32_16x16x32_bf16 v[64:67], v[148:151], v[168:171], v[64:67]
    s_add_u32 m0, s41, 110592
    s_add_u32 s51, s47, 110592
    buffer_load_dwordx4 v1, s[20:23], s51 offen lds
    v_mfma_f32_16x16x32_bf16 v[68:71], v[148:151], v[172:175], v[68:71]
    v_mfma_f32_16x16x32_bf16 v[72:75], v[148:151], v[176:179], v[72:75]
    v_mfma_f32_16x16x32_bf16 v[76:79], v[152:155], v[156:159], v[76:79]
    v_mfma_f32_16x16x32_bf16 v[80:83], v[152:155], v[160:163], v[80:83]
    s_add_u32 m0, s41, 114688
    s_add_u32 s51, s47, 147456
    buffer_load_dwordx4 v1, s[20:23], s51 offen lds
    v_mfma_f32_16x16x32_bf16 v[84:87], v[152:155], v[164:167], v[84:87]
    v_mfma_f32_16x16x32_bf16 v[88:91], v[152:155], v[168:171], v[88:91]
    v_mfma_f32_16x16x32_bf16 v[92:95], v[152:155], v[172:175], v[92:95]
    v_mfma_f32_16x16x32_bf16 v[96:99], v[152:155], v[176:179], v[96:99]
    s_add_u32 m0, s41, 118784
    s_add_u32 s51, s47, 184320
    buffer_load_dwordx4 v1, s[20:23], s51 offen lds
    s_waitcnt vmcnt(10)
    s_barrier
    v_add_u32 v180, 40960, v180
    v_add_u32 v181, 40960, v181
    v_add_u32 v182, 40960, v182
    v_add_u32 v183, 40960, v183
    ds_read_b128 v[116:119], v182 offset:16384
    ds_read_b128 v[120:123], v182 offset:18432
    ds_read_b128 v[124:127], v182 offset:20480
    ds_read_b128 v[128:131], v182 offset:22528
    ds_read_b128 v[132:135], v182 offset:24576
    ds_read_b128 v[136:139], v182 offset:26624
    ds_read_b128 v[100:103], v180 offset:0
    ds_read_b128 v[104:107], v180 offset:2048
    ds_read_b128 v[108:111], v180 offset:4096
    ds_read_b128 v[112:115], v180 offset:6144
    s_waitcnt lgkmcnt(0)
    v_mfma_f32_16x16x32_bf16 v[4:7], v[100:103], v[116:119], v[4:7]
    v_mfma_f32_16x16x32_bf16 v[8:11], v[100:103], v[120:123], v[8:11]
    ds_read_b128 v[156:159], v183 offset:16384
    v_mfma_f32_16x16x32_bf16 v[12:15], v[100:103], v[124:127], v[12:15]
    v_mfma_f32_16x16x32_bf16 v[16:19], v[100:103], v[128:131], v[16:19]
    ds_read_b128 v[160:163], v183 offset:18432
    v_mfma_f32_16x16x32_bf16 v[20:23], v[100:103], v[132:135], v[20:23]
    ds_read_b128 v[164:167], v183 offset:20480
    v_mfma_f32_16x16x32_bf16 v[24:27], v[100:103], v[136:139], v[24:27]
    v_mfma_f32_16x16x32_bf16 v[28:31], v[104:107], v[116:119], v[28:31]
    ds_read_b128 v[168:171], v183 offset:22528
    v_mfma_f32_16x16x32_bf16 v[32:35], v[104:107], v[120:123], v[32:35]
    ds_read_b128 v[172:175], v183 offset:24576
    v_mfma_f32_16x16x32_bf16 v[36:39], v[104:107], v[124:127], v[36:39]
    v_mfma_f32_16x16x32_bf16 v[40:43], v[104:107], v[128:131], v[40:43]
    ds_read_b128 v[176:179], v183 offset:26624
    v_mfma_f32_16x16x32_bf16 v[44:47], v[104:107], v[132:135], v[44:47]
    v_mfma_f32_16x16x32_bf16 v[48:51], v[104:107], v[136:139], v[48:51]
    ds_read_b128 v[140:143], v181 offset:0
    v_mfma_f32_16x16x32_bf16 v[52:55], v[108:111], v[116:119], v[52:55]
    ds_read_b128 v[144:147], v181 offset:2048
    v_mfma_f32_16x16x32_bf16 v[56:59], v[108:111], v[120:123], v[56:59]
    v_mfma_f32_16x16x32_bf16 v[60:63], v[108:111], v[124:127], v[60:63]
    ds_read_b128 v[148:151], v181 offset:4096
    v_mfma_f32_16x16x32_bf16 v[64:67], v[108:111], v[128:131], v[64:67]
    ds_read_b128 v[152:155], v181 offset:6144
    v_mfma_f32_16x16x32_bf16 v[68:71], v[108:111], v[132:135], v[68:71]
    v_mfma_f32_16x16x32_bf16 v[72:75], v[108:111], v[136:139], v[72:75]
    s_add_u32 s46, s46, 128
    s_add_u32 s47, s47, 128
    v_mfma_f32_16x16x32_bf16 v[76:79], v[112:115], v[116:119], v[76:79]
    v_mfma_f32_16x16x32_bf16 v[80:83], v[112:115], v[120:123], v[80:83]
    s_add_u32 m0, s41, 0
    s_add_u32 s51, s46, 0
    buffer_load_dwordx4 v0, s[16:19], s51 offen lds
    v_mfma_f32_16x16x32_bf16 v[84:87], v[112:115], v[124:127], v[84:87]
    s_add_u32 m0, s41, 4096
    s_add_u32 s51, s46, 36864
    buffer_load_dwordx4 v0, s[16:19], s51 offen lds
    v_mfma_f32_16x16x32_bf16 v[88:91], v[112:115], v[128:131], v[88:91]
    v_mfma_f32_16x16x32_bf16 v[92:95], v[112:115], v[132:135], v[92:95]
    s_add_u32 m0, s41, 8192
    s_add_u32 s51, s46, 73728
    buffer_load_dwordx4 v0, s[16:19], s51 offen lds
    v_mfma_f32_16x16x32_bf16 v[96:99], v[112:115], v[136:139], v[96:99]
    s_add_u32 m0, s41, 12288
    s_add_u32 s51, s46, 110592
    buffer_load_dwordx4 v0, s[16:19], s51 offen lds
    s_waitcnt lgkmcnt(0)
    v_mfma_f32_16x16x32_bf16 v[4:7], v[140:143], v[156:159], v[4:7]
    v_mfma_f32_16x16x32_bf16 v[8:11], v[140:143], v[160:163], v[8:11]
    v_mfma_f32_16x16x32_bf16 v[12:15], v[140:143], v[164:167], v[12:15]
    v_mfma_f32_16x16x32_bf16 v[16:19], v[140:143], v[168:171], v[16:19]
    s_add_u32 m0, s41, 16384
    s_add_u32 s51, s47, 0
    buffer_load_dwordx4 v1, s[20:23], s51 offen lds
    v_mfma_f32_16x16x32_bf16 v[20:23], v[140:143], v[172:175], v[20:23]
    v_mfma_f32_16x16x32_bf16 v[24:27], v[140:143], v[176:179], v[24:27]
    v_mfma_f32_16x16x32_bf16 v[28:31], v[144:147], v[156:159], v[28:31]
    v_mfma_f32_16x16x32_bf16 v[32:35], v[144:147], v[160:163], v[32:35]
    s_add_u32 m0, s41, 20480
    s_add_u32 s51, s47, 36864
    buffer_load_dwordx4 v1, s[20:23], s51 offen lds
    v_mfma_f32_16x16x32_bf16 v[36:39], v[144:147], v[164:167], v[36:39]
    v_mfma_f32_16x16x32_bf16 v[40:43], v[144:147], v[168:171], v[40:43]
    v_mfma_f32_16x16x32_bf16 v[44:47], v[144:147], v[172:175], v[44:47]
    v_mfma_f32_16x16x32_bf16 v[48:51], v[144:147], v[176:179], v[48:51]
    s_add_u32 m0, s41, 24576
    s_add_u32 s51, s47, 73728
    buffer_load_dwordx4 v1, s[20:23], s51 offen lds
    v_mfma_f32_16x16x32_bf16 v[52:55], v[148:151], v[156:159], v[52:55]
    v_mfma_f32_16x16x32_bf16 v[56:59], v[148:151], v[160:163], v[56:59]
    v_mfma_f32_16x16x32_bf16 v[60:63], v[148:151], v[164:167], v[60:63]
    v_mfma_f32_16x16x32_bf16 v[64:67], v[148:151], v[168:171], v[64:67]
    s_add_u32 m0, s41, 28672
    s_add_u32 s51, s47, 110592
    buffer_load_dwordx4 v1, s[20:23], s51 offen lds
    v_mfma_f32_16x16x32_bf16 v[68:71], v[148:151], v[172:175], v[68:71]
    v_mfma_f32_16x16x32_bf16 v[72:75], v[148:151], v[176:179], v[72:75]
    v_mfma_f32_16x16x32_bf16 v[76:79], v[152:155], v[156:159], v[76:79]
    v_mfma_f32_16x16x32_bf16 v[80:83], v[152:155], v[160:163], v[80:83]
    s_add_u32 m0, s41, 32768
    s_add_u32 s51, s47, 147456
    buffer_load_dwordx4 v1, s[20:23], s51 offen lds
    v_mfma_f32_16x16x32_bf16 v[84:87], v[152:155], v[164:167], v[84:87]
    v_mfma_f32_16x16x32_bf16 v[88:91], v[152:155], v[168:171], v[88:91]
    v_mfma_f32_16x16x32_bf16 v[92:95], v[152:155], v[172:175], v[92:95]
    v_mfma_f32_16x16x32_bf16 v[96:99], v[152:155], v[176:179], v[96:99]
    s_add_u32 m0, s41, 36864
    s_add_u32 s51, s47, 184320
    buffer_load_dwordx4 v1, s[20:23], s51 offen lds
    s_waitcnt vmcnt(10)
    s_barrier
    v_add_u32 v180, 40960, v180
    v_add_u32 v181, 40960, v181
    v_add_u32 v182, 40960, v182
    v_add_u32 v183, 40960, v183
    ds_read_b128 v[116:119], v182 offset:16384
    ds_read_b128 v[120:123], v182 offset:18432
    ds_read_b128 v[124:127], v182 offset:20480
    ds_read_b128 v[128:131], v182 offset:22528
    ds_read_b128 v[132:135], v182 offset:24576
    ds_read_b128 v[136:139], v182 offset:26624
    ds_read_b128 v[100:103], v180 offset:0
    ds_read_b128 v[104:107], v180 offset:2048
    ds_read_b128 v[108:111], v180 offset:4096
    ds_read_b128 v[112:115], v180 offset:6144
    s_waitcnt lgkmcnt(0)
    v_mfma_f32_16x16x32_bf16 v[4:7], v[100:103], v[116:119], v[4:7]
    v_mfma_f32_16x16x32_bf16 v[8:11], v[100:103], v[120:123], v[8:11]
    ds_read_b128 v[156:159], v183 offset:16384
    v_mfma_f32_16x16x32_bf16 v[12:15], v[100:103], v[124:127], v[12:15]
    v_mfma_f32_16x16x32_bf16 v[16:19], v[100:103], v[128:131], v[16:19]
    ds_read_b128 v[160:163], v183 offset:18432
    v_mfma_f32_16x16x32_bf16 v[20:23], v[100:103], v[132:135], v[20:23]
    ds_read_b128 v[164:167], v183 offset:20480
    v_mfma_f32_16x16x32_bf16 v[24:27], v[100:103], v[136:139], v[24:27]
    v_mfma_f32_16x16x32_bf16 v[28:31], v[104:107], v[116:119], v[28:31]
    ds_read_b128 v[168:171], v183 offset:22528
    v_mfma_f32_16x16x32_bf16 v[32:35], v[104:107], v[120:123], v[32:35]
    ds_read_b128 v[172:175], v183 offset:24576
    v_mfma_f32_16x16x32_bf16 v[36:39], v[104:107], v[124:127], v[36:39]
    v_mfma_f32_16x16x32_bf16 v[40:43], v[104:107], v[128:131], v[40:43]
    ds_read_b128 v[176:179], v183 offset:26624
    v_mfma_f32_16x16x32_bf16 v[44:47], v[104:107], v[132:135], v[44:47]
    v_mfma_f32_16x16x32_bf16 v[48:51], v[104:107], v[136:139], v[48:51]
    ds_read_b128 v[140:143], v181 offset:0
    v_mfma_f32_16x16x32_bf16 v[52:55], v[108:111], v[116:119], v[52:55]
    ds_read_b128 v[144:147], v181 offset:2048
    v_mfma_f32_16x16x32_bf16 v[56:59], v[108:111], v[120:123], v[56:59]
    v_mfma_f32_16x16x32_bf16 v[60:63], v[108:111], v[124:127], v[60:63]
    ds_read_b128 v[148:151], v181 offset:4096
    v_mfma_f32_16x16x32_bf16 v[64:67], v[108:111], v[128:131], v[64:67]
    ds_read_b128 v[152:155], v181 offset:6144
    v_mfma_f32_16x16x32_bf16 v[68:71], v[108:111], v[132:135], v[68:71]
    v_mfma_f32_16x16x32_bf16 v[72:75], v[108:111], v[136:139], v[72:75]
    s_add_u32 s46, s46, 128
    s_add_u32 s47, s47, 128
    v_mfma_f32_16x16x32_bf16 v[76:79], v[112:115], v[116:119], v[76:79]
    v_mfma_f32_16x16x32_bf16 v[80:83], v[112:115], v[120:123], v[80:83]
    s_add_u32 m0, s41, 40960
    s_add_u32 s51, s46, 0
    buffer_load_dwordx4 v0, s[16:19], s51 offen lds
    v_mfma_f32_16x16x32_bf16 v[84:87], v[112:115], v[124:127], v[84:87]
    s_add_u32 m0, s41, 45056
    s_add_u32 s51, s46, 36864
    buffer_load_dwordx4 v0, s[16:19], s51 offen lds
    v_mfma_f32_16x16x32_bf16 v[88:91], v[112:115], v[128:131], v[88:91]
    v_mfma_f32_16x16x32_bf16 v[92:95], v[112:115], v[132:135], v[92:95]
    s_add_u32 m0, s41, 49152
    s_add_u32 s51, s46, 73728
    buffer_load_dwordx4 v0, s[16:19], s51 offen lds
    v_mfma_f32_16x16x32_bf16 v[96:99], v[112:115], v[136:139], v[96:99]
    s_add_u32 m0, s41, 53248
    s_add_u32 s51, s46, 110592
    buffer_load_dwordx4 v0, s[16:19], s51 offen lds
    s_waitcnt lgkmcnt(0)
    v_mfma_f32_16x16x32_bf16 v[4:7], v[140:143], v[156:159], v[4:7]
    v_mfma_f32_16x16x32_bf16 v[8:11], v[140:143], v[160:163], v[8:11]
    v_mfma_f32_16x16x32_bf16 v[12:15], v[140:143], v[164:167], v[12:15]
    v_mfma_f32_16x16x32_bf16 v[16:19], v[140:143], v[168:171], v[16:19]
    s_add_u32 m0, s41, 57344
    s_add_u32 s51, s47, 0
    buffer_load_dwordx4 v1, s[20:23], s51 offen lds
    v_mfma_f32_16x16x32_bf16 v[20:23], v[140:143], v[172:175], v[20:23]
    v_mfma_f32_16x16x32_bf16 v[24:27], v[140:143], v[176:179], v[24:27]
    v_mfma_f32_16x16x32_bf16 v[28:31], v[144:147], v[156:159], v[28:31]
    v_mfma_f32_16x16x32_bf16 v[32:35], v[144:147], v[160:163], v[32:35]
    s_add_u32 m0, s41, 61440
    s_add_u32 s51, s47, 36864
    buffer_load_dwordx4 v1, s[20:23], s51 offen lds
    v_mfma_f32_16x16x32_bf16 v[36:39], v[144:147], v[164:167], v[36:39]
    v_mfma_f32_16x16x32_bf16 v[40:43], v[144:147], v[168:171], v[40:43]
    v_mfma_f32_16x16x32_bf16 v[44:47], v[144:147], v[172:175], v[44:47]
    v_mfma_f32_16x16x32_bf16 v[48:51], v[144:147], v[176:179], v[48:51]
    s_add_u32 m0, s41, 65536
    s_add_u32 s51, s47, 73728
    buffer_load_dwordx4 v1, s[20:23], s51 offen lds
    v_mfma_f32_16x16x32_bf16 v[52:55], v[148:151], v[156:159], v[52:55]
    v_mfma_f32_16x16x32_bf16 v[56:59], v[148:151], v[160:163], v[56:59]
    v_mfma_f32_16x16x32_bf16 v[60:63], v[148:151], v[164:167], v[60:63]
    v_mfma_f32_16x16x32_bf16 v[64:67], v[148:151], v[168:171], v[64:67]
    s_add_u32 m0, s41, 69632
    s_add_u32 s51, s47, 110592
    buffer_load_dwordx4 v1, s[20:23], s51 offen lds
    v_mfma_f32_16x16x32_bf16 v[68:71], v[148:151], v[172:175], v[68:71]
    v_mfma_f32_16x16x32_bf16 v[72:75], v[148:151], v[176:179], v[72:75]
    v_mfma_f32_16x16x32_bf16 v[76:79], v[152:155], v[156:159], v[76:79]
    v_mfma_f32_16x16x32_bf16 v[80:83], v[152:155], v[160:163], v[80:83]
    s_add_u32 m0, s41, 73728
    s_add_u32 s51, s47, 147456
    buffer_load_dwordx4 v1, s[20:23], s51 offen lds
    v_mfma_f32_16x16x32_bf16 v[84:87], v[152:155], v[164:167], v[84:87]
    v_mfma_f32_16x16x32_bf16 v[88:91], v[152:155], v[168:171], v[88:91]
    v_mfma_f32_16x16x32_bf16 v[92:95], v[152:155], v[172:175], v[92:95]
    v_mfma_f32_16x16x32_bf16 v[96:99], v[152:155], v[176:179], v[96:99]
    s_add_u32 m0, s41, 77824
    s_add_u32 s51, s47, 184320
    buffer_load_dwordx4 v1, s[20:23], s51 offen lds
    s_waitcnt vmcnt(10)
    s_barrier
    v_subrev_u32 v180, 81920, v180
    v_subrev_u32 v181, 81920, v181
    v_subrev_u32 v182, 81920, v182
    v_subrev_u32 v183, 81920, v183
    ds_read_b128 v[116:119], v182 offset:16384
    ds_read_b128 v[120:123], v182 offset:18432
    ds_read_b128 v[124:127], v182 offset:20480
    ds_read_b128 v[128:131], v182 offset:22528
    ds_read_b128 v[132:135], v182 offset:24576
    ds_read_b128 v[136:139], v182 offset:26624
    ds_read_b128 v[100:103], v180 offset:0
    ds_read_b128 v[104:107], v180 offset:2048
    ds_read_b128 v[108:111], v180 offset:4096
    ds_read_b128 v[112:115], v180 offset:6144
    s_waitcnt lgkmcnt(0)
    v_mfma_f32_16x16x32_bf16 v[4:7], v[100:103], v[116:119], v[4:7]
    v_mfma_f32_16x16x32_bf16 v[8:11], v[100:103], v[120:123], v[8:11]
    ds_read_b128 v[156:159], v183 offset:16384
    v_mfma_f32_16x16x32_bf16 v[12:15], v[100:103], v[124:127], v[12:15]
    v_mfma_f32_16x16x32_bf16 v[16:19], v[100:103], v[128:131], v[16:19]
    ds_read_b128 v[160:163], v183 offset:18432
    v_mfma_f32_16x16x32_bf16 v[20:23], v[100:103], v[132:135], v[20:23]
    ds_read_b128 v[164:167], v183 offset:20480
    v_mfma_f32_16x16x32_bf16 v[24:27], v[100:103], v[136:139], v[24:27]
    v_mfma_f32_16x16x32_bf16 v[28:31], v[104:107], v[116:119], v[28:31]
    ds_read_b128 v[168:171], v183 offset:22528
    v_mfma_f32_16x16x32_bf16 v[32:35], v[104:107], v[120:123], v[32:35]
    ds_read_b128 v[172:175], v183 offset:24576
    v_mfma_f32_16x16x32_bf16 v[36:39], v[104:107], v[124:127], v[36:39]
    v_mfma_f32_16x16x32_bf16 v[40:43], v[104:107], v[128:131], v[40:43]
    ds_read_b128 v[176:179], v183 offset:26624
    v_mfma_f32_16x16x32_bf16 v[44:47], v[104:107], v[132:135], v[44:47]
    v_mfma_f32_16x16x32_bf16 v[48:51], v[104:107], v[136:139], v[48:51]
    ds_read_b128 v[140:143], v181 offset:0
    v_mfma_f32_16x16x32_bf16 v[52:55], v[108:111], v[116:119], v[52:55]
    ds_read_b128 v[144:147], v181 offset:2048
    v_mfma_f32_16x16x32_bf16 v[56:59], v[108:111], v[120:123], v[56:59]
    v_mfma_f32_16x16x32_bf16 v[60:63], v[108:111], v[124:127], v[60:63]
    ds_read_b128 v[148:151], v181 offset:4096
    v_mfma_f32_16x16x32_bf16 v[64:67], v[108:111], v[128:131], v[64:67]
    ds_read_b128 v[152:155], v181 offset:6144
    v_mfma_f32_16x16x32_bf16 v[68:71], v[108:111], v[132:135], v[68:71]
    v_mfma_f32_16x16x32_bf16 v[72:75], v[108:111], v[136:139], v[72:75]
    s_add_u32 s46, s46, 128
    s_add_u32 s47, s47, 128
    v_mfma_f32_16x16x32_bf16 v[76:79], v[112:115], v[116:119], v[76:79]
    v_mfma_f32_16x16x32_bf16 v[80:83], v[112:115], v[120:123], v[80:83]
    s_add_u32 m0, s41, 81920
    s_add_u32 s51, s46, 0
    buffer_load_dwordx4 v0, s[16:19], s51 offen lds
    v_mfma_f32_16x16x32_bf16 v[84:87], v[112:115], v[124:127], v[84:87]
    s_add_u32 m0, s41, 86016
    s_add_u32 s51, s46, 36864
    buffer_load_dwordx4 v0, s[16:19], s51 offen lds
    v_mfma_f32_16x16x32_bf16 v[88:91], v[112:115], v[128:131], v[88:91]
    v_mfma_f32_16x16x32_bf16 v[92:95], v[112:115], v[132:135], v[92:95]
    s_add_u32 m0, s41, 90112
    s_add_u32 s51, s46, 73728
    buffer_load_dwordx4 v0, s[16:19], s51 offen lds
    v_mfma_f32_16x16x32_bf16 v[96:99], v[112:115], v[136:139], v[96:99]
    s_add_u32 m0, s41, 94208
    s_add_u32 s51, s46, 110592
    buffer_load_dwordx4 v0, s[16:19], s51 offen lds
    s_waitcnt lgkmcnt(0)
    v_mfma_f32_16x16x32_bf16 v[4:7], v[140:143], v[156:159], v[4:7]
    v_mfma_f32_16x16x32_bf16 v[8:11], v[140:143], v[160:163], v[8:11]
    v_mfma_f32_16x16x32_bf16 v[12:15], v[140:143], v[164:167], v[12:15]
    v_mfma_f32_16x16x32_bf16 v[16:19], v[140:143], v[168:171], v[16:19]
    s_add_u32 m0, s41, 98304
    s_add_u32 s51, s47, 0
    buffer_load_dwordx4 v1, s[20:23], s51 offen lds
    v_mfma_f32_16x16x32_bf16 v[20:23], v[140:143], v[172:175], v[20:23]
    v_mfma_f32_16x16x32_bf16 v[24:27], v[140:143], v[176:179], v[24:27]
    v_mfma_f32_16x16x32_bf16 v[28:31], v[144:147], v[156:159], v[28:31]
    v_mfma_f32_16x16x32_bf16 v[32:35], v[144:147], v[160:163], v[32:35]
    s_add_u32 m0, s41, 102400
    s_add_u32 s51, s47, 36864
    buffer_load_dwordx4 v1, s[20:23], s51 offen lds
    v_mfma_f32_16x16x32_bf16 v[36:39], v[144:147], v[164:167], v[36:39]
    v_mfma_f32_16x16x32_bf16 v[40:43], v[144:147], v[168:171], v[40:43]
    v_mfma_f32_16x16x32_bf16 v[44:47], v[144:147], v[172:175], v[44:47]
    v_mfma_f32_16x16x32_bf16 v[48:51], v[144:147], v[176:179], v[48:51]
    s_add_u32 m0, s41, 106496
    s_add_u32 s51, s47, 73728
    buffer_load_dwordx4 v1, s[20:23], s51 offen lds
    v_mfma_f32_16x16x32_bf16 v[52:55], v[148:151], v[156:159], v[52:55]
    v_mfma_f32_16x16x32_bf16 v[56:59], v[148:151], v[160:163], v[56:59]
    v_mfma_f32_16x16x32_bf16 v[60:63], v[148:151], v[164:167], v[60:63]
    v_mfma_f32_16x16x32_bf16 v[64:67], v[148:151], v[168:171], v[64:67]
    s_add_u32 m0, s41, 110592
    s_add_u32 s51, s47, 110592
    buffer_load_dwordx4 v1, s[20:23], s51 offen lds
    v_mfma_f32_16x16x32_bf16 v[68:71], v[148:151], v[172:175], v[68:71]
    v_mfma_f32_16x16x32_bf16 v[72:75], v[148:151], v[176:179], v[72:75]
    v_mfma_f32_16x16x32_bf16 v[76:79], v[152:155], v[156:159], v[76:79]
    v_mfma_f32_16x16x32_bf16 v[80:83], v[152:155], v[160:163], v[80:83]
    s_add_u32 m0, s41, 114688
    s_add_u32 s51, s47, 147456
    buffer_load_dwordx4 v1, s[20:23], s51 offen lds
    v_mfma_f32_16x16x32_bf16 v[84:87], v[152:155], v[164:167], v[84:87]
    v_mfma_f32_16x16x32_bf16 v[88:91], v[152:155], v[168:171], v[88:91]
    v_mfma_f32_16x16x32_bf16 v[92:95], v[152:155], v[172:175], v[92:95]
    v_mfma_f32_16x16x32_bf16 v[96:99], v[152:155], v[176:179], v[96:99]
    s_add_u32 m0, s41, 118784
    s_add_u32 s51, s47, 184320
    buffer_load_dwordx4 v1, s[20:23], s51 offen lds
    s_waitcnt vmcnt(10)
    s_barrier
    v_add_u32 v180, 40960, v180
    v_add_u32 v181, 40960, v181
    v_add_u32 v182, 40960, v182
    v_add_u32 v183, 40960, v183
    ds_read_b128 v[116:119], v182 offset:16384
    ds_read_b128 v[120:123], v182 offset:18432
    ds_read_b128 v[124:127], v182 offset:20480
    ds_read_b128 v[128:131], v182 offset:22528
    ds_read_b128 v[132:135], v182 offset:24576
    ds_read_b128 v[136:139], v182 offset:26624
    ds_read_b128 v[100:103], v180 offset:0
    ds_read_b128 v[104:107], v180 offset:2048
    ds_read_b128 v[108:111], v180 offset:4096
    ds_read_b128 v[112:115], v180 offset:6144
    s_waitcnt lgkmcnt(0)
    v_mfma_f32_16x16x32_bf16 v[4:7], v[100:103], v[116:119], v[4:7]
    v_mfma_f32_16x16x32_bf16 v[8:11], v[100:103], v[120:123], v[8:11]
    v_mfma_f32_16x16x32_bf16 v[12:15], v[100:103], v[124:127], v[12:15]
    ds_read_b128 v[156:159], v183 offset:16384
    v_mfma_f32_16x16x32_bf16 v[16:19], v[100:103], v[128:131], v[16:19]
    v_mfma_f32_16x16x32_bf16 v[20:23], v[100:103], v[132:135], v[20:23]
    ds_read_b128 v[160:163], v183 offset:18432
    v_mfma_f32_16x16x32_bf16 v[24:27], v[100:103], v[136:139], v[24:27]
    v_mfma_f32_16x16x32_bf16 v[28:31], v[104:107], v[116:119], v[28:31]
    v_mfma_f32_16x16x32_bf16 v[32:35], v[104:107], v[120:123], v[32:35]
    ds_read_b128 v[164:167], v183 offset:20480
    v_mfma_f32_16x16x32_bf16 v[36:39], v[104:107], v[124:127], v[36:39]
    v_mfma_f32_16x16x32_bf16 v[40:43], v[104:107], v[128:131], v[40:43]
    ds_read_b128 v[168:171], v183 offset:22528
    v_mfma_f32_16x16x32_bf16 v[44:47], v[104:107], v[132:135], v[44:47]
    v_mfma_f32_16x16x32_bf16 v[48:51], v[104:107], v[136:139], v[48:51]
    ds_read_b128 v[172:175], v183 offset:24576
    v_mfma_f32_16x16x32_bf16 v[52:55], v[108:111], v[116:119], v[52:55]
    v_mfma_f32_16x16x32_bf16 v[56:59], v[108:111], v[120:123], v[56:59]
    v_mfma_f32_16x16x32_bf16 v[60:63], v[108:111], v[124:127], v[60:63]
    ds_read_b128 v[176:179], v183 offset:26624
    v_mfma_f32_16x16x32_bf16 v[64:67], v[108:111], v[128:131], v[64:67]
    v_mfma_f32_16x16x32_bf16 v[68:71], v[108:111], v[132:135], v[68:71]
    ds_read_b128 v[140:143], v181 offset:0
    v_mfma_f32_16x16x32_bf16 v[72:75], v[108:111], v[136:139], v[72:75]
    v_mfma_f32_16x16x32_bf16 v[76:79], v[112:115], v[116:119], v[76:79]
    v_mfma_f32_16x16x32_bf16 v[80:83], v[112:115], v[120:123], v[80:83]
    ds_read_b128 v[144:147], v181 offset:2048
    v_mfma_f32_16x16x32_bf16 v[84:87], v[112:115], v[124:127], v[84:87]
    v_mfma_f32_16x16x32_bf16 v[88:91], v[112:115], v[128:131], v[88:91]
    ds_read_b128 v[148:151], v181 offset:4096
    v_mfma_f32_16x16x32_bf16 v[92:95], v[112:115], v[132:135], v[92:95]
    v_mfma_f32_16x16x32_bf16 v[96:99], v[112:115], v[136:139], v[96:99]
    ds_read_b128 v[152:155], v181 offset:6144
    s_waitcnt lgkmcnt(0)
    v_mfma_f32_16x16x32_bf16 v[4:7], v[140:143], v[156:159], v[4:7]
    v_mfma_f32_16x16x32_bf16 v[8:11], v[140:143], v[160:163], v[8:11]
    v_mfma_f32_16x16x32_bf16 v[12:15], v[140:143], v[164:167], v[12:15]
    v_mfma_f32_16x16x32_bf16 v[16:19], v[140:143], v[168:171], v[16:19]
    v_mfma_f32_16x16x32_bf16 v[20:23], v[140:143], v[172:175], v[20:23]
    v_mfma_f32_16x16x32_bf16 v[24:27], v[140:143], v[176:179], v[24:27]
    v_mfma_f32_16x16x32_bf16 v[28:31], v[144:147], v[156:159], v[28:31]
    v_mfma_f32_16x16x32_bf16 v[32:35], v[144:147], v[160:163], v[32:35]
    v_mfma_f32_16x16x32_bf16 v[36:39], v[144:147], v[164:167], v[36:39]
    v_mfma_f32_16x16x32_bf16 v[40:43], v[144:147], v[168:171], v[40:43]
    v_mfma_f32_16x16x32_bf16 v[44:47], v[144:147], v[172:175], v[44:47]
    v_mfma_f32_16x16x32_bf16 v[48:51], v[144:147], v[176:179], v[48:51]
    v_mfma_f32_16x16x32_bf16 v[52:55], v[148:151], v[156:159], v[52:55]
    v_mfma_f32_16x16x32_bf16 v[56:59], v[148:151], v[160:163], v[56:59]
    v_mfma_f32_16x16x32_bf16 v[60:63], v[148:151], v[164:167], v[60:63]
    v_mfma_f32_16x16x32_bf16 v[64:67], v[148:151], v[168:171], v[64:67]
    v_mfma_f32_16x16x32_bf16 v[68:71], v[148:151], v[172:175], v[68:71]
    v_mfma_f32_16x16x32_bf16 v[72:75], v[148:151], v[176:179], v[72:75]
    v_mfma_f32_16x16x32_bf16 v[76:79], v[152:155], v[156:159], v[76:79]
    v_mfma_f32_16x16x32_bf16 v[80:83], v[152:155], v[160:163], v[80:83]
    v_mfma_f32_16x16x32_bf16 v[84:87], v[152:155], v[164:167], v[84:87]
    v_mfma_f32_16x16x32_bf16 v[88:91], v[152:155], v[168:171], v[88:91]
    v_mfma_f32_16x16x32_bf16 v[92:95], v[152:155], v[172:175], v[92:95]
    v_mfma_f32_16x16x32_bf16 v[96:99], v[152:155], v[176:179], v[96:99]
    s_waitcnt vmcnt(0)
    s_barrier
    v_add_u32 v180, 40960, v180
    v_add_u32 v181, 40960, v181
    v_add_u32 v182, 40960, v182
    v_add_u32 v183, 40960, v183
    ds_read_b128 v[116:119], v182 offset:16384
    ds_read_b128 v[120:123], v182 offset:18432
    ds_read_b128 v[124:127], v182 offset:20480
    ds_read_b128 v[128:131], v182 offset:22528
    ds_read_b128 v[132:135], v182 offset:24576
    ds_read_b128 v[136:139], v182 offset:26624
    ds_read_b128 v[100:103], v180 offset:0
    ds_read_b128 v[104:107], v180 offset:2048
    ds_read_b128 v[108:111], v180 offset:4096
    ds_read_b128 v[112:115], v180 offset:6144
    s_waitcnt lgkmcnt(0)
    v_mfma_f32_16x16x32_bf16 v[4:7], v[100:103], v[116:119], v[4:7]
    v_mfma_f32_16x16x32_bf16 v[8:11], v[100:103], v[120:123], v[8:11]
    v_mfma_f32_16x16x32_bf16 v[12:15], v[100:103], v[124:127], v[12:15]
    ds_read_b128 v[156:159], v183 offset:16384
    v_mfma_f32_16x16x32_bf16 v[16:19], v[100:103], v[128:131], v[16:19]
    v_mfma_f32_16x16x32_bf16 v[20:23], v[100:103], v[132:135], v[20:23]
    ds_read_b128 v[160:163], v183 offset:18432
    v_mfma_f32_16x16x32_bf16 v[24:27], v[100:103], v[136:139], v[24:27]
    v_mfma_f32_16x16x32_bf16 v[28:31], v[104:107], v[116:119], v[28:31]
    v_mfma_f32_16x16x32_bf16 v[32:35], v[104:107], v[120:123], v[32:35]
    ds_read_b128 v[164:167], v183 offset:20480
    v_mfma_f32_16x16x32_bf16 v[36:39], v[104:107], v[124:127], v[36:39]
    v_mfma_f32_16x16x32_bf16 v[40:43], v[104:107], v[128:131], v[40:43]
    ds_read_b128 v[168:171], v183 offset:22528
    v_mfma_f32_16x16x32_bf16 v[44:47], v[104:107], v[132:135], v[44:47]
    v_mfma_f32_16x16x32_bf16 v[48:51], v[104:107], v[136:139], v[48:51]
    ds_read_b128 v[172:175], v183 offset:24576
    v_mfma_f32_16x16x32_bf16 v[52:55], v[108:111], v[116:119], v[52:55]
    v_mfma_f32_16x16x32_bf16 v[56:59], v[108:111], v[120:123], v[56:59]
    v_mfma_f32_16x16x32_bf16 v[60:63], v[108:111], v[124:127], v[60:63]
    ds_read_b128 v[176:179], v183 offset:26624
    v_mfma_f32_16x16x32_bf16 v[64:67], v[108:111], v[128:131], v[64:67]
    v_mfma_f32_16x16x32_bf16 v[68:71], v[108:111], v[132:135], v[68:71]
    ds_read_b128 v[140:143], v181 offset:0
    v_mfma_f32_16x16x32_bf16 v[72:75], v[108:111], v[136:139], v[72:75]
    v_mfma_f32_16x16x32_bf16 v[76:79], v[112:115], v[116:119], v[76:79]
    v_mfma_f32_16x16x32_bf16 v[80:83], v[112:115], v[120:123], v[80:83]
    ds_read_b128 v[144:147], v181 offset:2048
    v_mfma_f32_16x16x32_bf16 v[84:87], v[112:115], v[124:127], v[84:87]
    v_mfma_f32_16x16x32_bf16 v[88:91], v[112:115], v[128:131], v[88:91]
    ds_read_b128 v[148:151], v181 offset:4096
    v_mfma_f32_16x16x32_bf16 v[92:95], v[112:115], v[132:135], v[92:95]
    v_mfma_f32_16x16x32_bf16 v[96:99], v[112:115], v[136:139], v[96:99]
    ds_read_b128 v[152:155], v181 offset:6144
    s_waitcnt lgkmcnt(0)
    v_mfma_f32_16x16x32_bf16 v[4:7], v[140:143], v[156:159], v[4:7]
    v_mfma_f32_16x16x32_bf16 v[8:11], v[140:143], v[160:163], v[8:11]
    v_mfma_f32_16x16x32_bf16 v[12:15], v[140:143], v[164:167], v[12:15]
    v_mfma_f32_16x16x32_bf16 v[16:19], v[140:143], v[168:171], v[16:19]
    v_mfma_f32_16x16x32_bf16 v[20:23], v[140:143], v[172:175], v[20:23]
    v_mfma_f32_16x16x32_bf16 v[24:27], v[140:143], v[176:179], v[24:27]
    v_mfma_f32_16x16x32_bf16 v[28:31], v[144:147], v[156:159], v[28:31]
    v_mfma_f32_16x16x32_bf16 v[32:35], v[144:147], v[160:163], v[32:35]
    v_mfma_f32_16x16x32_bf16 v[36:39], v[144:147], v[164:167], v[36:39]
    v_mfma_f32_16x16x32_bf16 v[40:43], v[144:147], v[168:171], v[40:43]
    v_mfma_f32_16x16x32_bf16 v[44:47], v[144:147], v[172:175], v[44:47]
    v_mfma_f32_16x16x32_bf16 v[48:51], v[144:147], v[176:179], v[48:51]
    v_mfma_f32_16x16x32_bf16 v[52:55], v[148:151], v[156:159], v[52:55]
    v_mfma_f32_16x16x32_bf16 v[56:59], v[148:151], v[160:163], v[56:59]
    v_mfma_f32_16x16x32_bf16 v[60:63], v[148:151], v[164:167], v[60:63]
    v_mfma_f32_16x16x32_bf16 v[64:67], v[148:151], v[168:171], v[64:67]
    v_mfma_f32_16x16x32_bf16 v[68:71], v[148:151], v[172:175], v[68:71]
    v_mfma_f32_16x16x32_bf16 v[72:75], v[148:151], v[176:179], v[72:75]
    v_mfma_f32_16x16x32_bf16 v[76:79], v[152:155], v[156:159], v[76:79]
    v_mfma_f32_16x16x32_bf16 v[80:83], v[152:155], v[160:163], v[80:83]
    v_mfma_f32_16x16x32_bf16 v[84:87], v[152:155], v[164:167], v[84:87]
    v_mfma_f32_16x16x32_bf16 v[88:91], v[152:155], v[168:171], v[88:91]
    v_mfma_f32_16x16x32_bf16 v[92:95], v[152:155], v[172:175], v[92:95]
    v_mfma_f32_16x16x32_bf16 v[96:99], v[152:155], v[176:179], v[96:99]
    s_waitcnt vmcnt(0)
    s_barrier
    s_nop 7
    s_nop 7
    v_and_b32 v249, 15, v250
    s_mul_i32 s55, s44, 192
    s_mul_i32 s56, s43, 96
    s_add_u32 s55, s55, s56
    v_add_u32 v249, s55, v249
    v_lshlrev_b32 v249, 12, v249
    v_lshrrev_b32 v248, 4, v250
    v_lshlrev_b32 v248, 3, v248
    v_add_u32 v249, v249, v248
    s_lshl_b32 s55, s45, 8
    s_lshl_b32 s56, s42, 7
    s_add_u32 s55, s55, s56
    v_add_u32 v249, s55, v249
    v_cvt_pk_bf16_f32 v184, v4, v5
    v_cvt_pk_bf16_f32 v185, v6, v7
    s_mov_b32 s55, 0
    buffer_store_dwordx2 v[184:185], v249, s[28:31], s55 offen offset:0
    s_nop 1
    v_cvt_pk_bf16_f32 v184, v8, v9
    v_cvt_pk_bf16_f32 v185, v10, v11
    s_mov_b32 s55, 65536
    buffer_store_dwordx2 v[184:185], v249, s[28:31], s55 offen offset:0
    s_nop 1
    v_cvt_pk_bf16_f32 v184, v12, v13
    v_cvt_pk_bf16_f32 v185, v14, v15
    s_mov_b32 s55, 131072
    buffer_store_dwordx2 v[184:185], v249, s[28:31], s55 offen offset:0
    s_nop 1
    v_cvt_pk_bf16_f32 v184, v16, v17
    v_cvt_pk_bf16_f32 v185, v18, v19
    s_mov_b32 s55, 196608
    buffer_store_dwordx2 v[184:185], v249, s[28:31], s55 offen offset:0
    s_nop 1
    v_cvt_pk_bf16_f32 v184, v20, v21
    v_cvt_pk_bf16_f32 v185, v22, v23
    s_mov_b32 s55, 262144
    buffer_store_dwordx2 v[184:185], v249, s[28:31], s55 offen offset:0
    s_nop 1
    v_cvt_pk_bf16_f32 v184, v24, v25
    v_cvt_pk_bf16_f32 v185, v26, v27
    s_mov_b32 s55, 327680
    buffer_store_dwordx2 v[184:185], v249, s[28:31], s55 offen offset:0
    s_nop 1
    v_cvt_pk_bf16_f32 v184, v28, v29
    v_cvt_pk_bf16_f32 v185, v30, v31
    s_mov_b32 s55, 0
    buffer_store_dwordx2 v[184:185], v249, s[28:31], s55 offen offset:32
    s_nop 1
    v_cvt_pk_bf16_f32 v184, v32, v33
    v_cvt_pk_bf16_f32 v185, v34, v35
    s_mov_b32 s55, 65536
    buffer_store_dwordx2 v[184:185], v249, s[28:31], s55 offen offset:32
    s_nop 1
    v_cvt_pk_bf16_f32 v184, v36, v37
    v_cvt_pk_bf16_f32 v185, v38, v39
    s_mov_b32 s55, 131072
    buffer_store_dwordx2 v[184:185], v249, s[28:31], s55 offen offset:32
    s_nop 1
    v_cvt_pk_bf16_f32 v184, v40, v41
    v_cvt_pk_bf16_f32 v185, v42, v43
    s_mov_b32 s55, 196608
    buffer_store_dwordx2 v[184:185], v249, s[28:31], s55 offen offset:32
    s_nop 1
    v_cvt_pk_bf16_f32 v184, v44, v45
    v_cvt_pk_bf16_f32 v185, v46, v47
    s_mov_b32 s55, 262144
    buffer_store_dwordx2 v[184:185], v249, s[28:31], s55 offen offset:32
    s_nop 1
    v_cvt_pk_bf16_f32 v184, v48, v49
    v_cvt_pk_bf16_f32 v185, v50, v51
    s_mov_b32 s55, 327680
    buffer_store_dwordx2 v[184:185], v249, s[28:31], s55 offen offset:32
    s_nop 1
    v_cvt_pk_bf16_f32 v184, v52, v53
    v_cvt_pk_bf16_f32 v185, v54, v55
    s_mov_b32 s55, 0
    buffer_store_dwordx2 v[184:185], v249, s[28:31], s55 offen offset:64
    s_nop 1
    v_cvt_pk_bf16_f32 v184, v56, v57
    v_cvt_pk_bf16_f32 v185, v58, v59
    s_mov_b32 s55, 65536
    buffer_store_dwordx2 v[184:185], v249, s[28:31], s55 offen offset:64
    s_nop 1
    v_cvt_pk_bf16_f32 v184, v60, v61
    v_cvt_pk_bf16_f32 v185, v62, v63
    s_mov_b32 s55, 131072
    buffer_store_dwordx2 v[184:185], v249, s[28:31], s55 offen offset:64
    s_nop 1
    v_cvt_pk_bf16_f32 v184, v64, v65
    v_cvt_pk_bf16_f32 v185, v66, v67
    s_mov_b32 s55, 196608
    buffer_store_dwordx2 v[184:185], v249, s[28:31], s55 offen offset:64
    s_nop 1
    v_cvt_pk_bf16_f32 v184, v68, v69
    v_cvt_pk_bf16_f32 v185, v70, v71
    s_mov_b32 s55, 262144
    buffer_store_dwordx2 v[184:185], v249, s[28:31], s55 offen offset:64
    s_nop 1
    v_cvt_pk_bf16_f32 v184, v72, v73
    v_cvt_pk_bf16_f32 v185, v74, v75
    s_mov_b32 s55, 327680
    buffer_store_dwordx2 v[184:185], v249, s[28:31], s55 offen offset:64
    s_nop 1
    v_cvt_pk_bf16_f32 v184, v76, v77
    v_cvt_pk_bf16_f32 v185, v78, v79
    s_mov_b32 s55, 0
    buffer_store_dwordx2 v[184:185], v249, s[28:31], s55 offen offset:96
    s_nop 1
    v_cvt_pk_bf16_f32 v184, v80, v81
    v_cvt_pk_bf16_f32 v185, v82, v83
    s_mov_b32 s55, 65536
    buffer_store_dwordx2 v[184:185], v249, s[28:31], s55 offen offset:96
    s_nop 1
    v_cvt_pk_bf16_f32 v184, v84, v85
    v_cvt_pk_bf16_f32 v185, v86, v87
    s_mov_b32 s55, 131072
    buffer_store_dwordx2 v[184:185], v249, s[28:31], s55 offen offset:96
    s_nop 1
    v_cvt_pk_bf16_f32 v184, v88, v89
    v_cvt_pk_bf16_f32 v185, v90, v91
    s_mov_b32 s55, 196608
    buffer_store_dwordx2 v[184:185], v249, s[28:31], s55 offen offset:96
    s_nop 1
    v_cvt_pk_bf16_f32 v184, v92, v93
    v_cvt_pk_bf16_f32 v185, v94, v95
    s_mov_b32 s55, 262144
    buffer_store_dwordx2 v[184:185], v249, s[28:31], s55 offen offset:96
    s_nop 1
    v_cvt_pk_bf16_f32 v184, v96, v97
    v_cvt_pk_bf16_f32 v185, v98, v99
    s_mov_b32 s55, 327680
    buffer_store_dwordx2 v[184:185], v249, s[28:31], s55 offen offset:96
    s_nop 1
K1_END:
    s_endpgm
.globl stageb_kernel
.p2align 8
.type stageb_kernel,@function
stageb_kernel:
    s_cmp_ge_u32 s2, 256
    s_cbranch_scc1 K2_END
    s_load_dwordx4 s[4:7], s[0:1], 8
    s_load_dwordx2 s[8:9], s[0:1], 64
    s_load_dwordx2 s[12:13], s[0:1], 88
    v_and_b32 v250, 63, v0
    v_lshrrev_b32 v251, 6, v0
    s_nop 0
    v_readfirstlane_b32 s40, v251
    s_lshl_b32 s41, s40, 10
    s_bfe_u32 s44, s2, 0x20003
    s_and_b32 s45, s2, 7
    s_lshr_b32 s46, s2, 5
    s_lshl_b32 s46, s46, 3
    s_add_u32 s45, s45, s46
    s_lshr_b32 s47, s45, 4
    s_and_b32 s45, s45, 15
    s_waitcnt lgkmcnt(0)
    s_mov_b32 s53, 0
    s_lshl_b32 s54, s40, 1
    s_cmp_ge_u32 s47, 2
    s_cbranch_scc1 K2_DOWN
    s_cmp_eq_u32 s47, 1
    s_cselect_b32 s16, s6, s4
    s_cselect_b32 s17, s7, s5
    s_mov_b32 s18, 0x800000
    s_mov_b32 s19, 0x00020000
    s_add_u32 s20, s12, 0x300000
    s_addc_u32 s21, s13, 0
    s_mov_b32 s22, 0x480000
    s_mov_b32 s23, 0x00020000
    s_cmp_eq_u32 s47, 1
    s_mov_b32 s56, 0x1a00000
    s_cselect_b32 s57, 0x1d00000, s56
    s_add_u32 s28, s12, s57
    s_addc_u32 s29, s13, 0
    s_mov_b32 s30, 0x240000
    s_mov_b32 s31, 0x00020000
    s_mov_b32 s58, 0
    s_mov_b32 s59, 0
    s_lshl_b32 s50, s45, 7
    v_lshrrev_b32 v249, 3, v250
    v_lshl_add_u32 v0, v251, 3, v249
    v_add_u32 v0, s50, v0
    s_mov_b32 s51, 4096
    v_mul_lo_u32 v0, v0, s51
    v_and_b32 v248, 7, v250
    v_xor_b32 v248, v248, v249
    v_lshl_add_u32 v0, v248, 4, v0
    s_mul_i32 s52, s44, 144
    s_mul_i32 s56, s47, 576
    s_add_u32 s52, s52, s56
    v_lshrrev_b32 v249, 3, v250
    v_lshl_add_u32 v1, v251, 3, v249
    v_add_u32 v1, s52, v1
    s_mov_b32 s51, 4096
    v_mul_lo_u32 v1, v1, s51
    v_and_b32 v248, 7, v250
    v_xor_b32 v248, v248, v249
    v_lshl_add_u32 v1, v248, 4, v1
    s_mov_b32 s60, 16
    v_mov_b32 v4, 0
    v_mov_b32 v5, 0
    v_mov_b32 v6, 0
    v_mov_b32 v7, 0
    v_mov_b32 v8, 0
    v_mov_b32 v9, 0
    v_mov_b32 v10, 0
    v_mov_b32 v11, 0
    v_mov_b32 v12, 0
    v_mov_b32 v13, 0
    v_mov_b32 v14, 0
    v_mov_b32 v15, 0
    v_mov_b32 v16, 0
    v_mov_b32 v17, 0
    v_mov_b32 v18, 0
    v_mov_b32 v19, 0
    v_mov_b32 v20, 0
    v_mov_b32 v21, 0
    v_mov_b32 v22, 0
    v_mov_b32 v23, 0
    v_mov_b32 v24, 0
    v_mov_b32 v25, 0
    v_mov_b32 v26, 0
    v_mov_b32 v27, 0
    v_mov_b32 v28, 0
    v_mov_b32 v29, 0
    v_mov_b32 v30, 0
    v_mov_b32 v31, 0
    v_mov_b32 v32, 0
    v_mov_b32 v33, 0
    v_mov_b32 v34, 0
    v_mov_b32 v35, 0
    v_mov_b32 v36, 0
    v_mov_b32 v37, 0
    v_mov_b32 v38, 0
    v_mov_b32 v39, 0
    v_mov_b32 v40, 0
    v_mov_b32 v41, 0
    v_mov_b32 v42, 0
    v_mov_b32 v43, 0
    v_mov_b32 v44, 0
    v_mov_b32 v45, 0
    v_mov_b32 v46, 0
    v_mov_b32 v47, 0
    v_mov_b32 v48, 0
    v_mov_b32 v49, 0
    v_mov_b32 v50, 0
    v_mov_b32 v51, 0
    v_mov_b32 v52, 0
    v_mov_b32 v53, 0
    v_mov_b32 v54, 0
    v_mov_b32 v55, 0
    v_mov_b32 v56, 0
    v_mov_b32 v57, 0
    v_mov_b32 v58, 0
    v_mov_b32 v59, 0
    v_mov_b32 v60, 0
    v_mov_b32 v61, 0
    v_mov_b32 v62, 0
    v_mov_b32 v63, 0
    v_mov_b32 v64, 0
    v_mov_b32 v65, 0
    v_mov_b32 v66, 0
    v_mov_b32 v67, 0
    v_mov_b32 v68, 0
    v_mov_b32 v69, 0
    v_mov_b32 v70, 0
    v_mov_b32 v71, 0
    v_mov_b32 v72, 0
    v_mov_b32 v73, 0
    v_mov_b32 v74, 0
    v_mov_b32 v75, 0
    v_and_b32 v164, 15, v250
    s_lshl_b32 s51, s53, 4
    v_add_u32 v164, s51, v164
    v_lshlrev_b32 v164, 7, v164
    v_lshrrev_b32 v249, 4, v250
    v_add_u32 v249, 0, v249
    v_and_b32 v248, 7, v250
    v_xor_b32 v249, v249, v248
    v_lshlrev_b32 v249, 4, v249
    v_add_u32 v164, v164, v249
    v_and_b32 v165, 15, v250
    s_lshl_b32 s51, s53, 4
    v_add_u32 v165, s51, v165
    v_lshlrev_b32 v165, 7, v165
    v_lshrrev_b32 v249, 4, v250
    v_add_u32 v249, 4, v249
    v_and_b32 v248, 7, v250
    v_xor_b32 v249, v249, v248
    v_lshlrev_b32 v249, 4, v249
    v_add_u32 v165, v165, v249
    v_and_b32 v166, 15, v250
    s_lshl_b32 s51, s54, 4
    v_add_u32 v166, s51, v166
    v_lshlrev_b32 v166, 7, v166
    v_lshrrev_b32 v249, 4, v250
    v_add_u32 v249, 0, v249
    v_and_b32 v248, 7, v250
    v_xor_b32 v249, v249, v248
    v_lshlrev_b32 v249, 4, v249
    v_add_u32 v166, v166, v249
    v_and_b32 v167, 15, v250
    s_lshl_b32 s51, s54, 4
    v_add_u32 v167, s51, v167
    v_lshlrev_b32 v167, 7, v167
    v_lshrrev_b32 v249, 4, v250
    v_add_u32 v249, 4, v249
    v_and_b32 v248, 7, v250
    v_xor_b32 v249, v249, v248
    v_lshlrev_b32 v249, 4, v249
    v_add_u32 v167, v167, v249
    s_add_u32 m0, s41, 0
    s_add_u32 s51, s58, 0
    buffer_load_dwordx4 v0, s[16:19], s51 offen lds
    s_add_u32 m0, s41, 4096
    s_add_u32 s51, s58, 131072
    buffer_load_dwordx4 v0, s[16:19], s51 offen lds
    s_add_u32 m0, s41, 8192
    s_add_u32 s51, s58, 262144
    buffer_load_dwordx4 v0, s[16:19], s51 offen lds
    s_add_u32 m0, s41, 12288
    s_add_u32 s51, s58, 393216
    buffer_load_dwordx4 v0, s[16:19], s51 offen lds
    s_add_u32 m0, s41, 16384
    s_add_u32 s51, s59, 0
    buffer_load_dwordx4 v1, s[20:23], s51 offen lds
    s_add_u32 m0, s41, 20480
    s_add_u32 s51, s59, 131072
    buffer_load_dwordx4 v1, s[20:23], s51 offen lds
    s_add_u32 m0, s41, 24576
    s_add_u32 s51, s59, 262144
    buffer_load_dwordx4 v1, s[20:23], s51 offen lds
    s_add_u32 m0, s41, 28672
    s_add_u32 s51, s59, 393216
    buffer_load_dwordx4 v1, s[20:23], s51 offen lds
    s_add_u32 m0, s41, 32768
    s_add_u32 s51, s59, 524288
    buffer_load_dwordx4 v1, s[20:23], s51 offen lds
    s_add_u32 s58, s58, 128
    s_add_u32 s59, s59, 128
    s_add_u32 m0, s41, 36864
    s_add_u32 s51, s58, 0
    buffer_load_dwordx4 v0, s[16:19], s51 offen lds
    s_add_u32 m0, s41, 40960
    s_add_u32 s51, s58, 131072
    buffer_load_dwordx4 v0, s[16:19], s51 offen lds
    s_add_u32 m0, s41, 45056
    s_add_u32 s51, s58, 262144
    buffer_load_dwordx4 v0, s[16:19], s51 offen lds
    s_add_u32 m0, s41, 49152
    s_add_u32 s51, s58, 393216
    buffer_load_dwordx4 v0, s[16:19], s51 offen lds
    s_add_u32 m0, s41, 53248
    s_add_u32 s51, s59, 0
    buffer_load_dwordx4 v1, s[20:23], s51 offen lds
    s_add_u32 m0, s41, 57344
    s_add_u32 s51, s59, 131072
    buffer_load_dwordx4 v1, s[20:23], s51 offen lds
    s_add_u32 m0, s41, 61440
    s_add_u32 s51, s59, 262144
    buffer_load_dwordx4 v1, s[20:23], s51 offen lds
    s_add_u32 m0, s41, 65536
    s_add_u32 s51, s59, 393216
    buffer_load_dwordx4 v1, s[20:23], s51 offen lds
    s_add_u32 m0, s41, 69632
    s_add_u32 s51, s59, 524288
    buffer_load_dwordx4 v1, s[20:23], s51 offen lds
    s_waitcnt vmcnt(9)
    s_barrier
    ds_read_b128 v[112:115], v166 offset:0
    ds_read_b128 v[116:119], v166 offset:2048
    ds_read_b128 v[76:79], v164 offset:16384
    ds_read_b128 v[80:83], v164 offset:18432
    ds_read_b128 v[84:87], v164 offset:20480
    ds_read_b128 v[88:91], v164 offset:22528
    ds_read_b128 v[92:95], v164 offset:24576
    ds_read_b128 v[96:99], v164 offset:26624
    ds_read_b128 v[100:103], v164 offset:28672
    ds_read_b128 v[104:107], v164 offset:30720
    ds_read_b128 v[108:111], v164 offset:32768
    s_waitcnt lgkmcnt(0)
    v_mfma_f32_16x16x32_bf16 v[4:7], v[76:79], v[112:115], v[4:7]
    v_mfma_f32_16x16x32_bf16 v[8:11], v[76:79], v[116:119], v[8:11]
    ds_read_b128 v[156:159], v167 offset:0
    v_mfma_f32_16x16x32_bf16 v[12:15], v[80:83], v[112:115], v[12:15]
    ds_read_b128 v[160:163], v167 offset:2048
    v_mfma_f32_16x16x32_bf16 v[16:19], v[80:83], v[116:119], v[16:19]
    ds_read_b128 v[120:123], v165 offset:16384
    v_mfma_f32_16x16x32_bf16 v[20:23], v[84:87], v[112:115], v[20:23]
    ds_read_b128 v[124:127], v165 offset:18432
    v_mfma_f32_16x16x32_bf16 v[24:27], v[84:87], v[116:119], v[24:27]
    ds_read_b128 v[128:131], v165 offset:20480
    v_mfma_f32_16x16x32_bf16 v[28:31], v[88:91], v[112:115], v[28:31]
    ds_read_b128 v[132:135], v165 offset:22528
    v_mfma_f32_16x16x32_bf16 v[32:35], v[88:91], v[116:119], v[32:35]
    ds_read_b128 v[136:139], v165 offset:24576
    v_mfma_f32_16x16x32_bf16 v[36:39], v[92:95], v[112:115], v[36:39]
    ds_read_b128 v[140:143], v165 offset:26624
    v_mfma_f32_16x16x32_bf16 v[40:43], v[92:95], v[116:119], v[40:43]
    v_mfma_f32_16x16x32_bf16 v[44:47], v[96:99], v[112:115], v[44:47]
    ds_read_b128 v[144:147], v165 offset:28672
    v_mfma_f32_16x16x32_bf16 v[48:51], v[96:99], v[116:119], v[48:51]
    ds_read_b128 v[148:151], v165 offset:30720
    v_mfma_f32_16x16x32_bf16 v[52:55], v[100:103], v[112:115], v[52:55]
    ds_read_b128 v[152:155], v165 offset:32768
    v_mfma_f32_16x16x32_bf16 v[56:59], v[100:103], v[116:119], v[56:59]
    s_add_u32 s58, s58, 128
    s_add_u32 s59, s59, 128
    v_mfma_f32_16x16x32_bf16 v[60:63], v[104:107], v[112:115], v[60:63]
    s_add_u32 m0, s41, 73728
    s_add_u32 s51, s58, 0
    buffer_load_dwordx4 v0, s[16:19], s51 offen lds
    v_mfma_f32_16x16x32_bf16 v[64:67], v[104:107], v[116:119], v[64:67]
    s_add_u32 m0, s41, 77824
    s_add_u32 s51, s58, 131072
    buffer_load_dwordx4 v0, s[16:19], s51 offen lds
    v_mfma_f32_16x16x32_bf16 v[68:71], v[108:111], v[112:115], v[68:71]
    s_add_u32 m0, s41, 81920
    s_add_u32 s51, s58, 262144
    buffer_load_dwordx4 v0, s[16:19], s51 offen lds
    v_mfma_f32_16x16x32_bf16 v[72:75], v[108:111], v[116:119], v[72:75]
    s_add_u32 m0, s41, 86016
    s_add_u32 s51, s58, 393216
    buffer_load_dwordx4 v0, s[16:19], s51 offen lds
    s_waitcnt lgkmcnt(0)
    v_mfma_f32_16x16x32_bf16 v[4:7], v[120:123], v[156:159], v[4:7]
    v_mfma_f32_16x16x32_bf16 v[8:11], v[120:123], v[160:163], v[8:11]
    v_mfma_f32_16x16x32_bf16 v[12:15], v[124:127], v[156:159], v[12:15]
    v_mfma_f32_16x16x32_bf16 v[16:19], v[124:127], v[160:163], v[16:19]
    s_add_u32 m0, s41, 90112
    s_add_u32 s51, s59, 0
    buffer_load_dwordx4 v1, s[20:23], s51 offen lds
    v_mfma_f32_16x16x32_bf16 v[20:23], v[128:131], v[156:159], v[20:23]
    v_mfma_f32_16x16x32_bf16 v[24:27], v[128:131], v[160:163], v[24:27]
    v_mfma_f32_16x16x32_bf16 v[28:31], v[132:135], v[156:159], v[28:31]
    v_mfma_f32_16x16x32_bf16 v[32:35], v[132:135], v[160:163], v[32:35]
    s_add_u32 m0, s41, 94208
    s_add_u32 s51, s59, 131072
    buffer_load_dwordx4 v1, s[20:23], s51 offen lds
    v_mfma_f32_16x16x32_bf16 v[36:39], v[136:139], v[156:159], v[36:39]
    v_mfma_f32_16x16x32_bf16 v[40:43], v[136:139], v[160:163], v[40:43]
    v_mfma_f32_16x16x32_bf16 v[44:47], v[140:143], v[156:159], v[44:47]
    s_add_u32 m0, s41, 98304
    s_add_u32 s51, s59, 262144
    buffer_load_dwordx4 v1, s[20:23], s51 offen lds
    v_mfma_f32_16x16x32_bf16 v[48:51], v[140:143], v[160:163], v[48:51]
    v_mfma_f32_16x16x32_bf16 v[52:55], v[144:147], v[156:159], v[52:55]
    v_mfma_f32_16x16x32_bf16 v[56:59], v[144:147], v[160:163], v[56:59]
    v_mfma_f32_16x16x32_bf16 v[60:63], v[148:151], v[156:159], v[60:63]
    s_add_u32 m0, s41, 102400
    s_add_u32 s51, s59, 393216
    buffer_load_dwordx4 v1, s[20:23], s51 offen lds
    v_mfma_f32_16x16x32_bf16 v[64:67], v[148:151], v[160:163], v[64:67]
    v_mfma_f32_16x16x32_bf16 v[68:71], v[152:155], v[156:159], v[68:71]
    v_mfma_f32_16x16x32_bf16 v[72:75], v[152:155], v[160:163], v[72:75]
    s_add_u32 m0, s41, 106496
    s_add_u32 s51, s59, 524288
    buffer_load_dwordx4 v1, s[20:23], s51 offen lds
    s_waitcnt vmcnt(9)
    s_barrier
    v_add_u32 v164, 36864, v164
    v_add_u32 v165, 36864, v165
    v_add_u32 v166, 36864, v166
    v_add_u32 v167, 36864, v167
    ds_read_b128 v[112:115], v166 offset:0
    ds_read_b128 v[116:119], v166 offset:2048
    ds_read_b128 v[76:79], v164 offset:16384
    ds_read_b128 v[80:83], v164 offset:18432
    ds_read_b128 v[84:87], v164 offset:20480
    ds_read_b128 v[88:91], v164 offset:22528
    ds_read_b128 v[92:95], v164 offset:24576
    ds_read_b128 v[96:99], v164 offset:26624
    ds_read_b128 v[100:103], v164 offset:28672
    ds_read_b128 v[104:107], v164 offset:30720
    ds_read_b128 v[108:111], v164 offset:32768
    s_waitcnt lgkmcnt(0)
    v_mfma_f32_16x16x32_bf16 v[4:7], v[76:79], v[112:115], v[4:7]
    v_mfma_f32_16x16x32_bf16 v[8:11], v[76:79], v[116:119], v[8:11]
    ds_read_b128 v[156:159], v167 offset:0
    v_mfma_f32_16x16x32_bf16 v[12:15], v[80:83], v[112:115], v[12:15]
    ds_read_b128 v[160:163], v167 offset:2048
    v_mfma_f32_16x16x32_bf16 v[16:19], v[80:83], v[116:119], v[16:19]
    ds_read_b128 v[120:123], v165 offset:16384
    v_mfma_f32_16x16x32_bf16 v[20:23], v[84:87], v[112:115], v[20:23]
    ds_read_b128 v[124:127], v165 offset:18432
    v_mfma_f32_16x16x32_bf16 v[24:27], v[84:87], v[116:119], v[24:27]
    ds_read_b128 v[128:131], v165 offset:20480
    v_mfma_f32_16x16x32_bf16 v[28:31], v[88:91], v[112:115], v[28:31]
    ds_read_b128 v[132:135], v165 offset:22528
    v_mfma_f32_16x16x32_bf16 v[32:35], v[88:91], v[116:119], v[32:35]
    ds_read_b128 v[136:139], v165 offset:24576
    v_mfma_f32_16x16x32_bf16 v[36:39], v[92:95], v[112:115], v[36:39]
    ds_read_b128 v[140:143], v165 offset:26624
    v_mfma_f32_16x16x32_bf16 v[40:43], v[92:95], v[116:119], v[40:43]
    v_mfma_f32_16x16x32_bf16 v[44:47], v[96:99], v[112:115], v[44:47]
    ds_read_b128 v[144:147], v165 offset:28672
    v_mfma_f32_16x16x32_bf16 v[48:51], v[96:99], v[116:119], v[48:51]
    ds_read_b128 v[148:151], v165 offset:30720
    v_mfma_f32_16x16x32_bf16 v[52:55], v[100:103], v[112:115], v[52:55]
    ds_read_b128 v[152:155], v165 offset:32768
    v_mfma_f32_16x16x32_bf16 v[56:59], v[100:103], v[116:119], v[56:59]
    s_add_u32 s58, s58, 128
    s_add_u32 s59, s59, 128
    v_mfma_f32_16x16x32_bf16 v[60:63], v[104:107], v[112:115], v[60:63]
    s_add_u32 m0, s41, 0
    s_add_u32 s51, s58, 0
    buffer_load_dwordx4 v0, s[16:19], s51 offen lds
    v_mfma_f32_16x16x32_bf16 v[64:67], v[104:107], v[116:119], v[64:67]
    s_add_u32 m0, s41, 4096
    s_add_u32 s51, s58, 131072
    buffer_load_dwordx4 v0, s[16:19], s51 offen lds
    v_mfma_f32_16x16x32_bf16 v[68:71], v[108:111], v[112:115], v[68:71]
    s_add_u32 m0, s41, 8192
    s_add_u32 s51, s58, 262144
    buffer_load_dwordx4 v0, s[16:19], s51 offen lds
    v_mfma_f32_16x16x32_bf16 v[72:75], v[108:111], v[116:119], v[72:75]
    s_add_u32 m0, s41, 12288
    s_add_u32 s51, s58, 393216
    buffer_load_dwordx4 v0, s[16:19], s51 offen lds
    s_waitcnt lgkmcnt(0)
    v_mfma_f32_16x16x32_bf16 v[4:7], v[120:123], v[156:159], v[4:7]
    v_mfma_f32_16x16x32_bf16 v[8:11], v[120:123], v[160:163], v[8:11]
    v_mfma_f32_16x16x32_bf16 v[12:15], v[124:127], v[156:159], v[12:15]
    v_mfma_f32_16x16x32_bf16 v[16:19], v[124:127], v[160:163], v[16:19]
    s_add_u32 m0, s41, 16384
    s_add_u32 s51, s59, 0
    buffer_load_dwordx4 v1, s[20:23], s51 offen lds
    v_mfma_f32_16x16x32_bf16 v[20:23], v[128:131], v[156:159], v[20:23]
    v_mfma_f32_16x16x32_bf16 v[24:27], v[128:131], v[160:163], v[24:27]
    v_mfma_f32_16x16x32_bf16 v[28:31], v[132:135], v[156:159], v[28:31]
    v_mfma_f32_16x16x32_bf16 v[32:35], v[132:135], v[160:163], v[32:35]
    s_add_u32 m0, s41, 20480
    s_add_u32 s51, s59, 131072
    buffer_load_dwordx4 v1, s[20:23], s51 offen lds
    v_mfma_f32_16x16x32_bf16 v[36:39], v[136:139], v[156:159], v[36:39]
    v_mfma_f32_16x16x32_bf16 v[40:43], v[136:139], v[160:163], v[40:43]
    v_mfma_f32_16x16x32_bf16 v[44:47], v[140:143], v[156:159], v[44:47]
    s_add_u32 m0, s41, 24576
    s_add_u32 s51, s59, 262144
    buffer_load_dwordx4 v1, s[20:23], s51 offen lds
    v_mfma_f32_16x16x32_bf16 v[48:51], v[140:143], v[160:163], v[48:51]
    v_mfma_f32_16x16x32_bf16 v[52:55], v[144:147], v[156:159], v[52:55]
    v_mfma_f32_16x16x32_bf16 v[56:59], v[144:147], v[160:163], v[56:59]
    v_mfma_f32_16x16x32_bf16 v[60:63], v[148:151], v[156:159], v[60:63]
    s_add_u32 m0, s41, 28672
    s_add_u32 s51, s59, 393216
    buffer_load_dwordx4 v1, s[20:23], s51 offen lds
    v_mfma_f32_16x16x32_bf16 v[64:67], v[148:151], v[160:163], v[64:67]
    v_mfma_f32_16x16x32_bf16 v[68:71], v[152:155], v[156:159], v[68:71]
    v_mfma_f32_16x16x32_bf16 v[72:75], v[152:155], v[160:163], v[72:75]
    s_add_u32 m0, s41, 32768
    s_add_u32 s51, s59, 524288
    buffer_load_dwordx4 v1, s[20:23], s51 offen lds
    s_waitcnt vmcnt(9)
    s_barrier
    v_add_u32 v164, 36864, v164
    v_add_u32 v165, 36864, v165
    v_add_u32 v166, 36864, v166
    v_add_u32 v167, 36864, v167
    ds_read_b128 v[112:115], v166 offset:0
    ds_read_b128 v[116:119], v166 offset:2048
    ds_read_b128 v[76:79], v164 offset:16384
    ds_read_b128 v[80:83], v164 offset:18432
    ds_read_b128 v[84:87], v164 offset:20480
    ds_read_b128 v[88:91], v164 offset:22528
    ds_read_b128 v[92:95], v164 offset:24576
    ds_read_b128 v[96:99], v164 offset:26624
    ds_read_b128 v[100:103], v164 offset:28672
    ds_read_b128 v[104:107], v164 offset:30720
    ds_read_b128 v[108:111], v164 offset:32768
    s_waitcnt lgkmcnt(0)
    v_mfma_f32_16x16x32_bf16 v[4:7], v[76:79], v[112:115], v[4:7]
    v_mfma_f32_16x16x32_bf16 v[8:11], v[76:79], v[116:119], v[8:11]
    ds_read_b128 v[156:159], v167 offset:0
    v_mfma_f32_16x16x32_bf16 v[12:15], v[80:83], v[112:115], v[12:15]
    ds_read_b128 v[160:163], v167 offset:2048
    v_mfma_f32_16x16x32_bf16 v[16:19], v[80:83], v[116:119], v[16:19]
    ds_read_b128 v[120:123], v165 offset:16384
    v_mfma_f32_16x16x32_bf16 v[20:23], v[84:87], v[112:115], v[20:23]
    ds_read_b128 v[124:127], v165 offset:18432
    v_mfma_f32_16x16x32_bf16 v[24:27], v[84:87], v[116:119], v[24:27]
    ds_read_b128 v[128:131], v165 offset:20480
    v_mfma_f32_16x16x32_bf16 v[28:31], v[88:91], v[112:115], v[28:31]
    ds_read_b128 v[132:135], v165 offset:22528
    v_mfma_f32_16x16x32_bf16 v[32:35], v[88:91], v[116:119], v[32:35]
    ds_read_b128 v[136:139], v165 offset:24576
    v_mfma_f32_16x16x32_bf16 v[36:39], v[92:95], v[112:115], v[36:39]
    ds_read_b128 v[140:143], v165 offset:26624
    v_mfma_f32_16x16x32_bf16 v[40:43], v[92:95], v[116:119], v[40:43]
    v_mfma_f32_16x16x32_bf16 v[44:47], v[96:99], v[112:115], v[44:47]
    ds_read_b128 v[144:147], v165 offset:28672
    v_mfma_f32_16x16x32_bf16 v[48:51], v[96:99], v[116:119], v[48:51]
    ds_read_b128 v[148:151], v165 offset:30720
    v_mfma_f32_16x16x32_bf16 v[52:55], v[100:103], v[112:115], v[52:55]
    ds_read_b128 v[152:155], v165 offset:32768
    v_mfma_f32_16x16x32_bf16 v[56:59], v[100:103], v[116:119], v[56:59]
    s_add_u32 s58, s58, 128
    s_add_u32 s59, s59, 128
    v_mfma_f32_16x16x32_bf16 v[60:63], v[104:107], v[112:115], v[60:63]
    s_add_u32 m0, s41, 36864
    s_add_u32 s51, s58, 0
    buffer_load_dwordx4 v0, s[16:19], s51 offen lds
    v_mfma_f32_16x16x32_bf16 v[64:67], v[104:107], v[116:119], v[64:67]
    s_add_u32 m0, s41, 40960
    s_add_u32 s51, s58, 131072
    buffer_load_dwordx4 v0, s[16:19], s51 offen lds
    v_mfma_f32_16x16x32_bf16 v[68:71], v[108:111], v[112:115], v[68:71]
    s_add_u32 m0, s41, 45056
    s_add_u32 s51, s58, 262144
    buffer_load_dwordx4 v0, s[16:19], s51 offen lds
    v_mfma_f32_16x16x32_bf16 v[72:75], v[108:111], v[116:119], v[72:75]
    s_add_u32 m0, s41, 49152
    s_add_u32 s51, s58, 393216
    buffer_load_dwordx4 v0, s[16:19], s51 offen lds
    s_waitcnt lgkmcnt(0)
    v_mfma_f32_16x16x32_bf16 v[4:7], v[120:123], v[156:159], v[4:7]
    v_mfma_f32_16x16x32_bf16 v[8:11], v[120:123], v[160:163], v[8:11]
    v_mfma_f32_16x16x32_bf16 v[12:15], v[124:127], v[156:159], v[12:15]
    v_mfma_f32_16x16x32_bf16 v[16:19], v[124:127], v[160:163], v[16:19]
    s_add_u32 m0, s41, 53248
    s_add_u32 s51, s59, 0
    buffer_load_dwordx4 v1, s[20:23], s51 offen lds
    v_mfma_f32_16x16x32_bf16 v[20:23], v[128:131], v[156:159], v[20:23]
    v_mfma_f32_16x16x32_bf16 v[24:27], v[128:131], v[160:163], v[24:27]
    v_mfma_f32_16x16x32_bf16 v[28:31], v[132:135], v[156:159], v[28:31]
    v_mfma_f32_16x16x32_bf16 v[32:35], v[132:135], v[160:163], v[32:35]
    s_add_u32 m0, s41, 57344
    s_add_u32 s51, s59, 131072
    buffer_load_dwordx4 v1, s[20:23], s51 offen lds
    v_mfma_f32_16x16x32_bf16 v[36:39], v[136:139], v[156:159], v[36:39]
    v_mfma_f32_16x16x32_bf16 v[40:43], v[136:139], v[160:163], v[40:43]
    v_mfma_f32_16x16x32_bf16 v[44:47], v[140:143], v[156:159], v[44:47]
    s_add_u32 m0, s41, 61440
    s_add_u32 s51, s59, 262144
    buffer_load_dwordx4 v1, s[20:23], s51 offen lds
    v_mfma_f32_16x16x32_bf16 v[48:51], v[140:143], v[160:163], v[48:51]
    v_mfma_f32_16x16x32_bf16 v[52:55], v[144:147], v[156:159], v[52:55]
    v_mfma_f32_16x16x32_bf16 v[56:59], v[144:147], v[160:163], v[56:59]
    v_mfma_f32_16x16x32_bf16 v[60:63], v[148:151], v[156:159], v[60:63]
    s_add_u32 m0, s41, 65536
    s_add_u32 s51, s59, 393216
    buffer_load_dwordx4 v1, s[20:23], s51 offen lds
    v_mfma_f32_16x16x32_bf16 v[64:67], v[148:151], v[160:163], v[64:67]
    v_mfma_f32_16x16x32_bf16 v[68:71], v[152:155], v[156:159], v[68:71]
    v_mfma_f32_16x16x32_bf16 v[72:75], v[152:155], v[160:163], v[72:75]
    s_add_u32 m0, s41, 69632
    s_add_u32 s51, s59, 524288
    buffer_load_dwordx4 v1, s[20:23], s51 offen lds
    s_waitcnt vmcnt(9)
    s_barrier
    v_subrev_u32 v164, 73728, v164
    v_subrev_u32 v165, 73728, v165
    v_subrev_u32 v166, 73728, v166
    v_subrev_u32 v167, 73728, v167
    ds_read_b128 v[112:115], v166 offset:0
    ds_read_b128 v[116:119], v166 offset:2048
    ds_read_b128 v[76:79], v164 offset:16384
    ds_read_b128 v[80:83], v164 offset:18432
    ds_read_b128 v[84:87], v164 offset:20480
    ds_read_b128 v[88:91], v164 offset:22528
    ds_read_b128 v[92:95], v164 offset:24576
    ds_read_b128 v[96:99], v164 offset:26624
    ds_read_b128 v[100:103], v164 offset:28672
    ds_read_b128 v[104:107], v164 offset:30720
    ds_read_b128 v[108:111], v164 offset:32768
    s_waitcnt lgkmcnt(0)
    v_mfma_f32_16x16x32_bf16 v[4:7], v[76:79], v[112:115], v[4:7]
    v_mfma_f32_16x16x32_bf16 v[8:11], v[76:79], v[116:119], v[8:11]
    ds_read_b128 v[156:159], v167 offset:0
    v_mfma_f32_16x16x32_bf16 v[12:15], v[80:83], v[112:115], v[12:15]
    ds_read_b128 v[160:163], v167 offset:2048
    v_mfma_f32_16x16x32_bf16 v[16:19], v[80:83], v[116:119], v[16:19]
    ds_read_b128 v[120:123], v165 offset:16384
    v_mfma_f32_16x16x32_bf16 v[20:23], v[84:87], v[112:115], v[20:23]
    ds_read_b128 v[124:127], v165 offset:18432
    v_mfma_f32_16x16x32_bf16 v[24:27], v[84:87], v[116:119], v[24:27]
    ds_read_b128 v[128:131], v165 offset:20480
    v_mfma_f32_16x16x32_bf16 v[28:31], v[88:91], v[112:115], v[28:31]
    ds_read_b128 v[132:135], v165 offset:22528
    v_mfma_f32_16x16x32_bf16 v[32:35], v[88:91], v[116:119], v[32:35]
    ds_read_b128 v[136:139], v165 offset:24576
    v_mfma_f32_16x16x32_bf16 v[36:39], v[92:95], v[112:115], v[36:39]
    ds_read_b128 v[140:143], v165 offset:26624
    v_mfma_f32_16x16x32_bf16 v[40:43], v[92:95], v[116:119], v[40:43]
    v_mfma_f32_16x16x32_bf16 v[44:47], v[96:99], v[112:115], v[44:47]
    ds_read_b128 v[144:147], v165 offset:28672
    v_mfma_f32_16x16x32_bf16 v[48:51], v[96:99], v[116:119], v[48:51]
    ds_read_b128 v[148:151], v165 offset:30720
    v_mfma_f32_16x16x32_bf16 v[52:55], v[100:103], v[112:115], v[52:55]
    ds_read_b128 v[152:155], v165 offset:32768
    v_mfma_f32_16x16x32_bf16 v[56:59], v[100:103], v[116:119], v[56:59]
    s_add_u32 s58, s58, 128
    s_add_u32 s59, s59, 128
    v_mfma_f32_16x16x32_bf16 v[60:63], v[104:107], v[112:115], v[60:63]
    s_add_u32 m0, s41, 73728
    s_add_u32 s51, s58, 0
    buffer_load_dwordx4 v0, s[16:19], s51 offen lds
    v_mfma_f32_16x16x32_bf16 v[64:67], v[104:107], v[116:119], v[64:67]
    s_add_u32 m0, s41, 77824
    s_add_u32 s51, s58, 131072
    buffer_load_dwordx4 v0, s[16:19], s51 offen lds
    v_mfma_f32_16x16x32_bf16 v[68:71], v[108:111], v[112:115], v[68:71]
    s_add_u32 m0, s41, 81920
    s_add_u32 s51, s58, 262144
    buffer_load_dwordx4 v0, s[16:19], s51 offen lds
    v_mfma_f32_16x16x32_bf16 v[72:75], v[108:111], v[116:119], v[72:75]
    s_add_u32 m0, s41, 86016
    s_add_u32 s51, s58, 393216
    buffer_load_dwordx4 v0, s[16:19], s51 offen lds
    s_waitcnt lgkmcnt(0)
    v_mfma_f32_16x16x32_bf16 v[4:7], v[120:123], v[156:159], v[4:7]
    v_mfma_f32_16x16x32_bf16 v[8:11], v[120:123], v[160:163], v[8:11]
    v_mfma_f32_16x16x32_bf16 v[12:15], v[124:127], v[156:159], v[12:15]
    v_mfma_f32_16x16x32_bf16 v[16:19], v[124:127], v[160:163], v[16:19]
    s_add_u32 m0, s41, 90112
    s_add_u32 s51, s59, 0
    buffer_load_dwordx4 v1, s[20:23], s51 offen lds
    v_mfma_f32_16x16x32_bf16 v[20:23], v[128:131], v[156:159], v[20:23]
    v_mfma_f32_16x16x32_bf16 v[24:27], v[128:131], v[160:163], v[24:27]
    v_mfma_f32_16x16x32_bf16 v[28:31], v[132:135], v[156:159], v[28:31]
    v_mfma_f32_16x16x32_bf16 v[32:35], v[132:135], v[160:163], v[32:35]
    s_add_u32 m0, s41, 94208
    s_add_u32 s51, s59, 131072
    buffer_load_dwordx4 v1, s[20:23], s51 offen lds
    v_mfma_f32_16x16x32_bf16 v[36:39], v[136:139], v[156:159], v[36:39]
    v_mfma_f32_16x16x32_bf16 v[40:43], v[136:139], v[160:163], v[40:43]
    v_mfma_f32_16x16x32_bf16 v[44:47], v[140:143], v[156:159], v[44:47]
    s_add_u32 m0, s41, 98304
    s_add_u32 s51, s59, 262144
    buffer_load_dwordx4 v1, s[20:23], s51 offen lds
    v_mfma_f32_16x16x32_bf16 v[48:51], v[140:143], v[160:163], v[48:51]
    v_mfma_f32_16x16x32_bf16 v[52:55], v[144:147], v[156:159], v[52:55]
    v_mfma_f32_16x16x32_bf16 v[56:59], v[144:147], v[160:163], v[56:59]
    v_mfma_f32_16x16x32_bf16 v[60:63], v[148:151], v[156:159], v[60:63]
    s_add_u32 m0, s41, 102400
    s_add_u32 s51, s59, 393216
    buffer_load_dwordx4 v1, s[20:23], s51 offen lds
    v_mfma_f32_16x16x32_bf16 v[64:67], v[148:151], v[160:163], v[64:67]
    v_mfma_f32_16x16x32_bf16 v[68:71], v[152:155], v[156:159], v[68:71]
    v_mfma_f32_16x16x32_bf16 v[72:75], v[152:155], v[160:163], v[72:75]
    s_add_u32 m0, s41, 106496
    s_add_u32 s51, s59, 524288
    buffer_load_dwordx4 v1, s[20:23], s51 offen lds
    s_waitcnt vmcnt(9)
    s_barrier
    v_add_u32 v164, 36864, v164
    v_add_u32 v165, 36864, v165
    v_add_u32 v166, 36864, v166
    v_add_u32 v167, 36864, v167
    ds_read_b128 v[112:115], v166 offset:0
    ds_read_b128 v[116:119], v166 offset:2048
    ds_read_b128 v[76:79], v164 offset:16384
    ds_read_b128 v[80:83], v164 offset:18432
    ds_read_b128 v[84:87], v164 offset:20480
    ds_read_b128 v[88:91], v164 offset:22528
    ds_read_b128 v[92:95], v164 offset:24576
    ds_read_b128 v[96:99], v164 offset:26624
    ds_read_b128 v[100:103], v164 offset:28672
    ds_read_b128 v[104:107], v164 offset:30720
    ds_read_b128 v[108:111], v164 offset:32768
    s_waitcnt lgkmcnt(0)
    v_mfma_f32_16x16x32_bf16 v[4:7], v[76:79], v[112:115], v[4:7]
    v_mfma_f32_16x16x32_bf16 v[8:11], v[76:79], v[116:119], v[8:11]
    ds_read_b128 v[156:159], v167 offset:0
    v_mfma_f32_16x16x32_bf16 v[12:15], v[80:83], v[112:115], v[12:15]
    ds_read_b128 v[160:163], v167 offset:2048
    v_mfma_f32_16x16x32_bf16 v[16:19], v[80:83], v[116:119], v[16:19]
    ds_read_b128 v[120:123], v165 offset:16384
    v_mfma_f32_16x16x32_bf16 v[20:23], v[84:87], v[112:115], v[20:23]
    ds_read_b128 v[124:127], v165 offset:18432
    v_mfma_f32_16x16x32_bf16 v[24:27], v[84:87], v[116:119], v[24:27]
    ds_read_b128 v[128:131], v165 offset:20480
    v_mfma_f32_16x16x32_bf16 v[28:31], v[88:91], v[112:115], v[28:31]
    ds_read_b128 v[132:135], v165 offset:22528
    v_mfma_f32_16x16x32_bf16 v[32:35], v[88:91], v[116:119], v[32:35]
    ds_read_b128 v[136:139], v165 offset:24576
    v_mfma_f32_16x16x32_bf16 v[36:39], v[92:95], v[112:115], v[36:39]
    ds_read_b128 v[140:143], v165 offset:26624
    v_mfma_f32_16x16x32_bf16 v[40:43], v[92:95], v[116:119], v[40:43]
    v_mfma_f32_16x16x32_bf16 v[44:47], v[96:99], v[112:115], v[44:47]
    ds_read_b128 v[144:147], v165 offset:28672
    v_mfma_f32_16x16x32_bf16 v[48:51], v[96:99], v[116:119], v[48:51]
    ds_read_b128 v[148:151], v165 offset:30720
    v_mfma_f32_16x16x32_bf16 v[52:55], v[100:103], v[112:115], v[52:55]
    ds_read_b128 v[152:155], v165 offset:32768
    v_mfma_f32_16x16x32_bf16 v[56:59], v[100:103], v[116:119], v[56:59]
    s_add_u32 s58, s58, 128
    s_add_u32 s59, s59, 128
    v_mfma_f32_16x16x32_bf16 v[60:63], v[104:107], v[112:115], v[60:63]
    s_add_u32 m0, s41, 0
    s_add_u32 s51, s58, 0
    buffer_load_dwordx4 v0, s[16:19], s51 offen lds
    v_mfma_f32_16x16x32_bf16 v[64:67], v[104:107], v[116:119], v[64:67]
    s_add_u32 m0, s41, 4096
    s_add_u32 s51, s58, 131072
    buffer_load_dwordx4 v0, s[16:19], s51 offen lds
    v_mfma_f32_16x16x32_bf16 v[68:71], v[108:111], v[112:115], v[68:71]
    s_add_u32 m0, s41, 8192
    s_add_u32 s51, s58, 262144
    buffer_load_dwordx4 v0, s[16:19], s51 offen lds
    v_mfma_f32_16x16x32_bf16 v[72:75], v[108:111], v[116:119], v[72:75]
    s_add_u32 m0, s41, 12288
    s_add_u32 s51, s58, 393216
    buffer_load_dwordx4 v0, s[16:19], s51 offen lds
    s_waitcnt lgkmcnt(0)
    v_mfma_f32_16x16x32_bf16 v[4:7], v[120:123], v[156:159], v[4:7]
    v_mfma_f32_16x16x32_bf16 v[8:11], v[120:123], v[160:163], v[8:11]
    v_mfma_f32_16x16x32_bf16 v[12:15], v[124:127], v[156:159], v[12:15]
    v_mfma_f32_16x16x32_bf16 v[16:19], v[124:127], v[160:163], v[16:19]
    s_add_u32 m0, s41, 16384
    s_add_u32 s51, s59, 0
    buffer_load_dwordx4 v1, s[20:23], s51 offen lds
    v_mfma_f32_16x16x32_bf16 v[20:23], v[128:131], v[156:159], v[20:23]
    v_mfma_f32_16x16x32_bf16 v[24:27], v[128:131], v[160:163], v[24:27]
    v_mfma_f32_16x16x32_bf16 v[28:31], v[132:135], v[156:159], v[28:31]
    v_mfma_f32_16x16x32_bf16 v[32:35], v[132:135], v[160:163], v[32:35]
    s_add_u32 m0, s41, 20480
    s_add_u32 s51, s59, 131072
    buffer_load_dwordx4 v1, s[20:23], s51 offen lds
    v_mfma_f32_16x16x32_bf16 v[36:39], v[136:139], v[156:159], v[36:39]
    v_mfma_f32_16x16x32_bf16 v[40:43], v[136:139], v[160:163], v[40:43]
    v_mfma_f32_16x16x32_bf16 v[44:47], v[140:143], v[156:159], v[44:47]
    s_add_u32 m0, s41, 24576
    s_add_u32 s51, s59, 262144
    buffer_load_dwordx4 v1, s[20:23], s51 offen lds
    v_mfma_f32_16x16x32_bf16 v[48:51], v[140:143], v[160:163], v[48:51]
    v_mfma_f32_16x16x32_bf16 v[52:55], v[144:147], v[156:159], v[52:55]
    v_mfma_f32_16x16x32_bf16 v[56:59], v[144:147], v[160:163], v[56:59]
    v_mfma_f32_16x16x32_bf16 v[60:63], v[148:151], v[156:159], v[60:63]
    s_add_u32 m0, s41, 28672
    s_add_u32 s51, s59, 393216
    buffer_load_dwordx4 v1, s[20:23], s51 offen lds
    v_mfma_f32_16x16x32_bf16 v[64:67], v[148:151], v[160:163], v[64:67]
    v_mfma_f32_16x16x32_bf16 v[68:71], v[152:155], v[156:159], v[68:71]
    v_mfma_f32_16x16x32_bf16 v[72:75], v[152:155], v[160:163], v[72:75]
    s_add_u32 m0, s41, 32768
    s_add_u32 s51, s59, 524288
    buffer_load_dwordx4 v1, s[20:23], s51 offen lds
    s_waitcnt vmcnt(9)
    s_barrier
    v_add_u32 v164, 36864, v164
    v_add_u32 v165, 36864, v165
    v_add_u32 v166, 36864, v166
    v_add_u32 v167, 36864, v167
    ds_read_b128 v[112:115], v166 offset:0
    ds_read_b128 v[116:119], v166 offset:2048
    ds_read_b128 v[76:79], v164 offset:16384
    ds_read_b128 v[80:83], v164 offset:18432
    ds_read_b128 v[84:87], v164 offset:20480
    ds_read_b128 v[88:91], v164 offset:22528
    ds_read_b128 v[92:95], v164 offset:24576
    ds_read_b128 v[96:99], v164 offset:26624
    ds_read_b128 v[100:103], v164 offset:28672
    ds_read_b128 v[104:107], v164 offset:30720
    ds_read_b128 v[108:111], v164 offset:32768
    s_waitcnt lgkmcnt(0)
    v_mfma_f32_16x16x32_bf16 v[4:7], v[76:79], v[112:115], v[4:7]
    v_mfma_f32_16x16x32_bf16 v[8:11], v[76:79], v[116:119], v[8:11]
    ds_read_b128 v[156:159], v167 offset:0
    v_mfma_f32_16x16x32_bf16 v[12:15], v[80:83], v[112:115], v[12:15]
    ds_read_b128 v[160:163], v167 offset:2048
    v_mfma_f32_16x16x32_bf16 v[16:19], v[80:83], v[116:119], v[16:19]
    ds_read_b128 v[120:123], v165 offset:16384
    v_mfma_f32_16x16x32_bf16 v[20:23], v[84:87], v[112:115], v[20:23]
    ds_read_b128 v[124:127], v165 offset:18432
    v_mfma_f32_16x16x32_bf16 v[24:27], v[84:87], v[116:119], v[24:27]
    ds_read_b128 v[128:131], v165 offset:20480
    v_mfma_f32_16x16x32_bf16 v[28:31], v[88:91], v[112:115], v[28:31]
    ds_read_b128 v[132:135], v165 offset:22528
    v_mfma_f32_16x16x32_bf16 v[32:35], v[88:91], v[116:119], v[32:35]
    ds_read_b128 v[136:139], v165 offset:24576
    v_mfma_f32_16x16x32_bf16 v[36:39], v[92:95], v[112:115], v[36:39]
    ds_read_b128 v[140:143], v165 offset:26624
    v_mfma_f32_16x16x32_bf16 v[40:43], v[92:95], v[116:119], v[40:43]
    v_mfma_f32_16x16x32_bf16 v[44:47], v[96:99], v[112:115], v[44:47]
    ds_read_b128 v[144:147], v165 offset:28672
    v_mfma_f32_16x16x32_bf16 v[48:51], v[96:99], v[116:119], v[48:51]
    ds_read_b128 v[148:151], v165 offset:30720
    v_mfma_f32_16x16x32_bf16 v[52:55], v[100:103], v[112:115], v[52:55]
    ds_read_b128 v[152:155], v165 offset:32768
    v_mfma_f32_16x16x32_bf16 v[56:59], v[100:103], v[116:119], v[56:59]
    s_add_u32 s58, s58, 128
    s_add_u32 s59, s59, 128
    v_mfma_f32_16x16x32_bf16 v[60:63], v[104:107], v[112:115], v[60:63]
    s_add_u32 m0, s41, 36864
    s_add_u32 s51, s58, 0
    buffer_load_dwordx4 v0, s[16:19], s51 offen lds
    v_mfma_f32_16x16x32_bf16 v[64:67], v[104:107], v[116:119], v[64:67]
    s_add_u32 m0, s41, 40960
    s_add_u32 s51, s58, 131072
    buffer_load_dwordx4 v0, s[16:19], s51 offen lds
    v_mfma_f32_16x16x32_bf16 v[68:71], v[108:111], v[112:115], v[68:71]
    s_add_u32 m0, s41, 45056
    s_add_u32 s51, s58, 262144
    buffer_load_dwordx4 v0, s[16:19], s51 offen lds
    v_mfma_f32_16x16x32_bf16 v[72:75], v[108:111], v[116:119], v[72:75]
    s_add_u32 m0, s41, 49152
    s_add_u32 s51, s58, 393216
    buffer_load_dwordx4 v0, s[16:19], s51 offen lds
    s_waitcnt lgkmcnt(0)
    v_mfma_f32_16x16x32_bf16 v[4:7], v[120:123], v[156:159], v[4:7]
    v_mfma_f32_16x16x32_bf16 v[8:11], v[120:123], v[160:163], v[8:11]
    v_mfma_f32_16x16x32_bf16 v[12:15], v[124:127], v[156:159], v[12:15]
    v_mfma_f32_16x16x32_bf16 v[16:19], v[124:127], v[160:163], v[16:19]
    s_add_u32 m0, s41, 53248
    s_add_u32 s51, s59, 0
    buffer_load_dwordx4 v1, s[20:23], s51 offen lds
    v_mfma_f32_16x16x32_bf16 v[20:23], v[128:131], v[156:159], v[20:23]
    v_mfma_f32_16x16x32_bf16 v[24:27], v[128:131], v[160:163], v[24:27]
    v_mfma_f32_16x16x32_bf16 v[28:31], v[132:135], v[156:159], v[28:31]
    v_mfma_f32_16x16x32_bf16 v[32:35], v[132:135], v[160:163], v[32:35]
    s_add_u32 m0, s41, 57344
    s_add_u32 s51, s59, 131072
    buffer_load_dwordx4 v1, s[20:23], s51 offen lds
    v_mfma_f32_16x16x32_bf16 v[36:39], v[136:139], v[156:159], v[36:39]
    v_mfma_f32_16x16x32_bf16 v[40:43], v[136:139], v[160:163], v[40:43]
    v_mfma_f32_16x16x32_bf16 v[44:47], v[140:143], v[156:159], v[44:47]
    s_add_u32 m0, s41, 61440
    s_add_u32 s51, s59, 262144
    buffer_load_dwordx4 v1, s[20:23], s51 offen lds
    v_mfma_f32_16x16x32_bf16 v[48:51], v[140:143], v[160:163], v[48:51]
    v_mfma_f32_16x16x32_bf16 v[52:55], v[144:147], v[156:159], v[52:55]
    v_mfma_f32_16x16x32_bf16 v[56:59], v[144:147], v[160:163], v[56:59]
    v_mfma_f32_16x16x32_bf16 v[60:63], v[148:151], v[156:159], v[60:63]
    s_add_u32 m0, s41, 65536
    s_add_u32 s51, s59, 393216
    buffer_load_dwordx4 v1, s[20:23], s51 offen lds
    v_mfma_f32_16x16x32_bf16 v[64:67], v[148:151], v[160:163], v[64:67]
    v_mfma_f32_16x16x32_bf16 v[68:71], v[152:155], v[156:159], v[68:71]
    v_mfma_f32_16x16x32_bf16 v[72:75], v[152:155], v[160:163], v[72:75]
    s_add_u32 m0, s41, 69632
    s_add_u32 s51, s59, 524288
    buffer_load_dwordx4 v1, s[20:23], s51 offen lds
    s_waitcnt vmcnt(9)
    s_barrier
    v_subrev_u32 v164, 73728, v164
    v_subrev_u32 v165, 73728, v165
    v_subrev_u32 v166, 73728, v166
    v_subrev_u32 v167, 73728, v167
    ds_read_b128 v[112:115], v166 offset:0
    ds_read_b128 v[116:119], v166 offset:2048
    ds_read_b128 v[76:79], v164 offset:16384
    ds_read_b128 v[80:83], v164 offset:18432
    ds_read_b128 v[84:87], v164 offset:20480
    ds_read_b128 v[88:91], v164 offset:22528
    ds_read_b128 v[92:95], v164 offset:24576
    ds_read_b128 v[96:99], v164 offset:26624
    ds_read_b128 v[100:103], v164 offset:28672
    ds_read_b128 v[104:107], v164 offset:30720
    ds_read_b128 v[108:111], v164 offset:32768
    s_waitcnt lgkmcnt(0)
    v_mfma_f32_16x16x32_bf16 v[4:7], v[76:79], v[112:115], v[4:7]
    v_mfma_f32_16x16x32_bf16 v[8:11], v[76:79], v[116:119], v[8:11]
    ds_read_b128 v[156:159], v167 offset:0
    v_mfma_f32_16x16x32_bf16 v[12:15], v[80:83], v[112:115], v[12:15]
    ds_read_b128 v[160:163], v167 offset:2048
    v_mfma_f32_16x16x32_bf16 v[16:19], v[80:83], v[116:119], v[16:19]
    ds_read_b128 v[120:123], v165 offset:16384
    v_mfma_f32_16x16x32_bf16 v[20:23], v[84:87], v[112:115], v[20:23]
    ds_read_b128 v[124:127], v165 offset:18432
    v_mfma_f32_16x16x32_bf16 v[24:27], v[84:87], v[116:119], v[24:27]
    ds_read_b128 v[128:131], v165 offset:20480
    v_mfma_f32_16x16x32_bf16 v[28:31], v[88:91], v[112:115], v[28:31]
    ds_read_b128 v[132:135], v165 offset:22528
    v_mfma_f32_16x16x32_bf16 v[32:35], v[88:91], v[116:119], v[32:35]
    ds_read_b128 v[136:139], v165 offset:24576
    v_mfma_f32_16x16x32_bf16 v[36:39], v[92:95], v[112:115], v[36:39]
    ds_read_b128 v[140:143], v165 offset:26624
    v_mfma_f32_16x16x32_bf16 v[40:43], v[92:95], v[116:119], v[40:43]
    v_mfma_f32_16x16x32_bf16 v[44:47], v[96:99], v[112:115], v[44:47]
    ds_read_b128 v[144:147], v165 offset:28672
    v_mfma_f32_16x16x32_bf16 v[48:51], v[96:99], v[116:119], v[48:51]
    ds_read_b128 v[148:151], v165 offset:30720
    v_mfma_f32_16x16x32_bf16 v[52:55], v[100:103], v[112:115], v[52:55]
    ds_read_b128 v[152:155], v165 offset:32768
    v_mfma_f32_16x16x32_bf16 v[56:59], v[100:103], v[116:119], v[56:59]
    s_add_u32 s58, s58, 128
    s_add_u32 s59, s59, 128
    v_mfma_f32_16x16x32_bf16 v[60:63], v[104:107], v[112:115], v[60:63]
    s_add_u32 m0, s41, 73728
    s_add_u32 s51, s58, 0
    buffer_load_dwordx4 v0, s[16:19], s51 offen lds
    v_mfma_f32_16x16x32_bf16 v[64:67], v[104:107], v[116:119], v[64:67]
    s_add_u32 m0, s41, 77824
    s_add_u32 s51, s58, 131072
    buffer_load_dwordx4 v0, s[16:19], s51 offen lds
    v_mfma_f32_16x16x32_bf16 v[68:71], v[108:111], v[112:115], v[68:71]
    s_add_u32 m0, s41, 81920
    s_add_u32 s51, s58, 262144
    buffer_load_dwordx4 v0, s[16:19], s51 offen lds
    v_mfma_f32_16x16x32_bf16 v[72:75], v[108:111], v[116:119], v[72:75]
    s_add_u32 m0, s41, 86016
    s_add_u32 s51, s58, 393216
    buffer_load_dwordx4 v0, s[16:19], s51 offen lds
    s_waitcnt lgkmcnt(0)
    v_mfma_f32_16x16x32_bf16 v[4:7], v[120:123], v[156:159], v[4:7]
    v_mfma_f32_16x16x32_bf16 v[8:11], v[120:123], v[160:163], v[8:11]
    v_mfma_f32_16x16x32_bf16 v[12:15], v[124:127], v[156:159], v[12:15]
    v_mfma_f32_16x16x32_bf16 v[16:19], v[124:127], v[160:163], v[16:19]
    s_add_u32 m0, s41, 90112
    s_add_u32 s51, s59, 0
    buffer_load_dwordx4 v1, s[20:23], s51 offen lds
    v_mfma_f32_16x16x32_bf16 v[20:23], v[128:131], v[156:159], v[20:23]
    v_mfma_f32_16x16x32_bf16 v[24:27], v[128:131], v[160:163], v[24:27]
    v_mfma_f32_16x16x32_bf16 v[28:31], v[132:135], v[156:159], v[28:31]
    v_mfma_f32_16x16x32_bf16 v[32:35], v[132:135], v[160:163], v[32:35]
    s_add_u32 m0, s41, 94208
    s_add_u32 s51, s59, 131072
    buffer_load_dwordx4 v1, s[20:23], s51 offen lds
    v_mfma_f32_16x16x32_bf16 v[36:39], v[136:139], v[156:159], v[36:39]
    v_mfma_f32_16x16x32_bf16 v[40:43], v[136:139], v[160:163], v[40:43]
    v_mfma_f32_16x16x32_bf16 v[44:47], v[140:143], v[156:159], v[44:47]
    s_add_u32 m0, s41, 98304
    s_add_u32 s51, s59, 262144
    buffer_load_dwordx4 v1, s[20:23], s51 offen lds
    v_mfma_f32_16x16x32_bf16 v[48:51], v[140:143], v[160:163], v[48:51]
    v_mfma_f32_16x16x32_bf16 v[52:55], v[144:147], v[156:159], v[52:55]
    v_mfma_f32_16x16x32_bf16 v[56:59], v[144:147], v[160:163], v[56:59]
    v_mfma_f32_16x16x32_bf16 v[60:63], v[148:151], v[156:159], v[60:63]
    s_add_u32 m0, s41, 102400
    s_add_u32 s51, s59, 393216
    buffer_load_dwordx4 v1, s[20:23], s51 offen lds
    v_mfma_f32_16x16x32_bf16 v[64:67], v[148:151], v[160:163], v[64:67]
    v_mfma_f32_16x16x32_bf16 v[68:71], v[152:155], v[156:159], v[68:71]
    v_mfma_f32_16x16x32_bf16 v[72:75], v[152:155], v[160:163], v[72:75]
    s_add_u32 m0, s41, 106496
    s_add_u32 s51, s59, 524288
    buffer_load_dwordx4 v1, s[20:23], s51 offen lds
    s_waitcnt vmcnt(9)
    s_barrier
    v_add_u32 v164, 36864, v164
    v_add_u32 v165, 36864, v165
    v_add_u32 v166, 36864, v166
    v_add_u32 v167, 36864, v167
    ds_read_b128 v[112:115], v166 offset:0
    ds_read_b128 v[116:119], v166 offset:2048
    ds_read_b128 v[76:79], v164 offset:16384
    ds_read_b128 v[80:83], v164 offset:18432
    ds_read_b128 v[84:87], v164 offset:20480
    ds_read_b128 v[88:91], v164 offset:22528
    ds_read_b128 v[92:95], v164 offset:24576
    ds_read_b128 v[96:99], v164 offset:26624
    ds_read_b128 v[100:103], v164 offset:28672
    ds_read_b128 v[104:107], v164 offset:30720
    ds_read_b128 v[108:111], v164 offset:32768
    s_waitcnt lgkmcnt(0)
    v_mfma_f32_16x16x32_bf16 v[4:7], v[76:79], v[112:115], v[4:7]
    v_mfma_f32_16x16x32_bf16 v[8:11], v[76:79], v[116:119], v[8:11]
    ds_read_b128 v[156:159], v167 offset:0
    v_mfma_f32_16x16x32_bf16 v[12:15], v[80:83], v[112:115], v[12:15]
    ds_read_b128 v[160:163], v167 offset:2048
    v_mfma_f32_16x16x32_bf16 v[16:19], v[80:83], v[116:119], v[16:19]
    ds_read_b128 v[120:123], v165 offset:16384
    v_mfma_f32_16x16x32_bf16 v[20:23], v[84:87], v[112:115], v[20:23]
    ds_read_b128 v[124:127], v165 offset:18432
    v_mfma_f32_16x16x32_bf16 v[24:27], v[84:87], v[116:119], v[24:27]
    ds_read_b128 v[128:131], v165 offset:20480
    v_mfma_f32_16x16x32_bf16 v[28:31], v[88:91], v[112:115], v[28:31]
    ds_read_b128 v[132:135], v165 offset:22528
    v_mfma_f32_16x16x32_bf16 v[32:35], v[88:91], v[116:119], v[32:35]
    ds_read_b128 v[136:139], v165 offset:24576
    v_mfma_f32_16x16x32_bf16 v[36:39], v[92:95], v[112:115], v[36:39]
    ds_read_b128 v[140:143], v165 offset:26624
    v_mfma_f32_16x16x32_bf16 v[40:43], v[92:95], v[116:119], v[40:43]
    v_mfma_f32_16x16x32_bf16 v[44:47], v[96:99], v[112:115], v[44:47]
    ds_read_b128 v[144:147], v165 offset:28672
    v_mfma_f32_16x16x32_bf16 v[48:51], v[96:99], v[116:119], v[48:51]
    ds_read_b128 v[148:151], v165 offset:30720
    v_mfma_f32_16x16x32_bf16 v[52:55], v[100:103], v[112:115], v[52:55]
    ds_read_b128 v[152:155], v165 offset:32768
    v_mfma_f32_16x16x32_bf16 v[56:59], v[100:103], v[116:119], v[56:59]
    s_add_u32 s58, s58, 128
    s_add_u32 s59, s59, 128
    v_mfma_f32_16x16x32_bf16 v[60:63], v[104:107], v[112:115], v[60:63]
    s_add_u32 m0, s41, 0
    s_add_u32 s51, s58, 0
    buffer_load_dwordx4 v0, s[16:19], s51 offen lds
    v_mfma_f32_16x16x32_bf16 v[64:67], v[104:107], v[116:119], v[64:67]
    s_add_u32 m0, s41, 4096
    s_add_u32 s51, s58, 131072
    buffer_load_dwordx4 v0, s[16:19], s51 offen lds
    v_mfma_f32_16x16x32_bf16 v[68:71], v[108:111], v[112:115], v[68:71]
    s_add_u32 m0, s41, 8192
    s_add_u32 s51, s58, 262144
    buffer_load_dwordx4 v0, s[16:19], s51 offen lds
    v_mfma_f32_16x16x32_bf16 v[72:75], v[108:111], v[116:119], v[72:75]
    s_add_u32 m0, s41, 12288
    s_add_u32 s51, s58, 393216
    buffer_load_dwordx4 v0, s[16:19], s51 offen lds
    s_waitcnt lgkmcnt(0)
    v_mfma_f32_16x16x32_bf16 v[4:7], v[120:123], v[156:159], v[4:7]
    v_mfma_f32_16x16x32_bf16 v[8:11], v[120:123], v[160:163], v[8:11]
    v_mfma_f32_16x16x32_bf16 v[12:15], v[124:127], v[156:159], v[12:15]
    v_mfma_f32_16x16x32_bf16 v[16:19], v[124:127], v[160:163], v[16:19]
    s_add_u32 m0, s41, 16384
    s_add_u32 s51, s59, 0
    buffer_load_dwordx4 v1, s[20:23], s51 offen lds
    v_mfma_f32_16x16x32_bf16 v[20:23], v[128:131], v[156:159], v[20:23]
    v_mfma_f32_16x16x32_bf16 v[24:27], v[128:131], v[160:163], v[24:27]
    v_mfma_f32_16x16x32_bf16 v[28:31], v[132:135], v[156:159], v[28:31]
    v_mfma_f32_16x16x32_bf16 v[32:35], v[132:135], v[160:163], v[32:35]
    s_add_u32 m0, s41, 20480
    s_add_u32 s51, s59, 131072
    buffer_load_dwordx4 v1, s[20:23], s51 offen lds
    v_mfma_f32_16x16x32_bf16 v[36:39], v[136:139], v[156:159], v[36:39]
    v_mfma_f32_16x16x32_bf16 v[40:43], v[136:139], v[160:163], v[40:43]
    v_mfma_f32_16x16x32_bf16 v[44:47], v[140:143], v[156:159], v[44:47]
    s_add_u32 m0, s41, 24576
    s_add_u32 s51, s59, 262144
    buffer_load_dwordx4 v1, s[20:23], s51 offen lds
    v_mfma_f32_16x16x32_bf16 v[48:51], v[140:143], v[160:163], v[48:51]
    v_mfma_f32_16x16x32_bf16 v[52:55], v[144:147], v[156:159], v[52:55]
    v_mfma_f32_16x16x32_bf16 v[56:59], v[144:147], v[160:163], v[56:59]
    v_mfma_f32_16x16x32_bf16 v[60:63], v[148:151], v[156:159], v[60:63]
    s_add_u32 m0, s41, 28672
    s_add_u32 s51, s59, 393216
    buffer_load_dwordx4 v1, s[20:23], s51 offen lds
    v_mfma_f32_16x16x32_bf16 v[64:67], v[148:151], v[160:163], v[64:67]
    v_mfma_f32_16x16x32_bf16 v[68:71], v[152:155], v[156:159], v[68:71]
    v_mfma_f32_16x16x32_bf16 v[72:75], v[152:155], v[160:163], v[72:75]
    s_add_u32 m0, s41, 32768
    s_add_u32 s51, s59, 524288
    buffer_load_dwordx4 v1, s[20:23], s51 offen lds
    s_waitcnt vmcnt(9)
    s_barrier
    v_add_u32 v164, 36864, v164
    v_add_u32 v165, 36864, v165
    v_add_u32 v166, 36864, v166
    v_add_u32 v167, 36864, v167
    ds_read_b128 v[112:115], v166 offset:0
    ds_read_b128 v[116:119], v166 offset:2048
    ds_read_b128 v[76:79], v164 offset:16384
    ds_read_b128 v[80:83], v164 offset:18432
    ds_read_b128 v[84:87], v164 offset:20480
    ds_read_b128 v[88:91], v164 offset:22528
    ds_read_b128 v[92:95], v164 offset:24576
    ds_read_b128 v[96:99], v164 offset:26624
    ds_read_b128 v[100:103], v164 offset:28672
    ds_read_b128 v[104:107], v164 offset:30720
    ds_read_b128 v[108:111], v164 offset:32768
    s_waitcnt lgkmcnt(0)
    v_mfma_f32_16x16x32_bf16 v[4:7], v[76:79], v[112:115], v[4:7]
    v_mfma_f32_16x16x32_bf16 v[8:11], v[76:79], v[116:119], v[8:11]
    ds_read_b128 v[156:159], v167 offset:0
    v_mfma_f32_16x16x32_bf16 v[12:15], v[80:83], v[112:115], v[12:15]
    ds_read_b128 v[160:163], v167 offset:2048
    v_mfma_f32_16x16x32_bf16 v[16:19], v[80:83], v[116:119], v[16:19]
    ds_read_b128 v[120:123], v165 offset:16384
    v_mfma_f32_16x16x32_bf16 v[20:23], v[84:87], v[112:115], v[20:23]
    ds_read_b128 v[124:127], v165 offset:18432
    v_mfma_f32_16x16x32_bf16 v[24:27], v[84:87], v[116:119], v[24:27]
    ds_read_b128 v[128:131], v165 offset:20480
    v_mfma_f32_16x16x32_bf16 v[28:31], v[88:91], v[112:115], v[28:31]
    ds_read_b128 v[132:135], v165 offset:22528
    v_mfma_f32_16x16x32_bf16 v[32:35], v[88:91], v[116:119], v[32:35]
    ds_read_b128 v[136:139], v165 offset:24576
    v_mfma_f32_16x16x32_bf16 v[36:39], v[92:95], v[112:115], v[36:39]
    ds_read_b128 v[140:143], v165 offset:26624
    v_mfma_f32_16x16x32_bf16 v[40:43], v[92:95], v[116:119], v[40:43]
    v_mfma_f32_16x16x32_bf16 v[44:47], v[96:99], v[112:115], v[44:47]
    ds_read_b128 v[144:147], v165 offset:28672
    v_mfma_f32_16x16x32_bf16 v[48:51], v[96:99], v[116:119], v[48:51]
    ds_read_b128 v[148:151], v165 offset:30720
    v_mfma_f32_16x16x32_bf16 v[52:55], v[100:103], v[112:115], v[52:55]
    ds_read_b128 v[152:155], v165 offset:32768
    v_mfma_f32_16x16x32_bf16 v[56:59], v[100:103], v[116:119], v[56:59]
    s_add_u32 s58, s58, 128
    s_add_u32 s59, s59, 128
    v_mfma_f32_16x16x32_bf16 v[60:63], v[104:107], v[112:115], v[60:63]
    s_add_u32 m0, s41, 36864
    s_add_u32 s51, s58, 0
    buffer_load_dwordx4 v0, s[16:19], s51 offen lds
    v_mfma_f32_16x16x32_bf16 v[64:67], v[104:107], v[116:119], v[64:67]
    s_add_u32 m0, s41, 40960
    s_add_u32 s51, s58, 131072
    buffer_load_dwordx4 v0, s[16:19], s51 offen lds
    v_mfma_f32_16x16x32_bf16 v[68:71], v[108:111], v[112:115], v[68:71]
    s_add_u32 m0, s41, 45056
    s_add_u32 s51, s58, 262144
    buffer_load_dwordx4 v0, s[16:19], s51 offen lds
    v_mfma_f32_16x16x32_bf16 v[72:75], v[108:111], v[116:119], v[72:75]
    s_add_u32 m0, s41, 49152
    s_add_u32 s51, s58, 393216
    buffer_load_dwordx4 v0, s[16:19], s51 offen lds
    s_waitcnt lgkmcnt(0)
    v_mfma_f32_16x16x32_bf16 v[4:7], v[120:123], v[156:159], v[4:7]
    v_mfma_f32_16x16x32_bf16 v[8:11], v[120:123], v[160:163], v[8:11]
    v_mfma_f32_16x16x32_bf16 v[12:15], v[124:127], v[156:159], v[12:15]
    v_mfma_f32_16x16x32_bf16 v[16:19], v[124:127], v[160:163], v[16:19]
    s_add_u32 m0, s41, 53248
    s_add_u32 s51, s59, 0
    buffer_load_dwordx4 v1, s[20:23], s51 offen lds
    v_mfma_f32_16x16x32_bf16 v[20:23], v[128:131], v[156:159], v[20:23]
    v_mfma_f32_16x16x32_bf16 v[24:27], v[128:131], v[160:163], v[24:27]
    v_mfma_f32_16x16x32_bf16 v[28:31], v[132:135], v[156:159], v[28:31]
    v_mfma_f32_16x16x32_bf16 v[32:35], v[132:135], v[160:163], v[32:35]
    s_add_u32 m0, s41, 57344
    s_add_u32 s51, s59, 131072
    buffer_load_dwordx4 v1, s[20:23], s51 offen lds
    v_mfma_f32_16x16x32_bf16 v[36:39], v[136:139], v[156:159], v[36:39]
    v_mfma_f32_16x16x32_bf16 v[40:43], v[136:139], v[160:163], v[40:43]
    v_mfma_f32_16x16x32_bf16 v[44:47], v[140:143], v[156:159], v[44:47]
    s_add_u32 m0, s41, 61440
    s_add_u32 s51, s59, 262144
    buffer_load_dwordx4 v1, s[20:23], s51 offen lds
    v_mfma_f32_16x16x32_bf16 v[48:51], v[140:143], v[160:163], v[48:51]
    v_mfma_f32_16x16x32_bf16 v[52:55], v[144:147], v[156:159], v[52:55]
    v_mfma_f32_16x16x32_bf16 v[56:59], v[144:147], v[160:163], v[56:59]
    v_mfma_f32_16x16x32_bf16 v[60:63], v[148:151], v[156:159], v[60:63]
    s_add_u32 m0, s41, 65536
    s_add_u32 s51, s59, 393216
    buffer_load_dwordx4 v1, s[20:23], s51 offen lds
    v_mfma_f32_16x16x32_bf16 v[64:67], v[148:151], v[160:163], v[64:67]
    v_mfma_f32_16x16x32_bf16 v[68:71], v[152:155], v[156:159], v[68:71]
    v_mfma_f32_16x16x32_bf16 v[72:75], v[152:155], v[160:163], v[72:75]
    s_add_u32 m0, s41, 69632
    s_add_u32 s51, s59, 524288
    buffer_load_dwordx4 v1, s[20:23], s51 offen lds
    s_waitcnt vmcnt(9)
    s_barrier
    v_subrev_u32 v164, 73728, v164
    v_subrev_u32 v165, 73728, v165
    v_subrev_u32 v166, 73728, v166
    v_subrev_u32 v167, 73728, v167
    ds_read_b128 v[112:115], v166 offset:0
    ds_read_b128 v[116:119], v166 offset:2048
    ds_read_b128 v[76:79], v164 offset:16384
    ds_read_b128 v[80:83], v164 offset:18432
    ds_read_b128 v[84:87], v164 offset:20480
    ds_read_b128 v[88:91], v164 offset:22528
    ds_read_b128 v[92:95], v164 offset:24576
    ds_read_b128 v[96:99], v164 offset:26624
    ds_read_b128 v[100:103], v164 offset:28672
    ds_read_b128 v[104:107], v164 offset:30720
    ds_read_b128 v[108:111], v164 offset:32768
    s_waitcnt lgkmcnt(0)
    v_mfma_f32_16x16x32_bf16 v[4:7], v[76:79], v[112:115], v[4:7]
    v_mfma_f32_16x16x32_bf16 v[8:11], v[76:79], v[116:119], v[8:11]
    ds_read_b128 v[156:159], v167 offset:0
    v_mfma_f32_16x16x32_bf16 v[12:15], v[80:83], v[112:115], v[12:15]
    ds_read_b128 v[160:163], v167 offset:2048
    v_mfma_f32_16x16x32_bf16 v[16:19], v[80:83], v[116:119], v[16:19]
    ds_read_b128 v[120:123], v165 offset:16384
    v_mfma_f32_16x16x32_bf16 v[20:23], v[84:87], v[112:115], v[20:23]
    ds_read_b128 v[124:127], v165 offset:18432
    v_mfma_f32_16x16x32_bf16 v[24:27], v[84:87], v[116:119], v[24:27]
    ds_read_b128 v[128:131], v165 offset:20480
    v_mfma_f32_16x16x32_bf16 v[28:31], v[88:91], v[112:115], v[28:31]
    ds_read_b128 v[132:135], v165 offset:22528
    v_mfma_f32_16x16x32_bf16 v[32:35], v[88:91], v[116:119], v[32:35]
    ds_read_b128 v[136:139], v165 offset:24576
    v_mfma_f32_16x16x32_bf16 v[36:39], v[92:95], v[112:115], v[36:39]
    ds_read_b128 v[140:143], v165 offset:26624
    v_mfma_f32_16x16x32_bf16 v[40:43], v[92:95], v[116:119], v[40:43]
    v_mfma_f32_16x16x32_bf16 v[44:47], v[96:99], v[112:115], v[44:47]
    ds_read_b128 v[144:147], v165 offset:28672
    v_mfma_f32_16x16x32_bf16 v[48:51], v[96:99], v[116:119], v[48:51]
    ds_read_b128 v[148:151], v165 offset:30720
    v_mfma_f32_16x16x32_bf16 v[52:55], v[100:103], v[112:115], v[52:55]
    ds_read_b128 v[152:155], v165 offset:32768
    v_mfma_f32_16x16x32_bf16 v[56:59], v[100:103], v[116:119], v[56:59]
    s_add_u32 s58, s58, 128
    s_add_u32 s59, s59, 128
    v_mfma_f32_16x16x32_bf16 v[60:63], v[104:107], v[112:115], v[60:63]
    s_add_u32 m0, s41, 73728
    s_add_u32 s51, s58, 0
    buffer_load_dwordx4 v0, s[16:19], s51 offen lds
    v_mfma_f32_16x16x32_bf16 v[64:67], v[104:107], v[116:119], v[64:67]
    s_add_u32 m0, s41, 77824
    s_add_u32 s51, s58, 131072
    buffer_load_dwordx4 v0, s[16:19], s51 offen lds
    v_mfma_f32_16x16x32_bf16 v[68:71], v[108:111], v[112:115], v[68:71]
    s_add_u32 m0, s41, 81920
    s_add_u32 s51, s58, 262144
    buffer_load_dwordx4 v0, s[16:19], s51 offen lds
    v_mfma_f32_16x16x32_bf16 v[72:75], v[108:111], v[116:119], v[72:75]
    s_add_u32 m0, s41, 86016
    s_add_u32 s51, s58, 393216
    buffer_load_dwordx4 v0, s[16:19], s51 offen lds
    s_waitcnt lgkmcnt(0)
    v_mfma_f32_16x16x32_bf16 v[4:7], v[120:123], v[156:159], v[4:7]
    v_mfma_f32_16x16x32_bf16 v[8:11], v[120:123], v[160:163], v[8:11]
    v_mfma_f32_16x16x32_bf16 v[12:15], v[124:127], v[156:159], v[12:15]
    v_mfma_f32_16x16x32_bf16 v[16:19], v[124:127], v[160:163], v[16:19]
    s_add_u32 m0, s41, 90112
    s_add_u32 s51, s59, 0
    buffer_load_dwordx4 v1, s[20:23], s51 offen lds
    v_mfma_f32_16x16x32_bf16 v[20:23], v[128:131], v[156:159], v[20:23]
    v_mfma_f32_16x16x32_bf16 v[24:27], v[128:131], v[160:163], v[24:27]
    v_mfma_f32_16x16x32_bf16 v[28:31], v[132:135], v[156:159], v[28:31]
    v_mfma_f32_16x16x32_bf16 v[32:35], v[132:135], v[160:163], v[32:35]
    s_add_u32 m0, s41, 94208
    s_add_u32 s51, s59, 131072
    buffer_load_dwordx4 v1, s[20:23], s51 offen lds
    v_mfma_f32_16x16x32_bf16 v[36:39], v[136:139], v[156:159], v[36:39]
    v_mfma_f32_16x16x32_bf16 v[40:43], v[136:139], v[160:163], v[40:43]
    v_mfma_f32_16x16x32_bf16 v[44:47], v[140:143], v[156:159], v[44:47]
    s_add_u32 m0, s41, 98304
    s_add_u32 s51, s59, 262144
    buffer_load_dwordx4 v1, s[20:23], s51 offen lds
    v_mfma_f32_16x16x32_bf16 v[48:51], v[140:143], v[160:163], v[48:51]
    v_mfma_f32_16x16x32_bf16 v[52:55], v[144:147], v[156:159], v[52:55]
    v_mfma_f32_16x16x32_bf16 v[56:59], v[144:147], v[160:163], v[56:59]
    v_mfma_f32_16x16x32_bf16 v[60:63], v[148:151], v[156:159], v[60:63]
    s_add_u32 m0, s41, 102400
    s_add_u32 s51, s59, 393216
    buffer_load_dwordx4 v1, s[20:23], s51 offen lds
    v_mfma_f32_16x16x32_bf16 v[64:67], v[148:151], v[160:163], v[64:67]
    v_mfma_f32_16x16x32_bf16 v[68:71], v[152:155], v[156:159], v[68:71]
    v_mfma_f32_16x16x32_bf16 v[72:75], v[152:155], v[160:163], v[72:75]
    s_add_u32 m0, s41, 106496
    s_add_u32 s51, s59, 524288
    buffer_load_dwordx4 v1, s[20:23], s51 offen lds
    s_waitcnt vmcnt(9)
    s_barrier
    v_add_u32 v164, 36864, v164
    v_add_u32 v165, 36864, v165
    v_add_u32 v166, 36864, v166
    v_add_u32 v167, 36864, v167
    ds_read_b128 v[112:115], v166 offset:0
    ds_read_b128 v[116:119], v166 offset:2048
    ds_read_b128 v[76:79], v164 offset:16384
    ds_read_b128 v[80:83], v164 offset:18432
    ds_read_b128 v[84:87], v164 offset:20480
    ds_read_b128 v[88:91], v164 offset:22528
    ds_read_b128 v[92:95], v164 offset:24576
    ds_read_b128 v[96:99], v164 offset:26624
    ds_read_b128 v[100:103], v164 offset:28672
    ds_read_b128 v[104:107], v164 offset:30720
    ds_read_b128 v[108:111], v164 offset:32768
    s_waitcnt lgkmcnt(0)
    v_mfma_f32_16x16x32_bf16 v[4:7], v[76:79], v[112:115], v[4:7]
    v_mfma_f32_16x16x32_bf16 v[8:11], v[76:79], v[116:119], v[8:11]
    ds_read_b128 v[156:159], v167 offset:0
    v_mfma_f32_16x16x32_bf16 v[12:15], v[80:83], v[112:115], v[12:15]
    ds_read_b128 v[160:163], v167 offset:2048
    v_mfma_f32_16x16x32_bf16 v[16:19], v[80:83], v[116:119], v[16:19]
    ds_read_b128 v[120:123], v165 offset:16384
    v_mfma_f32_16x16x32_bf16 v[20:23], v[84:87], v[112:115], v[20:23]
    ds_read_b128 v[124:127], v165 offset:18432
    v_mfma_f32_16x16x32_bf16 v[24:27], v[84:87], v[116:119], v[24:27]
    ds_read_b128 v[128:131], v165 offset:20480
    v_mfma_f32_16x16x32_bf16 v[28:31], v[88:91], v[112:115], v[28:31]
    ds_read_b128 v[132:135], v165 offset:22528
    v_mfma_f32_16x16x32_bf16 v[32:35], v[88:91], v[116:119], v[32:35]
    ds_read_b128 v[136:139], v165 offset:24576
    v_mfma_f32_16x16x32_bf16 v[36:39], v[92:95], v[112:115], v[36:39]
    ds_read_b128 v[140:143], v165 offset:26624
    v_mfma_f32_16x16x32_bf16 v[40:43], v[92:95], v[116:119], v[40:43]
    v_mfma_f32_16x16x32_bf16 v[44:47], v[96:99], v[112:115], v[44:47]
    ds_read_b128 v[144:147], v165 offset:28672
    v_mfma_f32_16x16x32_bf16 v[48:51], v[96:99], v[116:119], v[48:51]
    ds_read_b128 v[148:151], v165 offset:30720
    v_mfma_f32_16x16x32_bf16 v[52:55], v[100:103], v[112:115], v[52:55]
    ds_read_b128 v[152:155], v165 offset:32768
    v_mfma_f32_16x16x32_bf16 v[56:59], v[100:103], v[116:119], v[56:59]
    s_add_u32 s58, s58, 128
    s_add_u32 s59, s59, 128
    v_mfma_f32_16x16x32_bf16 v[60:63], v[104:107], v[112:115], v[60:63]
    s_add_u32 m0, s41, 0
    s_add_u32 s51, s58, 0
    buffer_load_dwordx4 v0, s[16:19], s51 offen lds
    v_mfma_f32_16x16x32_bf16 v[64:67], v[104:107], v[116:119], v[64:67]
    s_add_u32 m0, s41, 4096
    s_add_u32 s51, s58, 131072
    buffer_load_dwordx4 v0, s[16:19], s51 offen lds
    v_mfma_f32_16x16x32_bf16 v[68:71], v[108:111], v[112:115], v[68:71]
    s_add_u32 m0, s41, 8192
    s_add_u32 s51, s58, 262144
    buffer_load_dwordx4 v0, s[16:19], s51 offen lds
    v_mfma_f32_16x16x32_bf16 v[72:75], v[108:111], v[116:119], v[72:75]
    s_add_u32 m0, s41, 12288
    s_add_u32 s51, s58, 393216
    buffer_load_dwordx4 v0, s[16:19], s51 offen lds
    s_waitcnt lgkmcnt(0)
    v_mfma_f32_16x16x32_bf16 v[4:7], v[120:123], v[156:159], v[4:7]
    v_mfma_f32_16x16x32_bf16 v[8:11], v[120:123], v[160:163], v[8:11]
    v_mfma_f32_16x16x32_bf16 v[12:15], v[124:127], v[156:159], v[12:15]
    v_mfma_f32_16x16x32_bf16 v[16:19], v[124:127], v[160:163], v[16:19]
    s_add_u32 m0, s41, 16384
    s_add_u32 s51, s59, 0
    buffer_load_dwordx4 v1, s[20:23], s51 offen lds
    v_mfma_f32_16x16x32_bf16 v[20:23], v[128:131], v[156:159], v[20:23]
    v_mfma_f32_16x16x32_bf16 v[24:27], v[128:131], v[160:163], v[24:27]
    v_mfma_f32_16x16x32_bf16 v[28:31], v[132:135], v[156:159], v[28:31]
    v_mfma_f32_16x16x32_bf16 v[32:35], v[132:135], v[160:163], v[32:35]
    s_add_u32 m0, s41, 20480
    s_add_u32 s51, s59, 131072
    buffer_load_dwordx4 v1, s[20:23], s51 offen lds
    v_mfma_f32_16x16x32_bf16 v[36:39], v[136:139], v[156:159], v[36:39]
    v_mfma_f32_16x16x32_bf16 v[40:43], v[136:139], v[160:163], v[40:43]
    v_mfma_f32_16x16x32_bf16 v[44:47], v[140:143], v[156:159], v[44:47]
    s_add_u32 m0, s41, 24576
    s_add_u32 s51, s59, 262144
    buffer_load_dwordx4 v1, s[20:23], s51 offen lds
    v_mfma_f32_16x16x32_bf16 v[48:51], v[140:143], v[160:163], v[48:51]
    v_mfma_f32_16x16x32_bf16 v[52:55], v[144:147], v[156:159], v[52:55]
    v_mfma_f32_16x16x32_bf16 v[56:59], v[144:147], v[160:163], v[56:59]
    v_mfma_f32_16x16x32_bf16 v[60:63], v[148:151], v[156:159], v[60:63]
    s_add_u32 m0, s41, 28672
    s_add_u32 s51, s59, 393216
    buffer_load_dwordx4 v1, s[20:23], s51 offen lds
    v_mfma_f32_16x16x32_bf16 v[64:67], v[148:151], v[160:163], v[64:67]
    v_mfma_f32_16x16x32_bf16 v[68:71], v[152:155], v[156:159], v[68:71]
    v_mfma_f32_16x16x32_bf16 v[72:75], v[152:155], v[160:163], v[72:75]
    s_add_u32 m0, s41, 32768
    s_add_u32 s51, s59, 524288
    buffer_load_dwordx4 v1, s[20:23], s51 offen lds
    s_waitcnt vmcnt(9)
    s_barrier
    v_add_u32 v164, 36864, v164
    v_add_u32 v165, 36864, v165
    v_add_u32 v166, 36864, v166
    v_add_u32 v167, 36864, v167
    ds_read_b128 v[112:115], v166 offset:0
    ds_read_b128 v[116:119], v166 offset:2048
    ds_read_b128 v[76:79], v164 offset:16384
    ds_read_b128 v[80:83], v164 offset:18432
    ds_read_b128 v[84:87], v164 offset:20480
    ds_read_b128 v[88:91], v164 offset:22528
    ds_read_b128 v[92:95], v164 offset:24576
    ds_read_b128 v[96:99], v164 offset:26624
    ds_read_b128 v[100:103], v164 offset:28672
    ds_read_b128 v[104:107], v164 offset:30720
    ds_read_b128 v[108:111], v164 offset:32768
    s_waitcnt lgkmcnt(0)
    v_mfma_f32_16x16x32_bf16 v[4:7], v[76:79], v[112:115], v[4:7]
    v_mfma_f32_16x16x32_bf16 v[8:11], v[76:79], v[116:119], v[8:11]
    ds_read_b128 v[156:159], v167 offset:0
    v_mfma_f32_16x16x32_bf16 v[12:15], v[80:83], v[112:115], v[12:15]
    ds_read_b128 v[160:163], v167 offset:2048
    v_mfma_f32_16x16x32_bf16 v[16:19], v[80:83], v[116:119], v[16:19]
    ds_read_b128 v[120:123], v165 offset:16384
    v_mfma_f32_16x16x32_bf16 v[20:23], v[84:87], v[112:115], v[20:23]
    ds_read_b128 v[124:127], v165 offset:18432
    v_mfma_f32_16x16x32_bf16 v[24:27], v[84:87], v[116:119], v[24:27]
    ds_read_b128 v[128:131], v165 offset:20480
    v_mfma_f32_16x16x32_bf16 v[28:31], v[88:91], v[112:115], v[28:31]
    ds_read_b128 v[132:135], v165 offset:22528
    v_mfma_f32_16x16x32_bf16 v[32:35], v[88:91], v[116:119], v[32:35]
    ds_read_b128 v[136:139], v165 offset:24576
    v_mfma_f32_16x16x32_bf16 v[36:39], v[92:95], v[112:115], v[36:39]
    ds_read_b128 v[140:143], v165 offset:26624
    v_mfma_f32_16x16x32_bf16 v[40:43], v[92:95], v[116:119], v[40:43]
    v_mfma_f32_16x16x32_bf16 v[44:47], v[96:99], v[112:115], v[44:47]
    ds_read_b128 v[144:147], v165 offset:28672
    v_mfma_f32_16x16x32_bf16 v[48:51], v[96:99], v[116:119], v[48:51]
    ds_read_b128 v[148:151], v165 offset:30720
    v_mfma_f32_16x16x32_bf16 v[52:55], v[100:103], v[112:115], v[52:55]
    ds_read_b128 v[152:155], v165 offset:32768
    v_mfma_f32_16x16x32_bf16 v[56:59], v[100:103], v[116:119], v[56:59]
    s_add_u32 s58, s58, 128
    s_add_u32 s59, s59, 128
    v_mfma_f32_16x16x32_bf16 v[60:63], v[104:107], v[112:115], v[60:63]
    s_add_u32 m0, s41, 36864
    s_add_u32 s51, s58, 0
    buffer_load_dwordx4 v0, s[16:19], s51 offen lds
    v_mfma_f32_16x16x32_bf16 v[64:67], v[104:107], v[116:119], v[64:67]
    s_add_u32 m0, s41, 40960
    s_add_u32 s51, s58, 131072
    buffer_load_dwordx4 v0, s[16:19], s51 offen lds
    v_mfma_f32_16x16x32_bf16 v[68:71], v[108:111], v[112:115], v[68:71]
    s_add_u32 m0, s41, 45056
    s_add_u32 s51, s58, 262144
    buffer_load_dwordx4 v0, s[16:19], s51 offen lds
    v_mfma_f32_16x16x32_bf16 v[72:75], v[108:111], v[116:119], v[72:75]
    s_add_u32 m0, s41, 49152
    s_add_u32 s51, s58, 393216
    buffer_load_dwordx4 v0, s[16:19], s51 offen lds
    s_waitcnt lgkmcnt(0)
    v_mfma_f32_16x16x32_bf16 v[4:7], v[120:123], v[156:159], v[4:7]
    v_mfma_f32_16x16x32_bf16 v[8:11], v[120:123], v[160:163], v[8:11]
    v_mfma_f32_16x16x32_bf16 v[12:15], v[124:127], v[156:159], v[12:15]
    v_mfma_f32_16x16x32_bf16 v[16:19], v[124:127], v[160:163], v[16:19]
    s_add_u32 m0, s41, 53248
    s_add_u32 s51, s59, 0
    buffer_load_dwordx4 v1, s[20:23], s51 offen lds
    v_mfma_f32_16x16x32_bf16 v[20:23], v[128:131], v[156:159], v[20:23]
    v_mfma_f32_16x16x32_bf16 v[24:27], v[128:131], v[160:163], v[24:27]
    v_mfma_f32_16x16x32_bf16 v[28:31], v[132:135], v[156:159], v[28:31]
    v_mfma_f32_16x16x32_bf16 v[32:35], v[132:135], v[160:163], v[32:35]
    s_add_u32 m0, s41, 57344
    s_add_u32 s51, s59, 131072
    buffer_load_dwordx4 v1, s[20:23], s51 offen lds
    v_mfma_f32_16x16x32_bf16 v[36:39], v[136:139], v[156:159], v[36:39]
    v_mfma_f32_16x16x32_bf16 v[40:43], v[136:139], v[160:163], v[40:43]
    v_mfma_f32_16x16x32_bf16 v[44:47], v[140:143], v[156:159], v[44:47]
    s_add_u32 m0, s41, 61440
    s_add_u32 s51, s59, 262144
    buffer_load_dwordx4 v1, s[20:23], s51 offen lds
    v_mfma_f32_16x16x32_bf16 v[48:51], v[140:143], v[160:163], v[48:51]
    v_mfma_f32_16x16x32_bf16 v[52:55], v[144:147], v[156:159], v[52:55]
    v_mfma_f32_16x16x32_bf16 v[56:59], v[144:147], v[160:163], v[56:59]
    v_mfma_f32_16x16x32_bf16 v[60:63], v[148:151], v[156:159], v[60:63]
    s_add_u32 m0, s41, 65536
    s_add_u32 s51, s59, 393216
    buffer_load_dwordx4 v1, s[20:23], s51 offen lds
    v_mfma_f32_16x16x32_bf16 v[64:67], v[148:151], v[160:163], v[64:67]
    v_mfma_f32_16x16x32_bf16 v[68:71], v[152:155], v[156:159], v[68:71]
    v_mfma_f32_16x16x32_bf16 v[72:75], v[152:155], v[160:163], v[72:75]
    s_add_u32 m0, s41, 69632
    s_add_u32 s51, s59, 524288
    buffer_load_dwordx4 v1, s[20:23], s51 offen lds
    s_waitcnt vmcnt(9)
    s_barrier
    v_subrev_u32 v164, 73728, v164
    v_subrev_u32 v165, 73728, v165
    v_subrev_u32 v166, 73728, v166
    v_subrev_u32 v167, 73728, v167
    ds_read_b128 v[112:115], v166 offset:0
    ds_read_b128 v[116:119], v166 offset:2048
    ds_read_b128 v[76:79], v164 offset:16384
    ds_read_b128 v[80:83], v164 offset:18432
    ds_read_b128 v[84:87], v164 offset:20480
    ds_read_b128 v[88:91], v164 offset:22528
    ds_read_b128 v[92:95], v164 offset:24576
    ds_read_b128 v[96:99], v164 offset:26624
    ds_read_b128 v[100:103], v164 offset:28672
    ds_read_b128 v[104:107], v164 offset:30720
    ds_read_b128 v[108:111], v164 offset:32768
    s_waitcnt lgkmcnt(0)
    v_mfma_f32_16x16x32_bf16 v[4:7], v[76:79], v[112:115], v[4:7]
    v_mfma_f32_16x16x32_bf16 v[8:11], v[76:79], v[116:119], v[8:11]
    ds_read_b128 v[156:159], v167 offset:0
    v_mfma_f32_16x16x32_bf16 v[12:15], v[80:83], v[112:115], v[12:15]
    ds_read_b128 v[160:163], v167 offset:2048
    v_mfma_f32_16x16x32_bf16 v[16:19], v[80:83], v[116:119], v[16:19]
    ds_read_b128 v[120:123], v165 offset:16384
    v_mfma_f32_16x16x32_bf16 v[20:23], v[84:87], v[112:115], v[20:23]
    ds_read_b128 v[124:127], v165 offset:18432
    v_mfma_f32_16x16x32_bf16 v[24:27], v[84:87], v[116:119], v[24:27]
    ds_read_b128 v[128:131], v165 offset:20480
    v_mfma_f32_16x16x32_bf16 v[28:31], v[88:91], v[112:115], v[28:31]
    ds_read_b128 v[132:135], v165 offset:22528
    v_mfma_f32_16x16x32_bf16 v[32:35], v[88:91], v[116:119], v[32:35]
    ds_read_b128 v[136:139], v165 offset:24576
    v_mfma_f32_16x16x32_bf16 v[36:39], v[92:95], v[112:115], v[36:39]
    ds_read_b128 v[140:143], v165 offset:26624
    v_mfma_f32_16x16x32_bf16 v[40:43], v[92:95], v[116:119], v[40:43]
    v_mfma_f32_16x16x32_bf16 v[44:47], v[96:99], v[112:115], v[44:47]
    ds_read_b128 v[144:147], v165 offset:28672
    v_mfma_f32_16x16x32_bf16 v[48:51], v[96:99], v[116:119], v[48:51]
    ds_read_b128 v[148:151], v165 offset:30720
    v_mfma_f32_16x16x32_bf16 v[52:55], v[100:103], v[112:115], v[52:55]
    ds_read_b128 v[152:155], v165 offset:32768
    v_mfma_f32_16x16x32_bf16 v[56:59], v[100:103], v[116:119], v[56:59]
    s_add_u32 s58, s58, 128
    s_add_u32 s59, s59, 128
    v_mfma_f32_16x16x32_bf16 v[60:63], v[104:107], v[112:115], v[60:63]
    s_add_u32 m0, s41, 73728
    s_add_u32 s51, s58, 0
    buffer_load_dwordx4 v0, s[16:19], s51 offen lds
    v_mfma_f32_16x16x32_bf16 v[64:67], v[104:107], v[116:119], v[64:67]
    s_add_u32 m0, s41, 77824
    s_add_u32 s51, s58, 131072
    buffer_load_dwordx4 v0, s[16:19], s51 offen lds
    v_mfma_f32_16x16x32_bf16 v[68:71], v[108:111], v[112:115], v[68:71]
    s_add_u32 m0, s41, 81920
    s_add_u32 s51, s58, 262144
    buffer_load_dwordx4 v0, s[16:19], s51 offen lds
    v_mfma_f32_16x16x32_bf16 v[72:75], v[108:111], v[116:119], v[72:75]
    s_add_u32 m0, s41, 86016
    s_add_u32 s51, s58, 393216
    buffer_load_dwordx4 v0, s[16:19], s51 offen lds
    s_waitcnt lgkmcnt(0)
    v_mfma_f32_16x16x32_bf16 v[4:7], v[120:123], v[156:159], v[4:7]
    v_mfma_f32_16x16x32_bf16 v[8:11], v[120:123], v[160:163], v[8:11]
    v_mfma_f32_16x16x32_bf16 v[12:15], v[124:127], v[156:159], v[12:15]
    v_mfma_f32_16x16x32_bf16 v[16:19], v[124:127], v[160:163], v[16:19]
    s_add_u32 m0, s41, 90112
    s_add_u32 s51, s59, 0
    buffer_load_dwordx4 v1, s[20:23], s51 offen lds
    v_mfma_f32_16x16x32_bf16 v[20:23], v[128:131], v[156:159], v[20:23]
    v_mfma_f32_16x16x32_bf16 v[24:27], v[128:131], v[160:163], v[24:27]
    v_mfma_f32_16x16x32_bf16 v[28:31], v[132:135], v[156:159], v[28:31]
    v_mfma_f32_16x16x32_bf16 v[32:35], v[132:135], v[160:163], v[32:35]
    s_add_u32 m0, s41, 94208
    s_add_u32 s51, s59, 131072
    buffer_load_dwordx4 v1, s[20:23], s51 offen lds
    v_mfma_f32_16x16x32_bf16 v[36:39], v[136:139], v[156:159], v[36:39]
    v_mfma_f32_16x16x32_bf16 v[40:43], v[136:139], v[160:163], v[40:43]
    v_mfma_f32_16x16x32_bf16 v[44:47], v[140:143], v[156:159], v[44:47]
    s_add_u32 m0, s41, 98304
    s_add_u32 s51, s59, 262144
    buffer_load_dwordx4 v1, s[20:23], s51 offen lds
    v_mfma_f32_16x16x32_bf16 v[48:51], v[140:143], v[160:163], v[48:51]
    v_mfma_f32_16x16x32_bf16 v[52:55], v[144:147], v[156:159], v[52:55]
    v_mfma_f32_16x16x32_bf16 v[56:59], v[144:147], v[160:163], v[56:59]
    v_mfma_f32_16x16x32_bf16 v[60:63], v[148:151], v[156:159], v[60:63]
    s_add_u32 m0, s41, 102400
    s_add_u32 s51, s59, 393216
    buffer_load_dwordx4 v1, s[20:23], s51 offen lds
    v_mfma_f32_16x16x32_bf16 v[64:67], v[148:151], v[160:163], v[64:67]
    v_mfma_f32_16x16x32_bf16 v[68:71], v[152:155], v[156:159], v[68:71]
    v_mfma_f32_16x16x32_bf16 v[72:75], v[152:155], v[160:163], v[72:75]
    s_add_u32 m0, s41, 106496
    s_add_u32 s51, s59, 524288
    buffer_load_dwordx4 v1, s[20:23], s51 offen lds
    s_waitcnt vmcnt(9)
    s_barrier
    v_add_u32 v164, 36864, v164
    v_add_u32 v165, 36864, v165
    v_add_u32 v166, 36864, v166
    v_add_u32 v167, 36864, v167
    ds_read_b128 v[112:115], v166 offset:0
    ds_read_b128 v[116:119], v166 offset:2048
    ds_read_b128 v[76:79], v164 offset:16384
    ds_read_b128 v[80:83], v164 offset:18432
    ds_read_b128 v[84:87], v164 offset:20480
    ds_read_b128 v[88:91], v164 offset:22528
    ds_read_b128 v[92:95], v164 offset:24576
    ds_read_b128 v[96:99], v164 offset:26624
    ds_read_b128 v[100:103], v164 offset:28672
    ds_read_b128 v[104:107], v164 offset:30720
    ds_read_b128 v[108:111], v164 offset:32768
    s_waitcnt lgkmcnt(0)
    v_mfma_f32_16x16x32_bf16 v[4:7], v[76:79], v[112:115], v[4:7]
    v_mfma_f32_16x16x32_bf16 v[8:11], v[76:79], v[116:119], v[8:11]
    ds_read_b128 v[156:159], v167 offset:0
    v_mfma_f32_16x16x32_bf16 v[12:15], v[80:83], v[112:115], v[12:15]
    ds_read_b128 v[160:163], v167 offset:2048
    v_mfma_f32_16x16x32_bf16 v[16:19], v[80:83], v[116:119], v[16:19]
    ds_read_b128 v[120:123], v165 offset:16384
    v_mfma_f32_16x16x32_bf16 v[20:23], v[84:87], v[112:115], v[20:23]
    ds_read_b128 v[124:127], v165 offset:18432
    v_mfma_f32_16x16x32_bf16 v[24:27], v[84:87], v[116:119], v[24:27]
    ds_read_b128 v[128:131], v165 offset:20480
    v_mfma_f32_16x16x32_bf16 v[28:31], v[88:91], v[112:115], v[28:31]
    ds_read_b128 v[132:135], v165 offset:22528
    v_mfma_f32_16x16x32_bf16 v[32:35], v[88:91], v[116:119], v[32:35]
    ds_read_b128 v[136:139], v165 offset:24576
    v_mfma_f32_16x16x32_bf16 v[36:39], v[92:95], v[112:115], v[36:39]
    ds_read_b128 v[140:143], v165 offset:26624
    v_mfma_f32_16x16x32_bf16 v[40:43], v[92:95], v[116:119], v[40:43]
    v_mfma_f32_16x16x32_bf16 v[44:47], v[96:99], v[112:115], v[44:47]
    ds_read_b128 v[144:147], v165 offset:28672
    v_mfma_f32_16x16x32_bf16 v[48:51], v[96:99], v[116:119], v[48:51]
    ds_read_b128 v[148:151], v165 offset:30720
    v_mfma_f32_16x16x32_bf16 v[52:55], v[100:103], v[112:115], v[52:55]
    ds_read_b128 v[152:155], v165 offset:32768
    v_mfma_f32_16x16x32_bf16 v[56:59], v[100:103], v[116:119], v[56:59]
    s_add_u32 s58, s58, 128
    s_add_u32 s59, s59, 128
    v_mfma_f32_16x16x32_bf16 v[60:63], v[104:107], v[112:115], v[60:63]
    s_add_u32 m0, s41, 0
    s_add_u32 s51, s58, 0
    buffer_load_dwordx4 v0, s[16:19], s51 offen lds
    v_mfma_f32_16x16x32_bf16 v[64:67], v[104:107], v[116:119], v[64:67]
    s_add_u32 m0, s41, 4096
    s_add_u32 s51, s58, 131072
    buffer_load_dwordx4 v0, s[16:19], s51 offen lds
    v_mfma_f32_16x16x32_bf16 v[68:71], v[108:111], v[112:115], v[68:71]
    s_add_u32 m0, s41, 8192
    s_add_u32 s51, s58, 262144
    buffer_load_dwordx4 v0, s[16:19], s51 offen lds
    v_mfma_f32_16x16x32_bf16 v[72:75], v[108:111], v[116:119], v[72:75]
    s_add_u32 m0, s41, 12288
    s_add_u32 s51, s58, 393216
    buffer_load_dwordx4 v0, s[16:19], s51 offen lds
    s_waitcnt lgkmcnt(0)
    v_mfma_f32_16x16x32_bf16 v[4:7], v[120:123], v[156:159], v[4:7]
    v_mfma_f32_16x16x32_bf16 v[8:11], v[120:123], v[160:163], v[8:11]
    v_mfma_f32_16x16x32_bf16 v[12:15], v[124:127], v[156:159], v[12:15]
    v_mfma_f32_16x16x32_bf16 v[16:19], v[124:127], v[160:163], v[16:19]
    s_add_u32 m0, s41, 16384
    s_add_u32 s51, s59, 0
    buffer_load_dwordx4 v1, s[20:23], s51 offen lds
    v_mfma_f32_16x16x32_bf16 v[20:23], v[128:131], v[156:159], v[20:23]
    v_mfma_f32_16x16x32_bf16 v[24:27], v[128:131], v[160:163], v[24:27]
    v_mfma_f32_16x16x32_bf16 v[28:31], v[132:135], v[156:159], v[28:31]
    v_mfma_f32_16x16x32_bf16 v[32:35], v[132:135], v[160:163], v[32:35]
    s_add_u32 m0, s41, 20480
    s_add_u32 s51, s59, 131072
    buffer_load_dwordx4 v1, s[20:23], s51 offen lds
    v_mfma_f32_16x16x32_bf16 v[36:39], v[136:139], v[156:159], v[36:39]
    v_mfma_f32_16x16x32_bf16 v[40:43], v[136:139], v[160:163], v[40:43]
    v_mfma_f32_16x16x32_bf16 v[44:47], v[140:143], v[156:159], v[44:47]
    s_add_u32 m0, s41, 24576
    s_add_u32 s51, s59, 262144
    buffer_load_dwordx4 v1, s[20:23], s51 offen lds
    v_mfma_f32_16x16x32_bf16 v[48:51], v[140:143], v[160:163], v[48:51]
    v_mfma_f32_16x16x32_bf16 v[52:55], v[144:147], v[156:159], v[52:55]
    v_mfma_f32_16x16x32_bf16 v[56:59], v[144:147], v[160:163], v[56:59]
    v_mfma_f32_16x16x32_bf16 v[60:63], v[148:151], v[156:159], v[60:63]
    s_add_u32 m0, s41, 28672
    s_add_u32 s51, s59, 393216
    buffer_load_dwordx4 v1, s[20:23], s51 offen lds
    v_mfma_f32_16x16x32_bf16 v[64:67], v[148:151], v[160:163], v[64:67]
    v_mfma_f32_16x16x32_bf16 v[68:71], v[152:155], v[156:159], v[68:71]
    v_mfma_f32_16x16x32_bf16 v[72:75], v[152:155], v[160:163], v[72:75]
    s_add_u32 m0, s41, 32768
    s_add_u32 s51, s59, 524288
    buffer_load_dwordx4 v1, s[20:23], s51 offen lds
    s_waitcnt vmcnt(9)
    s_barrier
    v_add_u32 v164, 36864, v164
    v_add_u32 v165, 36864, v165
    v_add_u32 v166, 36864, v166
    v_add_u32 v167, 36864, v167
    ds_read_b128 v[112:115], v166 offset:0
    ds_read_b128 v[116:119], v166 offset:2048
    ds_read_b128 v[76:79], v164 offset:16384
    ds_read_b128 v[80:83], v164 offset:18432
    ds_read_b128 v[84:87], v164 offset:20480
    ds_read_b128 v[88:91], v164 offset:22528
    ds_read_b128 v[92:95], v164 offset:24576
    ds_read_b128 v[96:99], v164 offset:26624
    ds_read_b128 v[100:103], v164 offset:28672
    ds_read_b128 v[104:107], v164 offset:30720
    ds_read_b128 v[108:111], v164 offset:32768
    s_waitcnt lgkmcnt(0)
    v_mfma_f32_16x16x32_bf16 v[4:7], v[76:79], v[112:115], v[4:7]
    v_mfma_f32_16x16x32_bf16 v[8:11], v[76:79], v[116:119], v[8:11]
    ds_read_b128 v[156:159], v167 offset:0
    v_mfma_f32_16x16x32_bf16 v[12:15], v[80:83], v[112:115], v[12:15]
    ds_read_b128 v[160:163], v167 offset:2048
    v_mfma_f32_16x16x32_bf16 v[16:19], v[80:83], v[116:119], v[16:19]
    ds_read_b128 v[120:123], v165 offset:16384
    v_mfma_f32_16x16x32_bf16 v[20:23], v[84:87], v[112:115], v[20:23]
    ds_read_b128 v[124:127], v165 offset:18432
    v_mfma_f32_16x16x32_bf16 v[24:27], v[84:87], v[116:119], v[24:27]
    ds_read_b128 v[128:131], v165 offset:20480
    v_mfma_f32_16x16x32_bf16 v[28:31], v[88:91], v[112:115], v[28:31]
    ds_read_b128 v[132:135], v165 offset:22528
    v_mfma_f32_16x16x32_bf16 v[32:35], v[88:91], v[116:119], v[32:35]
    ds_read_b128 v[136:139], v165 offset:24576
    v_mfma_f32_16x16x32_bf16 v[36:39], v[92:95], v[112:115], v[36:39]
    ds_read_b128 v[140:143], v165 offset:26624
    v_mfma_f32_16x16x32_bf16 v[40:43], v[92:95], v[116:119], v[40:43]
    v_mfma_f32_16x16x32_bf16 v[44:47], v[96:99], v[112:115], v[44:47]
    ds_read_b128 v[144:147], v165 offset:28672
    v_mfma_f32_16x16x32_bf16 v[48:51], v[96:99], v[116:119], v[48:51]
    ds_read_b128 v[148:151], v165 offset:30720
    v_mfma_f32_16x16x32_bf16 v[52:55], v[100:103], v[112:115], v[52:55]
    ds_read_b128 v[152:155], v165 offset:32768
    v_mfma_f32_16x16x32_bf16 v[56:59], v[100:103], v[116:119], v[56:59]
    s_add_u32 s58, s58, 128
    s_add_u32 s59, s59, 128
    v_mfma_f32_16x16x32_bf16 v[60:63], v[104:107], v[112:115], v[60:63]
    s_add_u32 m0, s41, 36864
    s_add_u32 s51, s58, 0
    buffer_load_dwordx4 v0, s[16:19], s51 offen lds
    v_mfma_f32_16x16x32_bf16 v[64:67], v[104:107], v[116:119], v[64:67]
    s_add_u32 m0, s41, 40960
    s_add_u32 s51, s58, 131072
    buffer_load_dwordx4 v0, s[16:19], s51 offen lds
    v_mfma_f32_16x16x32_bf16 v[68:71], v[108:111], v[112:115], v[68:71]
    s_add_u32 m0, s41, 45056
    s_add_u32 s51, s58, 262144
    buffer_load_dwordx4 v0, s[16:19], s51 offen lds
    v_mfma_f32_16x16x32_bf16 v[72:75], v[108:111], v[116:119], v[72:75]
    s_add_u32 m0, s41, 49152
    s_add_u32 s51, s58, 393216
    buffer_load_dwordx4 v0, s[16:19], s51 offen lds
    s_waitcnt lgkmcnt(0)
    v_mfma_f32_16x16x32_bf16 v[4:7], v[120:123], v[156:159], v[4:7]
    v_mfma_f32_16x16x32_bf16 v[8:11], v[120:123], v[160:163], v[8:11]
    v_mfma_f32_16x16x32_bf16 v[12:15], v[124:127], v[156:159], v[12:15]
    v_mfma_f32_16x16x32_bf16 v[16:19], v[124:127], v[160:163], v[16:19]
    s_add_u32 m0, s41, 53248
    s_add_u32 s51, s59, 0
    buffer_load_dwordx4 v1, s[20:23], s51 offen lds
    v_mfma_f32_16x16x32_bf16 v[20:23], v[128:131], v[156:159], v[20:23]
    v_mfma_f32_16x16x32_bf16 v[24:27], v[128:131], v[160:163], v[24:27]
    v_mfma_f32_16x16x32_bf16 v[28:31], v[132:135], v[156:159], v[28:31]
    v_mfma_f32_16x16x32_bf16 v[32:35], v[132:135], v[160:163], v[32:35]
    s_add_u32 m0, s41, 57344
    s_add_u32 s51, s59, 131072
    buffer_load_dwordx4 v1, s[20:23], s51 offen lds
    v_mfma_f32_16x16x32_bf16 v[36:39], v[136:139], v[156:159], v[36:39]
    v_mfma_f32_16x16x32_bf16 v[40:43], v[136:139], v[160:163], v[40:43]
    v_mfma_f32_16x16x32_bf16 v[44:47], v[140:143], v[156:159], v[44:47]
    s_add_u32 m0, s41, 61440
    s_add_u32 s51, s59, 262144
    buffer_load_dwordx4 v1, s[20:23], s51 offen lds
    v_mfma_f32_16x16x32_bf16 v[48:51], v[140:143], v[160:163], v[48:51]
    v_mfma_f32_16x16x32_bf16 v[52:55], v[144:147], v[156:159], v[52:55]
    v_mfma_f32_16x16x32_bf16 v[56:59], v[144:147], v[160:163], v[56:59]
    v_mfma_f32_16x16x32_bf16 v[60:63], v[148:151], v[156:159], v[60:63]
    s_add_u32 m0, s41, 65536
    s_add_u32 s51, s59, 393216
    buffer_load_dwordx4 v1, s[20:23], s51 offen lds
    v_mfma_f32_16x16x32_bf16 v[64:67], v[148:151], v[160:163], v[64:67]
    v_mfma_f32_16x16x32_bf16 v[68:71], v[152:155], v[156:159], v[68:71]
    v_mfma_f32_16x16x32_bf16 v[72:75], v[152:155], v[160:163], v[72:75]
    s_add_u32 m0, s41, 69632
    s_add_u32 s51, s59, 524288
    buffer_load_dwordx4 v1, s[20:23], s51 offen lds
    s_waitcnt vmcnt(9)
    s_barrier
    v_subrev_u32 v164, 73728, v164
    v_subrev_u32 v165, 73728, v165
    v_subrev_u32 v166, 73728, v166
    v_subrev_u32 v167, 73728, v167
    ds_read_b128 v[112:115], v166 offset:0
    ds_read_b128 v[116:119], v166 offset:2048
    ds_read_b128 v[76:79], v164 offset:16384
    ds_read_b128 v[80:83], v164 offset:18432
    ds_read_b128 v[84:87], v164 offset:20480
    ds_read_b128 v[88:91], v164 offset:22528
    ds_read_b128 v[92:95], v164 offset:24576
    ds_read_b128 v[96:99], v164 offset:26624
    ds_read_b128 v[100:103], v164 offset:28672
    ds_read_b128 v[104:107], v164 offset:30720
    ds_read_b128 v[108:111], v164 offset:32768
    s_waitcnt lgkmcnt(0)
    v_mfma_f32_16x16x32_bf16 v[4:7], v[76:79], v[112:115], v[4:7]
    v_mfma_f32_16x16x32_bf16 v[8:11], v[76:79], v[116:119], v[8:11]
    ds_read_b128 v[156:159], v167 offset:0
    v_mfma_f32_16x16x32_bf16 v[12:15], v[80:83], v[112:115], v[12:15]
    ds_read_b128 v[160:163], v167 offset:2048
    v_mfma_f32_16x16x32_bf16 v[16:19], v[80:83], v[116:119], v[16:19]
    ds_read_b128 v[120:123], v165 offset:16384
    v_mfma_f32_16x16x32_bf16 v[20:23], v[84:87], v[112:115], v[20:23]
    ds_read_b128 v[124:127], v165 offset:18432
    v_mfma_f32_16x16x32_bf16 v[24:27], v[84:87], v[116:119], v[24:27]
    ds_read_b128 v[128:131], v165 offset:20480
    v_mfma_f32_16x16x32_bf16 v[28:31], v[88:91], v[112:115], v[28:31]
    ds_read_b128 v[132:135], v165 offset:22528
    v_mfma_f32_16x16x32_bf16 v[32:35], v[88:91], v[116:119], v[32:35]
    ds_read_b128 v[136:139], v165 offset:24576
    v_mfma_f32_16x16x32_bf16 v[36:39], v[92:95], v[112:115], v[36:39]
    ds_read_b128 v[140:143], v165 offset:26624
    v_mfma_f32_16x16x32_bf16 v[40:43], v[92:95], v[116:119], v[40:43]
    v_mfma_f32_16x16x32_bf16 v[44:47], v[96:99], v[112:115], v[44:47]
    ds_read_b128 v[144:147], v165 offset:28672
    v_mfma_f32_16x16x32_bf16 v[48:51], v[96:99], v[116:119], v[48:51]
    ds_read_b128 v[148:151], v165 offset:30720
    v_mfma_f32_16x16x32_bf16 v[52:55], v[100:103], v[112:115], v[52:55]
    ds_read_b128 v[152:155], v165 offset:32768
    v_mfma_f32_16x16x32_bf16 v[56:59], v[100:103], v[116:119], v[56:59]
    s_add_u32 s58, s58, 128
    s_add_u32 s59, s59, 128
    v_mfma_f32_16x16x32_bf16 v[60:63], v[104:107], v[112:115], v[60:63]
    s_add_u32 m0, s41, 73728
    s_add_u32 s51, s58, 0
    buffer_load_dwordx4 v0, s[16:19], s51 offen lds
    v_mfma_f32_16x16x32_bf16 v[64:67], v[104:107], v[116:119], v[64:67]
    s_add_u32 m0, s41, 77824
    s_add_u32 s51, s58, 131072
    buffer_load_dwordx4 v0, s[16:19], s51 offen lds
    v_mfma_f32_16x16x32_bf16 v[68:71], v[108:111], v[112:115], v[68:71]
    s_add_u32 m0, s41, 81920
    s_add_u32 s51, s58, 262144
    buffer_load_dwordx4 v0, s[16:19], s51 offen lds
    v_mfma_f32_16x16x32_bf16 v[72:75], v[108:111], v[116:119], v[72:75]
    s_add_u32 m0, s41, 86016
    s_add_u32 s51, s58, 393216
    buffer_load_dwordx4 v0, s[16:19], s51 offen lds
    s_waitcnt lgkmcnt(0)
    v_mfma_f32_16x16x32_bf16 v[4:7], v[120:123], v[156:159], v[4:7]
    v_mfma_f32_16x16x32_bf16 v[8:11], v[120:123], v[160:163], v[8:11]
    v_mfma_f32_16x16x32_bf16 v[12:15], v[124:127], v[156:159], v[12:15]
    v_mfma_f32_16x16x32_bf16 v[16:19], v[124:127], v[160:163], v[16:19]
    s_add_u32 m0, s41, 90112
    s_add_u32 s51, s59, 0
    buffer_load_dwordx4 v1, s[20:23], s51 offen lds
    v_mfma_f32_16x16x32_bf16 v[20:23], v[128:131], v[156:159], v[20:23]
    v_mfma_f32_16x16x32_bf16 v[24:27], v[128:131], v[160:163], v[24:27]
    v_mfma_f32_16x16x32_bf16 v[28:31], v[132:135], v[156:159], v[28:31]
    v_mfma_f32_16x16x32_bf16 v[32:35], v[132:135], v[160:163], v[32:35]
    s_add_u32 m0, s41, 94208
    s_add_u32 s51, s59, 131072
    buffer_load_dwordx4 v1, s[20:23], s51 offen lds
    v_mfma_f32_16x16x32_bf16 v[36:39], v[136:139], v[156:159], v[36:39]
    v_mfma_f32_16x16x32_bf16 v[40:43], v[136:139], v[160:163], v[40:43]
    v_mfma_f32_16x16x32_bf16 v[44:47], v[140:143], v[156:159], v[44:47]
    s_add_u32 m0, s41, 98304
    s_add_u32 s51, s59, 262144
    buffer_load_dwordx4 v1, s[20:23], s51 offen lds
    v_mfma_f32_16x16x32_bf16 v[48:51], v[140:143], v[160:163], v[48:51]
    v_mfma_f32_16x16x32_bf16 v[52:55], v[144:147], v[156:159], v[52:55]
    v_mfma_f32_16x16x32_bf16 v[56:59], v[144:147], v[160:163], v[56:59]
    v_mfma_f32_16x16x32_bf16 v[60:63], v[148:151], v[156:159], v[60:63]
    s_add_u32 m0, s41, 102400
    s_add_u32 s51, s59, 393216
    buffer_load_dwordx4 v1, s[20:23], s51 offen lds
    v_mfma_f32_16x16x32_bf16 v[64:67], v[148:151], v[160:163], v[64:67]
    v_mfma_f32_16x16x32_bf16 v[68:71], v[152:155], v[156:159], v[68:71]
    v_mfma_f32_16x16x32_bf16 v[72:75], v[152:155], v[160:163], v[72:75]
    s_add_u32 m0, s41, 106496
    s_add_u32 s51, s59, 524288
    buffer_load_dwordx4 v1, s[20:23], s51 offen lds
    s_waitcnt vmcnt(9)
    s_barrier
    v_add_u32 v164, 36864, v164
    v_add_u32 v165, 36864, v165
    v_add_u32 v166, 36864, v166
    v_add_u32 v167, 36864, v167
    ds_read_b128 v[112:115], v166 offset:0
    ds_read_b128 v[116:119], v166 offset:2048
    ds_read_b128 v[76:79], v164 offset:16384
    ds_read_b128 v[80:83], v164 offset:18432
    ds_read_b128 v[84:87], v164 offset:20480
    ds_read_b128 v[88:91], v164 offset:22528
    ds_read_b128 v[92:95], v164 offset:24576
    ds_read_b128 v[96:99], v164 offset:26624
    ds_read_b128 v[100:103], v164 offset:28672
    ds_read_b128 v[104:107], v164 offset:30720
    ds_read_b128 v[108:111], v164 offset:32768
    s_waitcnt lgkmcnt(0)
    v_mfma_f32_16x16x32_bf16 v[4:7], v[76:79], v[112:115], v[4:7]
    v_mfma_f32_16x16x32_bf16 v[8:11], v[76:79], v[116:119], v[8:11]
    ds_read_b128 v[156:159], v167 offset:0
    v_mfma_f32_16x16x32_bf16 v[12:15], v[80:83], v[112:115], v[12:15]
    ds_read_b128 v[160:163], v167 offset:2048
    v_mfma_f32_16x16x32_bf16 v[16:19], v[80:83], v[116:119], v[16:19]
    ds_read_b128 v[120:123], v165 offset:16384
    v_mfma_f32_16x16x32_bf16 v[20:23], v[84:87], v[112:115], v[20:23]
    ds_read_b128 v[124:127], v165 offset:18432
    v_mfma_f32_16x16x32_bf16 v[24:27], v[84:87], v[116:119], v[24:27]
    ds_read_b128 v[128:131], v165 offset:20480
    v_mfma_f32_16x16x32_bf16 v[28:31], v[88:91], v[112:115], v[28:31]
    ds_read_b128 v[132:135], v165 offset:22528
    v_mfma_f32_16x16x32_bf16 v[32:35], v[88:91], v[116:119], v[32:35]
    ds_read_b128 v[136:139], v165 offset:24576
    v_mfma_f32_16x16x32_bf16 v[36:39], v[92:95], v[112:115], v[36:39]
    ds_read_b128 v[140:143], v165 offset:26624
    v_mfma_f32_16x16x32_bf16 v[40:43], v[92:95], v[116:119], v[40:43]
    v_mfma_f32_16x16x32_bf16 v[44:47], v[96:99], v[112:115], v[44:47]
    ds_read_b128 v[144:147], v165 offset:28672
    v_mfma_f32_16x16x32_bf16 v[48:51], v[96:99], v[116:119], v[48:51]
    ds_read_b128 v[148:151], v165 offset:30720
    v_mfma_f32_16x16x32_bf16 v[52:55], v[100:103], v[112:115], v[52:55]
    ds_read_b128 v[152:155], v165 offset:32768
    v_mfma_f32_16x16x32_bf16 v[56:59], v[100:103], v[116:119], v[56:59]
    s_add_u32 s58, s58, 128
    s_add_u32 s59, s59, 128
    v_mfma_f32_16x16x32_bf16 v[60:63], v[104:107], v[112:115], v[60:63]
    s_add_u32 m0, s41, 0
    s_add_u32 s51, s58, 0
    buffer_load_dwordx4 v0, s[16:19], s51 offen lds
    v_mfma_f32_16x16x32_bf16 v[64:67], v[104:107], v[116:119], v[64:67]
    s_add_u32 m0, s41, 4096
    s_add_u32 s51, s58, 131072
    buffer_load_dwordx4 v0, s[16:19], s51 offen lds
    v_mfma_f32_16x16x32_bf16 v[68:71], v[108:111], v[112:115], v[68:71]
    s_add_u32 m0, s41, 8192
    s_add_u32 s51, s58, 262144
    buffer_load_dwordx4 v0, s[16:19], s51 offen lds
    v_mfma_f32_16x16x32_bf16 v[72:75], v[108:111], v[116:119], v[72:75]
    s_add_u32 m0, s41, 12288
    s_add_u32 s51, s58, 393216
    buffer_load_dwordx4 v0, s[16:19], s51 offen lds
    s_waitcnt lgkmcnt(0)
    v_mfma_f32_16x16x32_bf16 v[4:7], v[120:123], v[156:159], v[4:7]
    v_mfma_f32_16x16x32_bf16 v[8:11], v[120:123], v[160:163], v[8:11]
    v_mfma_f32_16x16x32_bf16 v[12:15], v[124:127], v[156:159], v[12:15]
    v_mfma_f32_16x16x32_bf16 v[16:19], v[124:127], v[160:163], v[16:19]
    s_add_u32 m0, s41, 16384
    s_add_u32 s51, s59, 0
    buffer_load_dwordx4 v1, s[20:23], s51 offen lds
    v_mfma_f32_16x16x32_bf16 v[20:23], v[128:131], v[156:159], v[20:23]
    v_mfma_f32_16x16x32_bf16 v[24:27], v[128:131], v[160:163], v[24:27]
    v_mfma_f32_16x16x32_bf16 v[28:31], v[132:135], v[156:159], v[28:31]
    v_mfma_f32_16x16x32_bf16 v[32:35], v[132:135], v[160:163], v[32:35]
    s_add_u32 m0, s41, 20480
    s_add_u32 s51, s59, 131072
    buffer_load_dwordx4 v1, s[20:23], s51 offen lds
    v_mfma_f32_16x16x32_bf16 v[36:39], v[136:139], v[156:159], v[36:39]
    v_mfma_f32_16x16x32_bf16 v[40:43], v[136:139], v[160:163], v[40:43]
    v_mfma_f32_16x16x32_bf16 v[44:47], v[140:143], v[156:159], v[44:47]
    s_add_u32 m0, s41, 24576
    s_add_u32 s51, s59, 262144
    buffer_load_dwordx4 v1, s[20:23], s51 offen lds
    v_mfma_f32_16x16x32_bf16 v[48:51], v[140:143], v[160:163], v[48:51]
    v_mfma_f32_16x16x32_bf16 v[52:55], v[144:147], v[156:159], v[52:55]
    v_mfma_f32_16x16x32_bf16 v[56:59], v[144:147], v[160:163], v[56:59]
    v_mfma_f32_16x16x32_bf16 v[60:63], v[148:151], v[156:159], v[60:63]
    s_add_u32 m0, s41, 28672
    s_add_u32 s51, s59, 393216
    buffer_load_dwordx4 v1, s[20:23], s51 offen lds
    v_mfma_f32_16x16x32_bf16 v[64:67], v[148:151], v[160:163], v[64:67]
    v_mfma_f32_16x16x32_bf16 v[68:71], v[152:155], v[156:159], v[68:71]
    v_mfma_f32_16x16x32_bf16 v[72:75], v[152:155], v[160:163], v[72:75]
    s_add_u32 m0, s41, 32768
    s_add_u32 s51, s59, 524288
    buffer_load_dwordx4 v1, s[20:23], s51 offen lds
    s_waitcnt vmcnt(9)
    s_barrier
    v_add_u32 v164, 36864, v164
    v_add_u32 v165, 36864, v165
    v_add_u32 v166, 36864, v166
    v_add_u32 v167, 36864, v167
    ds_read_b128 v[112:115], v166 offset:0
    ds_read_b128 v[116:119], v166 offset:2048
    ds_read_b128 v[76:79], v164 offset:16384
    ds_read_b128 v[80:83], v164 offset:18432
    ds_read_b128 v[84:87], v164 offset:20480
    ds_read_b128 v[88:91], v164 offset:22528
    ds_read_b128 v[92:95], v164 offset:24576
    ds_read_b128 v[96:99], v164 offset:26624
    ds_read_b128 v[100:103], v164 offset:28672
    ds_read_b128 v[104:107], v164 offset:30720
    ds_read_b128 v[108:111], v164 offset:32768
    s_waitcnt lgkmcnt(0)
    v_mfma_f32_16x16x32_bf16 v[4:7], v[76:79], v[112:115], v[4:7]
    v_mfma_f32_16x16x32_bf16 v[8:11], v[76:79], v[116:119], v[8:11]
    ds_read_b128 v[156:159], v167 offset:0
    v_mfma_f32_16x16x32_bf16 v[12:15], v[80:83], v[112:115], v[12:15]
    ds_read_b128 v[160:163], v167 offset:2048
    v_mfma_f32_16x16x32_bf16 v[16:19], v[80:83], v[116:119], v[16:19]
    ds_read_b128 v[120:123], v165 offset:16384
    v_mfma_f32_16x16x32_bf16 v[20:23], v[84:87], v[112:115], v[20:23]
    ds_read_b128 v[124:127], v165 offset:18432
    v_mfma_f32_16x16x32_bf16 v[24:27], v[84:87], v[116:119], v[24:27]
    ds_read_b128 v[128:131], v165 offset:20480
    v_mfma_f32_16x16x32_bf16 v[28:31], v[88:91], v[112:115], v[28:31]
    ds_read_b128 v[132:135], v165 offset:22528
    v_mfma_f32_16x16x32_bf16 v[32:35], v[88:91], v[116:119], v[32:35]
    ds_read_b128 v[136:139], v165 offset:24576
    v_mfma_f32_16x16x32_bf16 v[36:39], v[92:95], v[112:115], v[36:39]
    ds_read_b128 v[140:143], v165 offset:26624
    v_mfma_f32_16x16x32_bf16 v[40:43], v[92:95], v[116:119], v[40:43]
    v_mfma_f32_16x16x32_bf16 v[44:47], v[96:99], v[112:115], v[44:47]
    ds_read_b128 v[144:147], v165 offset:28672
    v_mfma_f32_16x16x32_bf16 v[48:51], v[96:99], v[116:119], v[48:51]
    ds_read_b128 v[148:151], v165 offset:30720
    v_mfma_f32_16x16x32_bf16 v[52:55], v[100:103], v[112:115], v[52:55]
    ds_read_b128 v[152:155], v165 offset:32768
    v_mfma_f32_16x16x32_bf16 v[56:59], v[100:103], v[116:119], v[56:59]
    s_add_u32 s58, s58, 128
    s_add_u32 s59, s59, 128
    v_mfma_f32_16x16x32_bf16 v[60:63], v[104:107], v[112:115], v[60:63]
    s_add_u32 m0, s41, 36864
    s_add_u32 s51, s58, 0
    buffer_load_dwordx4 v0, s[16:19], s51 offen lds
    v_mfma_f32_16x16x32_bf16 v[64:67], v[104:107], v[116:119], v[64:67]
    s_add_u32 m0, s41, 40960
    s_add_u32 s51, s58, 131072
    buffer_load_dwordx4 v0, s[16:19], s51 offen lds
    v_mfma_f32_16x16x32_bf16 v[68:71], v[108:111], v[112:115], v[68:71]
    s_add_u32 m0, s41, 45056
    s_add_u32 s51, s58, 262144
    buffer_load_dwordx4 v0, s[16:19], s51 offen lds
    v_mfma_f32_16x16x32_bf16 v[72:75], v[108:111], v[116:119], v[72:75]
    s_add_u32 m0, s41, 49152
    s_add_u32 s51, s58, 393216
    buffer_load_dwordx4 v0, s[16:19], s51 offen lds
    s_waitcnt lgkmcnt(0)
    v_mfma_f32_16x16x32_bf16 v[4:7], v[120:123], v[156:159], v[4:7]
    v_mfma_f32_16x16x32_bf16 v[8:11], v[120:123], v[160:163], v[8:11]
    v_mfma_f32_16x16x32_bf16 v[12:15], v[124:127], v[156:159], v[12:15]
    v_mfma_f32_16x16x32_bf16 v[16:19], v[124:127], v[160:163], v[16:19]
    s_add_u32 m0, s41, 53248
    s_add_u32 s51, s59, 0
    buffer_load_dwordx4 v1, s[20:23], s51 offen lds
    v_mfma_f32_16x16x32_bf16 v[20:23], v[128:131], v[156:159], v[20:23]
    v_mfma_f32_16x16x32_bf16 v[24:27], v[128:131], v[160:163], v[24:27]
    v_mfma_f32_16x16x32_bf16 v[28:31], v[132:135], v[156:159], v[28:31]
    v_mfma_f32_16x16x32_bf16 v[32:35], v[132:135], v[160:163], v[32:35]
    s_add_u32 m0, s41, 57344
    s_add_u32 s51, s59, 131072
    buffer_load_dwordx4 v1, s[20:23], s51 offen lds
    v_mfma_f32_16x16x32_bf16 v[36:39], v[136:139], v[156:159], v[36:39]
    v_mfma_f32_16x16x32_bf16 v[40:43], v[136:139], v[160:163], v[40:43]
    v_mfma_f32_16x16x32_bf16 v[44:47], v[140:143], v[156:159], v[44:47]
    s_add_u32 m0, s41, 61440
    s_add_u32 s51, s59, 262144
    buffer_load_dwordx4 v1, s[20:23], s51 offen lds
    v_mfma_f32_16x16x32_bf16 v[48:51], v[140:143], v[160:163], v[48:51]
    v_mfma_f32_16x16x32_bf16 v[52:55], v[144:147], v[156:159], v[52:55]
    v_mfma_f32_16x16x32_bf16 v[56:59], v[144:147], v[160:163], v[56:59]
    v_mfma_f32_16x16x32_bf16 v[60:63], v[148:151], v[156:159], v[60:63]
    s_add_u32 m0, s41, 65536
    s_add_u32 s51, s59, 393216
    buffer_load_dwordx4 v1, s[20:23], s51 offen lds
    v_mfma_f32_16x16x32_bf16 v[64:67], v[148:151], v[160:163], v[64:67]
    v_mfma_f32_16x16x32_bf16 v[68:71], v[152:155], v[156:159], v[68:71]
    v_mfma_f32_16x16x32_bf16 v[72:75], v[152:155], v[160:163], v[72:75]
    s_add_u32 m0, s41, 69632
    s_add_u32 s51, s59, 524288
    buffer_load_dwordx4 v1, s[20:23], s51 offen lds
    s_waitcnt vmcnt(9)
    s_barrier
    v_subrev_u32 v164, 73728, v164
    v_subrev_u32 v165, 73728, v165
    v_subrev_u32 v166, 73728, v166
    v_subrev_u32 v167, 73728, v167
    ds_read_b128 v[112:115], v166 offset:0
    ds_read_b128 v[116:119], v166 offset:2048
    ds_read_b128 v[76:79], v164 offset:16384
    ds_read_b128 v[80:83], v164 offset:18432
    ds_read_b128 v[84:87], v164 offset:20480
    ds_read_b128 v[88:91], v164 offset:22528
    ds_read_b128 v[92:95], v164 offset:24576
    ds_read_b128 v[96:99], v164 offset:26624
    ds_read_b128 v[100:103], v164 offset:28672
    ds_read_b128 v[104:107], v164 offset:30720
    ds_read_b128 v[108:111], v164 offset:32768
    s_waitcnt lgkmcnt(0)
    v_mfma_f32_16x16x32_bf16 v[4:7], v[76:79], v[112:115], v[4:7]
    v_mfma_f32_16x16x32_bf16 v[8:11], v[76:79], v[116:119], v[8:11]
    ds_read_b128 v[156:159], v167 offset:0
    v_mfma_f32_16x16x32_bf16 v[12:15], v[80:83], v[112:115], v[12:15]
    ds_read_b128 v[160:163], v167 offset:2048
    v_mfma_f32_16x16x32_bf16 v[16:19], v[80:83], v[116:119], v[16:19]
    ds_read_b128 v[120:123], v165 offset:16384
    v_mfma_f32_16x16x32_bf16 v[20:23], v[84:87], v[112:115], v[20:23]
    ds_read_b128 v[124:127], v165 offset:18432
    v_mfma_f32_16x16x32_bf16 v[24:27], v[84:87], v[116:119], v[24:27]
    ds_read_b128 v[128:131], v165 offset:20480
    v_mfma_f32_16x16x32_bf16 v[28:31], v[88:91], v[112:115], v[28:31]
    ds_read_b128 v[132:135], v165 offset:22528
    v_mfma_f32_16x16x32_bf16 v[32:35], v[88:91], v[116:119], v[32:35]
    ds_read_b128 v[136:139], v165 offset:24576
    v_mfma_f32_16x16x32_bf16 v[36:39], v[92:95], v[112:115], v[36:39]
    ds_read_b128 v[140:143], v165 offset:26624
    v_mfma_f32_16x16x32_bf16 v[40:43], v[92:95], v[116:119], v[40:43]
    v_mfma_f32_16x16x32_bf16 v[44:47], v[96:99], v[112:115], v[44:47]
    ds_read_b128 v[144:147], v165 offset:28672
    v_mfma_f32_16x16x32_bf16 v[48:51], v[96:99], v[116:119], v[48:51]
    ds_read_b128 v[148:151], v165 offset:30720
    v_mfma_f32_16x16x32_bf16 v[52:55], v[100:103], v[112:115], v[52:55]
    ds_read_b128 v[152:155], v165 offset:32768
    v_mfma_f32_16x16x32_bf16 v[56:59], v[100:103], v[116:119], v[56:59]
    s_add_u32 s58, s58, 128
    s_add_u32 s59, s59, 128
    v_mfma_f32_16x16x32_bf16 v[60:63], v[104:107], v[112:115], v[60:63]
    s_add_u32 m0, s41, 73728
    s_add_u32 s51, s58, 0
    buffer_load_dwordx4 v0, s[16:19], s51 offen lds
    v_mfma_f32_16x16x32_bf16 v[64:67], v[104:107], v[116:119], v[64:67]
    s_add_u32 m0, s41, 77824
    s_add_u32 s51, s58, 131072
    buffer_load_dwordx4 v0, s[16:19], s51 offen lds
    v_mfma_f32_16x16x32_bf16 v[68:71], v[108:111], v[112:115], v[68:71]
    s_add_u32 m0, s41, 81920
    s_add_u32 s51, s58, 262144
    buffer_load_dwordx4 v0, s[16:19], s51 offen lds
    v_mfma_f32_16x16x32_bf16 v[72:75], v[108:111], v[116:119], v[72:75]
    s_add_u32 m0, s41, 86016
    s_add_u32 s51, s58, 393216
    buffer_load_dwordx4 v0, s[16:19], s51 offen lds
    s_waitcnt lgkmcnt(0)
    v_mfma_f32_16x16x32_bf16 v[4:7], v[120:123], v[156:159], v[4:7]
    v_mfma_f32_16x16x32_bf16 v[8:11], v[120:123], v[160:163], v[8:11]
    v_mfma_f32_16x16x32_bf16 v[12:15], v[124:127], v[156:159], v[12:15]
    v_mfma_f32_16x16x32_bf16 v[16:19], v[124:127], v[160:163], v[16:19]
    s_add_u32 m0, s41, 90112
    s_add_u32 s51, s59, 0
    buffer_load_dwordx4 v1, s[20:23], s51 offen lds
    v_mfma_f32_16x16x32_bf16 v[20:23], v[128:131], v[156:159], v[20:23]
    v_mfma_f32_16x16x32_bf16 v[24:27], v[128:131], v[160:163], v[24:27]
    v_mfma_f32_16x16x32_bf16 v[28:31], v[132:135], v[156:159], v[28:31]
    v_mfma_f32_16x16x32_bf16 v[32:35], v[132:135], v[160:163], v[32:35]
    s_add_u32 m0, s41, 94208
    s_add_u32 s51, s59, 131072
    buffer_load_dwordx4 v1, s[20:23], s51 offen lds
    v_mfma_f32_16x16x32_bf16 v[36:39], v[136:139], v[156:159], v[36:39]
    v_mfma_f32_16x16x32_bf16 v[40:43], v[136:139], v[160:163], v[40:43]
    v_mfma_f32_16x16x32_bf16 v[44:47], v[140:143], v[156:159], v[44:47]
    s_add_u32 m0, s41, 98304
    s_add_u32 s51, s59, 262144
    buffer_load_dwordx4 v1, s[20:23], s51 offen lds
    v_mfma_f32_16x16x32_bf16 v[48:51], v[140:143], v[160:163], v[48:51]
    v_mfma_f32_16x16x32_bf16 v[52:55], v[144:147], v[156:159], v[52:55]
    v_mfma_f32_16x16x32_bf16 v[56:59], v[144:147], v[160:163], v[56:59]
    v_mfma_f32_16x16x32_bf16 v[60:63], v[148:151], v[156:159], v[60:63]
    s_add_u32 m0, s41, 102400
    s_add_u32 s51, s59, 393216
    buffer_load_dwordx4 v1, s[20:23], s51 offen lds
    v_mfma_f32_16x16x32_bf16 v[64:67], v[148:151], v[160:163], v[64:67]
    v_mfma_f32_16x16x32_bf16 v[68:71], v[152:155], v[156:159], v[68:71]
    v_mfma_f32_16x16x32_bf16 v[72:75], v[152:155], v[160:163], v[72:75]
    s_add_u32 m0, s41, 106496
    s_add_u32 s51, s59, 524288
    buffer_load_dwordx4 v1, s[20:23], s51 offen lds
    s_waitcnt vmcnt(9)
    s_barrier
    v_add_u32 v164, 36864, v164
    v_add_u32 v165, 36864, v165
    v_add_u32 v166, 36864, v166
    v_add_u32 v167, 36864, v167
    ds_read_b128 v[112:115], v166 offset:0
    ds_read_b128 v[116:119], v166 offset:2048
    ds_read_b128 v[76:79], v164 offset:16384
    ds_read_b128 v[80:83], v164 offset:18432
    ds_read_b128 v[84:87], v164 offset:20480
    ds_read_b128 v[88:91], v164 offset:22528
    ds_read_b128 v[92:95], v164 offset:24576
    ds_read_b128 v[96:99], v164 offset:26624
    ds_read_b128 v[100:103], v164 offset:28672
    ds_read_b128 v[104:107], v164 offset:30720
    ds_read_b128 v[108:111], v164 offset:32768
    s_waitcnt lgkmcnt(0)
    v_mfma_f32_16x16x32_bf16 v[4:7], v[76:79], v[112:115], v[4:7]
    v_mfma_f32_16x16x32_bf16 v[8:11], v[76:79], v[116:119], v[8:11]
    ds_read_b128 v[156:159], v167 offset:0
    v_mfma_f32_16x16x32_bf16 v[12:15], v[80:83], v[112:115], v[12:15]
    ds_read_b128 v[160:163], v167 offset:2048
    v_mfma_f32_16x16x32_bf16 v[16:19], v[80:83], v[116:119], v[16:19]
    ds_read_b128 v[120:123], v165 offset:16384
    v_mfma_f32_16x16x32_bf16 v[20:23], v[84:87], v[112:115], v[20:23]
    ds_read_b128 v[124:127], v165 offset:18432
    v_mfma_f32_16x16x32_bf16 v[24:27], v[84:87], v[116:119], v[24:27]
    ds_read_b128 v[128:131], v165 offset:20480
    v_mfma_f32_16x16x32_bf16 v[28:31], v[88:91], v[112:115], v[28:31]
    ds_read_b128 v[132:135], v165 offset:22528
    v_mfma_f32_16x16x32_bf16 v[32:35], v[88:91], v[116:119], v[32:35]
    ds_read_b128 v[136:139], v165 offset:24576
    v_mfma_f32_16x16x32_bf16 v[36:39], v[92:95], v[112:115], v[36:39]
    ds_read_b128 v[140:143], v165 offset:26624
    v_mfma_f32_16x16x32_bf16 v[40:43], v[92:95], v[116:119], v[40:43]
    v_mfma_f32_16x16x32_bf16 v[44:47], v[96:99], v[112:115], v[44:47]
    ds_read_b128 v[144:147], v165 offset:28672
    v_mfma_f32_16x16x32_bf16 v[48:51], v[96:99], v[116:119], v[48:51]
    ds_read_b128 v[148:151], v165 offset:30720
    v_mfma_f32_16x16x32_bf16 v[52:55], v[100:103], v[112:115], v[52:55]
    ds_read_b128 v[152:155], v165 offset:32768
    v_mfma_f32_16x16x32_bf16 v[56:59], v[100:103], v[116:119], v[56:59]
    s_add_u32 s58, s58, 128
    s_add_u32 s59, s59, 128
    v_mfma_f32_16x16x32_bf16 v[60:63], v[104:107], v[112:115], v[60:63]
    s_add_u32 m0, s41, 0
    s_add_u32 s51, s58, 0
    buffer_load_dwordx4 v0, s[16:19], s51 offen lds
    v_mfma_f32_16x16x32_bf16 v[64:67], v[104:107], v[116:119], v[64:67]
    s_add_u32 m0, s41, 4096
    s_add_u32 s51, s58, 131072
    buffer_load_dwordx4 v0, s[16:19], s51 offen lds
    v_mfma_f32_16x16x32_bf16 v[68:71], v[108:111], v[112:115], v[68:71]
    s_add_u32 m0, s41, 8192
    s_add_u32 s51, s58, 262144
    buffer_load_dwordx4 v0, s[16:19], s51 offen lds
    v_mfma_f32_16x16x32_bf16 v[72:75], v[108:111], v[116:119], v[72:75]
    s_add_u32 m0, s41, 12288
    s_add_u32 s51, s58, 393216
    buffer_load_dwordx4 v0, s[16:19], s51 offen lds
    s_waitcnt lgkmcnt(0)
    v_mfma_f32_16x16x32_bf16 v[4:7], v[120:123], v[156:159], v[4:7]
    v_mfma_f32_16x16x32_bf16 v[8:11], v[120:123], v[160:163], v[8:11]
    v_mfma_f32_16x16x32_bf16 v[12:15], v[124:127], v[156:159], v[12:15]
    v_mfma_f32_16x16x32_bf16 v[16:19], v[124:127], v[160:163], v[16:19]
    s_add_u32 m0, s41, 16384
    s_add_u32 s51, s59, 0
    buffer_load_dwordx4 v1, s[20:23], s51 offen lds
    v_mfma_f32_16x16x32_bf16 v[20:23], v[128:131], v[156:159], v[20:23]
    v_mfma_f32_16x16x32_bf16 v[24:27], v[128:131], v[160:163], v[24:27]
    v_mfma_f32_16x16x32_bf16 v[28:31], v[132:135], v[156:159], v[28:31]
    v_mfma_f32_16x16x32_bf16 v[32:35], v[132:135], v[160:163], v[32:35]
    s_add_u32 m0, s41, 20480
    s_add_u32 s51, s59, 131072
    buffer_load_dwordx4 v1, s[20:23], s51 offen lds
    v_mfma_f32_16x16x32_bf16 v[36:39], v[136:139], v[156:159], v[36:39]
    v_mfma_f32_16x16x32_bf16 v[40:43], v[136:139], v[160:163], v[40:43]
    v_mfma_f32_16x16x32_bf16 v[44:47], v[140:143], v[156:159], v[44:47]
    s_add_u32 m0, s41, 24576
    s_add_u32 s51, s59, 262144
    buffer_load_dwordx4 v1, s[20:23], s51 offen lds
    v_mfma_f32_16x16x32_bf16 v[48:51], v[140:143], v[160:163], v[48:51]
    v_mfma_f32_16x16x32_bf16 v[52:55], v[144:147], v[156:159], v[52:55]
    v_mfma_f32_16x16x32_bf16 v[56:59], v[144:147], v[160:163], v[56:59]
    v_mfma_f32_16x16x32_bf16 v[60:63], v[148:151], v[156:159], v[60:63]
    s_add_u32 m0, s41, 28672
    s_add_u32 s51, s59, 393216
    buffer_load_dwordx4 v1, s[20:23], s51 offen lds
    v_mfma_f32_16x16x32_bf16 v[64:67], v[148:151], v[160:163], v[64:67]
    v_mfma_f32_16x16x32_bf16 v[68:71], v[152:155], v[156:159], v[68:71]
    v_mfma_f32_16x16x32_bf16 v[72:75], v[152:155], v[160:163], v[72:75]
    s_add_u32 m0, s41, 32768
    s_add_u32 s51, s59, 524288
    buffer_load_dwordx4 v1, s[20:23], s51 offen lds
    s_waitcnt vmcnt(9)
    s_barrier
    v_add_u32 v164, 36864, v164
    v_add_u32 v165, 36864, v165
    v_add_u32 v166, 36864, v166
    v_add_u32 v167, 36864, v167
    ds_read_b128 v[112:115], v166 offset:0
    ds_read_b128 v[116:119], v166 offset:2048
    ds_read_b128 v[76:79], v164 offset:16384
    ds_read_b128 v[80:83], v164 offset:18432
    ds_read_b128 v[84:87], v164 offset:20480
    ds_read_b128 v[88:91], v164 offset:22528
    ds_read_b128 v[92:95], v164 offset:24576
    ds_read_b128 v[96:99], v164 offset:26624
    ds_read_b128 v[100:103], v164 offset:28672
    ds_read_b128 v[104:107], v164 offset:30720
    ds_read_b128 v[108:111], v164 offset:32768
    s_waitcnt lgkmcnt(0)
    v_mfma_f32_16x16x32_bf16 v[4:7], v[76:79], v[112:115], v[4:7]
    v_mfma_f32_16x16x32_bf16 v[8:11], v[76:79], v[116:119], v[8:11]
    ds_read_b128 v[156:159], v167 offset:0
    v_mfma_f32_16x16x32_bf16 v[12:15], v[80:83], v[112:115], v[12:15]
    ds_read_b128 v[160:163], v167 offset:2048
    v_mfma_f32_16x16x32_bf16 v[16:19], v[80:83], v[116:119], v[16:19]
    ds_read_b128 v[120:123], v165 offset:16384
    v_mfma_f32_16x16x32_bf16 v[20:23], v[84:87], v[112:115], v[20:23]
    ds_read_b128 v[124:127], v165 offset:18432
    v_mfma_f32_16x16x32_bf16 v[24:27], v[84:87], v[116:119], v[24:27]
    ds_read_b128 v[128:131], v165 offset:20480
    v_mfma_f32_16x16x32_bf16 v[28:31], v[88:91], v[112:115], v[28:31]
    ds_read_b128 v[132:135], v165 offset:22528
    v_mfma_f32_16x16x32_bf16 v[32:35], v[88:91], v[116:119], v[32:35]
    ds_read_b128 v[136:139], v165 offset:24576
    v_mfma_f32_16x16x32_bf16 v[36:39], v[92:95], v[112:115], v[36:39]
    ds_read_b128 v[140:143], v165 offset:26624
    v_mfma_f32_16x16x32_bf16 v[40:43], v[92:95], v[116:119], v[40:43]
    v_mfma_f32_16x16x32_bf16 v[44:47], v[96:99], v[112:115], v[44:47]
    ds_read_b128 v[144:147], v165 offset:28672
    v_mfma_f32_16x16x32_bf16 v[48:51], v[96:99], v[116:119], v[48:51]
    ds_read_b128 v[148:151], v165 offset:30720
    v_mfma_f32_16x16x32_bf16 v[52:55], v[100:103], v[112:115], v[52:55]
    ds_read_b128 v[152:155], v165 offset:32768
    v_mfma_f32_16x16x32_bf16 v[56:59], v[100:103], v[116:119], v[56:59]
    s_add_u32 s58, s58, 128
    s_add_u32 s59, s59, 128
    v_mfma_f32_16x16x32_bf16 v[60:63], v[104:107], v[112:115], v[60:63]
    s_add_u32 m0, s41, 36864
    s_add_u32 s51, s58, 0
    buffer_load_dwordx4 v0, s[16:19], s51 offen lds
    v_mfma_f32_16x16x32_bf16 v[64:67], v[104:107], v[116:119], v[64:67]
    s_add_u32 m0, s41, 40960
    s_add_u32 s51, s58, 131072
    buffer_load_dwordx4 v0, s[16:19], s51 offen lds
    v_mfma_f32_16x16x32_bf16 v[68:71], v[108:111], v[112:115], v[68:71]
    s_add_u32 m0, s41, 45056
    s_add_u32 s51, s58, 262144
    buffer_load_dwordx4 v0, s[16:19], s51 offen lds
    v_mfma_f32_16x16x32_bf16 v[72:75], v[108:111], v[116:119], v[72:75]
    s_add_u32 m0, s41, 49152
    s_add_u32 s51, s58, 393216
    buffer_load_dwordx4 v0, s[16:19], s51 offen lds
    s_waitcnt lgkmcnt(0)
    v_mfma_f32_16x16x32_bf16 v[4:7], v[120:123], v[156:159], v[4:7]
    v_mfma_f32_16x16x32_bf16 v[8:11], v[120:123], v[160:163], v[8:11]
    v_mfma_f32_16x16x32_bf16 v[12:15], v[124:127], v[156:159], v[12:15]
    v_mfma_f32_16x16x32_bf16 v[16:19], v[124:127], v[160:163], v[16:19]
    s_add_u32 m0, s41, 53248
    s_add_u32 s51, s59, 0
    buffer_load_dwordx4 v1, s[20:23], s51 offen lds
    v_mfma_f32_16x16x32_bf16 v[20:23], v[128:131], v[156:159], v[20:23]
    v_mfma_f32_16x16x32_bf16 v[24:27], v[128:131], v[160:163], v[24:27]
    v_mfma_f32_16x16x32_bf16 v[28:31], v[132:135], v[156:159], v[28:31]
    v_mfma_f32_16x16x32_bf16 v[32:35], v[132:135], v[160:163], v[32:35]
    s_add_u32 m0, s41, 57344
    s_add_u32 s51, s59, 131072
    buffer_load_dwordx4 v1, s[20:23], s51 offen lds
    v_mfma_f32_16x16x32_bf16 v[36:39], v[136:139], v[156:159], v[36:39]
    v_mfma_f32_16x16x32_bf16 v[40:43], v[136:139], v[160:163], v[40:43]
    v_mfma_f32_16x16x32_bf16 v[44:47], v[140:143], v[156:159], v[44:47]
    s_add_u32 m0, s41, 61440
    s_add_u32 s51, s59, 262144
    buffer_load_dwordx4 v1, s[20:23], s51 offen lds
    v_mfma_f32_16x16x32_bf16 v[48:51], v[140:143], v[160:163], v[48:51]
    v_mfma_f32_16x16x32_bf16 v[52:55], v[144:147], v[156:159], v[52:55]
    v_mfma_f32_16x16x32_bf16 v[56:59], v[144:147], v[160:163], v[56:59]
    v_mfma_f32_16x16x32_bf16 v[60:63], v[148:151], v[156:159], v[60:63]
    s_add_u32 m0, s41, 65536
    s_add_u32 s51, s59, 393216
    buffer_load_dwordx4 v1, s[20:23], s51 offen lds
    v_mfma_f32_16x16x32_bf16 v[64:67], v[148:151], v[160:163], v[64:67]
    v_mfma_f32_16x16x32_bf16 v[68:71], v[152:155], v[156:159], v[68:71]
    v_mfma_f32_16x16x32_bf16 v[72:75], v[152:155], v[160:163], v[72:75]
    s_add_u32 m0, s41, 69632
    s_add_u32 s51, s59, 524288
    buffer_load_dwordx4 v1, s[20:23], s51 offen lds
    s_waitcnt vmcnt(9)
    s_barrier
    v_subrev_u32 v164, 73728, v164
    v_subrev_u32 v165, 73728, v165
    v_subrev_u32 v166, 73728, v166
    v_subrev_u32 v167, 73728, v167
    ds_read_b128 v[112:115], v166 offset:0
    ds_read_b128 v[116:119], v166 offset:2048
    ds_read_b128 v[76:79], v164 offset:16384
    ds_read_b128 v[80:83], v164 offset:18432
    ds_read_b128 v[84:87], v164 offset:20480
    ds_read_b128 v[88:91], v164 offset:22528
    ds_read_b128 v[92:95], v164 offset:24576
    ds_read_b128 v[96:99], v164 offset:26624
    ds_read_b128 v[100:103], v164 offset:28672
    ds_read_b128 v[104:107], v164 offset:30720
    ds_read_b128 v[108:111], v164 offset:32768
    s_waitcnt lgkmcnt(0)
    v_mfma_f32_16x16x32_bf16 v[4:7], v[76:79], v[112:115], v[4:7]
    v_mfma_f32_16x16x32_bf16 v[8:11], v[76:79], v[116:119], v[8:11]
    ds_read_b128 v[156:159], v167 offset:0
    v_mfma_f32_16x16x32_bf16 v[12:15], v[80:83], v[112:115], v[12:15]
    ds_read_b128 v[160:163], v167 offset:2048
    v_mfma_f32_16x16x32_bf16 v[16:19], v[80:83], v[116:119], v[16:19]
    ds_read_b128 v[120:123], v165 offset:16384
    v_mfma_f32_16x16x32_bf16 v[20:23], v[84:87], v[112:115], v[20:23]
    ds_read_b128 v[124:127], v165 offset:18432
    v_mfma_f32_16x16x32_bf16 v[24:27], v[84:87], v[116:119], v[24:27]
    ds_read_b128 v[128:131], v165 offset:20480
    v_mfma_f32_16x16x32_bf16 v[28:31], v[88:91], v[112:115], v[28:31]
    ds_read_b128 v[132:135], v165 offset:22528
    v_mfma_f32_16x16x32_bf16 v[32:35], v[88:91], v[116:119], v[32:35]
    ds_read_b128 v[136:139], v165 offset:24576
    v_mfma_f32_16x16x32_bf16 v[36:39], v[92:95], v[112:115], v[36:39]
    ds_read_b128 v[140:143], v165 offset:26624
    v_mfma_f32_16x16x32_bf16 v[40:43], v[92:95], v[116:119], v[40:43]
    v_mfma_f32_16x16x32_bf16 v[44:47], v[96:99], v[112:115], v[44:47]
    ds_read_b128 v[144:147], v165 offset:28672
    v_mfma_f32_16x16x32_bf16 v[48:51], v[96:99], v[116:119], v[48:51]
    ds_read_b128 v[148:151], v165 offset:30720
    v_mfma_f32_16x16x32_bf16 v[52:55], v[100:103], v[112:115], v[52:55]
    ds_read_b128 v[152:155], v165 offset:32768
    v_mfma_f32_16x16x32_bf16 v[56:59], v[100:103], v[116:119], v[56:59]
    s_add_u32 s58, s58, 128
    s_add_u32 s59, s59, 128
    v_mfma_f32_16x16x32_bf16 v[60:63], v[104:107], v[112:115], v[60:63]
    s_add_u32 m0, s41, 73728
    s_add_u32 s51, s58, 0
    buffer_load_dwordx4 v0, s[16:19], s51 offen lds
    v_mfma_f32_16x16x32_bf16 v[64:67], v[104:107], v[116:119], v[64:67]
    s_add_u32 m0, s41, 77824
    s_add_u32 s51, s58, 131072
    buffer_load_dwordx4 v0, s[16:19], s51 offen lds
    v_mfma_f32_16x16x32_bf16 v[68:71], v[108:111], v[112:115], v[68:71]
    s_add_u32 m0, s41, 81920
    s_add_u32 s51, s58, 262144
    buffer_load_dwordx4 v0, s[16:19], s51 offen lds
    v_mfma_f32_16x16x32_bf16 v[72:75], v[108:111], v[116:119], v[72:75]
    s_add_u32 m0, s41, 86016
    s_add_u32 s51, s58, 393216
    buffer_load_dwordx4 v0, s[16:19], s51 offen lds
    s_waitcnt lgkmcnt(0)
    v_mfma_f32_16x16x32_bf16 v[4:7], v[120:123], v[156:159], v[4:7]
    v_mfma_f32_16x16x32_bf16 v[8:11], v[120:123], v[160:163], v[8:11]
    v_mfma_f32_16x16x32_bf16 v[12:15], v[124:127], v[156:159], v[12:15]
    v_mfma_f32_16x16x32_bf16 v[16:19], v[124:127], v[160:163], v[16:19]
    s_add_u32 m0, s41, 90112
    s_add_u32 s51, s59, 0
    buffer_load_dwordx4 v1, s[20:23], s51 offen lds
    v_mfma_f32_16x16x32_bf16 v[20:23], v[128:131], v[156:159], v[20:23]
    v_mfma_f32_16x16x32_bf16 v[24:27], v[128:131], v[160:163], v[24:27]
    v_mfma_f32_16x16x32_bf16 v[28:31], v[132:135], v[156:159], v[28:31]
    v_mfma_f32_16x16x32_bf16 v[32:35], v[132:135], v[160:163], v[32:35]
    s_add_u32 m0, s41, 94208
    s_add_u32 s51, s59, 131072
    buffer_load_dwordx4 v1, s[20:23], s51 offen lds
    v_mfma_f32_16x16x32_bf16 v[36:39], v[136:139], v[156:159], v[36:39]
    v_mfma_f32_16x16x32_bf16 v[40:43], v[136:139], v[160:163], v[40:43]
    v_mfma_f32_16x16x32_bf16 v[44:47], v[140:143], v[156:159], v[44:47]
    s_add_u32 m0, s41, 98304
    s_add_u32 s51, s59, 262144
    buffer_load_dwordx4 v1, s[20:23], s51 offen lds
    v_mfma_f32_16x16x32_bf16 v[48:51], v[140:143], v[160:163], v[48:51]
    v_mfma_f32_16x16x32_bf16 v[52:55], v[144:147], v[156:159], v[52:55]
    v_mfma_f32_16x16x32_bf16 v[56:59], v[144:147], v[160:163], v[56:59]
    v_mfma_f32_16x16x32_bf16 v[60:63], v[148:151], v[156:159], v[60:63]
    s_add_u32 m0, s41, 102400
    s_add_u32 s51, s59, 393216
    buffer_load_dwordx4 v1, s[20:23], s51 offen lds
    v_mfma_f32_16x16x32_bf16 v[64:67], v[148:151], v[160:163], v[64:67]
    v_mfma_f32_16x16x32_bf16 v[68:71], v[152:155], v[156:159], v[68:71]
    v_mfma_f32_16x16x32_bf16 v[72:75], v[152:155], v[160:163], v[72:75]
    s_add_u32 m0, s41, 106496
    s_add_u32 s51, s59, 524288
    buffer_load_dwordx4 v1, s[20:23], s51 offen lds
    s_waitcnt vmcnt(9)
    s_barrier
    v_add_u32 v164, 36864, v164
    v_add_u32 v165, 36864, v165
    v_add_u32 v166, 36864, v166
    v_add_u32 v167, 36864, v167
    ds_read_b128 v[112:115], v166 offset:0
    ds_read_b128 v[116:119], v166 offset:2048
    ds_read_b128 v[76:79], v164 offset:16384
    ds_read_b128 v[80:83], v164 offset:18432
    ds_read_b128 v[84:87], v164 offset:20480
    ds_read_b128 v[88:91], v164 offset:22528
    ds_read_b128 v[92:95], v164 offset:24576
    ds_read_b128 v[96:99], v164 offset:26624
    ds_read_b128 v[100:103], v164 offset:28672
    ds_read_b128 v[104:107], v164 offset:30720
    ds_read_b128 v[108:111], v164 offset:32768
    s_waitcnt lgkmcnt(0)
    v_mfma_f32_16x16x32_bf16 v[4:7], v[76:79], v[112:115], v[4:7]
    v_mfma_f32_16x16x32_bf16 v[8:11], v[76:79], v[116:119], v[8:11]
    ds_read_b128 v[156:159], v167 offset:0
    v_mfma_f32_16x16x32_bf16 v[12:15], v[80:83], v[112:115], v[12:15]
    ds_read_b128 v[160:163], v167 offset:2048
    v_mfma_f32_16x16x32_bf16 v[16:19], v[80:83], v[116:119], v[16:19]
    ds_read_b128 v[120:123], v165 offset:16384
    v_mfma_f32_16x16x32_bf16 v[20:23], v[84:87], v[112:115], v[20:23]
    ds_read_b128 v[124:127], v165 offset:18432
    v_mfma_f32_16x16x32_bf16 v[24:27], v[84:87], v[116:119], v[24:27]
    ds_read_b128 v[128:131], v165 offset:20480
    v_mfma_f32_16x16x32_bf16 v[28:31], v[88:91], v[112:115], v[28:31]
    ds_read_b128 v[132:135], v165 offset:22528
    v_mfma_f32_16x16x32_bf16 v[32:35], v[88:91], v[116:119], v[32:35]
    ds_read_b128 v[136:139], v165 offset:24576
    v_mfma_f32_16x16x32_bf16 v[36:39], v[92:95], v[112:115], v[36:39]
    ds_read_b128 v[140:143], v165 offset:26624
    v_mfma_f32_16x16x32_bf16 v[40:43], v[92:95], v[116:119], v[40:43]
    v_mfma_f32_16x16x32_bf16 v[44:47], v[96:99], v[112:115], v[44:47]
    ds_read_b128 v[144:147], v165 offset:28672
    v_mfma_f32_16x16x32_bf16 v[48:51], v[96:99], v[116:119], v[48:51]
    ds_read_b128 v[148:151], v165 offset:30720
    v_mfma_f32_16x16x32_bf16 v[52:55], v[100:103], v[112:115], v[52:55]
    ds_read_b128 v[152:155], v165 offset:32768
    v_mfma_f32_16x16x32_bf16 v[56:59], v[100:103], v[116:119], v[56:59]
    s_add_u32 s58, s58, 128
    s_add_u32 s59, s59, 128
    v_mfma_f32_16x16x32_bf16 v[60:63], v[104:107], v[112:115], v[60:63]
    s_add_u32 m0, s41, 0
    s_add_u32 s51, s58, 0
    buffer_load_dwordx4 v0, s[16:19], s51 offen lds
    v_mfma_f32_16x16x32_bf16 v[64:67], v[104:107], v[116:119], v[64:67]
    s_add_u32 m0, s41, 4096
    s_add_u32 s51, s58, 131072
    buffer_load_dwordx4 v0, s[16:19], s51 offen lds
    v_mfma_f32_16x16x32_bf16 v[68:71], v[108:111], v[112:115], v[68:71]
    s_add_u32 m0, s41, 8192
    s_add_u32 s51, s58, 262144
    buffer_load_dwordx4 v0, s[16:19], s51 offen lds
    v_mfma_f32_16x16x32_bf16 v[72:75], v[108:111], v[116:119], v[72:75]
    s_add_u32 m0, s41, 12288
    s_add_u32 s51, s58, 393216
    buffer_load_dwordx4 v0, s[16:19], s51 offen lds
    s_waitcnt lgkmcnt(0)
    v_mfma_f32_16x16x32_bf16 v[4:7], v[120:123], v[156:159], v[4:7]
    v_mfma_f32_16x16x32_bf16 v[8:11], v[120:123], v[160:163], v[8:11]
    v_mfma_f32_16x16x32_bf16 v[12:15], v[124:127], v[156:159], v[12:15]
    v_mfma_f32_16x16x32_bf16 v[16:19], v[124:127], v[160:163], v[16:19]
    s_add_u32 m0, s41, 16384
    s_add_u32 s51, s59, 0
    buffer_load_dwordx4 v1, s[20:23], s51 offen lds
    v_mfma_f32_16x16x32_bf16 v[20:23], v[128:131], v[156:159], v[20:23]
    v_mfma_f32_16x16x32_bf16 v[24:27], v[128:131], v[160:163], v[24:27]
    v_mfma_f32_16x16x32_bf16 v[28:31], v[132:135], v[156:159], v[28:31]
    v_mfma_f32_16x16x32_bf16 v[32:35], v[132:135], v[160:163], v[32:35]
    s_add_u32 m0, s41, 20480
    s_add_u32 s51, s59, 131072
    buffer_load_dwordx4 v1, s[20:23], s51 offen lds
    v_mfma_f32_16x16x32_bf16 v[36:39], v[136:139], v[156:159], v[36:39]
    v_mfma_f32_16x16x32_bf16 v[40:43], v[136:139], v[160:163], v[40:43]
    v_mfma_f32_16x16x32_bf16 v[44:47], v[140:143], v[156:159], v[44:47]
    s_add_u32 m0, s41, 24576
    s_add_u32 s51, s59, 262144
    buffer_load_dwordx4 v1, s[20:23], s51 offen lds
    v_mfma_f32_16x16x32_bf16 v[48:51], v[140:143], v[160:163], v[48:51]
    v_mfma_f32_16x16x32_bf16 v[52:55], v[144:147], v[156:159], v[52:55]
    v_mfma_f32_16x16x32_bf16 v[56:59], v[144:147], v[160:163], v[56:59]
    v_mfma_f32_16x16x32_bf16 v[60:63], v[148:151], v[156:159], v[60:63]
    s_add_u32 m0, s41, 28672
    s_add_u32 s51, s59, 393216
    buffer_load_dwordx4 v1, s[20:23], s51 offen lds
    v_mfma_f32_16x16x32_bf16 v[64:67], v[148:151], v[160:163], v[64:67]
    v_mfma_f32_16x16x32_bf16 v[68:71], v[152:155], v[156:159], v[68:71]
    v_mfma_f32_16x16x32_bf16 v[72:75], v[152:155], v[160:163], v[72:75]
    s_add_u32 m0, s41, 32768
    s_add_u32 s51, s59, 524288
    buffer_load_dwordx4 v1, s[20:23], s51 offen lds
    s_waitcnt vmcnt(9)
    s_barrier
    v_add_u32 v164, 36864, v164
    v_add_u32 v165, 36864, v165
    v_add_u32 v166, 36864, v166
    v_add_u32 v167, 36864, v167
    ds_read_b128 v[112:115], v166 offset:0
    ds_read_b128 v[116:119], v166 offset:2048
    ds_read_b128 v[76:79], v164 offset:16384
    ds_read_b128 v[80:83], v164 offset:18432
    ds_read_b128 v[84:87], v164 offset:20480
    ds_read_b128 v[88:91], v164 offset:22528
    ds_read_b128 v[92:95], v164 offset:24576
    ds_read_b128 v[96:99], v164 offset:26624
    ds_read_b128 v[100:103], v164 offset:28672
    ds_read_b128 v[104:107], v164 offset:30720
    ds_read_b128 v[108:111], v164 offset:32768
    s_waitcnt lgkmcnt(0)
    v_mfma_f32_16x16x32_bf16 v[4:7], v[76:79], v[112:115], v[4:7]
    v_mfma_f32_16x16x32_bf16 v[8:11], v[76:79], v[116:119], v[8:11]
    ds_read_b128 v[156:159], v167 offset:0
    v_mfma_f32_16x16x32_bf16 v[12:15], v[80:83], v[112:115], v[12:15]
    ds_read_b128 v[160:163], v167 offset:2048
    v_mfma_f32_16x16x32_bf16 v[16:19], v[80:83], v[116:119], v[16:19]
    ds_read_b128 v[120:123], v165 offset:16384
    v_mfma_f32_16x16x32_bf16 v[20:23], v[84:87], v[112:115], v[20:23]
    ds_read_b128 v[124:127], v165 offset:18432
    v_mfma_f32_16x16x32_bf16 v[24:27], v[84:87], v[116:119], v[24:27]
    ds_read_b128 v[128:131], v165 offset:20480
    v_mfma_f32_16x16x32_bf16 v[28:31], v[88:91], v[112:115], v[28:31]
    ds_read_b128 v[132:135], v165 offset:22528
    v_mfma_f32_16x16x32_bf16 v[32:35], v[88:91], v[116:119], v[32:35]
    ds_read_b128 v[136:139], v165 offset:24576
    v_mfma_f32_16x16x32_bf16 v[36:39], v[92:95], v[112:115], v[36:39]
    ds_read_b128 v[140:143], v165 offset:26624
    v_mfma_f32_16x16x32_bf16 v[40:43], v[92:95], v[116:119], v[40:43]
    v_mfma_f32_16x16x32_bf16 v[44:47], v[96:99], v[112:115], v[44:47]
    ds_read_b128 v[144:147], v165 offset:28672
    v_mfma_f32_16x16x32_bf16 v[48:51], v[96:99], v[116:119], v[48:51]
    ds_read_b128 v[148:151], v165 offset:30720
    v_mfma_f32_16x16x32_bf16 v[52:55], v[100:103], v[112:115], v[52:55]
    ds_read_b128 v[152:155], v165 offset:32768
    v_mfma_f32_16x16x32_bf16 v[56:59], v[100:103], v[116:119], v[56:59]
    s_add_u32 s58, s58, 128
    s_add_u32 s59, s59, 128
    v_mfma_f32_16x16x32_bf16 v[60:63], v[104:107], v[112:115], v[60:63]
    s_add_u32 m0, s41, 36864
    s_add_u32 s51, s58, 0
    buffer_load_dwordx4 v0, s[16:19], s51 offen lds
    v_mfma_f32_16x16x32_bf16 v[64:67], v[104:107], v[116:119], v[64:67]
    s_add_u32 m0, s41, 40960
    s_add_u32 s51, s58, 131072
    buffer_load_dwordx4 v0, s[16:19], s51 offen lds
    v_mfma_f32_16x16x32_bf16 v[68:71], v[108:111], v[112:115], v[68:71]
    s_add_u32 m0, s41, 45056
    s_add_u32 s51, s58, 262144
    buffer_load_dwordx4 v0, s[16:19], s51 offen lds
    v_mfma_f32_16x16x32_bf16 v[72:75], v[108:111], v[116:119], v[72:75]
    s_add_u32 m0, s41, 49152
    s_add_u32 s51, s58, 393216
    buffer_load_dwordx4 v0, s[16:19], s51 offen lds
    s_waitcnt lgkmcnt(0)
    v_mfma_f32_16x16x32_bf16 v[4:7], v[120:123], v[156:159], v[4:7]
    v_mfma_f32_16x16x32_bf16 v[8:11], v[120:123], v[160:163], v[8:11]
    v_mfma_f32_16x16x32_bf16 v[12:15], v[124:127], v[156:159], v[12:15]
    v_mfma_f32_16x16x32_bf16 v[16:19], v[124:127], v[160:163], v[16:19]
    s_add_u32 m0, s41, 53248
    s_add_u32 s51, s59, 0
    buffer_load_dwordx4 v1, s[20:23], s51 offen lds
    v_mfma_f32_16x16x32_bf16 v[20:23], v[128:131], v[156:159], v[20:23]
    v_mfma_f32_16x16x32_bf16 v[24:27], v[128:131], v[160:163], v[24:27]
    v_mfma_f32_16x16x32_bf16 v[28:31], v[132:135], v[156:159], v[28:31]
    v_mfma_f32_16x16x32_bf16 v[32:35], v[132:135], v[160:163], v[32:35]
    s_add_u32 m0, s41, 57344
    s_add_u32 s51, s59, 131072
    buffer_load_dwordx4 v1, s[20:23], s51 offen lds
    v_mfma_f32_16x16x32_bf16 v[36:39], v[136:139], v[156:159], v[36:39]
    v_mfma_f32_16x16x32_bf16 v[40:43], v[136:139], v[160:163], v[40:43]
    v_mfma_f32_16x16x32_bf16 v[44:47], v[140:143], v[156:159], v[44:47]
    s_add_u32 m0, s41, 61440
    s_add_u32 s51, s59, 262144
    buffer_load_dwordx4 v1, s[20:23], s51 offen lds
    v_mfma_f32_16x16x32_bf16 v[48:51], v[140:143], v[160:163], v[48:51]
    v_mfma_f32_16x16x32_bf16 v[52:55], v[144:147], v[156:159], v[52:55]
    v_mfma_f32_16x16x32_bf16 v[56:59], v[144:147], v[160:163], v[56:59]
    v_mfma_f32_16x16x32_bf16 v[60:63], v[148:151], v[156:159], v[60:63]
    s_add_u32 m0, s41, 65536
    s_add_u32 s51, s59, 393216
    buffer_load_dwordx4 v1, s[20:23], s51 offen lds
    v_mfma_f32_16x16x32_bf16 v[64:67], v[148:151], v[160:163], v[64:67]
    v_mfma_f32_16x16x32_bf16 v[68:71], v[152:155], v[156:159], v[68:71]
    v_mfma_f32_16x16x32_bf16 v[72:75], v[152:155], v[160:163], v[72:75]
    s_add_u32 m0, s41, 69632
    s_add_u32 s51, s59, 524288
    buffer_load_dwordx4 v1, s[20:23], s51 offen lds
    s_waitcnt vmcnt(9)
    s_barrier
    v_subrev_u32 v164, 73728, v164
    v_subrev_u32 v165, 73728, v165
    v_subrev_u32 v166, 73728, v166
    v_subrev_u32 v167, 73728, v167
    ds_read_b128 v[112:115], v166 offset:0
    ds_read_b128 v[116:119], v166 offset:2048
    ds_read_b128 v[76:79], v164 offset:16384
    ds_read_b128 v[80:83], v164 offset:18432
    ds_read_b128 v[84:87], v164 offset:20480
    ds_read_b128 v[88:91], v164 offset:22528
    ds_read_b128 v[92:95], v164 offset:24576
    ds_read_b128 v[96:99], v164 offset:26624
    ds_read_b128 v[100:103], v164 offset:28672
    ds_read_b128 v[104:107], v164 offset:30720
    ds_read_b128 v[108:111], v164 offset:32768
    s_waitcnt lgkmcnt(0)
    v_mfma_f32_16x16x32_bf16 v[4:7], v[76:79], v[112:115], v[4:7]
    v_mfma_f32_16x16x32_bf16 v[8:11], v[76:79], v[116:119], v[8:11]
    ds_read_b128 v[156:159], v167 offset:0
    v_mfma_f32_16x16x32_bf16 v[12:15], v[80:83], v[112:115], v[12:15]
    ds_read_b128 v[160:163], v167 offset:2048
    v_mfma_f32_16x16x32_bf16 v[16:19], v[80:83], v[116:119], v[16:19]
    ds_read_b128 v[120:123], v165 offset:16384
    v_mfma_f32_16x16x32_bf16 v[20:23], v[84:87], v[112:115], v[20:23]
    ds_read_b128 v[124:127], v165 offset:18432
    v_mfma_f32_16x16x32_bf16 v[24:27], v[84:87], v[116:119], v[24:27]
    ds_read_b128 v[128:131], v165 offset:20480
    v_mfma_f32_16x16x32_bf16 v[28:31], v[88:91], v[112:115], v[28:31]
    ds_read_b128 v[132:135], v165 offset:22528
    v_mfma_f32_16x16x32_bf16 v[32:35], v[88:91], v[116:119], v[32:35]
    ds_read_b128 v[136:139], v165 offset:24576
    v_mfma_f32_16x16x32_bf16 v[36:39], v[92:95], v[112:115], v[36:39]
    ds_read_b128 v[140:143], v165 offset:26624
    v_mfma_f32_16x16x32_bf16 v[40:43], v[92:95], v[116:119], v[40:43]
    v_mfma_f32_16x16x32_bf16 v[44:47], v[96:99], v[112:115], v[44:47]
    ds_read_b128 v[144:147], v165 offset:28672
    v_mfma_f32_16x16x32_bf16 v[48:51], v[96:99], v[116:119], v[48:51]
    ds_read_b128 v[148:151], v165 offset:30720
    v_mfma_f32_16x16x32_bf16 v[52:55], v[100:103], v[112:115], v[52:55]
    ds_read_b128 v[152:155], v165 offset:32768
    v_mfma_f32_16x16x32_bf16 v[56:59], v[100:103], v[116:119], v[56:59]
    s_add_u32 s58, s58, 128
    s_add_u32 s59, s59, 128
    v_mfma_f32_16x16x32_bf16 v[60:63], v[104:107], v[112:115], v[60:63]
    s_add_u32 m0, s41, 73728
    s_add_u32 s51, s58, 0
    buffer_load_dwordx4 v0, s[16:19], s51 offen lds
    v_mfma_f32_16x16x32_bf16 v[64:67], v[104:107], v[116:119], v[64:67]
    s_add_u32 m0, s41, 77824
    s_add_u32 s51, s58, 131072
    buffer_load_dwordx4 v0, s[16:19], s51 offen lds
    v_mfma_f32_16x16x32_bf16 v[68:71], v[108:111], v[112:115], v[68:71]
    s_add_u32 m0, s41, 81920
    s_add_u32 s51, s58, 262144
    buffer_load_dwordx4 v0, s[16:19], s51 offen lds
    v_mfma_f32_16x16x32_bf16 v[72:75], v[108:111], v[116:119], v[72:75]
    s_add_u32 m0, s41, 86016
    s_add_u32 s51, s58, 393216
    buffer_load_dwordx4 v0, s[16:19], s51 offen lds
    s_waitcnt lgkmcnt(0)
    v_mfma_f32_16x16x32_bf16 v[4:7], v[120:123], v[156:159], v[4:7]
    v_mfma_f32_16x16x32_bf16 v[8:11], v[120:123], v[160:163], v[8:11]
    v_mfma_f32_16x16x32_bf16 v[12:15], v[124:127], v[156:159], v[12:15]
    v_mfma_f32_16x16x32_bf16 v[16:19], v[124:127], v[160:163], v[16:19]
    s_add_u32 m0, s41, 90112
    s_add_u32 s51, s59, 0
    buffer_load_dwordx4 v1, s[20:23], s51 offen lds
    v_mfma_f32_16x16x32_bf16 v[20:23], v[128:131], v[156:159], v[20:23]
    v_mfma_f32_16x16x32_bf16 v[24:27], v[128:131], v[160:163], v[24:27]
    v_mfma_f32_16x16x32_bf16 v[28:31], v[132:135], v[156:159], v[28:31]
    v_mfma_f32_16x16x32_bf16 v[32:35], v[132:135], v[160:163], v[32:35]
    s_add_u32 m0, s41, 94208
    s_add_u32 s51, s59, 131072
    buffer_load_dwordx4 v1, s[20:23], s51 offen lds
    v_mfma_f32_16x16x32_bf16 v[36:39], v[136:139], v[156:159], v[36:39]
    v_mfma_f32_16x16x32_bf16 v[40:43], v[136:139], v[160:163], v[40:43]
    v_mfma_f32_16x16x32_bf16 v[44:47], v[140:143], v[156:159], v[44:47]
    s_add_u32 m0, s41, 98304
    s_add_u32 s51, s59, 262144
    buffer_load_dwordx4 v1, s[20:23], s51 offen lds
    v_mfma_f32_16x16x32_bf16 v[48:51], v[140:143], v[160:163], v[48:51]
    v_mfma_f32_16x16x32_bf16 v[52:55], v[144:147], v[156:159], v[52:55]
    v_mfma_f32_16x16x32_bf16 v[56:59], v[144:147], v[160:163], v[56:59]
    v_mfma_f32_16x16x32_bf16 v[60:63], v[148:151], v[156:159], v[60:63]
    s_add_u32 m0, s41, 102400
    s_add_u32 s51, s59, 393216
    buffer_load_dwordx4 v1, s[20:23], s51 offen lds
    v_mfma_f32_16x16x32_bf16 v[64:67], v[148:151], v[160:163], v[64:67]
    v_mfma_f32_16x16x32_bf16 v[68:71], v[152:155], v[156:159], v[68:71]
    v_mfma_f32_16x16x32_bf16 v[72:75], v[152:155], v[160:163], v[72:75]
    s_add_u32 m0, s41, 106496
    s_add_u32 s51, s59, 524288
    buffer_load_dwordx4 v1, s[20:23], s51 offen lds
    s_waitcnt vmcnt(9)
    s_barrier
    v_add_u32 v164, 36864, v164
    v_add_u32 v165, 36864, v165
    v_add_u32 v166, 36864, v166
    v_add_u32 v167, 36864, v167
    ds_read_b128 v[112:115], v166 offset:0
    ds_read_b128 v[116:119], v166 offset:2048
    ds_read_b128 v[76:79], v164 offset:16384
    ds_read_b128 v[80:83], v164 offset:18432
    ds_read_b128 v[84:87], v164 offset:20480
    ds_read_b128 v[88:91], v164 offset:22528
    ds_read_b128 v[92:95], v164 offset:24576
    ds_read_b128 v[96:99], v164 offset:26624
    ds_read_b128 v[100:103], v164 offset:28672
    ds_read_b128 v[104:107], v164 offset:30720
    ds_read_b128 v[108:111], v164 offset:32768
    s_waitcnt lgkmcnt(0)
    v_mfma_f32_16x16x32_bf16 v[4:7], v[76:79], v[112:115], v[4:7]
    v_mfma_f32_16x16x32_bf16 v[8:11], v[76:79], v[116:119], v[8:11]
    ds_read_b128 v[156:159], v167 offset:0
    v_mfma_f32_16x16x32_bf16 v[12:15], v[80:83], v[112:115], v[12:15]
    ds_read_b128 v[160:163], v167 offset:2048
    v_mfma_f32_16x16x32_bf16 v[16:19], v[80:83], v[116:119], v[16:19]
    ds_read_b128 v[120:123], v165 offset:16384
    v_mfma_f32_16x16x32_bf16 v[20:23], v[84:87], v[112:115], v[20:23]
    ds_read_b128 v[124:127], v165 offset:18432
    v_mfma_f32_16x16x32_bf16 v[24:27], v[84:87], v[116:119], v[24:27]
    ds_read_b128 v[128:131], v165 offset:20480
    v_mfma_f32_16x16x32_bf16 v[28:31], v[88:91], v[112:115], v[28:31]
    ds_read_b128 v[132:135], v165 offset:22528
    v_mfma_f32_16x16x32_bf16 v[32:35], v[88:91], v[116:119], v[32:35]
    ds_read_b128 v[136:139], v165 offset:24576
    v_mfma_f32_16x16x32_bf16 v[36:39], v[92:95], v[112:115], v[36:39]
    ds_read_b128 v[140:143], v165 offset:26624
    v_mfma_f32_16x16x32_bf16 v[40:43], v[92:95], v[116:119], v[40:43]
    v_mfma_f32_16x16x32_bf16 v[44:47], v[96:99], v[112:115], v[44:47]
    ds_read_b128 v[144:147], v165 offset:28672
    v_mfma_f32_16x16x32_bf16 v[48:51], v[96:99], v[116:119], v[48:51]
    ds_read_b128 v[148:151], v165 offset:30720
    v_mfma_f32_16x16x32_bf16 v[52:55], v[100:103], v[112:115], v[52:55]
    ds_read_b128 v[152:155], v165 offset:32768
    v_mfma_f32_16x16x32_bf16 v[56:59], v[100:103], v[116:119], v[56:59]
    s_add_u32 s58, s58, 128
    s_add_u32 s59, s59, 128
    v_mfma_f32_16x16x32_bf16 v[60:63], v[104:107], v[112:115], v[60:63]
    s_add_u32 m0, s41, 0
    s_add_u32 s51, s58, 0
    buffer_load_dwordx4 v0, s[16:19], s51 offen lds
    v_mfma_f32_16x16x32_bf16 v[64:67], v[104:107], v[116:119], v[64:67]
    s_add_u32 m0, s41, 4096
    s_add_u32 s51, s58, 131072
    buffer_load_dwordx4 v0, s[16:19], s51 offen lds
    v_mfma_f32_16x16x32_bf16 v[68:71], v[108:111], v[112:115], v[68:71]
    s_add_u32 m0, s41, 8192
    s_add_u32 s51, s58, 262144
    buffer_load_dwordx4 v0, s[16:19], s51 offen lds
    v_mfma_f32_16x16x32_bf16 v[72:75], v[108:111], v[116:119], v[72:75]
    s_add_u32 m0, s41, 12288
    s_add_u32 s51, s58, 393216
    buffer_load_dwordx4 v0, s[16:19], s51 offen lds
    s_waitcnt lgkmcnt(0)
    v_mfma_f32_16x16x32_bf16 v[4:7], v[120:123], v[156:159], v[4:7]
    v_mfma_f32_16x16x32_bf16 v[8:11], v[120:123], v[160:163], v[8:11]
    v_mfma_f32_16x16x32_bf16 v[12:15], v[124:127], v[156:159], v[12:15]
    v_mfma_f32_16x16x32_bf16 v[16:19], v[124:127], v[160:163], v[16:19]
    s_add_u32 m0, s41, 16384
    s_add_u32 s51, s59, 0
    buffer_load_dwordx4 v1, s[20:23], s51 offen lds
    v_mfma_f32_16x16x32_bf16 v[20:23], v[128:131], v[156:159], v[20:23]
    v_mfma_f32_16x16x32_bf16 v[24:27], v[128:131], v[160:163], v[24:27]
    v_mfma_f32_16x16x32_bf16 v[28:31], v[132:135], v[156:159], v[28:31]
    v_mfma_f32_16x16x32_bf16 v[32:35], v[132:135], v[160:163], v[32:35]
    s_add_u32 m0, s41, 20480
    s_add_u32 s51, s59, 131072
    buffer_load_dwordx4 v1, s[20:23], s51 offen lds
    v_mfma_f32_16x16x32_bf16 v[36:39], v[136:139], v[156:159], v[36:39]
    v_mfma_f32_16x16x32_bf16 v[40:43], v[136:139], v[160:163], v[40:43]
    v_mfma_f32_16x16x32_bf16 v[44:47], v[140:143], v[156:159], v[44:47]
    s_add_u32 m0, s41, 24576
    s_add_u32 s51, s59, 262144
    buffer_load_dwordx4 v1, s[20:23], s51 offen lds
    v_mfma_f32_16x16x32_bf16 v[48:51], v[140:143], v[160:163], v[48:51]
    v_mfma_f32_16x16x32_bf16 v[52:55], v[144:147], v[156:159], v[52:55]
    v_mfma_f32_16x16x32_bf16 v[56:59], v[144:147], v[160:163], v[56:59]
    v_mfma_f32_16x16x32_bf16 v[60:63], v[148:151], v[156:159], v[60:63]
    s_add_u32 m0, s41, 28672
    s_add_u32 s51, s59, 393216
    buffer_load_dwordx4 v1, s[20:23], s51 offen lds
    v_mfma_f32_16x16x32_bf16 v[64:67], v[148:151], v[160:163], v[64:67]
    v_mfma_f32_16x16x32_bf16 v[68:71], v[152:155], v[156:159], v[68:71]
    v_mfma_f32_16x16x32_bf16 v[72:75], v[152:155], v[160:163], v[72:75]
    s_add_u32 m0, s41, 32768
    s_add_u32 s51, s59, 524288
    buffer_load_dwordx4 v1, s[20:23], s51 offen lds
    s_waitcnt vmcnt(9)
    s_barrier
    v_add_u32 v164, 36864, v164
    v_add_u32 v165, 36864, v165
    v_add_u32 v166, 36864, v166
    v_add_u32 v167, 36864, v167
    ds_read_b128 v[112:115], v166 offset:0
    ds_read_b128 v[116:119], v166 offset:2048
    ds_read_b128 v[76:79], v164 offset:16384
    ds_read_b128 v[80:83], v164 offset:18432
    ds_read_b128 v[84:87], v164 offset:20480
    ds_read_b128 v[88:91], v164 offset:22528
    ds_read_b128 v[92:95], v164 offset:24576
    ds_read_b128 v[96:99], v164 offset:26624
    ds_read_b128 v[100:103], v164 offset:28672
    ds_read_b128 v[104:107], v164 offset:30720
    ds_read_b128 v[108:111], v164 offset:32768
    s_waitcnt lgkmcnt(0)
    v_mfma_f32_16x16x32_bf16 v[4:7], v[76:79], v[112:115], v[4:7]
    v_mfma_f32_16x16x32_bf16 v[8:11], v[76:79], v[116:119], v[8:11]
    ds_read_b128 v[156:159], v167 offset:0
    v_mfma_f32_16x16x32_bf16 v[12:15], v[80:83], v[112:115], v[12:15]
    ds_read_b128 v[160:163], v167 offset:2048
    v_mfma_f32_16x16x32_bf16 v[16:19], v[80:83], v[116:119], v[16:19]
    ds_read_b128 v[120:123], v165 offset:16384
    v_mfma_f32_16x16x32_bf16 v[20:23], v[84:87], v[112:115], v[20:23]
    ds_read_b128 v[124:127], v165 offset:18432
    v_mfma_f32_16x16x32_bf16 v[24:27], v[84:87], v[116:119], v[24:27]
    ds_read_b128 v[128:131], v165 offset:20480
    v_mfma_f32_16x16x32_bf16 v[28:31], v[88:91], v[112:115], v[28:31]
    ds_read_b128 v[132:135], v165 offset:22528
    v_mfma_f32_16x16x32_bf16 v[32:35], v[88:91], v[116:119], v[32:35]
    ds_read_b128 v[136:139], v165 offset:24576
    v_mfma_f32_16x16x32_bf16 v[36:39], v[92:95], v[112:115], v[36:39]
    ds_read_b128 v[140:143], v165 offset:26624
    v_mfma_f32_16x16x32_bf16 v[40:43], v[92:95], v[116:119], v[40:43]
    v_mfma_f32_16x16x32_bf16 v[44:47], v[96:99], v[112:115], v[44:47]
    ds_read_b128 v[144:147], v165 offset:28672
    v_mfma_f32_16x16x32_bf16 v[48:51], v[96:99], v[116:119], v[48:51]
    ds_read_b128 v[148:151], v165 offset:30720
    v_mfma_f32_16x16x32_bf16 v[52:55], v[100:103], v[112:115], v[52:55]
    ds_read_b128 v[152:155], v165 offset:32768
    v_mfma_f32_16x16x32_bf16 v[56:59], v[100:103], v[116:119], v[56:59]
    s_add_u32 s58, s58, 128
    s_add_u32 s59, s59, 128
    v_mfma_f32_16x16x32_bf16 v[60:63], v[104:107], v[112:115], v[60:63]
    s_add_u32 m0, s41, 36864
    s_add_u32 s51, s58, 0
    buffer_load_dwordx4 v0, s[16:19], s51 offen lds
    v_mfma_f32_16x16x32_bf16 v[64:67], v[104:107], v[116:119], v[64:67]
    s_add_u32 m0, s41, 40960
    s_add_u32 s51, s58, 131072
    buffer_load_dwordx4 v0, s[16:19], s51 offen lds
    v_mfma_f32_16x16x32_bf16 v[68:71], v[108:111], v[112:115], v[68:71]
    s_add_u32 m0, s41, 45056
    s_add_u32 s51, s58, 262144
    buffer_load_dwordx4 v0, s[16:19], s51 offen lds
    v_mfma_f32_16x16x32_bf16 v[72:75], v[108:111], v[116:119], v[72:75]
    s_add_u32 m0, s41, 49152
    s_add_u32 s51, s58, 393216
    buffer_load_dwordx4 v0, s[16:19], s51 offen lds
    s_waitcnt lgkmcnt(0)
    v_mfma_f32_16x16x32_bf16 v[4:7], v[120:123], v[156:159], v[4:7]
    v_mfma_f32_16x16x32_bf16 v[8:11], v[120:123], v[160:163], v[8:11]
    v_mfma_f32_16x16x32_bf16 v[12:15], v[124:127], v[156:159], v[12:15]
    v_mfma_f32_16x16x32_bf16 v[16:19], v[124:127], v[160:163], v[16:19]
    s_add_u32 m0, s41, 53248
    s_add_u32 s51, s59, 0
    buffer_load_dwordx4 v1, s[20:23], s51 offen lds
    v_mfma_f32_16x16x32_bf16 v[20:23], v[128:131], v[156:159], v[20:23]
    v_mfma_f32_16x16x32_bf16 v[24:27], v[128:131], v[160:163], v[24:27]
    v_mfma_f32_16x16x32_bf16 v[28:31], v[132:135], v[156:159], v[28:31]
    v_mfma_f32_16x16x32_bf16 v[32:35], v[132:135], v[160:163], v[32:35]
    s_add_u32 m0, s41, 57344
    s_add_u32 s51, s59, 131072
    buffer_load_dwordx4 v1, s[20:23], s51 offen lds
    v_mfma_f32_16x16x32_bf16 v[36:39], v[136:139], v[156:159], v[36:39]
    v_mfma_f32_16x16x32_bf16 v[40:43], v[136:139], v[160:163], v[40:43]
    v_mfma_f32_16x16x32_bf16 v[44:47], v[140:143], v[156:159], v[44:47]
    s_add_u32 m0, s41, 61440
    s_add_u32 s51, s59, 262144
    buffer_load_dwordx4 v1, s[20:23], s51 offen lds
    v_mfma_f32_16x16x32_bf16 v[48:51], v[140:143], v[160:163], v[48:51]
    v_mfma_f32_16x16x32_bf16 v[52:55], v[144:147], v[156:159], v[52:55]
    v_mfma_f32_16x16x32_bf16 v[56:59], v[144:147], v[160:163], v[56:59]
    v_mfma_f32_16x16x32_bf16 v[60:63], v[148:151], v[156:159], v[60:63]
    s_add_u32 m0, s41, 65536
    s_add_u32 s51, s59, 393216
    buffer_load_dwordx4 v1, s[20:23], s51 offen lds
    v_mfma_f32_16x16x32_bf16 v[64:67], v[148:151], v[160:163], v[64:67]
    v_mfma_f32_16x16x32_bf16 v[68:71], v[152:155], v[156:159], v[68:71]
    v_mfma_f32_16x16x32_bf16 v[72:75], v[152:155], v[160:163], v[72:75]
    s_add_u32 m0, s41, 69632
    s_add_u32 s51, s59, 524288
    buffer_load_dwordx4 v1, s[20:23], s51 offen lds
    s_waitcnt vmcnt(9)
    s_barrier
    v_subrev_u32 v164, 73728, v164
    v_subrev_u32 v165, 73728, v165
    v_subrev_u32 v166, 73728, v166
    v_subrev_u32 v167, 73728, v167
    ds_read_b128 v[112:115], v166 offset:0
    ds_read_b128 v[116:119], v166 offset:2048
    ds_read_b128 v[76:79], v164 offset:16384
    ds_read_b128 v[80:83], v164 offset:18432
    ds_read_b128 v[84:87], v164 offset:20480
    ds_read_b128 v[88:91], v164 offset:22528
    ds_read_b128 v[92:95], v164 offset:24576
    ds_read_b128 v[96:99], v164 offset:26624
    ds_read_b128 v[100:103], v164 offset:28672
    ds_read_b128 v[104:107], v164 offset:30720
    ds_read_b128 v[108:111], v164 offset:32768
    s_waitcnt lgkmcnt(0)
    v_mfma_f32_16x16x32_bf16 v[4:7], v[76:79], v[112:115], v[4:7]
    v_mfma_f32_16x16x32_bf16 v[8:11], v[76:79], v[116:119], v[8:11]
    ds_read_b128 v[156:159], v167 offset:0
    v_mfma_f32_16x16x32_bf16 v[12:15], v[80:83], v[112:115], v[12:15]
    ds_read_b128 v[160:163], v167 offset:2048
    v_mfma_f32_16x16x32_bf16 v[16:19], v[80:83], v[116:119], v[16:19]
    ds_read_b128 v[120:123], v165 offset:16384
    v_mfma_f32_16x16x32_bf16 v[20:23], v[84:87], v[112:115], v[20:23]
    ds_read_b128 v[124:127], v165 offset:18432
    v_mfma_f32_16x16x32_bf16 v[24:27], v[84:87], v[116:119], v[24:27]
    ds_read_b128 v[128:131], v165 offset:20480
    v_mfma_f32_16x16x32_bf16 v[28:31], v[88:91], v[112:115], v[28:31]
    ds_read_b128 v[132:135], v165 offset:22528
    v_mfma_f32_16x16x32_bf16 v[32:35], v[88:91], v[116:119], v[32:35]
    ds_read_b128 v[136:139], v165 offset:24576
    v_mfma_f32_16x16x32_bf16 v[36:39], v[92:95], v[112:115], v[36:39]
    ds_read_b128 v[140:143], v165 offset:26624
    v_mfma_f32_16x16x32_bf16 v[40:43], v[92:95], v[116:119], v[40:43]
    v_mfma_f32_16x16x32_bf16 v[44:47], v[96:99], v[112:115], v[44:47]
    ds_read_b128 v[144:147], v165 offset:28672
    v_mfma_f32_16x16x32_bf16 v[48:51], v[96:99], v[116:119], v[48:51]
    ds_read_b128 v[148:151], v165 offset:30720
    v_mfma_f32_16x16x32_bf16 v[52:55], v[100:103], v[112:115], v[52:55]
    ds_read_b128 v[152:155], v165 offset:32768
    v_mfma_f32_16x16x32_bf16 v[56:59], v[100:103], v[116:119], v[56:59]
    s_add_u32 s58, s58, 128
    s_add_u32 s59, s59, 128
    v_mfma_f32_16x16x32_bf16 v[60:63], v[104:107], v[112:115], v[60:63]
    s_add_u32 m0, s41, 73728
    s_add_u32 s51, s58, 0
    buffer_load_dwordx4 v0, s[16:19], s51 offen lds
    v_mfma_f32_16x16x32_bf16 v[64:67], v[104:107], v[116:119], v[64:67]
    s_add_u32 m0, s41, 77824
    s_add_u32 s51, s58, 131072
    buffer_load_dwordx4 v0, s[16:19], s51 offen lds
    v_mfma_f32_16x16x32_bf16 v[68:71], v[108:111], v[112:115], v[68:71]
    s_add_u32 m0, s41, 81920
    s_add_u32 s51, s58, 262144
    buffer_load_dwordx4 v0, s[16:19], s51 offen lds
    v_mfma_f32_16x16x32_bf16 v[72:75], v[108:111], v[116:119], v[72:75]
    s_add_u32 m0, s41, 86016
    s_add_u32 s51, s58, 393216
    buffer_load_dwordx4 v0, s[16:19], s51 offen lds
    s_waitcnt lgkmcnt(0)
    v_mfma_f32_16x16x32_bf16 v[4:7], v[120:123], v[156:159], v[4:7]
    v_mfma_f32_16x16x32_bf16 v[8:11], v[120:123], v[160:163], v[8:11]
    v_mfma_f32_16x16x32_bf16 v[12:15], v[124:127], v[156:159], v[12:15]
    v_mfma_f32_16x16x32_bf16 v[16:19], v[124:127], v[160:163], v[16:19]
    s_add_u32 m0, s41, 90112
    s_add_u32 s51, s59, 0
    buffer_load_dwordx4 v1, s[20:23], s51 offen lds
    v_mfma_f32_16x16x32_bf16 v[20:23], v[128:131], v[156:159], v[20:23]
    v_mfma_f32_16x16x32_bf16 v[24:27], v[128:131], v[160:163], v[24:27]
    v_mfma_f32_16x16x32_bf16 v[28:31], v[132:135], v[156:159], v[28:31]
    v_mfma_f32_16x16x32_bf16 v[32:35], v[132:135], v[160:163], v[32:35]
    s_add_u32 m0, s41, 94208
    s_add_u32 s51, s59, 131072
    buffer_load_dwordx4 v1, s[20:23], s51 offen lds
    v_mfma_f32_16x16x32_bf16 v[36:39], v[136:139], v[156:159], v[36:39]
    v_mfma_f32_16x16x32_bf16 v[40:43], v[136:139], v[160:163], v[40:43]
    v_mfma_f32_16x16x32_bf16 v[44:47], v[140:143], v[156:159], v[44:47]
    s_add_u32 m0, s41, 98304
    s_add_u32 s51, s59, 262144
    buffer_load_dwordx4 v1, s[20:23], s51 offen lds
    v_mfma_f32_16x16x32_bf16 v[48:51], v[140:143], v[160:163], v[48:51]
    v_mfma_f32_16x16x32_bf16 v[52:55], v[144:147], v[156:159], v[52:55]
    v_mfma_f32_16x16x32_bf16 v[56:59], v[144:147], v[160:163], v[56:59]
    v_mfma_f32_16x16x32_bf16 v[60:63], v[148:151], v[156:159], v[60:63]
    s_add_u32 m0, s41, 102400
    s_add_u32 s51, s59, 393216
    buffer_load_dwordx4 v1, s[20:23], s51 offen lds
    v_mfma_f32_16x16x32_bf16 v[64:67], v[148:151], v[160:163], v[64:67]
    v_mfma_f32_16x16x32_bf16 v[68:71], v[152:155], v[156:159], v[68:71]
    v_mfma_f32_16x16x32_bf16 v[72:75], v[152:155], v[160:163], v[72:75]
    s_add_u32 m0, s41, 106496
    s_add_u32 s51, s59, 524288
    buffer_load_dwordx4 v1, s[20:23], s51 offen lds
    s_waitcnt vmcnt(9)
    s_barrier
    v_add_u32 v164, 36864, v164
    v_add_u32 v165, 36864, v165
    v_add_u32 v166, 36864, v166
    v_add_u32 v167, 36864, v167
    ds_read_b128 v[112:115], v166 offset:0
    ds_read_b128 v[116:119], v166 offset:2048
    ds_read_b128 v[76:79], v164 offset:16384
    ds_read_b128 v[80:83], v164 offset:18432
    ds_read_b128 v[84:87], v164 offset:20480
    ds_read_b128 v[88:91], v164 offset:22528
    ds_read_b128 v[92:95], v164 offset:24576
    ds_read_b128 v[96:99], v164 offset:26624
    ds_read_b128 v[100:103], v164 offset:28672
    ds_read_b128 v[104:107], v164 offset:30720
    ds_read_b128 v[108:111], v164 offset:32768
    s_waitcnt lgkmcnt(0)
    v_mfma_f32_16x16x32_bf16 v[4:7], v[76:79], v[112:115], v[4:7]
    v_mfma_f32_16x16x32_bf16 v[8:11], v[76:79], v[116:119], v[8:11]
    ds_read_b128 v[156:159], v167 offset:0
    v_mfma_f32_16x16x32_bf16 v[12:15], v[80:83], v[112:115], v[12:15]
    ds_read_b128 v[160:163], v167 offset:2048
    v_mfma_f32_16x16x32_bf16 v[16:19], v[80:83], v[116:119], v[16:19]
    ds_read_b128 v[120:123], v165 offset:16384
    v_mfma_f32_16x16x32_bf16 v[20:23], v[84:87], v[112:115], v[20:23]
    ds_read_b128 v[124:127], v165 offset:18432
    v_mfma_f32_16x16x32_bf16 v[24:27], v[84:87], v[116:119], v[24:27]
    ds_read_b128 v[128:131], v165 offset:20480
    v_mfma_f32_16x16x32_bf16 v[28:31], v[88:91], v[112:115], v[28:31]
    ds_read_b128 v[132:135], v165 offset:22528
    v_mfma_f32_16x16x32_bf16 v[32:35], v[88:91], v[116:119], v[32:35]
    ds_read_b128 v[136:139], v165 offset:24576
    v_mfma_f32_16x16x32_bf16 v[36:39], v[92:95], v[112:115], v[36:39]
    ds_read_b128 v[140:143], v165 offset:26624
    v_mfma_f32_16x16x32_bf16 v[40:43], v[92:95], v[116:119], v[40:43]
    v_mfma_f32_16x16x32_bf16 v[44:47], v[96:99], v[112:115], v[44:47]
    ds_read_b128 v[144:147], v165 offset:28672
    v_mfma_f32_16x16x32_bf16 v[48:51], v[96:99], v[116:119], v[48:51]
    ds_read_b128 v[148:151], v165 offset:30720
    v_mfma_f32_16x16x32_bf16 v[52:55], v[100:103], v[112:115], v[52:55]
    ds_read_b128 v[152:155], v165 offset:32768
    v_mfma_f32_16x16x32_bf16 v[56:59], v[100:103], v[116:119], v[56:59]
    s_add_u32 s58, s58, 128
    s_add_u32 s59, s59, 128
    v_mfma_f32_16x16x32_bf16 v[60:63], v[104:107], v[112:115], v[60:63]
    s_add_u32 m0, s41, 0
    s_add_u32 s51, s58, 0
    buffer_load_dwordx4 v0, s[16:19], s51 offen lds
    v_mfma_f32_16x16x32_bf16 v[64:67], v[104:107], v[116:119], v[64:67]
    s_add_u32 m0, s41, 4096
    s_add_u32 s51, s58, 131072
    buffer_load_dwordx4 v0, s[16:19], s51 offen lds
    v_mfma_f32_16x16x32_bf16 v[68:71], v[108:111], v[112:115], v[68:71]
    s_add_u32 m0, s41, 8192
    s_add_u32 s51, s58, 262144
    buffer_load_dwordx4 v0, s[16:19], s51 offen lds
    v_mfma_f32_16x16x32_bf16 v[72:75], v[108:111], v[116:119], v[72:75]
    s_add_u32 m0, s41, 12288
    s_add_u32 s51, s58, 393216
    buffer_load_dwordx4 v0, s[16:19], s51 offen lds
    s_waitcnt lgkmcnt(0)
    v_mfma_f32_16x16x32_bf16 v[4:7], v[120:123], v[156:159], v[4:7]
    v_mfma_f32_16x16x32_bf16 v[8:11], v[120:123], v[160:163], v[8:11]
    v_mfma_f32_16x16x32_bf16 v[12:15], v[124:127], v[156:159], v[12:15]
    v_mfma_f32_16x16x32_bf16 v[16:19], v[124:127], v[160:163], v[16:19]
    s_add_u32 m0, s41, 16384
    s_add_u32 s51, s59, 0
    buffer_load_dwordx4 v1, s[20:23], s51 offen lds
    v_mfma_f32_16x16x32_bf16 v[20:23], v[128:131], v[156:159], v[20:23]
    v_mfma_f32_16x16x32_bf16 v[24:27], v[128:131], v[160:163], v[24:27]
    v_mfma_f32_16x16x32_bf16 v[28:31], v[132:135], v[156:159], v[28:31]
    v_mfma_f32_16x16x32_bf16 v[32:35], v[132:135], v[160:163], v[32:35]
    s_add_u32 m0, s41, 20480
    s_add_u32 s51, s59, 131072
    buffer_load_dwordx4 v1, s[20:23], s51 offen lds
    v_mfma_f32_16x16x32_bf16 v[36:39], v[136:139], v[156:159], v[36:39]
    v_mfma_f32_16x16x32_bf16 v[40:43], v[136:139], v[160:163], v[40:43]
    v_mfma_f32_16x16x32_bf16 v[44:47], v[140:143], v[156:159], v[44:47]
    s_add_u32 m0, s41, 24576
    s_add_u32 s51, s59, 262144
    buffer_load_dwordx4 v1, s[20:23], s51 offen lds
    v_mfma_f32_16x16x32_bf16 v[48:51], v[140:143], v[160:163], v[48:51]
    v_mfma_f32_16x16x32_bf16 v[52:55], v[144:147], v[156:159], v[52:55]
    v_mfma_f32_16x16x32_bf16 v[56:59], v[144:147], v[160:163], v[56:59]
    v_mfma_f32_16x16x32_bf16 v[60:63], v[148:151], v[156:159], v[60:63]
    s_add_u32 m0, s41, 28672
    s_add_u32 s51, s59, 393216
    buffer_load_dwordx4 v1, s[20:23], s51 offen lds
    v_mfma_f32_16x16x32_bf16 v[64:67], v[148:151], v[160:163], v[64:67]
    v_mfma_f32_16x16x32_bf16 v[68:71], v[152:155], v[156:159], v[68:71]
    v_mfma_f32_16x16x32_bf16 v[72:75], v[152:155], v[160:163], v[72:75]
    s_add_u32 m0, s41, 32768
    s_add_u32 s51, s59, 524288
    buffer_load_dwordx4 v1, s[20:23], s51 offen lds
    s_waitcnt vmcnt(9)
    s_barrier
    v_add_u32 v164, 36864, v164
    v_add_u32 v165, 36864, v165
    v_add_u32 v166, 36864, v166
    v_add_u32 v167, 36864, v167
    ds_read_b128 v[112:115], v166 offset:0
    ds_read_b128 v[116:119], v166 offset:2048
    ds_read_b128 v[76:79], v164 offset:16384
    ds_read_b128 v[80:83], v164 offset:18432
    ds_read_b128 v[84:87], v164 offset:20480
    ds_read_b128 v[88:91], v164 offset:22528
    ds_read_b128 v[92:95], v164 offset:24576
    ds_read_b128 v[96:99], v164 offset:26624
    ds_read_b128 v[100:103], v164 offset:28672
    ds_read_b128 v[104:107], v164 offset:30720
    ds_read_b128 v[108:111], v164 offset:32768
    s_waitcnt lgkmcnt(0)
    v_mfma_f32_16x16x32_bf16 v[4:7], v[76:79], v[112:115], v[4:7]
    v_mfma_f32_16x16x32_bf16 v[8:11], v[76:79], v[116:119], v[8:11]
    ds_read_b128 v[156:159], v167 offset:0
    v_mfma_f32_16x16x32_bf16 v[12:15], v[80:83], v[112:115], v[12:15]
    ds_read_b128 v[160:163], v167 offset:2048
    v_mfma_f32_16x16x32_bf16 v[16:19], v[80:83], v[116:119], v[16:19]
    ds_read_b128 v[120:123], v165 offset:16384
    v_mfma_f32_16x16x32_bf16 v[20:23], v[84:87], v[112:115], v[20:23]
    ds_read_b128 v[124:127], v165 offset:18432
    v_mfma_f32_16x16x32_bf16 v[24:27], v[84:87], v[116:119], v[24:27]
    ds_read_b128 v[128:131], v165 offset:20480
    v_mfma_f32_16x16x32_bf16 v[28:31], v[88:91], v[112:115], v[28:31]
    ds_read_b128 v[132:135], v165 offset:22528
    v_mfma_f32_16x16x32_bf16 v[32:35], v[88:91], v[116:119], v[32:35]
    ds_read_b128 v[136:139], v165 offset:24576
    v_mfma_f32_16x16x32_bf16 v[36:39], v[92:95], v[112:115], v[36:39]
    ds_read_b128 v[140:143], v165 offset:26624
    v_mfma_f32_16x16x32_bf16 v[40:43], v[92:95], v[116:119], v[40:43]
    v_mfma_f32_16x16x32_bf16 v[44:47], v[96:99], v[112:115], v[44:47]
    ds_read_b128 v[144:147], v165 offset:28672
    v_mfma_f32_16x16x32_bf16 v[48:51], v[96:99], v[116:119], v[48:51]
    ds_read_b128 v[148:151], v165 offset:30720
    v_mfma_f32_16x16x32_bf16 v[52:55], v[100:103], v[112:115], v[52:55]
    ds_read_b128 v[152:155], v165 offset:32768
    v_mfma_f32_16x16x32_bf16 v[56:59], v[100:103], v[116:119], v[56:59]
    s_add_u32 s58, s58, 128
    s_add_u32 s59, s59, 128
    v_mfma_f32_16x16x32_bf16 v[60:63], v[104:107], v[112:115], v[60:63]
    s_add_u32 m0, s41, 36864
    s_add_u32 s51, s58, 0
    buffer_load_dwordx4 v0, s[16:19], s51 offen lds
    v_mfma_f32_16x16x32_bf16 v[64:67], v[104:107], v[116:119], v[64:67]
    s_add_u32 m0, s41, 40960
    s_add_u32 s51, s58, 131072
    buffer_load_dwordx4 v0, s[16:19], s51 offen lds
    v_mfma_f32_16x16x32_bf16 v[68:71], v[108:111], v[112:115], v[68:71]
    s_add_u32 m0, s41, 45056
    s_add_u32 s51, s58, 262144
    buffer_load_dwordx4 v0, s[16:19], s51 offen lds
    v_mfma_f32_16x16x32_bf16 v[72:75], v[108:111], v[116:119], v[72:75]
    s_add_u32 m0, s41, 49152
    s_add_u32 s51, s58, 393216
    buffer_load_dwordx4 v0, s[16:19], s51 offen lds
    s_waitcnt lgkmcnt(0)
    v_mfma_f32_16x16x32_bf16 v[4:7], v[120:123], v[156:159], v[4:7]
    v_mfma_f32_16x16x32_bf16 v[8:11], v[120:123], v[160:163], v[8:11]
    v_mfma_f32_16x16x32_bf16 v[12:15], v[124:127], v[156:159], v[12:15]
    v_mfma_f32_16x16x32_bf16 v[16:19], v[124:127], v[160:163], v[16:19]
    s_add_u32 m0, s41, 53248
    s_add_u32 s51, s59, 0
    buffer_load_dwordx4 v1, s[20:23], s51 offen lds
    v_mfma_f32_16x16x32_bf16 v[20:23], v[128:131], v[156:159], v[20:23]
    v_mfma_f32_16x16x32_bf16 v[24:27], v[128:131], v[160:163], v[24:27]
    v_mfma_f32_16x16x32_bf16 v[28:31], v[132:135], v[156:159], v[28:31]
    v_mfma_f32_16x16x32_bf16 v[32:35], v[132:135], v[160:163], v[32:35]
    s_add_u32 m0, s41, 57344
    s_add_u32 s51, s59, 131072
    buffer_load_dwordx4 v1, s[20:23], s51 offen lds
    v_mfma_f32_16x16x32_bf16 v[36:39], v[136:139], v[156:159], v[36:39]
    v_mfma_f32_16x16x32_bf16 v[40:43], v[136:139], v[160:163], v[40:43]
    v_mfma_f32_16x16x32_bf16 v[44:47], v[140:143], v[156:159], v[44:47]
    s_add_u32 m0, s41, 61440
    s_add_u32 s51, s59, 262144
    buffer_load_dwordx4 v1, s[20:23], s51 offen lds
    v_mfma_f32_16x16x32_bf16 v[48:51], v[140:143], v[160:163], v[48:51]
    v_mfma_f32_16x16x32_bf16 v[52:55], v[144:147], v[156:159], v[52:55]
    v_mfma_f32_16x16x32_bf16 v[56:59], v[144:147], v[160:163], v[56:59]
    v_mfma_f32_16x16x32_bf16 v[60:63], v[148:151], v[156:159], v[60:63]
    s_add_u32 m0, s41, 65536
    s_add_u32 s51, s59, 393216
    buffer_load_dwordx4 v1, s[20:23], s51 offen lds
    v_mfma_f32_16x16x32_bf16 v[64:67], v[148:151], v[160:163], v[64:67]
    v_mfma_f32_16x16x32_bf16 v[68:71], v[152:155], v[156:159], v[68:71]
    v_mfma_f32_16x16x32_bf16 v[72:75], v[152:155], v[160:163], v[72:75]
    s_add_u32 m0, s41, 69632
    s_add_u32 s51, s59, 524288
    buffer_load_dwordx4 v1, s[20:23], s51 offen lds
    s_waitcnt vmcnt(9)
    s_barrier
    v_subrev_u32 v164, 73728, v164
    v_subrev_u32 v165, 73728, v165
    v_subrev_u32 v166, 73728, v166
    v_subrev_u32 v167, 73728, v167
    ds_read_b128 v[112:115], v166 offset:0
    ds_read_b128 v[116:119], v166 offset:2048
    ds_read_b128 v[76:79], v164 offset:16384
    ds_read_b128 v[80:83], v164 offset:18432
    ds_read_b128 v[84:87], v164 offset:20480
    ds_read_b128 v[88:91], v164 offset:22528
    ds_read_b128 v[92:95], v164 offset:24576
    ds_read_b128 v[96:99], v164 offset:26624
    ds_read_b128 v[100:103], v164 offset:28672
    ds_read_b128 v[104:107], v164 offset:30720
    ds_read_b128 v[108:111], v164 offset:32768
    s_waitcnt lgkmcnt(0)
    v_mfma_f32_16x16x32_bf16 v[4:7], v[76:79], v[112:115], v[4:7]
    v_mfma_f32_16x16x32_bf16 v[8:11], v[76:79], v[116:119], v[8:11]
    ds_read_b128 v[156:159], v167 offset:0
    v_mfma_f32_16x16x32_bf16 v[12:15], v[80:83], v[112:115], v[12:15]
    v_mfma_f32_16x16x32_bf16 v[16:19], v[80:83], v[116:119], v[16:19]
    ds_read_b128 v[160:163], v167 offset:2048
    v_mfma_f32_16x16x32_bf16 v[20:23], v[84:87], v[112:115], v[20:23]
    ds_read_b128 v[120:123], v165 offset:16384
    v_mfma_f32_16x16x32_bf16 v[24:27], v[84:87], v[116:119], v[24:27]
    v_mfma_f32_16x16x32_bf16 v[28:31], v[88:91], v[112:115], v[28:31]
    ds_read_b128 v[124:127], v165 offset:18432
    v_mfma_f32_16x16x32_bf16 v[32:35], v[88:91], v[116:119], v[32:35]
    v_mfma_f32_16x16x32_bf16 v[36:39], v[92:95], v[112:115], v[36:39]
    ds_read_b128 v[128:131], v165 offset:20480
    v_mfma_f32_16x16x32_bf16 v[40:43], v[92:95], v[116:119], v[40:43]
    ds_read_b128 v[132:135], v165 offset:22528
    v_mfma_f32_16x16x32_bf16 v[44:47], v[96:99], v[112:115], v[44:47]
    v_mfma_f32_16x16x32_bf16 v[48:51], v[96:99], v[116:119], v[48:51]
    ds_read_b128 v[136:139], v165 offset:24576
    v_mfma_f32_16x16x32_bf16 v[52:55], v[100:103], v[112:115], v[52:55]
    v_mfma_f32_16x16x32_bf16 v[56:59], v[100:103], v[116:119], v[56:59]
    ds_read_b128 v[140:143], v165 offset:26624
    v_mfma_f32_16x16x32_bf16 v[60:63], v[104:107], v[112:115], v[60:63]
    ds_read_b128 v[144:147], v165 offset:28672
    v_mfma_f32_16x16x32_bf16 v[64:67], v[104:107], v[116:119], v[64:67]
    v_mfma_f32_16x16x32_bf16 v[68:71], v[108:111], v[112:115], v[68:71]
    ds_read_b128 v[148:151], v165 offset:30720
    v_mfma_f32_16x16x32_bf16 v[72:75], v[108:111], v[116:119], v[72:75]
    ds_read_b128 v[152:155], v165 offset:32768
    s_waitcnt lgkmcnt(0)
    v_mfma_f32_16x16x32_bf16 v[4:7], v[120:123], v[156:159], v[4:7]
    v_mfma_f32_16x16x32_bf16 v[8:11], v[120:123], v[160:163], v[8:11]
    v_mfma_f32_16x16x32_bf16 v[12:15], v[124:127], v[156:159], v[12:15]
    v_mfma_f32_16x16x32_bf16 v[16:19], v[124:127], v[160:163], v[16:19]
    v_mfma_f32_16x16x32_bf16 v[20:23], v[128:131], v[156:159], v[20:23]
    v_mfma_f32_16x16x32_bf16 v[24:27], v[128:131], v[160:163], v[24:27]
    v_mfma_f32_16x16x32_bf16 v[28:31], v[132:135], v[156:159], v[28:31]
    v_mfma_f32_16x16x32_bf16 v[32:35], v[132:135], v[160:163], v[32:35]
    v_mfma_f32_16x16x32_bf16 v[36:39], v[136:139], v[156:159], v[36:39]
    v_mfma_f32_16x16x32_bf16 v[40:43], v[136:139], v[160:163], v[40:43]
    v_mfma_f32_16x16x32_bf16 v[44:47], v[140:143], v[156:159], v[44:47]
    v_mfma_f32_16x16x32_bf16 v[48:51], v[140:143], v[160:163], v[48:51]
    v_mfma_f32_16x16x32_bf16 v[52:55], v[144:147], v[156:159], v[52:55]
    v_mfma_f32_16x16x32_bf16 v[56:59], v[144:147], v[160:163], v[56:59]
    v_mfma_f32_16x16x32_bf16 v[60:63], v[148:151], v[156:159], v[60:63]
    v_mfma_f32_16x16x32_bf16 v[64:67], v[148:151], v[160:163], v[64:67]
    v_mfma_f32_16x16x32_bf16 v[68:71], v[152:155], v[156:159], v[68:71]
    v_mfma_f32_16x16x32_bf16 v[72:75], v[152:155], v[160:163], v[72:75]
    s_waitcnt vmcnt(0)
    s_barrier
    v_add_u32 v164, 36864, v164
    v_add_u32 v165, 36864, v165
    v_add_u32 v166, 36864, v166
    v_add_u32 v167, 36864, v167
    ds_read_b128 v[112:115], v166 offset:0
    ds_read_b128 v[116:119], v166 offset:2048
    ds_read_b128 v[76:79], v164 offset:16384
    ds_read_b128 v[80:83], v164 offset:18432
    ds_read_b128 v[84:87], v164 offset:20480
    ds_read_b128 v[88:91], v164 offset:22528
    ds_read_b128 v[92:95], v164 offset:24576
    ds_read_b128 v[96:99], v164 offset:26624
    ds_read_b128 v[100:103], v164 offset:28672
    ds_read_b128 v[104:107], v164 offset:30720
    ds_read_b128 v[108:111], v164 offset:32768
    s_waitcnt lgkmcnt(0)
    v_mfma_f32_16x16x32_bf16 v[4:7], v[76:79], v[112:115], v[4:7]
    v_mfma_f32_16x16x32_bf16 v[8:11], v[76:79], v[116:119], v[8:11]
    ds_read_b128 v[156:159], v167 offset:0
    v_mfma_f32_16x16x32_bf16 v[12:15], v[80:83], v[112:115], v[12:15]
    v_mfma_f32_16x16x32_bf16 v[16:19], v[80:83], v[116:119], v[16:19]
    ds_read_b128 v[160:163], v167 offset:2048
    v_mfma_f32_16x16x32_bf16 v[20:23], v[84:87], v[112:115], v[20:23]
    ds_read_b128 v[120:123], v165 offset:16384
    v_mfma_f32_16x16x32_bf16 v[24:27], v[84:87], v[116:119], v[24:27]
    v_mfma_f32_16x16x32_bf16 v[28:31], v[88:91], v[112:115], v[28:31]
    ds_read_b128 v[124:127], v165 offset:18432
    v_mfma_f32_16x16x32_bf16 v[32:35], v[88:91], v[116:119], v[32:35]
    v_mfma_f32_16x16x32_bf16 v[36:39], v[92:95], v[112:115], v[36:39]
    ds_read_b128 v[128:131], v165 offset:20480
    v_mfma_f32_16x16x32_bf16 v[40:43], v[92:95], v[116:119], v[40:43]
    ds_read_b128 v[132:135], v165 offset:22528
    v_mfma_f32_16x16x32_bf16 v[44:47], v[96:99], v[112:115], v[44:47]
    v_mfma_f32_16x16x32_bf16 v[48:51], v[96:99], v[116:119], v[48:51]
    ds_read_b128 v[136:139], v165 offset:24576
    v_mfma_f32_16x16x32_bf16 v[52:55], v[100:103], v[112:115], v[52:55]
    v_mfma_f32_16x16x32_bf16 v[56:59], v[100:103], v[116:119], v[56:59]
    ds_read_b128 v[140:143], v165 offset:26624
    v_mfma_f32_16x16x32_bf16 v[60:63], v[104:107], v[112:115], v[60:63]
    ds_read_b128 v[144:147], v165 offset:28672
    v_mfma_f32_16x16x32_bf16 v[64:67], v[104:107], v[116:119], v[64:67]
    v_mfma_f32_16x16x32_bf16 v[68:71], v[108:111], v[112:115], v[68:71]
    ds_read_b128 v[148:151], v165 offset:30720
    v_mfma_f32_16x16x32_bf16 v[72:75], v[108:111], v[116:119], v[72:75]
    ds_read_b128 v[152:155], v165 offset:32768
    s_waitcnt lgkmcnt(0)
    v_mfma_f32_16x16x32_bf16 v[4:7], v[120:123], v[156:159], v[4:7]
    v_mfma_f32_16x16x32_bf16 v[8:11], v[120:123], v[160:163], v[8:11]
    v_mfma_f32_16x16x32_bf16 v[12:15], v[124:127], v[156:159], v[12:15]
    v_mfma_f32_16x16x32_bf16 v[16:19], v[124:127], v[160:163], v[16:19]
    v_mfma_f32_16x16x32_bf16 v[20:23], v[128:131], v[156:159], v[20:23]
    v_mfma_f32_16x16x32_bf16 v[24:27], v[128:131], v[160:163], v[24:27]
    v_mfma_f32_16x16x32_bf16 v[28:31], v[132:135], v[156:159], v[28:31]
    v_mfma_f32_16x16x32_bf16 v[32:35], v[132:135], v[160:163], v[32:35]
    v_mfma_f32_16x16x32_bf16 v[36:39], v[136:139], v[156:159], v[36:39]
    v_mfma_f32_16x16x32_bf16 v[40:43], v[136:139], v[160:163], v[40:43]
    v_mfma_f32_16x16x32_bf16 v[44:47], v[140:143], v[156:159], v[44:47]
    v_mfma_f32_16x16x32_bf16 v[48:51], v[140:143], v[160:163], v[48:51]
    v_mfma_f32_16x16x32_bf16 v[52:55], v[144:147], v[156:159], v[52:55]
    v_mfma_f32_16x16x32_bf16 v[56:59], v[144:147], v[160:163], v[56:59]
    v_mfma_f32_16x16x32_bf16 v[60:63], v[148:151], v[156:159], v[60:63]
    v_mfma_f32_16x16x32_bf16 v[64:67], v[148:151], v[160:163], v[64:67]
    v_mfma_f32_16x16x32_bf16 v[68:71], v[152:155], v[156:159], v[68:71]
    v_mfma_f32_16x16x32_bf16 v[72:75], v[152:155], v[160:163], v[72:75]
    s_waitcnt vmcnt(0)
    s_barrier
    s_nop 7
    s_nop 7
    v_and_b32 v249, 15, v250
    s_lshl_b32 s55, s45, 7
    s_lshl_b32 s56, s40, 5
    s_add_u32 s55, s55, s56
    v_add_u32 v249, s55, v249
    s_movk_i32 s56, 1152
    v_mul_lo_u32 v249, v249, s56
    v_lshrrev_b32 v248, 4, v250
    v_lshlrev_b32 v248, 3, v248
    v_add_u32 v249, v249, v248
    s_mul_i32 s55, s44, 288
    v_add_u32 v249, s55, v249
    v_cvt_pk_bf16_f32 v168, v4, v5
    v_cvt_pk_bf16_f32 v169, v6, v7
    s_mov_b32 s55, 0
    buffer_store_dwordx2 v[168:169], v249, s[28:31], s55 offen offset:0
    s_nop 1
    v_cvt_pk_bf16_f32 v168, v8, v9
    v_cvt_pk_bf16_f32 v169, v10, v11
    s_mov_b32 s55, 18432
    buffer_store_dwordx2 v[168:169], v249, s[28:31], s55 offen offset:0
    s_nop 1
    v_cvt_pk_bf16_f32 v168, v12, v13
    v_cvt_pk_bf16_f32 v169, v14, v15
    s_mov_b32 s55, 0
    buffer_store_dwordx2 v[168:169], v249, s[28:31], s55 offen offset:32
    s_nop 1
    v_cvt_pk_bf16_f32 v168, v16, v17
    v_cvt_pk_bf16_f32 v169, v18, v19
    s_mov_b32 s55, 18432
    buffer_store_dwordx2 v[168:169], v249, s[28:31], s55 offen offset:32
    s_nop 1
    v_cvt_pk_bf16_f32 v168, v20, v21
    v_cvt_pk_bf16_f32 v169, v22, v23
    s_mov_b32 s55, 0
    buffer_store_dwordx2 v[168:169], v249, s[28:31], s55 offen offset:64
    s_nop 1
    v_cvt_pk_bf16_f32 v168, v24, v25
    v_cvt_pk_bf16_f32 v169, v26, v27
    s_mov_b32 s55, 18432
    buffer_store_dwordx2 v[168:169], v249, s[28:31], s55 offen offset:64
    s_nop 1
    v_cvt_pk_bf16_f32 v168, v28, v29
    v_cvt_pk_bf16_f32 v169, v30, v31
    s_mov_b32 s55, 0
    buffer_store_dwordx2 v[168:169], v249, s[28:31], s55 offen offset:96
    s_nop 1
    v_cvt_pk_bf16_f32 v168, v32, v33
    v_cvt_pk_bf16_f32 v169, v34, v35
    s_mov_b32 s55, 18432
    buffer_store_dwordx2 v[168:169], v249, s[28:31], s55 offen offset:96
    s_nop 1
    v_cvt_pk_bf16_f32 v168, v36, v37
    v_cvt_pk_bf16_f32 v169, v38, v39
    s_mov_b32 s55, 0
    buffer_store_dwordx2 v[168:169], v249, s[28:31], s55 offen offset:128
    s_nop 1
    v_cvt_pk_bf16_f32 v168, v40, v41
    v_cvt_pk_bf16_f32 v169, v42, v43
    s_mov_b32 s55, 18432
    buffer_store_dwordx2 v[168:169], v249, s[28:31], s55 offen offset:128
    s_nop 1
    v_cvt_pk_bf16_f32 v168, v44, v45
    v_cvt_pk_bf16_f32 v169, v46, v47
    s_mov_b32 s55, 0
    buffer_store_dwordx2 v[168:169], v249, s[28:31], s55 offen offset:160
    s_nop 1
    v_cvt_pk_bf16_f32 v168, v48, v49
    v_cvt_pk_bf16_f32 v169, v50, v51
    s_mov_b32 s55, 18432
    buffer_store_dwordx2 v[168:169], v249, s[28:31], s55 offen offset:160
    s_nop 1
    v_cvt_pk_bf16_f32 v168, v52, v53
    v_cvt_pk_bf16_f32 v169, v54, v55
    s_mov_b32 s55, 0
    buffer_store_dwordx2 v[168:169], v249, s[28:31], s55 offen offset:192
    s_nop 1
    v_cvt_pk_bf16_f32 v168, v56, v57
    v_cvt_pk_bf16_f32 v169, v58, v59
    s_mov_b32 s55, 18432
    buffer_store_dwordx2 v[168:169], v249, s[28:31], s55 offen offset:192
    s_nop 1
    v_cvt_pk_bf16_f32 v168, v60, v61
    v_cvt_pk_bf16_f32 v169, v62, v63
    s_mov_b32 s55, 0
    buffer_store_dwordx2 v[168:169], v249, s[28:31], s55 offen offset:224
    s_nop 1
    v_cvt_pk_bf16_f32 v168, v64, v65
    v_cvt_pk_bf16_f32 v169, v66, v67
    s_mov_b32 s55, 18432
    buffer_store_dwordx2 v[168:169], v249, s[28:31], s55 offen offset:224
    s_nop 1
    v_cvt_pk_bf16_f32 v168, v68, v69
    v_cvt_pk_bf16_f32 v169, v70, v71
    s_mov_b32 s55, 0
    buffer_store_dwordx2 v[168:169], v249, s[28:31], s55 offen offset:256
    s_nop 1
    v_cvt_pk_bf16_f32 v168, v72, v73
    v_cvt_pk_bf16_f32 v169, v74, v75
    s_mov_b32 s55, 18432
    buffer_store_dwordx2 v[168:169], v249, s[28:31], s55 offen offset:256
    s_nop 1
    s_branch K2_END
K2_DOWN:
    s_add_u32 s16, s12, 0x800000
    s_addc_u32 s17, s13, 0
    s_mov_b32 s18, 0x1200000
    s_mov_b32 s19, 0x00020000
    s_mov_b32 s20, s8
    s_mov_b32 s21, s9
    s_mov_b32 s22, 0x510000
    s_mov_b32 s23, 0x00020000
    s_cmp_eq_u32 s47, 3
    s_mov_b32 s56, 0x2000000
    s_cselect_b32 s57, 0x2480000, s56
    s_add_u32 s28, s12, s57
    s_addc_u32 s29, s13, 0
    s_mov_b32 s30, 0x480000
    s_mov_b32 s31, 0x00020000
    s_sub_u32 s56, s47, 2
    s_mul_i32 s58, s56, 4608
    s_mul_i32 s59, s56, 2304*1152
    s_lshl_b32 s50, s45, 7
    v_lshrrev_b32 v249, 3, v250
    v_lshl_add_u32 v0, v251, 3, v249
    v_add_u32 v0, s50, v0
    s_mov_b32 s51, 9216
    v_mul_lo_u32 v0, v0, s51
    v_and_b32 v248, 7, v250
    v_xor_b32 v248, v248, v249
    v_lshl_add_u32 v0, v248, 4, v0
    s_mul_i32 s52, s44, 144
    v_lshrrev_b32 v249, 5, v250
    v_mul_u32_u24 v248, 2, v251
    v_add_u32 v249, v249, v248
    v_and_b32 v248, 3, v249
    v_bfe_u32 v247, v249, 3, 1
    v_lshl_or_b32 v248, v247, 2, v248
    v_bfe_u32 v247, v250, 1, 4
    v_xor_b32 v248, v247, v248
    s_mov_b32 s51, 1152
    v_mul_lo_u32 v1, v249, s51
    v_lshl_add_u32 v1, v248, 5, v1
    v_and_b32 v247, 1, v250
    v_lshl_add_u32 v1, v247, 4, v1
    s_lshl_b32 s51, s52, 1
    v_add_u32 v1, s51, v1
    v_cmp_gt_u32 vcc, 9, v248
    v_mov_b32 v247, 0x7ffffff0
    s_nop 1
    v_cndmask_b32 v1, v247, v1, vcc
    v_lshrrev_b32 v249, 5, v250
    v_mul_u32_u24 v248, 2, v251
    v_add_u32 v249, v249, v248
    v_add_u32 v249, 8, v249
    v_and_b32 v248, 3, v249
    v_bfe_u32 v247, v249, 3, 1
    v_lshl_or_b32 v248, v247, 2, v248
    v_subrev_u32 v249, 8, v249
    v_bfe_u32 v247, v250, 1, 4
    v_xor_b32 v248, v247, v248
    s_mov_b32 s51, 1152
    v_mul_lo_u32 v2, v249, s51
    v_lshl_add_u32 v2, v248, 5, v2
    v_and_b32 v247, 1, v250
    v_lshl_add_u32 v2, v247, 4, v2
    s_lshl_b32 s51, s52, 1
    v_add_u32 v2, s51, v2
    v_cmp_gt_u32 vcc, 9, v248
    v_mov_b32 v247, 0x7ffffff0
    s_nop 1
    v_cndmask_b32 v2, v247, v2, vcc
    s_mov_b32 s60, 18
    v_mov_b32 v4, 0
    v_mov_b32 v5, 0
    v_mov_b32 v6, 0
    v_mov_b32 v7, 0
    v_mov_b32 v8, 0
    v_mov_b32 v9, 0
    v_mov_b32 v10, 0
    v_mov_b32 v11, 0
    v_mov_b32 v12, 0
    v_mov_b32 v13, 0
    v_mov_b32 v14, 0
    v_mov_b32 v15, 0
    v_mov_b32 v16, 0
    v_mov_b32 v17, 0
    v_mov_b32 v18, 0
    v_mov_b32 v19, 0
    v_mov_b32 v20, 0
    v_mov_b32 v21, 0
    v_mov_b32 v22, 0
    v_mov_b32 v23, 0
    v_mov_b32 v24, 0
    v_mov_b32 v25, 0
    v_mov_b32 v26, 0
    v_mov_b32 v27, 0
    v_mov_b32 v28, 0
    v_mov_b32 v29, 0
    v_mov_b32 v30, 0
    v_mov_b32 v31, 0
    v_mov_b32 v32, 0
    v_mov_b32 v33, 0
    v_mov_b32 v34, 0
    v_mov_b32 v35, 0
    v_mov_b32 v36, 0
    v_mov_b32 v37, 0
    v_mov_b32 v38, 0
    v_mov_b32 v39, 0
    v_mov_b32 v40, 0
    v_mov_b32 v41, 0
    v_mov_b32 v42, 0
    v_mov_b32 v43, 0
    v_mov_b32 v44, 0
    v_mov_b32 v45, 0
    v_mov_b32 v46, 0
    v_mov_b32 v47, 0
    v_mov_b32 v48, 0
    v_mov_b32 v49, 0
    v_mov_b32 v50, 0
    v_mov_b32 v51, 0
    v_mov_b32 v52, 0
    v_mov_b32 v53, 0
    v_mov_b32 v54, 0
    v_mov_b32 v55, 0
    v_mov_b32 v56, 0
    v_mov_b32 v57, 0
    v_mov_b32 v58, 0
    v_mov_b32 v59, 0
    v_mov_b32 v60, 0
    v_mov_b32 v61, 0
    v_mov_b32 v62, 0
    v_mov_b32 v63, 0
    v_mov_b32 v64, 0
    v_mov_b32 v65, 0
    v_mov_b32 v66, 0
    v_mov_b32 v67, 0
    v_mov_b32 v68, 0
    v_mov_b32 v69, 0
    v_mov_b32 v70, 0
    v_mov_b32 v71, 0
    v_mov_b32 v72, 0
    v_mov_b32 v73, 0
    v_mov_b32 v74, 0
    v_mov_b32 v75, 0
    v_lshrrev_b32 v249, 4, v250
    v_bfe_u32 v248, v250, 2, 2
    v_lshl_add_u32 v164, v249, 3, v248
    s_movk_i32 s51, 512
    v_mul_lo_u32 v164, v164, s51
    v_and_b32 v249, 1, v249
    v_lshl_or_b32 v248, v249, 2, v248
    s_add_u32 s51, s53, 0
    v_xor_b32 v248, s51, v248
    v_lshl_add_u32 v164, v248, 5, v164
    v_and_b32 v248, 3, v250
    v_lshl_add_u32 v164, v248, 3, v164
    v_lshrrev_b32 v249, 4, v250
    v_bfe_u32 v248, v250, 2, 2
    v_lshl_add_u32 v165, v249, 3, v248
    s_movk_i32 s51, 512
    v_mul_lo_u32 v165, v165, s51
    v_and_b32 v249, 1, v249
    v_lshl_or_b32 v248, v249, 2, v248
    s_add_u32 s51, s53, 1
    v_xor_b32 v248, s51, v248
    v_lshl_add_u32 v165, v248, 5, v165
    v_and_b32 v248, 3, v250
    v_lshl_add_u32 v165, v248, 3, v165
    v_lshrrev_b32 v249, 4, v250
    v_bfe_u32 v248, v250, 2, 2
    v_lshl_add_u32 v166, v249, 3, v248
    s_movk_i32 s51, 512
    v_mul_lo_u32 v166, v166, s51
    v_and_b32 v249, 1, v249
    v_lshl_or_b32 v248, v249, 2, v248
    s_add_u32 s51, s53, 2
    v_xor_b32 v248, s51, v248
    v_lshl_add_u32 v166, v248, 5, v166
    v_and_b32 v248, 3, v250
    v_lshl_add_u32 v166, v248, 3, v166
    v_lshrrev_b32 v249, 4, v250
    v_bfe_u32 v248, v250, 2, 2
    v_lshl_add_u32 v167, v249, 3, v248
    s_movk_i32 s51, 512
    v_mul_lo_u32 v167, v167, s51
    v_and_b32 v249, 1, v249
    v_lshl_or_b32 v248, v249, 2, v248
    s_add_u32 s51, s53, 3
    v_xor_b32 v248, s51, v248
    v_lshl_add_u32 v167, v248, 5, v167
    v_and_b32 v248, 3, v250
    v_lshl_add_u32 v167, v248, 3, v167
    v_lshrrev_b32 v249, 4, v250
    v_bfe_u32 v248, v250, 2, 2
    v_lshl_add_u32 v168, v249, 3, v248
    s_movk_i32 s51, 512
    v_mul_lo_u32 v168, v168, s51
    v_and_b32 v249, 1, v249
    v_lshl_or_b32 v248, v249, 2, v248
    s_add_u32 s51, s53, 4
    v_xor_b32 v248, s51, v248
    v_lshl_add_u32 v168, v248, 5, v168
    v_and_b32 v248, 3, v250
    v_lshl_add_u32 v168, v248, 3, v168
    v_lshrrev_b32 v249, 4, v250
    v_bfe_u32 v248, v250, 2, 2
    v_lshl_add_u32 v169, v249, 3, v248
    s_movk_i32 s51, 512
    v_mul_lo_u32 v169, v169, s51
    v_and_b32 v249, 1, v249
    v_lshl_or_b32 v248, v249, 2, v248
    s_add_u32 s51, s53, 5
    v_xor_b32 v248, s51, v248
    v_lshl_add_u32 v169, v248, 5, v169
    v_and_b32 v248, 3, v250
    v_lshl_add_u32 v169, v248, 3, v169
    v_lshrrev_b32 v249, 4, v250
    v_bfe_u32 v248, v250, 2, 2
    v_lshl_add_u32 v170, v249, 3, v248
    s_movk_i32 s51, 512
    v_mul_lo_u32 v170, v170, s51
    v_and_b32 v249, 1, v249
    v_lshl_or_b32 v248, v249, 2, v248
    s_add_u32 s51, s53, 6
    v_xor_b32 v248, s51, v248
    v_lshl_add_u32 v170, v248, 5, v170
    v_and_b32 v248, 3, v250
    v_lshl_add_u32 v170, v248, 3, v170
    v_lshrrev_b32 v249, 4, v250
    v_bfe_u32 v248, v250, 2, 2
    v_lshl_add_u32 v171, v249, 3, v248
    s_movk_i32 s51, 512
    v_mul_lo_u32 v171, v171, s51
    v_and_b32 v249, 1, v249
    v_lshl_or_b32 v248, v249, 2, v248
    s_add_u32 s51, s53, 7
    v_xor_b32 v248, s51, v248
    v_lshl_add_u32 v171, v248, 5, v171
    v_and_b32 v248, 3, v250
    v_lshl_add_u32 v171, v248, 3, v171
    v_lshrrev_b32 v249, 4, v250
    v_bfe_u32 v248, v250, 2, 2
    v_lshl_add_u32 v172, v249, 3, v248
    s_movk_i32 s51, 512
    v_mul_lo_u32 v172, v172, s51
    v_and_b32 v249, 1, v249
    v_lshl_or_b32 v248, v249, 2, v248
    s_add_u32 s51, s53, 8
    v_xor_b32 v248, s51, v248
    v_lshl_add_u32 v172, v248, 5, v172
    v_and_b32 v248, 3, v250
    v_lshl_add_u32 v172, v248, 3, v172
    v_and_b32 v173, 15, v250
    s_lshl_b32 s51, s54, 4
    v_add_u32 v173, s51, v173
    v_lshlrev_b32 v173, 7, v173
    v_lshrrev_b32 v249, 4, v250
    v_add_u32 v249, 0, v249
    v_and_b32 v248, 7, v250
    v_xor_b32 v249, v249, v248
    v_lshlrev_b32 v249, 4, v249
    v_add_u32 v173, v173, v249
    v_and_b32 v174, 15, v250
    s_lshl_b32 s51, s54, 4
    v_add_u32 v174, s51, v174
    v_lshlrev_b32 v174, 7, v174
    v_lshrrev_b32 v249, 4, v250
    v_add_u32 v249, 4, v249
    v_and_b32 v248, 7, v250
    v_xor_b32 v249, v249, v248
    v_lshlrev_b32 v249, 4, v249
    v_add_u32 v174, v174, v249
    s_add_u32 m0, s41, 0
    s_add_u32 s51, s58, 0
    buffer_load_dwordx4 v0, s[16:19], s51 offen lds
    s_add_u32 m0, s41, 4096
    s_add_u32 s51, s58, 294912
    buffer_load_dwordx4 v0, s[16:19], s51 offen lds
    s_add_u32 m0, s41, 8192
    s_add_u32 s51, s58, 589824
    buffer_load_dwordx4 v0, s[16:19], s51 offen lds
    s_add_u32 m0, s41, 12288
    s_add_u32 s51, s58, 884736
    buffer_load_dwordx4 v0, s[16:19], s51 offen lds
    s_add_u32 m0, s41, 16384
    s_add_u32 s51, s59, 0
    buffer_load_dwordx4 v1, s[20:23], s51 offen lds
    s_add_u32 m0, s41, 20480
    s_add_u32 s51, s59, 9216
    buffer_load_dwordx4 v2, s[20:23], s51 offen lds
    s_add_u32 m0, s41, 24576
    s_add_u32 s51, s59, 18432
    buffer_load_dwordx4 v1, s[20:23], s51 offen lds
    s_add_u32 m0, s41, 28672
    s_add_u32 s51, s59, 27648
    buffer_load_dwordx4 v2, s[20:23], s51 offen lds
    s_add_u32 m0, s41, 32768
    s_add_u32 s51, s59, 36864
    buffer_load_dwordx4 v1, s[20:23], s51 offen lds
    s_add_u32 m0, s41, 36864
    s_add_u32 s51, s59, 46080
    buffer_load_dwordx4 v2, s[20:23], s51 offen lds
    s_add_u32 m0, s41, 40960
    s_add_u32 s51, s59, 55296
    buffer_load_dwordx4 v1, s[20:23], s51 offen lds
    s_add_u32 m0, s41, 45056
    s_add_u32 s51, s59, 64512
    buffer_load_dwordx4 v2, s[20:23], s51 offen lds
    s_add_u32 s58, s58, 128
    s_add_u32 s59, s59, 73728
    s_add_u32 m0, s41, 49152
    s_add_u32 s51, s58, 0
    buffer_load_dwordx4 v0, s[16:19], s51 offen lds
    s_add_u32 m0, s41, 53248
    s_add_u32 s51, s58, 294912
    buffer_load_dwordx4 v0, s[16:19], s51 offen lds
    s_add_u32 m0, s41, 57344
    s_add_u32 s51, s58, 589824
    buffer_load_dwordx4 v0, s[16:19], s51 offen lds
    s_add_u32 m0, s41, 61440
    s_add_u32 s51, s58, 884736
    buffer_load_dwordx4 v0, s[16:19], s51 offen lds
    s_add_u32 m0, s41, 65536
    s_add_u32 s51, s59, 0
    buffer_load_dwordx4 v1, s[20:23], s51 offen lds
    s_add_u32 m0, s41, 69632
    s_add_u32 s51, s59, 9216
    buffer_load_dwordx4 v2, s[20:23], s51 offen lds
    s_add_u32 m0, s41, 73728
    s_add_u32 s51, s59, 18432
    buffer_load_dwordx4 v1, s[20:23], s51 offen lds
    s_add_u32 m0, s41, 77824
    s_add_u32 s51, s59, 27648
    buffer_load_dwordx4 v2, s[20:23], s51 offen lds
    s_add_u32 m0, s41, 81920
    s_add_u32 s51, s59, 36864
    buffer_load_dwordx4 v1, s[20:23], s51 offen lds
    s_add_u32 m0, s41, 86016
    s_add_u32 s51, s59, 46080
    buffer_load_dwordx4 v2, s[20:23], s51 offen lds
    s_add_u32 m0, s41, 90112
    s_add_u32 s51, s59, 55296
    buffer_load_dwordx4 v1, s[20:23], s51 offen lds
    s_add_u32 m0, s41, 94208
    s_add_u32 s51, s59, 64512
    buffer_load_dwordx4 v2, s[20:23], s51 offen lds
    s_waitcnt vmcnt(12)
    s_barrier
    ds_read_b128 v[112:115], v173 offset:0
    ds_read_b128 v[116:119], v173 offset:2048
    ds_read_b64_tr_b16 v[76:77], v164 offset:16384
    ds_read_b64_tr_b16 v[78:79], v164 offset:18432
    ds_read_b64_tr_b16 v[80:81], v165 offset:16384
    ds_read_b64_tr_b16 v[82:83], v165 offset:18432
    ds_read_b64_tr_b16 v[84:85], v166 offset:16384
    ds_read_b64_tr_b16 v[86:87], v166 offset:18432
    ds_read_b64_tr_b16 v[88:89], v167 offset:16384
    ds_read_b64_tr_b16 v[90:91], v167 offset:18432
    ds_read_b64_tr_b16 v[92:93], v168 offset:16384
    ds_read_b64_tr_b16 v[94:95], v168 offset:18432
    ds_read_b64_tr_b16 v[96:97], v169 offset:16384
    ds_read_b64_tr_b16 v[98:99], v169 offset:18432
    ds_read_b64_tr_b16 v[100:101], v170 offset:16384
    ds_read_b64_tr_b16 v[102:103], v170 offset:18432
    ds_read_b64_tr_b16 v[104:105], v171 offset:16384
    ds_read_b64_tr_b16 v[106:107], v171 offset:18432
    ds_read_b64_tr_b16 v[108:109], v172 offset:16384
    ds_read_b64_tr_b16 v[110:111], v172 offset:18432
    s_waitcnt lgkmcnt(0)
    v_mfma_f32_16x16x32_bf16 v[4:7], v[76:79], v[112:115], v[4:7]
    ds_read_b128 v[156:159], v174 offset:0
    v_mfma_f32_16x16x32_bf16 v[8:11], v[76:79], v[116:119], v[8:11]
    ds_read_b128 v[160:163], v174 offset:2048
    v_mfma_f32_16x16x32_bf16 v[12:15], v[80:83], v[112:115], v[12:15]
    ds_read_b64_tr_b16 v[120:121], v164 offset:32768
    ds_read_b64_tr_b16 v[122:123], v164 offset:34816
    v_mfma_f32_16x16x32_bf16 v[16:19], v[80:83], v[116:119], v[16:19]
    ds_read_b64_tr_b16 v[124:125], v165 offset:32768
    v_mfma_f32_16x16x32_bf16 v[20:23], v[84:87], v[112:115], v[20:23]
    ds_read_b64_tr_b16 v[126:127], v165 offset:34816
    ds_read_b64_tr_b16 v[128:129], v166 offset:32768
    v_mfma_f32_16x16x32_bf16 v[24:27], v[84:87], v[116:119], v[24:27]
    ds_read_b64_tr_b16 v[130:131], v166 offset:34816
    v_mfma_f32_16x16x32_bf16 v[28:31], v[88:91], v[112:115], v[28:31]
    ds_read_b64_tr_b16 v[132:133], v167 offset:32768
    ds_read_b64_tr_b16 v[134:135], v167 offset:34816
    v_mfma_f32_16x16x32_bf16 v[32:35], v[88:91], v[116:119], v[32:35]
    ds_read_b64_tr_b16 v[136:137], v168 offset:32768
    v_mfma_f32_16x16x32_bf16 v[36:39], v[92:95], v[112:115], v[36:39]
    ds_read_b64_tr_b16 v[138:139], v168 offset:34816
    ds_read_b64_tr_b16 v[140:141], v169 offset:32768
    v_mfma_f32_16x16x32_bf16 v[40:43], v[92:95], v[116:119], v[40:43]
    ds_read_b64_tr_b16 v[142:143], v169 offset:34816
    v_mfma_f32_16x16x32_bf16 v[44:47], v[96:99], v[112:115], v[44:47]
    ds_read_b64_tr_b16 v[144:145], v170 offset:32768
    v_mfma_f32_16x16x32_bf16 v[48:51], v[96:99], v[116:119], v[48:51]
    ds_read_b64_tr_b16 v[146:147], v170 offset:34816
    ds_read_b64_tr_b16 v[148:149], v171 offset:32768
    v_mfma_f32_16x16x32_bf16 v[52:55], v[100:103], v[112:115], v[52:55]
    ds_read_b64_tr_b16 v[150:151], v171 offset:34816
    v_mfma_f32_16x16x32_bf16 v[56:59], v[100:103], v[116:119], v[56:59]
    ds_read_b64_tr_b16 v[152:153], v172 offset:32768
    ds_read_b64_tr_b16 v[154:155], v172 offset:34816
    v_mfma_f32_16x16x32_bf16 v[60:63], v[104:107], v[112:115], v[60:63]
    s_add_u32 s58, s58, 128
    s_add_u32 s59, s59, 73728
    v_mfma_f32_16x16x32_bf16 v[64:67], v[104:107], v[116:119], v[64:67]
    s_add_u32 m0, s41, 98304
    s_add_u32 s51, s58, 0
    buffer_load_dwordx4 v0, s[16:19], s51 offen lds
    s_add_u32 m0, s41, 102400
    s_add_u32 s51, s58, 294912
    buffer_load_dwordx4 v0, s[16:19], s51 offen lds
    v_mfma_f32_16x16x32_bf16 v[68:71], v[108:111], v[112:115], v[68:71]
    s_add_u32 m0, s41, 106496
    s_add_u32 s51, s58, 589824
    buffer_load_dwordx4 v0, s[16:19], s51 offen lds
    v_mfma_f32_16x16x32_bf16 v[72:75], v[108:111], v[116:119], v[72:75]
    s_add_u32 m0, s41, 110592
    s_add_u32 s51, s58, 884736
    buffer_load_dwordx4 v0, s[16:19], s51 offen lds
    s_add_u32 m0, s41, 114688
    s_add_u32 s51, s59, 0
    buffer_load_dwordx4 v1, s[20:23], s51 offen lds
    s_waitcnt lgkmcnt(0)
    v_mfma_f32_16x16x32_bf16 v[4:7], v[120:123], v[156:159], v[4:7]
    v_mfma_f32_16x16x32_bf16 v[8:11], v[120:123], v[160:163], v[8:11]
    v_mfma_f32_16x16x32_bf16 v[12:15], v[124:127], v[156:159], v[12:15]
    s_add_u32 m0, s41, 118784
    s_add_u32 s51, s59, 9216
    buffer_load_dwordx4 v2, s[20:23], s51 offen lds
    v_mfma_f32_16x16x32_bf16 v[16:19], v[124:127], v[160:163], v[16:19]
    v_mfma_f32_16x16x32_bf16 v[20:23], v[128:131], v[156:159], v[20:23]
    v_mfma_f32_16x16x32_bf16 v[24:27], v[128:131], v[160:163], v[24:27]
    s_add_u32 m0, s41, 122880
    s_add_u32 s51, s59, 18432
    buffer_load_dwordx4 v1, s[20:23], s51 offen lds
    v_mfma_f32_16x16x32_bf16 v[28:31], v[132:135], v[156:159], v[28:31]
    v_mfma_f32_16x16x32_bf16 v[32:35], v[132:135], v[160:163], v[32:35]
    s_add_u32 m0, s41, 126976
    s_add_u32 s51, s59, 27648
    buffer_load_dwordx4 v2, s[20:23], s51 offen lds
    v_mfma_f32_16x16x32_bf16 v[36:39], v[136:139], v[156:159], v[36:39]
    v_mfma_f32_16x16x32_bf16 v[40:43], v[136:139], v[160:163], v[40:43]
    v_mfma_f32_16x16x32_bf16 v[44:47], v[140:143], v[156:159], v[44:47]
    s_add_u32 m0, s41, 131072
    s_add_u32 s51, s59, 36864
    buffer_load_dwordx4 v1, s[20:23], s51 offen lds
    v_mfma_f32_16x16x32_bf16 v[48:51], v[140:143], v[160:163], v[48:51]
    v_mfma_f32_16x16x32_bf16 v[52:55], v[144:147], v[156:159], v[52:55]
    s_add_u32 m0, s41, 135168
    s_add_u32 s51, s59, 46080
    buffer_load_dwordx4 v2, s[20:23], s51 offen lds
    v_mfma_f32_16x16x32_bf16 v[56:59], v[144:147], v[160:163], v[56:59]
    v_mfma_f32_16x16x32_bf16 v[60:63], v[148:151], v[156:159], v[60:63]
    v_mfma_f32_16x16x32_bf16 v[64:67], v[148:151], v[160:163], v[64:67]
    s_add_u32 m0, s41, 139264
    s_add_u32 s51, s59, 55296
    buffer_load_dwordx4 v1, s[20:23], s51 offen lds
    v_mfma_f32_16x16x32_bf16 v[68:71], v[152:155], v[156:159], v[68:71]
    v_mfma_f32_16x16x32_bf16 v[72:75], v[152:155], v[160:163], v[72:75]
    s_add_u32 m0, s41, 143360
    s_add_u32 s51, s59, 64512
    buffer_load_dwordx4 v2, s[20:23], s51 offen lds
    s_waitcnt vmcnt(12)
    s_barrier
    v_add_u32 v164, 49152, v164
    v_add_u32 v165, 49152, v165
    v_add_u32 v166, 49152, v166
    v_add_u32 v167, 49152, v167
    v_add_u32 v168, 49152, v168
    v_add_u32 v169, 49152, v169
    v_add_u32 v170, 49152, v170
    v_add_u32 v171, 49152, v171
    v_add_u32 v172, 49152, v172
    v_add_u32 v173, 49152, v173
    v_add_u32 v174, 49152, v174
    ds_read_b128 v[112:115], v173 offset:0
    ds_read_b128 v[116:119], v173 offset:2048
    ds_read_b64_tr_b16 v[76:77], v164 offset:16384
    ds_read_b64_tr_b16 v[78:79], v164 offset:18432
    ds_read_b64_tr_b16 v[80:81], v165 offset:16384
    ds_read_b64_tr_b16 v[82:83], v165 offset:18432
    ds_read_b64_tr_b16 v[84:85], v166 offset:16384
    ds_read_b64_tr_b16 v[86:87], v166 offset:18432
    ds_read_b64_tr_b16 v[88:89], v167 offset:16384
    ds_read_b64_tr_b16 v[90:91], v167 offset:18432
    ds_read_b64_tr_b16 v[92:93], v168 offset:16384
    ds_read_b64_tr_b16 v[94:95], v168 offset:18432
    ds_read_b64_tr_b16 v[96:97], v169 offset:16384
    ds_read_b64_tr_b16 v[98:99], v169 offset:18432
    ds_read_b64_tr_b16 v[100:101], v170 offset:16384
    ds_read_b64_tr_b16 v[102:103], v170 offset:18432
    ds_read_b64_tr_b16 v[104:105], v171 offset:16384
    ds_read_b64_tr_b16 v[106:107], v171 offset:18432
    ds_read_b64_tr_b16 v[108:109], v172 offset:16384
    ds_read_b64_tr_b16 v[110:111], v172 offset:18432
    s_waitcnt lgkmcnt(0)
    v_mfma_f32_16x16x32_bf16 v[4:7], v[76:79], v[112:115], v[4:7]
    ds_read_b128 v[156:159], v174 offset:0
    v_mfma_f32_16x16x32_bf16 v[8:11], v[76:79], v[116:119], v[8:11]
    ds_read_b128 v[160:163], v174 offset:2048
    v_mfma_f32_16x16x32_bf16 v[12:15], v[80:83], v[112:115], v[12:15]
    ds_read_b64_tr_b16 v[120:121], v164 offset:32768
    ds_read_b64_tr_b16 v[122:123], v164 offset:34816
    v_mfma_f32_16x16x32_bf16 v[16:19], v[80:83], v[116:119], v[16:19]
    ds_read_b64_tr_b16 v[124:125], v165 offset:32768
    v_mfma_f32_16x16x32_bf16 v[20:23], v[84:87], v[112:115], v[20:23]
    ds_read_b64_tr_b16 v[126:127], v165 offset:34816
    ds_read_b64_tr_b16 v[128:129], v166 offset:32768
    v_mfma_f32_16x16x32_bf16 v[24:27], v[84:87], v[116:119], v[24:27]
    ds_read_b64_tr_b16 v[130:131], v166 offset:34816
    v_mfma_f32_16x16x32_bf16 v[28:31], v[88:91], v[112:115], v[28:31]
    ds_read_b64_tr_b16 v[132:133], v167 offset:32768
    ds_read_b64_tr_b16 v[134:135], v167 offset:34816
    v_mfma_f32_16x16x32_bf16 v[32:35], v[88:91], v[116:119], v[32:35]
    ds_read_b64_tr_b16 v[136:137], v168 offset:32768
    v_mfma_f32_16x16x32_bf16 v[36:39], v[92:95], v[112:115], v[36:39]
    ds_read_b64_tr_b16 v[138:139], v168 offset:34816
    ds_read_b64_tr_b16 v[140:141], v169 offset:32768
    v_mfma_f32_16x16x32_bf16 v[40:43], v[92:95], v[116:119], v[40:43]
    ds_read_b64_tr_b16 v[142:143], v169 offset:34816
    v_mfma_f32_16x16x32_bf16 v[44:47], v[96:99], v[112:115], v[44:47]
    ds_read_b64_tr_b16 v[144:145], v170 offset:32768
    v_mfma_f32_16x16x32_bf16 v[48:51], v[96:99], v[116:119], v[48:51]
    ds_read_b64_tr_b16 v[146:147], v170 offset:34816
    ds_read_b64_tr_b16 v[148:149], v171 offset:32768
    v_mfma_f32_16x16x32_bf16 v[52:55], v[100:103], v[112:115], v[52:55]
    ds_read_b64_tr_b16 v[150:151], v171 offset:34816
    v_mfma_f32_16x16x32_bf16 v[56:59], v[100:103], v[116:119], v[56:59]
    ds_read_b64_tr_b16 v[152:153], v172 offset:32768
    ds_read_b64_tr_b16 v[154:155], v172 offset:34816
    v_mfma_f32_16x16x32_bf16 v[60:63], v[104:107], v[112:115], v[60:63]
    s_add_u32 s58, s58, 128
    s_add_u32 s59, s59, 73728
    v_mfma_f32_16x16x32_bf16 v[64:67], v[104:107], v[116:119], v[64:67]
    s_add_u32 m0, s41, 0
    s_add_u32 s51, s58, 0
    buffer_load_dwordx4 v0, s[16:19], s51 offen lds
    s_add_u32 m0, s41, 4096
    s_add_u32 s51, s58, 294912
    buffer_load_dwordx4 v0, s[16:19], s51 offen lds
    v_mfma_f32_16x16x32_bf16 v[68:71], v[108:111], v[112:115], v[68:71]
    s_add_u32 m0, s41, 8192
    s_add_u32 s51, s58, 589824
    buffer_load_dwordx4 v0, s[16:19], s51 offen lds
    v_mfma_f32_16x16x32_bf16 v[72:75], v[108:111], v[116:119], v[72:75]
    s_add_u32 m0, s41, 12288
    s_add_u32 s51, s58, 884736
    buffer_load_dwordx4 v0, s[16:19], s51 offen lds
    s_add_u32 m0, s41, 16384
    s_add_u32 s51, s59, 0
    buffer_load_dwordx4 v1, s[20:23], s51 offen lds
    s_waitcnt lgkmcnt(0)
    v_mfma_f32_16x16x32_bf16 v[4:7], v[120:123], v[156:159], v[4:7]
    v_mfma_f32_16x16x32_bf16 v[8:11], v[120:123], v[160:163], v[8:11]
    v_mfma_f32_16x16x32_bf16 v[12:15], v[124:127], v[156:159], v[12:15]
    s_add_u32 m0, s41, 20480
    s_add_u32 s51, s59, 9216
    buffer_load_dwordx4 v2, s[20:23], s51 offen lds
    v_mfma_f32_16x16x32_bf16 v[16:19], v[124:127], v[160:163], v[16:19]
    v_mfma_f32_16x16x32_bf16 v[20:23], v[128:131], v[156:159], v[20:23]
    v_mfma_f32_16x16x32_bf16 v[24:27], v[128:131], v[160:163], v[24:27]
    s_add_u32 m0, s41, 24576
    s_add_u32 s51, s59, 18432
    buffer_load_dwordx4 v1, s[20:23], s51 offen lds
    v_mfma_f32_16x16x32_bf16 v[28:31], v[132:135], v[156:159], v[28:31]
    v_mfma_f32_16x16x32_bf16 v[32:35], v[132:135], v[160:163], v[32:35]
    s_add_u32 m0, s41, 28672
    s_add_u32 s51, s59, 27648
    buffer_load_dwordx4 v2, s[20:23], s51 offen lds
    v_mfma_f32_16x16x32_bf16 v[36:39], v[136:139], v[156:159], v[36:39]
    v_mfma_f32_16x16x32_bf16 v[40:43], v[136:139], v[160:163], v[40:43]
    v_mfma_f32_16x16x32_bf16 v[44:47], v[140:143], v[156:159], v[44:47]
    s_add_u32 m0, s41, 32768
    s_add_u32 s51, s59, 36864
    buffer_load_dwordx4 v1, s[20:23], s51 offen lds
    v_mfma_f32_16x16x32_bf16 v[48:51], v[140:143], v[160:163], v[48:51]
    v_mfma_f32_16x16x32_bf16 v[52:55], v[144:147], v[156:159], v[52:55]
    s_add_u32 m0, s41, 36864
    s_add_u32 s51, s59, 46080
    buffer_load_dwordx4 v2, s[20:23], s51 offen lds
    v_mfma_f32_16x16x32_bf16 v[56:59], v[144:147], v[160:163], v[56:59]
    v_mfma_f32_16x16x32_bf16 v[60:63], v[148:151], v[156:159], v[60:63]
    v_mfma_f32_16x16x32_bf16 v[64:67], v[148:151], v[160:163], v[64:67]
    s_add_u32 m0, s41, 40960
    s_add_u32 s51, s59, 55296
    buffer_load_dwordx4 v1, s[20:23], s51 offen lds
    v_mfma_f32_16x16x32_bf16 v[68:71], v[152:155], v[156:159], v[68:71]
    v_mfma_f32_16x16x32_bf16 v[72:75], v[152:155], v[160:163], v[72:75]
    s_add_u32 m0, s41, 45056
    s_add_u32 s51, s59, 64512
    buffer_load_dwordx4 v2, s[20:23], s51 offen lds
    s_waitcnt vmcnt(12)
    s_barrier
    v_add_u32 v164, 49152, v164
    v_add_u32 v165, 49152, v165
    v_add_u32 v166, 49152, v166
    v_add_u32 v167, 49152, v167
    v_add_u32 v168, 49152, v168
    v_add_u32 v169, 49152, v169
    v_add_u32 v170, 49152, v170
    v_add_u32 v171, 49152, v171
    v_add_u32 v172, 49152, v172
    v_add_u32 v173, 49152, v173
    v_add_u32 v174, 49152, v174
    ds_read_b128 v[112:115], v173 offset:0
    ds_read_b128 v[116:119], v173 offset:2048
    ds_read_b64_tr_b16 v[76:77], v164 offset:16384
    ds_read_b64_tr_b16 v[78:79], v164 offset:18432
    ds_read_b64_tr_b16 v[80:81], v165 offset:16384
    ds_read_b64_tr_b16 v[82:83], v165 offset:18432
    ds_read_b64_tr_b16 v[84:85], v166 offset:16384
    ds_read_b64_tr_b16 v[86:87], v166 offset:18432
    ds_read_b64_tr_b16 v[88:89], v167 offset:16384
    ds_read_b64_tr_b16 v[90:91], v167 offset:18432
    ds_read_b64_tr_b16 v[92:93], v168 offset:16384
    ds_read_b64_tr_b16 v[94:95], v168 offset:18432
    ds_read_b64_tr_b16 v[96:97], v169 offset:16384
    ds_read_b64_tr_b16 v[98:99], v169 offset:18432
    ds_read_b64_tr_b16 v[100:101], v170 offset:16384
    ds_read_b64_tr_b16 v[102:103], v170 offset:18432
    ds_read_b64_tr_b16 v[104:105], v171 offset:16384
    ds_read_b64_tr_b16 v[106:107], v171 offset:18432
    ds_read_b64_tr_b16 v[108:109], v172 offset:16384
    ds_read_b64_tr_b16 v[110:111], v172 offset:18432
    s_waitcnt lgkmcnt(0)
    v_mfma_f32_16x16x32_bf16 v[4:7], v[76:79], v[112:115], v[4:7]
    ds_read_b128 v[156:159], v174 offset:0
    v_mfma_f32_16x16x32_bf16 v[8:11], v[76:79], v[116:119], v[8:11]
    ds_read_b128 v[160:163], v174 offset:2048
    v_mfma_f32_16x16x32_bf16 v[12:15], v[80:83], v[112:115], v[12:15]
    ds_read_b64_tr_b16 v[120:121], v164 offset:32768
    ds_read_b64_tr_b16 v[122:123], v164 offset:34816
    v_mfma_f32_16x16x32_bf16 v[16:19], v[80:83], v[116:119], v[16:19]
    ds_read_b64_tr_b16 v[124:125], v165 offset:32768
    v_mfma_f32_16x16x32_bf16 v[20:23], v[84:87], v[112:115], v[20:23]
    ds_read_b64_tr_b16 v[126:127], v165 offset:34816
    ds_read_b64_tr_b16 v[128:129], v166 offset:32768
    v_mfma_f32_16x16x32_bf16 v[24:27], v[84:87], v[116:119], v[24:27]
    ds_read_b64_tr_b16 v[130:131], v166 offset:34816
    v_mfma_f32_16x16x32_bf16 v[28:31], v[88:91], v[112:115], v[28:31]
    ds_read_b64_tr_b16 v[132:133], v167 offset:32768
    ds_read_b64_tr_b16 v[134:135], v167 offset:34816
    v_mfma_f32_16x16x32_bf16 v[32:35], v[88:91], v[116:119], v[32:35]
    ds_read_b64_tr_b16 v[136:137], v168 offset:32768
    v_mfma_f32_16x16x32_bf16 v[36:39], v[92:95], v[112:115], v[36:39]
    ds_read_b64_tr_b16 v[138:139], v168 offset:34816
    ds_read_b64_tr_b16 v[140:141], v169 offset:32768
    v_mfma_f32_16x16x32_bf16 v[40:43], v[92:95], v[116:119], v[40:43]
    ds_read_b64_tr_b16 v[142:143], v169 offset:34816
    v_mfma_f32_16x16x32_bf16 v[44:47], v[96:99], v[112:115], v[44:47]
    ds_read_b64_tr_b16 v[144:145], v170 offset:32768
    v_mfma_f32_16x16x32_bf16 v[48:51], v[96:99], v[116:119], v[48:51]
    ds_read_b64_tr_b16 v[146:147], v170 offset:34816
    ds_read_b64_tr_b16 v[148:149], v171 offset:32768
    v_mfma_f32_16x16x32_bf16 v[52:55], v[100:103], v[112:115], v[52:55]
    ds_read_b64_tr_b16 v[150:151], v171 offset:34816
    v_mfma_f32_16x16x32_bf16 v[56:59], v[100:103], v[116:119], v[56:59]
    ds_read_b64_tr_b16 v[152:153], v172 offset:32768
    ds_read_b64_tr_b16 v[154:155], v172 offset:34816
    v_mfma_f32_16x16x32_bf16 v[60:63], v[104:107], v[112:115], v[60:63]
    s_add_u32 s58, s58, 128
    s_add_u32 s59, s59, 73728
    v_mfma_f32_16x16x32_bf16 v[64:67], v[104:107], v[116:119], v[64:67]
    s_add_u32 m0, s41, 49152
    s_add_u32 s51, s58, 0
    buffer_load_dwordx4 v0, s[16:19], s51 offen lds
    s_add_u32 m0, s41, 53248
    s_add_u32 s51, s58, 294912
    buffer_load_dwordx4 v0, s[16:19], s51 offen lds
    v_mfma_f32_16x16x32_bf16 v[68:71], v[108:111], v[112:115], v[68:71]
    s_add_u32 m0, s41, 57344
    s_add_u32 s51, s58, 589824
    buffer_load_dwordx4 v0, s[16:19], s51 offen lds
    v_mfma_f32_16x16x32_bf16 v[72:75], v[108:111], v[116:119], v[72:75]
    s_add_u32 m0, s41, 61440
    s_add_u32 s51, s58, 884736
    buffer_load_dwordx4 v0, s[16:19], s51 offen lds
    s_add_u32 m0, s41, 65536
    s_add_u32 s51, s59, 0
    buffer_load_dwordx4 v1, s[20:23], s51 offen lds
    s_waitcnt lgkmcnt(0)
    v_mfma_f32_16x16x32_bf16 v[4:7], v[120:123], v[156:159], v[4:7]
    v_mfma_f32_16x16x32_bf16 v[8:11], v[120:123], v[160:163], v[8:11]
    v_mfma_f32_16x16x32_bf16 v[12:15], v[124:127], v[156:159], v[12:15]
    s_add_u32 m0, s41, 69632
    s_add_u32 s51, s59, 9216
    buffer_load_dwordx4 v2, s[20:23], s51 offen lds
    v_mfma_f32_16x16x32_bf16 v[16:19], v[124:127], v[160:163], v[16:19]
    v_mfma_f32_16x16x32_bf16 v[20:23], v[128:131], v[156:159], v[20:23]
    v_mfma_f32_16x16x32_bf16 v[24:27], v[128:131], v[160:163], v[24:27]
    s_add_u32 m0, s41, 73728
    s_add_u32 s51, s59, 18432
    buffer_load_dwordx4 v1, s[20:23], s51 offen lds
    v_mfma_f32_16x16x32_bf16 v[28:31], v[132:135], v[156:159], v[28:31]
    v_mfma_f32_16x16x32_bf16 v[32:35], v[132:135], v[160:163], v[32:35]
    s_add_u32 m0, s41, 77824
    s_add_u32 s51, s59, 27648
    buffer_load_dwordx4 v2, s[20:23], s51 offen lds
    v_mfma_f32_16x16x32_bf16 v[36:39], v[136:139], v[156:159], v[36:39]
    v_mfma_f32_16x16x32_bf16 v[40:43], v[136:139], v[160:163], v[40:43]
    v_mfma_f32_16x16x32_bf16 v[44:47], v[140:143], v[156:159], v[44:47]
    s_add_u32 m0, s41, 81920
    s_add_u32 s51, s59, 36864
    buffer_load_dwordx4 v1, s[20:23], s51 offen lds
    v_mfma_f32_16x16x32_bf16 v[48:51], v[140:143], v[160:163], v[48:51]
    v_mfma_f32_16x16x32_bf16 v[52:55], v[144:147], v[156:159], v[52:55]
    s_add_u32 m0, s41, 86016
    s_add_u32 s51, s59, 46080
    buffer_load_dwordx4 v2, s[20:23], s51 offen lds
    v_mfma_f32_16x16x32_bf16 v[56:59], v[144:147], v[160:163], v[56:59]
    v_mfma_f32_16x16x32_bf16 v[60:63], v[148:151], v[156:159], v[60:63]
    v_mfma_f32_16x16x32_bf16 v[64:67], v[148:151], v[160:163], v[64:67]
    s_add_u32 m0, s41, 90112
    s_add_u32 s51, s59, 55296
    buffer_load_dwordx4 v1, s[20:23], s51 offen lds
    v_mfma_f32_16x16x32_bf16 v[68:71], v[152:155], v[156:159], v[68:71]
    v_mfma_f32_16x16x32_bf16 v[72:75], v[152:155], v[160:163], v[72:75]
    s_add_u32 m0, s41, 94208
    s_add_u32 s51, s59, 64512
    buffer_load_dwordx4 v2, s[20:23], s51 offen lds
    s_waitcnt vmcnt(12)
    s_barrier
    v_subrev_u32 v164, 98304, v164
    v_subrev_u32 v165, 98304, v165
    v_subrev_u32 v166, 98304, v166
    v_subrev_u32 v167, 98304, v167
    v_subrev_u32 v168, 98304, v168
    v_subrev_u32 v169, 98304, v169
    v_subrev_u32 v170, 98304, v170
    v_subrev_u32 v171, 98304, v171
    v_subrev_u32 v172, 98304, v172
    v_subrev_u32 v173, 98304, v173
    v_subrev_u32 v174, 98304, v174
    ds_read_b128 v[112:115], v173 offset:0
    ds_read_b128 v[116:119], v173 offset:2048
    ds_read_b64_tr_b16 v[76:77], v164 offset:16384
    ds_read_b64_tr_b16 v[78:79], v164 offset:18432
    ds_read_b64_tr_b16 v[80:81], v165 offset:16384
    ds_read_b64_tr_b16 v[82:83], v165 offset:18432
    ds_read_b64_tr_b16 v[84:85], v166 offset:16384
    ds_read_b64_tr_b16 v[86:87], v166 offset:18432
    ds_read_b64_tr_b16 v[88:89], v167 offset:16384
    ds_read_b64_tr_b16 v[90:91], v167 offset:18432
    ds_read_b64_tr_b16 v[92:93], v168 offset:16384
    ds_read_b64_tr_b16 v[94:95], v168 offset:18432
    ds_read_b64_tr_b16 v[96:97], v169 offset:16384
    ds_read_b64_tr_b16 v[98:99], v169 offset:18432
    ds_read_b64_tr_b16 v[100:101], v170 offset:16384
    ds_read_b64_tr_b16 v[102:103], v170 offset:18432
    ds_read_b64_tr_b16 v[104:105], v171 offset:16384
    ds_read_b64_tr_b16 v[106:107], v171 offset:18432
    ds_read_b64_tr_b16 v[108:109], v172 offset:16384
    ds_read_b64_tr_b16 v[110:111], v172 offset:18432
    s_waitcnt lgkmcnt(0)
    v_mfma_f32_16x16x32_bf16 v[4:7], v[76:79], v[112:115], v[4:7]
    ds_read_b128 v[156:159], v174 offset:0
    v_mfma_f32_16x16x32_bf16 v[8:11], v[76:79], v[116:119], v[8:11]
    ds_read_b128 v[160:163], v174 offset:2048
    v_mfma_f32_16x16x32_bf16 v[12:15], v[80:83], v[112:115], v[12:15]
    ds_read_b64_tr_b16 v[120:121], v164 offset:32768
    ds_read_b64_tr_b16 v[122:123], v164 offset:34816
    v_mfma_f32_16x16x32_bf16 v[16:19], v[80:83], v[116:119], v[16:19]
    ds_read_b64_tr_b16 v[124:125], v165 offset:32768
    v_mfma_f32_16x16x32_bf16 v[20:23], v[84:87], v[112:115], v[20:23]
    ds_read_b64_tr_b16 v[126:127], v165 offset:34816
    ds_read_b64_tr_b16 v[128:129], v166 offset:32768
    v_mfma_f32_16x16x32_bf16 v[24:27], v[84:87], v[116:119], v[24:27]
    ds_read_b64_tr_b16 v[130:131], v166 offset:34816
    v_mfma_f32_16x16x32_bf16 v[28:31], v[88:91], v[112:115], v[28:31]
    ds_read_b64_tr_b16 v[132:133], v167 offset:32768
    ds_read_b64_tr_b16 v[134:135], v167 offset:34816
    v_mfma_f32_16x16x32_bf16 v[32:35], v[88:91], v[116:119], v[32:35]
    ds_read_b64_tr_b16 v[136:137], v168 offset:32768
    v_mfma_f32_16x16x32_bf16 v[36:39], v[92:95], v[112:115], v[36:39]
    ds_read_b64_tr_b16 v[138:139], v168 offset:34816
    ds_read_b64_tr_b16 v[140:141], v169 offset:32768
    v_mfma_f32_16x16x32_bf16 v[40:43], v[92:95], v[116:119], v[40:43]
    ds_read_b64_tr_b16 v[142:143], v169 offset:34816
    v_mfma_f32_16x16x32_bf16 v[44:47], v[96:99], v[112:115], v[44:47]
    ds_read_b64_tr_b16 v[144:145], v170 offset:32768
    v_mfma_f32_16x16x32_bf16 v[48:51], v[96:99], v[116:119], v[48:51]
    ds_read_b64_tr_b16 v[146:147], v170 offset:34816
    ds_read_b64_tr_b16 v[148:149], v171 offset:32768
    v_mfma_f32_16x16x32_bf16 v[52:55], v[100:103], v[112:115], v[52:55]
    ds_read_b64_tr_b16 v[150:151], v171 offset:34816
    v_mfma_f32_16x16x32_bf16 v[56:59], v[100:103], v[116:119], v[56:59]
    ds_read_b64_tr_b16 v[152:153], v172 offset:32768
    ds_read_b64_tr_b16 v[154:155], v172 offset:34816
    v_mfma_f32_16x16x32_bf16 v[60:63], v[104:107], v[112:115], v[60:63]
    s_add_u32 s58, s58, 128
    s_add_u32 s59, s59, 73728
    v_mfma_f32_16x16x32_bf16 v[64:67], v[104:107], v[116:119], v[64:67]
    s_add_u32 m0, s41, 98304
    s_add_u32 s51, s58, 0
    buffer_load_dwordx4 v0, s[16:19], s51 offen lds
    s_add_u32 m0, s41, 102400
    s_add_u32 s51, s58, 294912
    buffer_load_dwordx4 v0, s[16:19], s51 offen lds
    v_mfma_f32_16x16x32_bf16 v[68:71], v[108:111], v[112:115], v[68:71]
    s_add_u32 m0, s41, 106496
    s_add_u32 s51, s58, 589824
    buffer_load_dwordx4 v0, s[16:19], s51 offen lds
    v_mfma_f32_16x16x32_bf16 v[72:75], v[108:111], v[116:119], v[72:75]
    s_add_u32 m0, s41, 110592
    s_add_u32 s51, s58, 884736
    buffer_load_dwordx4 v0, s[16:19], s51 offen lds
    s_add_u32 m0, s41, 114688
    s_add_u32 s51, s59, 0
    buffer_load_dwordx4 v1, s[20:23], s51 offen lds
    s_waitcnt lgkmcnt(0)
    v_mfma_f32_16x16x32_bf16 v[4:7], v[120:123], v[156:159], v[4:7]
    v_mfma_f32_16x16x32_bf16 v[8:11], v[120:123], v[160:163], v[8:11]
    v_mfma_f32_16x16x32_bf16 v[12:15], v[124:127], v[156:159], v[12:15]
    s_add_u32 m0, s41, 118784
    s_add_u32 s51, s59, 9216
    buffer_load_dwordx4 v2, s[20:23], s51 offen lds
    v_mfma_f32_16x16x32_bf16 v[16:19], v[124:127], v[160:163], v[16:19]
    v_mfma_f32_16x16x32_bf16 v[20:23], v[128:131], v[156:159], v[20:23]
    v_mfma_f32_16x16x32_bf16 v[24:27], v[128:131], v[160:163], v[24:27]
    s_add_u32 m0, s41, 122880
    s_add_u32 s51, s59, 18432
    buffer_load_dwordx4 v1, s[20:23], s51 offen lds
    v_mfma_f32_16x16x32_bf16 v[28:31], v[132:135], v[156:159], v[28:31]
    v_mfma_f32_16x16x32_bf16 v[32:35], v[132:135], v[160:163], v[32:35]
    s_add_u32 m0, s41, 126976
    s_add_u32 s51, s59, 27648
    buffer_load_dwordx4 v2, s[20:23], s51 offen lds
    v_mfma_f32_16x16x32_bf16 v[36:39], v[136:139], v[156:159], v[36:39]
    v_mfma_f32_16x16x32_bf16 v[40:43], v[136:139], v[160:163], v[40:43]
    v_mfma_f32_16x16x32_bf16 v[44:47], v[140:143], v[156:159], v[44:47]
    s_add_u32 m0, s41, 131072
    s_add_u32 s51, s59, 36864
    buffer_load_dwordx4 v1, s[20:23], s51 offen lds
    v_mfma_f32_16x16x32_bf16 v[48:51], v[140:143], v[160:163], v[48:51]
    v_mfma_f32_16x16x32_bf16 v[52:55], v[144:147], v[156:159], v[52:55]
    s_add_u32 m0, s41, 135168
    s_add_u32 s51, s59, 46080
    buffer_load_dwordx4 v2, s[20:23], s51 offen lds
    v_mfma_f32_16x16x32_bf16 v[56:59], v[144:147], v[160:163], v[56:59]
    v_mfma_f32_16x16x32_bf16 v[60:63], v[148:151], v[156:159], v[60:63]
    v_mfma_f32_16x16x32_bf16 v[64:67], v[148:151], v[160:163], v[64:67]
    s_add_u32 m0, s41, 139264
    s_add_u32 s51, s59, 55296
    buffer_load_dwordx4 v1, s[20:23], s51 offen lds
    v_mfma_f32_16x16x32_bf16 v[68:71], v[152:155], v[156:159], v[68:71]
    v_mfma_f32_16x16x32_bf16 v[72:75], v[152:155], v[160:163], v[72:75]
    s_add_u32 m0, s41, 143360
    s_add_u32 s51, s59, 64512
    buffer_load_dwordx4 v2, s[20:23], s51 offen lds
    s_waitcnt vmcnt(12)
    s_barrier
    v_add_u32 v164, 49152, v164
    v_add_u32 v165, 49152, v165
    v_add_u32 v166, 49152, v166
    v_add_u32 v167, 49152, v167
    v_add_u32 v168, 49152, v168
    v_add_u32 v169, 49152, v169
    v_add_u32 v170, 49152, v170
    v_add_u32 v171, 49152, v171
    v_add_u32 v172, 49152, v172
    v_add_u32 v173, 49152, v173
    v_add_u32 v174, 49152, v174
    ds_read_b128 v[112:115], v173 offset:0
    ds_read_b128 v[116:119], v173 offset:2048
    ds_read_b64_tr_b16 v[76:77], v164 offset:16384
    ds_read_b64_tr_b16 v[78:79], v164 offset:18432
    ds_read_b64_tr_b16 v[80:81], v165 offset:16384
    ds_read_b64_tr_b16 v[82:83], v165 offset:18432
    ds_read_b64_tr_b16 v[84:85], v166 offset:16384
    ds_read_b64_tr_b16 v[86:87], v166 offset:18432
    ds_read_b64_tr_b16 v[88:89], v167 offset:16384
    ds_read_b64_tr_b16 v[90:91], v167 offset:18432
    ds_read_b64_tr_b16 v[92:93], v168 offset:16384
    ds_read_b64_tr_b16 v[94:95], v168 offset:18432
    ds_read_b64_tr_b16 v[96:97], v169 offset:16384
    ds_read_b64_tr_b16 v[98:99], v169 offset:18432
    ds_read_b64_tr_b16 v[100:101], v170 offset:16384
    ds_read_b64_tr_b16 v[102:103], v170 offset:18432
    ds_read_b64_tr_b16 v[104:105], v171 offset:16384
    ds_read_b64_tr_b16 v[106:107], v171 offset:18432
    ds_read_b64_tr_b16 v[108:109], v172 offset:16384
    ds_read_b64_tr_b16 v[110:111], v172 offset:18432
    s_waitcnt lgkmcnt(0)
    v_mfma_f32_16x16x32_bf16 v[4:7], v[76:79], v[112:115], v[4:7]
    ds_read_b128 v[156:159], v174 offset:0
    v_mfma_f32_16x16x32_bf16 v[8:11], v[76:79], v[116:119], v[8:11]
    ds_read_b128 v[160:163], v174 offset:2048
    v_mfma_f32_16x16x32_bf16 v[12:15], v[80:83], v[112:115], v[12:15]
    ds_read_b64_tr_b16 v[120:121], v164 offset:32768
    ds_read_b64_tr_b16 v[122:123], v164 offset:34816
    v_mfma_f32_16x16x32_bf16 v[16:19], v[80:83], v[116:119], v[16:19]
    ds_read_b64_tr_b16 v[124:125], v165 offset:32768
    v_mfma_f32_16x16x32_bf16 v[20:23], v[84:87], v[112:115], v[20:23]
    ds_read_b64_tr_b16 v[126:127], v165 offset:34816
    ds_read_b64_tr_b16 v[128:129], v166 offset:32768
    v_mfma_f32_16x16x32_bf16 v[24:27], v[84:87], v[116:119], v[24:27]
    ds_read_b64_tr_b16 v[130:131], v166 offset:34816
    v_mfma_f32_16x16x32_bf16 v[28:31], v[88:91], v[112:115], v[28:31]
    ds_read_b64_tr_b16 v[132:133], v167 offset:32768
    ds_read_b64_tr_b16 v[134:135], v167 offset:34816
    v_mfma_f32_16x16x32_bf16 v[32:35], v[88:91], v[116:119], v[32:35]
    ds_read_b64_tr_b16 v[136:137], v168 offset:32768
    v_mfma_f32_16x16x32_bf16 v[36:39], v[92:95], v[112:115], v[36:39]
    ds_read_b64_tr_b16 v[138:139], v168 offset:34816
    ds_read_b64_tr_b16 v[140:141], v169 offset:32768
    v_mfma_f32_16x16x32_bf16 v[40:43], v[92:95], v[116:119], v[40:43]
    ds_read_b64_tr_b16 v[142:143], v169 offset:34816
    v_mfma_f32_16x16x32_bf16 v[44:47], v[96:99], v[112:115], v[44:47]
    ds_read_b64_tr_b16 v[144:145], v170 offset:32768
    v_mfma_f32_16x16x32_bf16 v[48:51], v[96:99], v[116:119], v[48:51]
    ds_read_b64_tr_b16 v[146:147], v170 offset:34816
    ds_read_b64_tr_b16 v[148:149], v171 offset:32768
    v_mfma_f32_16x16x32_bf16 v[52:55], v[100:103], v[112:115], v[52:55]
    ds_read_b64_tr_b16 v[150:151], v171 offset:34816
    v_mfma_f32_16x16x32_bf16 v[56:59], v[100:103], v[116:119], v[56:59]
    ds_read_b64_tr_b16 v[152:153], v172 offset:32768
    ds_read_b64_tr_b16 v[154:155], v172 offset:34816
    v_mfma_f32_16x16x32_bf16 v[60:63], v[104:107], v[112:115], v[60:63]
    s_add_u32 s58, s58, 128
    s_add_u32 s59, s59, 73728
    v_mfma_f32_16x16x32_bf16 v[64:67], v[104:107], v[116:119], v[64:67]
    s_add_u32 m0, s41, 0
    s_add_u32 s51, s58, 0
    buffer_load_dwordx4 v0, s[16:19], s51 offen lds
    s_add_u32 m0, s41, 4096
    s_add_u32 s51, s58, 294912
    buffer_load_dwordx4 v0, s[16:19], s51 offen lds
    v_mfma_f32_16x16x32_bf16 v[68:71], v[108:111], v[112:115], v[68:71]
    s_add_u32 m0, s41, 8192
    s_add_u32 s51, s58, 589824
    buffer_load_dwordx4 v0, s[16:19], s51 offen lds
    v_mfma_f32_16x16x32_bf16 v[72:75], v[108:111], v[116:119], v[72:75]
    s_add_u32 m0, s41, 12288
    s_add_u32 s51, s58, 884736
    buffer_load_dwordx4 v0, s[16:19], s51 offen lds
    s_add_u32 m0, s41, 16384
    s_add_u32 s51, s59, 0
    buffer_load_dwordx4 v1, s[20:23], s51 offen lds
    s_waitcnt lgkmcnt(0)
    v_mfma_f32_16x16x32_bf16 v[4:7], v[120:123], v[156:159], v[4:7]
    v_mfma_f32_16x16x32_bf16 v[8:11], v[120:123], v[160:163], v[8:11]
    v_mfma_f32_16x16x32_bf16 v[12:15], v[124:127], v[156:159], v[12:15]
    s_add_u32 m0, s41, 20480
    s_add_u32 s51, s59, 9216
    buffer_load_dwordx4 v2, s[20:23], s51 offen lds
    v_mfma_f32_16x16x32_bf16 v[16:19], v[124:127], v[160:163], v[16:19]
    v_mfma_f32_16x16x32_bf16 v[20:23], v[128:131], v[156:159], v[20:23]
    v_mfma_f32_16x16x32_bf16 v[24:27], v[128:131], v[160:163], v[24:27]
    s_add_u32 m0, s41, 24576
    s_add_u32 s51, s59, 18432
    buffer_load_dwordx4 v1, s[20:23], s51 offen lds
    v_mfma_f32_16x16x32_bf16 v[28:31], v[132:135], v[156:159], v[28:31]
    v_mfma_f32_16x16x32_bf16 v[32:35], v[132:135], v[160:163], v[32:35]
    s_add_u32 m0, s41, 28672
    s_add_u32 s51, s59, 27648
    buffer_load_dwordx4 v2, s[20:23], s51 offen lds
    v_mfma_f32_16x16x32_bf16 v[36:39], v[136:139], v[156:159], v[36:39]
    v_mfma_f32_16x16x32_bf16 v[40:43], v[136:139], v[160:163], v[40:43]
    v_mfma_f32_16x16x32_bf16 v[44:47], v[140:143], v[156:159], v[44:47]
    s_add_u32 m0, s41, 32768
    s_add_u32 s51, s59, 36864
    buffer_load_dwordx4 v1, s[20:23], s51 offen lds
    v_mfma_f32_16x16x32_bf16 v[48:51], v[140:143], v[160:163], v[48:51]
    v_mfma_f32_16x16x32_bf16 v[52:55], v[144:147], v[156:159], v[52:55]
    s_add_u32 m0, s41, 36864
    s_add_u32 s51, s59, 46080
    buffer_load_dwordx4 v2, s[20:23], s51 offen lds
    v_mfma_f32_16x16x32_bf16 v[56:59], v[144:147], v[160:163], v[56:59]
    v_mfma_f32_16x16x32_bf16 v[60:63], v[148:151], v[156:159], v[60:63]
    v_mfma_f32_16x16x32_bf16 v[64:67], v[148:151], v[160:163], v[64:67]
    s_add_u32 m0, s41, 40960
    s_add_u32 s51, s59, 55296
    buffer_load_dwordx4 v1, s[20:23], s51 offen lds
    v_mfma_f32_16x16x32_bf16 v[68:71], v[152:155], v[156:159], v[68:71]
    v_mfma_f32_16x16x32_bf16 v[72:75], v[152:155], v[160:163], v[72:75]
    s_add_u32 m0, s41, 45056
    s_add_u32 s51, s59, 64512
    buffer_load_dwordx4 v2, s[20:23], s51 offen lds
    s_waitcnt vmcnt(12)
    s_barrier
    v_add_u32 v164, 49152, v164
    v_add_u32 v165, 49152, v165
    v_add_u32 v166, 49152, v166
    v_add_u32 v167, 49152, v167
    v_add_u32 v168, 49152, v168
    v_add_u32 v169, 49152, v169
    v_add_u32 v170, 49152, v170
    v_add_u32 v171, 49152, v171
    v_add_u32 v172, 49152, v172
    v_add_u32 v173, 49152, v173
    v_add_u32 v174, 49152, v174
    ds_read_b128 v[112:115], v173 offset:0
    ds_read_b128 v[116:119], v173 offset:2048
    ds_read_b64_tr_b16 v[76:77], v164 offset:16384
    ds_read_b64_tr_b16 v[78:79], v164 offset:18432
    ds_read_b64_tr_b16 v[80:81], v165 offset:16384
    ds_read_b64_tr_b16 v[82:83], v165 offset:18432
    ds_read_b64_tr_b16 v[84:85], v166 offset:16384
    ds_read_b64_tr_b16 v[86:87], v166 offset:18432
    ds_read_b64_tr_b16 v[88:89], v167 offset:16384
    ds_read_b64_tr_b16 v[90:91], v167 offset:18432
    ds_read_b64_tr_b16 v[92:93], v168 offset:16384
    ds_read_b64_tr_b16 v[94:95], v168 offset:18432
    ds_read_b64_tr_b16 v[96:97], v169 offset:16384
    ds_read_b64_tr_b16 v[98:99], v169 offset:18432
    ds_read_b64_tr_b16 v[100:101], v170 offset:16384
    ds_read_b64_tr_b16 v[102:103], v170 offset:18432
    ds_read_b64_tr_b16 v[104:105], v171 offset:16384
    ds_read_b64_tr_b16 v[106:107], v171 offset:18432
    ds_read_b64_tr_b16 v[108:109], v172 offset:16384
    ds_read_b64_tr_b16 v[110:111], v172 offset:18432
    s_waitcnt lgkmcnt(0)
    v_mfma_f32_16x16x32_bf16 v[4:7], v[76:79], v[112:115], v[4:7]
    ds_read_b128 v[156:159], v174 offset:0
    v_mfma_f32_16x16x32_bf16 v[8:11], v[76:79], v[116:119], v[8:11]
    ds_read_b128 v[160:163], v174 offset:2048
    v_mfma_f32_16x16x32_bf16 v[12:15], v[80:83], v[112:115], v[12:15]
    ds_read_b64_tr_b16 v[120:121], v164 offset:32768
    ds_read_b64_tr_b16 v[122:123], v164 offset:34816
    v_mfma_f32_16x16x32_bf16 v[16:19], v[80:83], v[116:119], v[16:19]
    ds_read_b64_tr_b16 v[124:125], v165 offset:32768
    v_mfma_f32_16x16x32_bf16 v[20:23], v[84:87], v[112:115], v[20:23]
    ds_read_b64_tr_b16 v[126:127], v165 offset:34816
    ds_read_b64_tr_b16 v[128:129], v166 offset:32768
    v_mfma_f32_16x16x32_bf16 v[24:27], v[84:87], v[116:119], v[24:27]
    ds_read_b64_tr_b16 v[130:131], v166 offset:34816
    v_mfma_f32_16x16x32_bf16 v[28:31], v[88:91], v[112:115], v[28:31]
    ds_read_b64_tr_b16 v[132:133], v167 offset:32768
    ds_read_b64_tr_b16 v[134:135], v167 offset:34816
    v_mfma_f32_16x16x32_bf16 v[32:35], v[88:91], v[116:119], v[32:35]
    ds_read_b64_tr_b16 v[136:137], v168 offset:32768
    v_mfma_f32_16x16x32_bf16 v[36:39], v[92:95], v[112:115], v[36:39]
    ds_read_b64_tr_b16 v[138:139], v168 offset:34816
    ds_read_b64_tr_b16 v[140:141], v169 offset:32768
    v_mfma_f32_16x16x32_bf16 v[40:43], v[92:95], v[116:119], v[40:43]
    ds_read_b64_tr_b16 v[142:143], v169 offset:34816
    v_mfma_f32_16x16x32_bf16 v[44:47], v[96:99], v[112:115], v[44:47]
    ds_read_b64_tr_b16 v[144:145], v170 offset:32768
    v_mfma_f32_16x16x32_bf16 v[48:51], v[96:99], v[116:119], v[48:51]
    ds_read_b64_tr_b16 v[146:147], v170 offset:34816
    ds_read_b64_tr_b16 v[148:149], v171 offset:32768
    v_mfma_f32_16x16x32_bf16 v[52:55], v[100:103], v[112:115], v[52:55]
    ds_read_b64_tr_b16 v[150:151], v171 offset:34816
    v_mfma_f32_16x16x32_bf16 v[56:59], v[100:103], v[116:119], v[56:59]
    ds_read_b64_tr_b16 v[152:153], v172 offset:32768
    ds_read_b64_tr_b16 v[154:155], v172 offset:34816
    v_mfma_f32_16x16x32_bf16 v[60:63], v[104:107], v[112:115], v[60:63]
    s_add_u32 s58, s58, 128
    s_add_u32 s59, s59, 73728
    v_mfma_f32_16x16x32_bf16 v[64:67], v[104:107], v[116:119], v[64:67]
    s_add_u32 m0, s41, 49152
    s_add_u32 s51, s58, 0
    buffer_load_dwordx4 v0, s[16:19], s51 offen lds
    s_add_u32 m0, s41, 53248
    s_add_u32 s51, s58, 294912
    buffer_load_dwordx4 v0, s[16:19], s51 offen lds
    v_mfma_f32_16x16x32_bf16 v[68:71], v[108:111], v[112:115], v[68:71]
    s_add_u32 m0, s41, 57344
    s_add_u32 s51, s58, 589824
    buffer_load_dwordx4 v0, s[16:19], s51 offen lds
    v_mfma_f32_16x16x32_bf16 v[72:75], v[108:111], v[116:119], v[72:75]
    s_add_u32 m0, s41, 61440
    s_add_u32 s51, s58, 884736
    buffer_load_dwordx4 v0, s[16:19], s51 offen lds
    s_add_u32 m0, s41, 65536
    s_add_u32 s51, s59, 0
    buffer_load_dwordx4 v1, s[20:23], s51 offen lds
    s_waitcnt lgkmcnt(0)
    v_mfma_f32_16x16x32_bf16 v[4:7], v[120:123], v[156:159], v[4:7]
    v_mfma_f32_16x16x32_bf16 v[8:11], v[120:123], v[160:163], v[8:11]
    v_mfma_f32_16x16x32_bf16 v[12:15], v[124:127], v[156:159], v[12:15]
    s_add_u32 m0, s41, 69632
    s_add_u32 s51, s59, 9216
    buffer_load_dwordx4 v2, s[20:23], s51 offen lds
    v_mfma_f32_16x16x32_bf16 v[16:19], v[124:127], v[160:163], v[16:19]
    v_mfma_f32_16x16x32_bf16 v[20:23], v[128:131], v[156:159], v[20:23]
    v_mfma_f32_16x16x32_bf16 v[24:27], v[128:131], v[160:163], v[24:27]
    s_add_u32 m0, s41, 73728
    s_add_u32 s51, s59, 18432
    buffer_load_dwordx4 v1, s[20:23], s51 offen lds
    v_mfma_f32_16x16x32_bf16 v[28:31], v[132:135], v[156:159], v[28:31]
    v_mfma_f32_16x16x32_bf16 v[32:35], v[132:135], v[160:163], v[32:35]
    s_add_u32 m0, s41, 77824
    s_add_u32 s51, s59, 27648
    buffer_load_dwordx4 v2, s[20:23], s51 offen lds
    v_mfma_f32_16x16x32_bf16 v[36:39], v[136:139], v[156:159], v[36:39]
    v_mfma_f32_16x16x32_bf16 v[40:43], v[136:139], v[160:163], v[40:43]
    v_mfma_f32_16x16x32_bf16 v[44:47], v[140:143], v[156:159], v[44:47]
    s_add_u32 m0, s41, 81920
    s_add_u32 s51, s59, 36864
    buffer_load_dwordx4 v1, s[20:23], s51 offen lds
    v_mfma_f32_16x16x32_bf16 v[48:51], v[140:143], v[160:163], v[48:51]
    v_mfma_f32_16x16x32_bf16 v[52:55], v[144:147], v[156:159], v[52:55]
    s_add_u32 m0, s41, 86016
    s_add_u32 s51, s59, 46080
    buffer_load_dwordx4 v2, s[20:23], s51 offen lds
    v_mfma_f32_16x16x32_bf16 v[56:59], v[144:147], v[160:163], v[56:59]
    v_mfma_f32_16x16x32_bf16 v[60:63], v[148:151], v[156:159], v[60:63]
    v_mfma_f32_16x16x32_bf16 v[64:67], v[148:151], v[160:163], v[64:67]
    s_add_u32 m0, s41, 90112
    s_add_u32 s51, s59, 55296
    buffer_load_dwordx4 v1, s[20:23], s51 offen lds
    v_mfma_f32_16x16x32_bf16 v[68:71], v[152:155], v[156:159], v[68:71]
    v_mfma_f32_16x16x32_bf16 v[72:75], v[152:155], v[160:163], v[72:75]
    s_add_u32 m0, s41, 94208
    s_add_u32 s51, s59, 64512
    buffer_load_dwordx4 v2, s[20:23], s51 offen lds
    s_waitcnt vmcnt(12)
    s_barrier
    v_subrev_u32 v164, 98304, v164
    v_subrev_u32 v165, 98304, v165
    v_subrev_u32 v166, 98304, v166
    v_subrev_u32 v167, 98304, v167
    v_subrev_u32 v168, 98304, v168
    v_subrev_u32 v169, 98304, v169
    v_subrev_u32 v170, 98304, v170
    v_subrev_u32 v171, 98304, v171
    v_subrev_u32 v172, 98304, v172
    v_subrev_u32 v173, 98304, v173
    v_subrev_u32 v174, 98304, v174
    ds_read_b128 v[112:115], v173 offset:0
    ds_read_b128 v[116:119], v173 offset:2048
    ds_read_b64_tr_b16 v[76:77], v164 offset:16384
    ds_read_b64_tr_b16 v[78:79], v164 offset:18432
    ds_read_b64_tr_b16 v[80:81], v165 offset:16384
    ds_read_b64_tr_b16 v[82:83], v165 offset:18432
    ds_read_b64_tr_b16 v[84:85], v166 offset:16384
    ds_read_b64_tr_b16 v[86:87], v166 offset:18432
    ds_read_b64_tr_b16 v[88:89], v167 offset:16384
    ds_read_b64_tr_b16 v[90:91], v167 offset:18432
    ds_read_b64_tr_b16 v[92:93], v168 offset:16384
    ds_read_b64_tr_b16 v[94:95], v168 offset:18432
    ds_read_b64_tr_b16 v[96:97], v169 offset:16384
    ds_read_b64_tr_b16 v[98:99], v169 offset:18432
    ds_read_b64_tr_b16 v[100:101], v170 offset:16384
    ds_read_b64_tr_b16 v[102:103], v170 offset:18432
    ds_read_b64_tr_b16 v[104:105], v171 offset:16384
    ds_read_b64_tr_b16 v[106:107], v171 offset:18432
    ds_read_b64_tr_b16 v[108:109], v172 offset:16384
    ds_read_b64_tr_b16 v[110:111], v172 offset:18432
    s_waitcnt lgkmcnt(0)
    v_mfma_f32_16x16x32_bf16 v[4:7], v[76:79], v[112:115], v[4:7]
    ds_read_b128 v[156:159], v174 offset:0
    v_mfma_f32_16x16x32_bf16 v[8:11], v[76:79], v[116:119], v[8:11]
    ds_read_b128 v[160:163], v174 offset:2048
    v_mfma_f32_16x16x32_bf16 v[12:15], v[80:83], v[112:115], v[12:15]
    ds_read_b64_tr_b16 v[120:121], v164 offset:32768
    ds_read_b64_tr_b16 v[122:123], v164 offset:34816
    v_mfma_f32_16x16x32_bf16 v[16:19], v[80:83], v[116:119], v[16:19]
    ds_read_b64_tr_b16 v[124:125], v165 offset:32768
    v_mfma_f32_16x16x32_bf16 v[20:23], v[84:87], v[112:115], v[20:23]
    ds_read_b64_tr_b16 v[126:127], v165 offset:34816
    ds_read_b64_tr_b16 v[128:129], v166 offset:32768
    v_mfma_f32_16x16x32_bf16 v[24:27], v[84:87], v[116:119], v[24:27]
    ds_read_b64_tr_b16 v[130:131], v166 offset:34816
    v_mfma_f32_16x16x32_bf16 v[28:31], v[88:91], v[112:115], v[28:31]
    ds_read_b64_tr_b16 v[132:133], v167 offset:32768
    ds_read_b64_tr_b16 v[134:135], v167 offset:34816
    v_mfma_f32_16x16x32_bf16 v[32:35], v[88:91], v[116:119], v[32:35]
    ds_read_b64_tr_b16 v[136:137], v168 offset:32768
    v_mfma_f32_16x16x32_bf16 v[36:39], v[92:95], v[112:115], v[36:39]
    ds_read_b64_tr_b16 v[138:139], v168 offset:34816
    ds_read_b64_tr_b16 v[140:141], v169 offset:32768
    v_mfma_f32_16x16x32_bf16 v[40:43], v[92:95], v[116:119], v[40:43]
    ds_read_b64_tr_b16 v[142:143], v169 offset:34816
    v_mfma_f32_16x16x32_bf16 v[44:47], v[96:99], v[112:115], v[44:47]
    ds_read_b64_tr_b16 v[144:145], v170 offset:32768
    v_mfma_f32_16x16x32_bf16 v[48:51], v[96:99], v[116:119], v[48:51]
    ds_read_b64_tr_b16 v[146:147], v170 offset:34816
    ds_read_b64_tr_b16 v[148:149], v171 offset:32768
    v_mfma_f32_16x16x32_bf16 v[52:55], v[100:103], v[112:115], v[52:55]
    ds_read_b64_tr_b16 v[150:151], v171 offset:34816
    v_mfma_f32_16x16x32_bf16 v[56:59], v[100:103], v[116:119], v[56:59]
    ds_read_b64_tr_b16 v[152:153], v172 offset:32768
    ds_read_b64_tr_b16 v[154:155], v172 offset:34816
    v_mfma_f32_16x16x32_bf16 v[60:63], v[104:107], v[112:115], v[60:63]
    s_add_u32 s58, s58, 128
    s_add_u32 s59, s59, 73728
    v_mfma_f32_16x16x32_bf16 v[64:67], v[104:107], v[116:119], v[64:67]
    s_add_u32 m0, s41, 98304
    s_add_u32 s51, s58, 0
    buffer_load_dwordx4 v0, s[16:19], s51 offen lds
    s_add_u32 m0, s41, 102400
    s_add_u32 s51, s58, 294912
    buffer_load_dwordx4 v0, s[16:19], s51 offen lds
    v_mfma_f32_16x16x32_bf16 v[68:71], v[108:111], v[112:115], v[68:71]
    s_add_u32 m0, s41, 106496
    s_add_u32 s51, s58, 589824
    buffer_load_dwordx4 v0, s[16:19], s51 offen lds
    v_mfma_f32_16x16x32_bf16 v[72:75], v[108:111], v[116:119], v[72:75]
    s_add_u32 m0, s41, 110592
    s_add_u32 s51, s58, 884736
    buffer_load_dwordx4 v0, s[16:19], s51 offen lds
    s_add_u32 m0, s41, 114688
    s_add_u32 s51, s59, 0
    buffer_load_dwordx4 v1, s[20:23], s51 offen lds
    s_waitcnt lgkmcnt(0)
    v_mfma_f32_16x16x32_bf16 v[4:7], v[120:123], v[156:159], v[4:7]
    v_mfma_f32_16x16x32_bf16 v[8:11], v[120:123], v[160:163], v[8:11]
    v_mfma_f32_16x16x32_bf16 v[12:15], v[124:127], v[156:159], v[12:15]
    s_add_u32 m0, s41, 118784
    s_add_u32 s51, s59, 9216
    buffer_load_dwordx4 v2, s[20:23], s51 offen lds
    v_mfma_f32_16x16x32_bf16 v[16:19], v[124:127], v[160:163], v[16:19]
    v_mfma_f32_16x16x32_bf16 v[20:23], v[128:131], v[156:159], v[20:23]
    v_mfma_f32_16x16x32_bf16 v[24:27], v[128:131], v[160:163], v[24:27]
    s_add_u32 m0, s41, 122880
    s_add_u32 s51, s59, 18432
    buffer_load_dwordx4 v1, s[20:23], s51 offen lds
    v_mfma_f32_16x16x32_bf16 v[28:31], v[132:135], v[156:159], v[28:31]
    v_mfma_f32_16x16x32_bf16 v[32:35], v[132:135], v[160:163], v[32:35]
    s_add_u32 m0, s41, 126976
    s_add_u32 s51, s59, 27648
    buffer_load_dwordx4 v2, s[20:23], s51 offen lds
    v_mfma_f32_16x16x32_bf16 v[36:39], v[136:139], v[156:159], v[36:39]
    v_mfma_f32_16x16x32_bf16 v[40:43], v[136:139], v[160:163], v[40:43]
    v_mfma_f32_16x16x32_bf16 v[44:47], v[140:143], v[156:159], v[44:47]
    s_add_u32 m0, s41, 131072
    s_add_u32 s51, s59, 36864
    buffer_load_dwordx4 v1, s[20:23], s51 offen lds
    v_mfma_f32_16x16x32_bf16 v[48:51], v[140:143], v[160:163], v[48:51]
    v_mfma_f32_16x16x32_bf16 v[52:55], v[144:147], v[156:159], v[52:55]
    s_add_u32 m0, s41, 135168
    s_add_u32 s51, s59, 46080
    buffer_load_dwordx4 v2, s[20:23], s51 offen lds
    v_mfma_f32_16x16x32_bf16 v[56:59], v[144:147], v[160:163], v[56:59]
    v_mfma_f32_16x16x32_bf16 v[60:63], v[148:151], v[156:159], v[60:63]
    v_mfma_f32_16x16x32_bf16 v[64:67], v[148:151], v[160:163], v[64:67]
    s_add_u32 m0, s41, 139264
    s_add_u32 s51, s59, 55296
    buffer_load_dwordx4 v1, s[20:23], s51 offen lds
    v_mfma_f32_16x16x32_bf16 v[68:71], v[152:155], v[156:159], v[68:71]
    v_mfma_f32_16x16x32_bf16 v[72:75], v[152:155], v[160:163], v[72:75]
    s_add_u32 m0, s41, 143360
    s_add_u32 s51, s59, 64512
    buffer_load_dwordx4 v2, s[20:23], s51 offen lds
    s_waitcnt vmcnt(12)
    s_barrier
    v_add_u32 v164, 49152, v164
    v_add_u32 v165, 49152, v165
    v_add_u32 v166, 49152, v166
    v_add_u32 v167, 49152, v167
    v_add_u32 v168, 49152, v168
    v_add_u32 v169, 49152, v169
    v_add_u32 v170, 49152, v170
    v_add_u32 v171, 49152, v171
    v_add_u32 v172, 49152, v172
    v_add_u32 v173, 49152, v173
    v_add_u32 v174, 49152, v174
    ds_read_b128 v[112:115], v173 offset:0
    ds_read_b128 v[116:119], v173 offset:2048
    ds_read_b64_tr_b16 v[76:77], v164 offset:16384
    ds_read_b64_tr_b16 v[78:79], v164 offset:18432
    ds_read_b64_tr_b16 v[80:81], v165 offset:16384
    ds_read_b64_tr_b16 v[82:83], v165 offset:18432
    ds_read_b64_tr_b16 v[84:85], v166 offset:16384
    ds_read_b64_tr_b16 v[86:87], v166 offset:18432
    ds_read_b64_tr_b16 v[88:89], v167 offset:16384
    ds_read_b64_tr_b16 v[90:91], v167 offset:18432
    ds_read_b64_tr_b16 v[92:93], v168 offset:16384
    ds_read_b64_tr_b16 v[94:95], v168 offset:18432
    ds_read_b64_tr_b16 v[96:97], v169 offset:16384
    ds_read_b64_tr_b16 v[98:99], v169 offset:18432
    ds_read_b64_tr_b16 v[100:101], v170 offset:16384
    ds_read_b64_tr_b16 v[102:103], v170 offset:18432
    ds_read_b64_tr_b16 v[104:105], v171 offset:16384
    ds_read_b64_tr_b16 v[106:107], v171 offset:18432
    ds_read_b64_tr_b16 v[108:109], v172 offset:16384
    ds_read_b64_tr_b16 v[110:111], v172 offset:18432
    s_waitcnt lgkmcnt(0)
    v_mfma_f32_16x16x32_bf16 v[4:7], v[76:79], v[112:115], v[4:7]
    ds_read_b128 v[156:159], v174 offset:0
    v_mfma_f32_16x16x32_bf16 v[8:11], v[76:79], v[116:119], v[8:11]
    ds_read_b128 v[160:163], v174 offset:2048
    v_mfma_f32_16x16x32_bf16 v[12:15], v[80:83], v[112:115], v[12:15]
    ds_read_b64_tr_b16 v[120:121], v164 offset:32768
    ds_read_b64_tr_b16 v[122:123], v164 offset:34816
    v_mfma_f32_16x16x32_bf16 v[16:19], v[80:83], v[116:119], v[16:19]
    ds_read_b64_tr_b16 v[124:125], v165 offset:32768
    v_mfma_f32_16x16x32_bf16 v[20:23], v[84:87], v[112:115], v[20:23]
    ds_read_b64_tr_b16 v[126:127], v165 offset:34816
    ds_read_b64_tr_b16 v[128:129], v166 offset:32768
    v_mfma_f32_16x16x32_bf16 v[24:27], v[84:87], v[116:119], v[24:27]
    ds_read_b64_tr_b16 v[130:131], v166 offset:34816
    v_mfma_f32_16x16x32_bf16 v[28:31], v[88:91], v[112:115], v[28:31]
    ds_read_b64_tr_b16 v[132:133], v167 offset:32768
    ds_read_b64_tr_b16 v[134:135], v167 offset:34816
    v_mfma_f32_16x16x32_bf16 v[32:35], v[88:91], v[116:119], v[32:35]
    ds_read_b64_tr_b16 v[136:137], v168 offset:32768
    v_mfma_f32_16x16x32_bf16 v[36:39], v[92:95], v[112:115], v[36:39]
    ds_read_b64_tr_b16 v[138:139], v168 offset:34816
    ds_read_b64_tr_b16 v[140:141], v169 offset:32768
    v_mfma_f32_16x16x32_bf16 v[40:43], v[92:95], v[116:119], v[40:43]
    ds_read_b64_tr_b16 v[142:143], v169 offset:34816
    v_mfma_f32_16x16x32_bf16 v[44:47], v[96:99], v[112:115], v[44:47]
    ds_read_b64_tr_b16 v[144:145], v170 offset:32768
    v_mfma_f32_16x16x32_bf16 v[48:51], v[96:99], v[116:119], v[48:51]
    ds_read_b64_tr_b16 v[146:147], v170 offset:34816
    ds_read_b64_tr_b16 v[148:149], v171 offset:32768
    v_mfma_f32_16x16x32_bf16 v[52:55], v[100:103], v[112:115], v[52:55]
    ds_read_b64_tr_b16 v[150:151], v171 offset:34816
    v_mfma_f32_16x16x32_bf16 v[56:59], v[100:103], v[116:119], v[56:59]
    ds_read_b64_tr_b16 v[152:153], v172 offset:32768
    ds_read_b64_tr_b16 v[154:155], v172 offset:34816
    v_mfma_f32_16x16x32_bf16 v[60:63], v[104:107], v[112:115], v[60:63]
    s_add_u32 s58, s58, 128
    s_add_u32 s59, s59, 73728
    v_mfma_f32_16x16x32_bf16 v[64:67], v[104:107], v[116:119], v[64:67]
    s_add_u32 m0, s41, 0
    s_add_u32 s51, s58, 0
    buffer_load_dwordx4 v0, s[16:19], s51 offen lds
    s_add_u32 m0, s41, 4096
    s_add_u32 s51, s58, 294912
    buffer_load_dwordx4 v0, s[16:19], s51 offen lds
    v_mfma_f32_16x16x32_bf16 v[68:71], v[108:111], v[112:115], v[68:71]
    s_add_u32 m0, s41, 8192
    s_add_u32 s51, s58, 589824
    buffer_load_dwordx4 v0, s[16:19], s51 offen lds
    v_mfma_f32_16x16x32_bf16 v[72:75], v[108:111], v[116:119], v[72:75]
    s_add_u32 m0, s41, 12288
    s_add_u32 s51, s58, 884736
    buffer_load_dwordx4 v0, s[16:19], s51 offen lds
    s_add_u32 m0, s41, 16384
    s_add_u32 s51, s59, 0
    buffer_load_dwordx4 v1, s[20:23], s51 offen lds
    s_waitcnt lgkmcnt(0)
    v_mfma_f32_16x16x32_bf16 v[4:7], v[120:123], v[156:159], v[4:7]
    v_mfma_f32_16x16x32_bf16 v[8:11], v[120:123], v[160:163], v[8:11]
    v_mfma_f32_16x16x32_bf16 v[12:15], v[124:127], v[156:159], v[12:15]
    s_add_u32 m0, s41, 20480
    s_add_u32 s51, s59, 9216
    buffer_load_dwordx4 v2, s[20:23], s51 offen lds
    v_mfma_f32_16x16x32_bf16 v[16:19], v[124:127], v[160:163], v[16:19]
    v_mfma_f32_16x16x32_bf16 v[20:23], v[128:131], v[156:159], v[20:23]
    v_mfma_f32_16x16x32_bf16 v[24:27], v[128:131], v[160:163], v[24:27]
    s_add_u32 m0, s41, 24576
    s_add_u32 s51, s59, 18432
    buffer_load_dwordx4 v1, s[20:23], s51 offen lds
    v_mfma_f32_16x16x32_bf16 v[28:31], v[132:135], v[156:159], v[28:31]
    v_mfma_f32_16x16x32_bf16 v[32:35], v[132:135], v[160:163], v[32:35]
    s_add_u32 m0, s41, 28672
    s_add_u32 s51, s59, 27648
    buffer_load_dwordx4 v2, s[20:23], s51 offen lds
    v_mfma_f32_16x16x32_bf16 v[36:39], v[136:139], v[156:159], v[36:39]
    v_mfma_f32_16x16x32_bf16 v[40:43], v[136:139], v[160:163], v[40:43]
    v_mfma_f32_16x16x32_bf16 v[44:47], v[140:143], v[156:159], v[44:47]
    s_add_u32 m0, s41, 32768
    s_add_u32 s51, s59, 36864
    buffer_load_dwordx4 v1, s[20:23], s51 offen lds
    v_mfma_f32_16x16x32_bf16 v[48:51], v[140:143], v[160:163], v[48:51]
    v_mfma_f32_16x16x32_bf16 v[52:55], v[144:147], v[156:159], v[52:55]
    s_add_u32 m0, s41, 36864
    s_add_u32 s51, s59, 46080
    buffer_load_dwordx4 v2, s[20:23], s51 offen lds
    v_mfma_f32_16x16x32_bf16 v[56:59], v[144:147], v[160:163], v[56:59]
    v_mfma_f32_16x16x32_bf16 v[60:63], v[148:151], v[156:159], v[60:63]
    v_mfma_f32_16x16x32_bf16 v[64:67], v[148:151], v[160:163], v[64:67]
    s_add_u32 m0, s41, 40960
    s_add_u32 s51, s59, 55296
    buffer_load_dwordx4 v1, s[20:23], s51 offen lds
    v_mfma_f32_16x16x32_bf16 v[68:71], v[152:155], v[156:159], v[68:71]
    v_mfma_f32_16x16x32_bf16 v[72:75], v[152:155], v[160:163], v[72:75]
    s_add_u32 m0, s41, 45056
    s_add_u32 s51, s59, 64512
    buffer_load_dwordx4 v2, s[20:23], s51 offen lds
    s_waitcnt vmcnt(12)
    s_barrier
    v_add_u32 v164, 49152, v164
    v_add_u32 v165, 49152, v165
    v_add_u32 v166, 49152, v166
    v_add_u32 v167, 49152, v167
    v_add_u32 v168, 49152, v168
    v_add_u32 v169, 49152, v169
    v_add_u32 v170, 49152, v170
    v_add_u32 v171, 49152, v171
    v_add_u32 v172, 49152, v172
    v_add_u32 v173, 49152, v173
    v_add_u32 v174, 49152, v174
    ds_read_b128 v[112:115], v173 offset:0
    ds_read_b128 v[116:119], v173 offset:2048
    ds_read_b64_tr_b16 v[76:77], v164 offset:16384
    ds_read_b64_tr_b16 v[78:79], v164 offset:18432
    ds_read_b64_tr_b16 v[80:81], v165 offset:16384
    ds_read_b64_tr_b16 v[82:83], v165 offset:18432
    ds_read_b64_tr_b16 v[84:85], v166 offset:16384
    ds_read_b64_tr_b16 v[86:87], v166 offset:18432
    ds_read_b64_tr_b16 v[88:89], v167 offset:16384
    ds_read_b64_tr_b16 v[90:91], v167 offset:18432
    ds_read_b64_tr_b16 v[92:93], v168 offset:16384
    ds_read_b64_tr_b16 v[94:95], v168 offset:18432
    ds_read_b64_tr_b16 v[96:97], v169 offset:16384
    ds_read_b64_tr_b16 v[98:99], v169 offset:18432
    ds_read_b64_tr_b16 v[100:101], v170 offset:16384
    ds_read_b64_tr_b16 v[102:103], v170 offset:18432
    ds_read_b64_tr_b16 v[104:105], v171 offset:16384
    ds_read_b64_tr_b16 v[106:107], v171 offset:18432
    ds_read_b64_tr_b16 v[108:109], v172 offset:16384
    ds_read_b64_tr_b16 v[110:111], v172 offset:18432
    s_waitcnt lgkmcnt(0)
    v_mfma_f32_16x16x32_bf16 v[4:7], v[76:79], v[112:115], v[4:7]
    ds_read_b128 v[156:159], v174 offset:0
    v_mfma_f32_16x16x32_bf16 v[8:11], v[76:79], v[116:119], v[8:11]
    ds_read_b128 v[160:163], v174 offset:2048
    v_mfma_f32_16x16x32_bf16 v[12:15], v[80:83], v[112:115], v[12:15]
    ds_read_b64_tr_b16 v[120:121], v164 offset:32768
    ds_read_b64_tr_b16 v[122:123], v164 offset:34816
    v_mfma_f32_16x16x32_bf16 v[16:19], v[80:83], v[116:119], v[16:19]
    ds_read_b64_tr_b16 v[124:125], v165 offset:32768
    v_mfma_f32_16x16x32_bf16 v[20:23], v[84:87], v[112:115], v[20:23]
    ds_read_b64_tr_b16 v[126:127], v165 offset:34816
    ds_read_b64_tr_b16 v[128:129], v166 offset:32768
    v_mfma_f32_16x16x32_bf16 v[24:27], v[84:87], v[116:119], v[24:27]
    ds_read_b64_tr_b16 v[130:131], v166 offset:34816
    v_mfma_f32_16x16x32_bf16 v[28:31], v[88:91], v[112:115], v[28:31]
    ds_read_b64_tr_b16 v[132:133], v167 offset:32768
    ds_read_b64_tr_b16 v[134:135], v167 offset:34816
    v_mfma_f32_16x16x32_bf16 v[32:35], v[88:91], v[116:119], v[32:35]
    ds_read_b64_tr_b16 v[136:137], v168 offset:32768
    v_mfma_f32_16x16x32_bf16 v[36:39], v[92:95], v[112:115], v[36:39]
    ds_read_b64_tr_b16 v[138:139], v168 offset:34816
    ds_read_b64_tr_b16 v[140:141], v169 offset:32768
    v_mfma_f32_16x16x32_bf16 v[40:43], v[92:95], v[116:119], v[40:43]
    ds_read_b64_tr_b16 v[142:143], v169 offset:34816
    v_mfma_f32_16x16x32_bf16 v[44:47], v[96:99], v[112:115], v[44:47]
    ds_read_b64_tr_b16 v[144:145], v170 offset:32768
    v_mfma_f32_16x16x32_bf16 v[48:51], v[96:99], v[116:119], v[48:51]
    ds_read_b64_tr_b16 v[146:147], v170 offset:34816
    ds_read_b64_tr_b16 v[148:149], v171 offset:32768
    v_mfma_f32_16x16x32_bf16 v[52:55], v[100:103], v[112:115], v[52:55]
    ds_read_b64_tr_b16 v[150:151], v171 offset:34816
    v_mfma_f32_16x16x32_bf16 v[56:59], v[100:103], v[116:119], v[56:59]
    ds_read_b64_tr_b16 v[152:153], v172 offset:32768
    ds_read_b64_tr_b16 v[154:155], v172 offset:34816
    v_mfma_f32_16x16x32_bf16 v[60:63], v[104:107], v[112:115], v[60:63]
    s_add_u32 s58, s58, 128
    s_add_u32 s59, s59, 73728
    v_mfma_f32_16x16x32_bf16 v[64:67], v[104:107], v[116:119], v[64:67]
    s_add_u32 m0, s41, 49152
    s_add_u32 s51, s58, 0
    buffer_load_dwordx4 v0, s[16:19], s51 offen lds
    s_add_u32 m0, s41, 53248
    s_add_u32 s51, s58, 294912
    buffer_load_dwordx4 v0, s[16:19], s51 offen lds
    v_mfma_f32_16x16x32_bf16 v[68:71], v[108:111], v[112:115], v[68:71]
    s_add_u32 m0, s41, 57344
    s_add_u32 s51, s58, 589824
    buffer_load_dwordx4 v0, s[16:19], s51 offen lds
    v_mfma_f32_16x16x32_bf16 v[72:75], v[108:111], v[116:119], v[72:75]
    s_add_u32 m0, s41, 61440
    s_add_u32 s51, s58, 884736
    buffer_load_dwordx4 v0, s[16:19], s51 offen lds
    s_add_u32 m0, s41, 65536
    s_add_u32 s51, s59, 0
    buffer_load_dwordx4 v1, s[20:23], s51 offen lds
    s_waitcnt lgkmcnt(0)
    v_mfma_f32_16x16x32_bf16 v[4:7], v[120:123], v[156:159], v[4:7]
    v_mfma_f32_16x16x32_bf16 v[8:11], v[120:123], v[160:163], v[8:11]
    v_mfma_f32_16x16x32_bf16 v[12:15], v[124:127], v[156:159], v[12:15]
    s_add_u32 m0, s41, 69632
    s_add_u32 s51, s59, 9216
    buffer_load_dwordx4 v2, s[20:23], s51 offen lds
    v_mfma_f32_16x16x32_bf16 v[16:19], v[124:127], v[160:163], v[16:19]
    v_mfma_f32_16x16x32_bf16 v[20:23], v[128:131], v[156:159], v[20:23]
    v_mfma_f32_16x16x32_bf16 v[24:27], v[128:131], v[160:163], v[24:27]
    s_add_u32 m0, s41, 73728
    s_add_u32 s51, s59, 18432
    buffer_load_dwordx4 v1, s[20:23], s51 offen lds
    v_mfma_f32_16x16x32_bf16 v[28:31], v[132:135], v[156:159], v[28:31]
    v_mfma_f32_16x16x32_bf16 v[32:35], v[132:135], v[160:163], v[32:35]
    s_add_u32 m0, s41, 77824
    s_add_u32 s51, s59, 27648
    buffer_load_dwordx4 v2, s[20:23], s51 offen lds
    v_mfma_f32_16x16x32_bf16 v[36:39], v[136:139], v[156:159], v[36:39]
    v_mfma_f32_16x16x32_bf16 v[40:43], v[136:139], v[160:163], v[40:43]
    v_mfma_f32_16x16x32_bf16 v[44:47], v[140:143], v[156:159], v[44:47]
    s_add_u32 m0, s41, 81920
    s_add_u32 s51, s59, 36864
    buffer_load_dwordx4 v1, s[20:23], s51 offen lds
    v_mfma_f32_16x16x32_bf16 v[48:51], v[140:143], v[160:163], v[48:51]
    v_mfma_f32_16x16x32_bf16 v[52:55], v[144:147], v[156:159], v[52:55]
    s_add_u32 m0, s41, 86016
    s_add_u32 s51, s59, 46080
    buffer_load_dwordx4 v2, s[20:23], s51 offen lds
    v_mfma_f32_16x16x32_bf16 v[56:59], v[144:147], v[160:163], v[56:59]
    v_mfma_f32_16x16x32_bf16 v[60:63], v[148:151], v[156:159], v[60:63]
    v_mfma_f32_16x16x32_bf16 v[64:67], v[148:151], v[160:163], v[64:67]
    s_add_u32 m0, s41, 90112
    s_add_u32 s51, s59, 55296
    buffer_load_dwordx4 v1, s[20:23], s51 offen lds
    v_mfma_f32_16x16x32_bf16 v[68:71], v[152:155], v[156:159], v[68:71]
    v_mfma_f32_16x16x32_bf16 v[72:75], v[152:155], v[160:163], v[72:75]
    s_add_u32 m0, s41, 94208
    s_add_u32 s51, s59, 64512
    buffer_load_dwordx4 v2, s[20:23], s51 offen lds
    s_waitcnt vmcnt(12)
    s_barrier
    v_subrev_u32 v164, 98304, v164
    v_subrev_u32 v165, 98304, v165
    v_subrev_u32 v166, 98304, v166
    v_subrev_u32 v167, 98304, v167
    v_subrev_u32 v168, 98304, v168
    v_subrev_u32 v169, 98304, v169
    v_subrev_u32 v170, 98304, v170
    v_subrev_u32 v171, 98304, v171
    v_subrev_u32 v172, 98304, v172
    v_subrev_u32 v173, 98304, v173
    v_subrev_u32 v174, 98304, v174
    ds_read_b128 v[112:115], v173 offset:0
    ds_read_b128 v[116:119], v173 offset:2048
    ds_read_b64_tr_b16 v[76:77], v164 offset:16384
    ds_read_b64_tr_b16 v[78:79], v164 offset:18432
    ds_read_b64_tr_b16 v[80:81], v165 offset:16384
    ds_read_b64_tr_b16 v[82:83], v165 offset:18432
    ds_read_b64_tr_b16 v[84:85], v166 offset:16384
    ds_read_b64_tr_b16 v[86:87], v166 offset:18432
    ds_read_b64_tr_b16 v[88:89], v167 offset:16384
    ds_read_b64_tr_b16 v[90:91], v167 offset:18432
    ds_read_b64_tr_b16 v[92:93], v168 offset:16384
    ds_read_b64_tr_b16 v[94:95], v168 offset:18432
    ds_read_b64_tr_b16 v[96:97], v169 offset:16384
    ds_read_b64_tr_b16 v[98:99], v169 offset:18432
    ds_read_b64_tr_b16 v[100:101], v170 offset:16384
    ds_read_b64_tr_b16 v[102:103], v170 offset:18432
    ds_read_b64_tr_b16 v[104:105], v171 offset:16384
    ds_read_b64_tr_b16 v[106:107], v171 offset:18432
    ds_read_b64_tr_b16 v[108:109], v172 offset:16384
    ds_read_b64_tr_b16 v[110:111], v172 offset:18432
    s_waitcnt lgkmcnt(0)
    v_mfma_f32_16x16x32_bf16 v[4:7], v[76:79], v[112:115], v[4:7]
    ds_read_b128 v[156:159], v174 offset:0
    v_mfma_f32_16x16x32_bf16 v[8:11], v[76:79], v[116:119], v[8:11]
    ds_read_b128 v[160:163], v174 offset:2048
    v_mfma_f32_16x16x32_bf16 v[12:15], v[80:83], v[112:115], v[12:15]
    ds_read_b64_tr_b16 v[120:121], v164 offset:32768
    ds_read_b64_tr_b16 v[122:123], v164 offset:34816
    v_mfma_f32_16x16x32_bf16 v[16:19], v[80:83], v[116:119], v[16:19]
    ds_read_b64_tr_b16 v[124:125], v165 offset:32768
    v_mfma_f32_16x16x32_bf16 v[20:23], v[84:87], v[112:115], v[20:23]
    ds_read_b64_tr_b16 v[126:127], v165 offset:34816
    ds_read_b64_tr_b16 v[128:129], v166 offset:32768
    v_mfma_f32_16x16x32_bf16 v[24:27], v[84:87], v[116:119], v[24:27]
    ds_read_b64_tr_b16 v[130:131], v166 offset:34816
    v_mfma_f32_16x16x32_bf16 v[28:31], v[88:91], v[112:115], v[28:31]
    ds_read_b64_tr_b16 v[132:133], v167 offset:32768
    ds_read_b64_tr_b16 v[134:135], v167 offset:34816
    v_mfma_f32_16x16x32_bf16 v[32:35], v[88:91], v[116:119], v[32:35]
    ds_read_b64_tr_b16 v[136:137], v168 offset:32768
    v_mfma_f32_16x16x32_bf16 v[36:39], v[92:95], v[112:115], v[36:39]
    ds_read_b64_tr_b16 v[138:139], v168 offset:34816
    ds_read_b64_tr_b16 v[140:141], v169 offset:32768
    v_mfma_f32_16x16x32_bf16 v[40:43], v[92:95], v[116:119], v[40:43]
    ds_read_b64_tr_b16 v[142:143], v169 offset:34816
    v_mfma_f32_16x16x32_bf16 v[44:47], v[96:99], v[112:115], v[44:47]
    ds_read_b64_tr_b16 v[144:145], v170 offset:32768
    v_mfma_f32_16x16x32_bf16 v[48:51], v[96:99], v[116:119], v[48:51]
    ds_read_b64_tr_b16 v[146:147], v170 offset:34816
    ds_read_b64_tr_b16 v[148:149], v171 offset:32768
    v_mfma_f32_16x16x32_bf16 v[52:55], v[100:103], v[112:115], v[52:55]
    ds_read_b64_tr_b16 v[150:151], v171 offset:34816
    v_mfma_f32_16x16x32_bf16 v[56:59], v[100:103], v[116:119], v[56:59]
    ds_read_b64_tr_b16 v[152:153], v172 offset:32768
    ds_read_b64_tr_b16 v[154:155], v172 offset:34816
    v_mfma_f32_16x16x32_bf16 v[60:63], v[104:107], v[112:115], v[60:63]
    s_add_u32 s58, s58, 128
    s_add_u32 s59, s59, 73728
    v_mfma_f32_16x16x32_bf16 v[64:67], v[104:107], v[116:119], v[64:67]
    s_add_u32 m0, s41, 98304
    s_add_u32 s51, s58, 0
    buffer_load_dwordx4 v0, s[16:19], s51 offen lds
    s_add_u32 m0, s41, 102400
    s_add_u32 s51, s58, 294912
    buffer_load_dwordx4 v0, s[16:19], s51 offen lds
    v_mfma_f32_16x16x32_bf16 v[68:71], v[108:111], v[112:115], v[68:71]
    s_add_u32 m0, s41, 106496
    s_add_u32 s51, s58, 589824
    buffer_load_dwordx4 v0, s[16:19], s51 offen lds
    v_mfma_f32_16x16x32_bf16 v[72:75], v[108:111], v[116:119], v[72:75]
    s_add_u32 m0, s41, 110592
    s_add_u32 s51, s58, 884736
    buffer_load_dwordx4 v0, s[16:19], s51 offen lds
    s_add_u32 m0, s41, 114688
    s_add_u32 s51, s59, 0
    buffer_load_dwordx4 v1, s[20:23], s51 offen lds
    s_waitcnt lgkmcnt(0)
    v_mfma_f32_16x16x32_bf16 v[4:7], v[120:123], v[156:159], v[4:7]
    v_mfma_f32_16x16x32_bf16 v[8:11], v[120:123], v[160:163], v[8:11]
    v_mfma_f32_16x16x32_bf16 v[12:15], v[124:127], v[156:159], v[12:15]
    s_add_u32 m0, s41, 118784
    s_add_u32 s51, s59, 9216
    buffer_load_dwordx4 v2, s[20:23], s51 offen lds
    v_mfma_f32_16x16x32_bf16 v[16:19], v[124:127], v[160:163], v[16:19]
    v_mfma_f32_16x16x32_bf16 v[20:23], v[128:131], v[156:159], v[20:23]
    v_mfma_f32_16x16x32_bf16 v[24:27], v[128:131], v[160:163], v[24:27]
    s_add_u32 m0, s41, 122880
    s_add_u32 s51, s59, 18432
    buffer_load_dwordx4 v1, s[20:23], s51 offen lds
    v_mfma_f32_16x16x32_bf16 v[28:31], v[132:135], v[156:159], v[28:31]
    v_mfma_f32_16x16x32_bf16 v[32:35], v[132:135], v[160:163], v[32:35]
    s_add_u32 m0, s41, 126976
    s_add_u32 s51, s59, 27648
    buffer_load_dwordx4 v2, s[20:23], s51 offen lds
    v_mfma_f32_16x16x32_bf16 v[36:39], v[136:139], v[156:159], v[36:39]
    v_mfma_f32_16x16x32_bf16 v[40:43], v[136:139], v[160:163], v[40:43]
    v_mfma_f32_16x16x32_bf16 v[44:47], v[140:143], v[156:159], v[44:47]
    s_add_u32 m0, s41, 131072
    s_add_u32 s51, s59, 36864
    buffer_load_dwordx4 v1, s[20:23], s51 offen lds
    v_mfma_f32_16x16x32_bf16 v[48:51], v[140:143], v[160:163], v[48:51]
    v_mfma_f32_16x16x32_bf16 v[52:55], v[144:147], v[156:159], v[52:55]
    s_add_u32 m0, s41, 135168
    s_add_u32 s51, s59, 46080
    buffer_load_dwordx4 v2, s[20:23], s51 offen lds
    v_mfma_f32_16x16x32_bf16 v[56:59], v[144:147], v[160:163], v[56:59]
    v_mfma_f32_16x16x32_bf16 v[60:63], v[148:151], v[156:159], v[60:63]
    v_mfma_f32_16x16x32_bf16 v[64:67], v[148:151], v[160:163], v[64:67]
    s_add_u32 m0, s41, 139264
    s_add_u32 s51, s59, 55296
    buffer_load_dwordx4 v1, s[20:23], s51 offen lds
    v_mfma_f32_16x16x32_bf16 v[68:71], v[152:155], v[156:159], v[68:71]
    v_mfma_f32_16x16x32_bf16 v[72:75], v[152:155], v[160:163], v[72:75]
    s_add_u32 m0, s41, 143360
    s_add_u32 s51, s59, 64512
    buffer_load_dwordx4 v2, s[20:23], s51 offen lds
    s_waitcnt vmcnt(12)
    s_barrier
    v_add_u32 v164, 49152, v164
    v_add_u32 v165, 49152, v165
    v_add_u32 v166, 49152, v166
    v_add_u32 v167, 49152, v167
    v_add_u32 v168, 49152, v168
    v_add_u32 v169, 49152, v169
    v_add_u32 v170, 49152, v170
    v_add_u32 v171, 49152, v171
    v_add_u32 v172, 49152, v172
    v_add_u32 v173, 49152, v173
    v_add_u32 v174, 49152, v174
    ds_read_b128 v[112:115], v173 offset:0
    ds_read_b128 v[116:119], v173 offset:2048
    ds_read_b64_tr_b16 v[76:77], v164 offset:16384
    ds_read_b64_tr_b16 v[78:79], v164 offset:18432
    ds_read_b64_tr_b16 v[80:81], v165 offset:16384
    ds_read_b64_tr_b16 v[82:83], v165 offset:18432
    ds_read_b64_tr_b16 v[84:85], v166 offset:16384
    ds_read_b64_tr_b16 v[86:87], v166 offset:18432
    ds_read_b64_tr_b16 v[88:89], v167 offset:16384
    ds_read_b64_tr_b16 v[90:91], v167 offset:18432
    ds_read_b64_tr_b16 v[92:93], v168 offset:16384
    ds_read_b64_tr_b16 v[94:95], v168 offset:18432
    ds_read_b64_tr_b16 v[96:97], v169 offset:16384
    ds_read_b64_tr_b16 v[98:99], v169 offset:18432
    ds_read_b64_tr_b16 v[100:101], v170 offset:16384
    ds_read_b64_tr_b16 v[102:103], v170 offset:18432
    ds_read_b64_tr_b16 v[104:105], v171 offset:16384
    ds_read_b64_tr_b16 v[106:107], v171 offset:18432
    ds_read_b64_tr_b16 v[108:109], v172 offset:16384
    ds_read_b64_tr_b16 v[110:111], v172 offset:18432
    s_waitcnt lgkmcnt(0)
    v_mfma_f32_16x16x32_bf16 v[4:7], v[76:79], v[112:115], v[4:7]
    ds_read_b128 v[156:159], v174 offset:0
    v_mfma_f32_16x16x32_bf16 v[8:11], v[76:79], v[116:119], v[8:11]
    ds_read_b128 v[160:163], v174 offset:2048
    v_mfma_f32_16x16x32_bf16 v[12:15], v[80:83], v[112:115], v[12:15]
    ds_read_b64_tr_b16 v[120:121], v164 offset:32768
    ds_read_b64_tr_b16 v[122:123], v164 offset:34816
    v_mfma_f32_16x16x32_bf16 v[16:19], v[80:83], v[116:119], v[16:19]
    ds_read_b64_tr_b16 v[124:125], v165 offset:32768
    v_mfma_f32_16x16x32_bf16 v[20:23], v[84:87], v[112:115], v[20:23]
    ds_read_b64_tr_b16 v[126:127], v165 offset:34816
    ds_read_b64_tr_b16 v[128:129], v166 offset:32768
    v_mfma_f32_16x16x32_bf16 v[24:27], v[84:87], v[116:119], v[24:27]
    ds_read_b64_tr_b16 v[130:131], v166 offset:34816
    v_mfma_f32_16x16x32_bf16 v[28:31], v[88:91], v[112:115], v[28:31]
    ds_read_b64_tr_b16 v[132:133], v167 offset:32768
    ds_read_b64_tr_b16 v[134:135], v167 offset:34816
    v_mfma_f32_16x16x32_bf16 v[32:35], v[88:91], v[116:119], v[32:35]
    ds_read_b64_tr_b16 v[136:137], v168 offset:32768
    v_mfma_f32_16x16x32_bf16 v[36:39], v[92:95], v[112:115], v[36:39]
    ds_read_b64_tr_b16 v[138:139], v168 offset:34816
    ds_read_b64_tr_b16 v[140:141], v169 offset:32768
    v_mfma_f32_16x16x32_bf16 v[40:43], v[92:95], v[116:119], v[40:43]
    ds_read_b64_tr_b16 v[142:143], v169 offset:34816
    v_mfma_f32_16x16x32_bf16 v[44:47], v[96:99], v[112:115], v[44:47]
    ds_read_b64_tr_b16 v[144:145], v170 offset:32768
    v_mfma_f32_16x16x32_bf16 v[48:51], v[96:99], v[116:119], v[48:51]
    ds_read_b64_tr_b16 v[146:147], v170 offset:34816
    ds_read_b64_tr_b16 v[148:149], v171 offset:32768
    v_mfma_f32_16x16x32_bf16 v[52:55], v[100:103], v[112:115], v[52:55]
    ds_read_b64_tr_b16 v[150:151], v171 offset:34816
    v_mfma_f32_16x16x32_bf16 v[56:59], v[100:103], v[116:119], v[56:59]
    ds_read_b64_tr_b16 v[152:153], v172 offset:32768
    ds_read_b64_tr_b16 v[154:155], v172 offset:34816
    v_mfma_f32_16x16x32_bf16 v[60:63], v[104:107], v[112:115], v[60:63]
    s_add_u32 s58, s58, 128
    s_add_u32 s59, s59, 73728
    v_mfma_f32_16x16x32_bf16 v[64:67], v[104:107], v[116:119], v[64:67]
    s_add_u32 m0, s41, 0
    s_add_u32 s51, s58, 0
    buffer_load_dwordx4 v0, s[16:19], s51 offen lds
    s_add_u32 m0, s41, 4096
    s_add_u32 s51, s58, 294912
    buffer_load_dwordx4 v0, s[16:19], s51 offen lds
    v_mfma_f32_16x16x32_bf16 v[68:71], v[108:111], v[112:115], v[68:71]
    s_add_u32 m0, s41, 8192
    s_add_u32 s51, s58, 589824
    buffer_load_dwordx4 v0, s[16:19], s51 offen lds
    v_mfma_f32_16x16x32_bf16 v[72:75], v[108:111], v[116:119], v[72:75]
    s_add_u32 m0, s41, 12288
    s_add_u32 s51, s58, 884736
    buffer_load_dwordx4 v0, s[16:19], s51 offen lds
    s_add_u32 m0, s41, 16384
    s_add_u32 s51, s59, 0
    buffer_load_dwordx4 v1, s[20:23], s51 offen lds
    s_waitcnt lgkmcnt(0)
    v_mfma_f32_16x16x32_bf16 v[4:7], v[120:123], v[156:159], v[4:7]
    v_mfma_f32_16x16x32_bf16 v[8:11], v[120:123], v[160:163], v[8:11]
    v_mfma_f32_16x16x32_bf16 v[12:15], v[124:127], v[156:159], v[12:15]
    s_add_u32 m0, s41, 20480
    s_add_u32 s51, s59, 9216
    buffer_load_dwordx4 v2, s[20:23], s51 offen lds
    v_mfma_f32_16x16x32_bf16 v[16:19], v[124:127], v[160:163], v[16:19]
    v_mfma_f32_16x16x32_bf16 v[20:23], v[128:131], v[156:159], v[20:23]
    v_mfma_f32_16x16x32_bf16 v[24:27], v[128:131], v[160:163], v[24:27]
    s_add_u32 m0, s41, 24576
    s_add_u32 s51, s59, 18432
    buffer_load_dwordx4 v1, s[20:23], s51 offen lds
    v_mfma_f32_16x16x32_bf16 v[28:31], v[132:135], v[156:159], v[28:31]
    v_mfma_f32_16x16x32_bf16 v[32:35], v[132:135], v[160:163], v[32:35]
    s_add_u32 m0, s41, 28672
    s_add_u32 s51, s59, 27648
    buffer_load_dwordx4 v2, s[20:23], s51 offen lds
    v_mfma_f32_16x16x32_bf16 v[36:39], v[136:139], v[156:159], v[36:39]
    v_mfma_f32_16x16x32_bf16 v[40:43], v[136:139], v[160:163], v[40:43]
    v_mfma_f32_16x16x32_bf16 v[44:47], v[140:143], v[156:159], v[44:47]
    s_add_u32 m0, s41, 32768
    s_add_u32 s51, s59, 36864
    buffer_load_dwordx4 v1, s[20:23], s51 offen lds
    v_mfma_f32_16x16x32_bf16 v[48:51], v[140:143], v[160:163], v[48:51]
    v_mfma_f32_16x16x32_bf16 v[52:55], v[144:147], v[156:159], v[52:55]
    s_add_u32 m0, s41, 36864
    s_add_u32 s51, s59, 46080
    buffer_load_dwordx4 v2, s[20:23], s51 offen lds
    v_mfma_f32_16x16x32_bf16 v[56:59], v[144:147], v[160:163], v[56:59]
    v_mfma_f32_16x16x32_bf16 v[60:63], v[148:151], v[156:159], v[60:63]
    v_mfma_f32_16x16x32_bf16 v[64:67], v[148:151], v[160:163], v[64:67]
    s_add_u32 m0, s41, 40960
    s_add_u32 s51, s59, 55296
    buffer_load_dwordx4 v1, s[20:23], s51 offen lds
    v_mfma_f32_16x16x32_bf16 v[68:71], v[152:155], v[156:159], v[68:71]
    v_mfma_f32_16x16x32_bf16 v[72:75], v[152:155], v[160:163], v[72:75]
    s_add_u32 m0, s41, 45056
    s_add_u32 s51, s59, 64512
    buffer_load_dwordx4 v2, s[20:23], s51 offen lds
    s_waitcnt vmcnt(12)
    s_barrier
    v_add_u32 v164, 49152, v164
    v_add_u32 v165, 49152, v165
    v_add_u32 v166, 49152, v166
    v_add_u32 v167, 49152, v167
    v_add_u32 v168, 49152, v168
    v_add_u32 v169, 49152, v169
    v_add_u32 v170, 49152, v170
    v_add_u32 v171, 49152, v171
    v_add_u32 v172, 49152, v172
    v_add_u32 v173, 49152, v173
    v_add_u32 v174, 49152, v174
    ds_read_b128 v[112:115], v173 offset:0
    ds_read_b128 v[116:119], v173 offset:2048
    ds_read_b64_tr_b16 v[76:77], v164 offset:16384
    ds_read_b64_tr_b16 v[78:79], v164 offset:18432
    ds_read_b64_tr_b16 v[80:81], v165 offset:16384
    ds_read_b64_tr_b16 v[82:83], v165 offset:18432
    ds_read_b64_tr_b16 v[84:85], v166 offset:16384
    ds_read_b64_tr_b16 v[86:87], v166 offset:18432
    ds_read_b64_tr_b16 v[88:89], v167 offset:16384
    ds_read_b64_tr_b16 v[90:91], v167 offset:18432
    ds_read_b64_tr_b16 v[92:93], v168 offset:16384
    ds_read_b64_tr_b16 v[94:95], v168 offset:18432
    ds_read_b64_tr_b16 v[96:97], v169 offset:16384
    ds_read_b64_tr_b16 v[98:99], v169 offset:18432
    ds_read_b64_tr_b16 v[100:101], v170 offset:16384
    ds_read_b64_tr_b16 v[102:103], v170 offset:18432
    ds_read_b64_tr_b16 v[104:105], v171 offset:16384
    ds_read_b64_tr_b16 v[106:107], v171 offset:18432
    ds_read_b64_tr_b16 v[108:109], v172 offset:16384
    ds_read_b64_tr_b16 v[110:111], v172 offset:18432
    s_waitcnt lgkmcnt(0)
    v_mfma_f32_16x16x32_bf16 v[4:7], v[76:79], v[112:115], v[4:7]
    ds_read_b128 v[156:159], v174 offset:0
    v_mfma_f32_16x16x32_bf16 v[8:11], v[76:79], v[116:119], v[8:11]
    ds_read_b128 v[160:163], v174 offset:2048
    v_mfma_f32_16x16x32_bf16 v[12:15], v[80:83], v[112:115], v[12:15]
    ds_read_b64_tr_b16 v[120:121], v164 offset:32768
    ds_read_b64_tr_b16 v[122:123], v164 offset:34816
    v_mfma_f32_16x16x32_bf16 v[16:19], v[80:83], v[116:119], v[16:19]
    ds_read_b64_tr_b16 v[124:125], v165 offset:32768
    v_mfma_f32_16x16x32_bf16 v[20:23], v[84:87], v[112:115], v[20:23]
    ds_read_b64_tr_b16 v[126:127], v165 offset:34816
    ds_read_b64_tr_b16 v[128:129], v166 offset:32768
    v_mfma_f32_16x16x32_bf16 v[24:27], v[84:87], v[116:119], v[24:27]
    ds_read_b64_tr_b16 v[130:131], v166 offset:34816
    v_mfma_f32_16x16x32_bf16 v[28:31], v[88:91], v[112:115], v[28:31]
    ds_read_b64_tr_b16 v[132:133], v167 offset:32768
    ds_read_b64_tr_b16 v[134:135], v167 offset:34816
    v_mfma_f32_16x16x32_bf16 v[32:35], v[88:91], v[116:119], v[32:35]
    ds_read_b64_tr_b16 v[136:137], v168 offset:32768
    v_mfma_f32_16x16x32_bf16 v[36:39], v[92:95], v[112:115], v[36:39]
    ds_read_b64_tr_b16 v[138:139], v168 offset:34816
    ds_read_b64_tr_b16 v[140:141], v169 offset:32768
    v_mfma_f32_16x16x32_bf16 v[40:43], v[92:95], v[116:119], v[40:43]
    ds_read_b64_tr_b16 v[142:143], v169 offset:34816
    v_mfma_f32_16x16x32_bf16 v[44:47], v[96:99], v[112:115], v[44:47]
    ds_read_b64_tr_b16 v[144:145], v170 offset:32768
    v_mfma_f32_16x16x32_bf16 v[48:51], v[96:99], v[116:119], v[48:51]
    ds_read_b64_tr_b16 v[146:147], v170 offset:34816
    ds_read_b64_tr_b16 v[148:149], v171 offset:32768
    v_mfma_f32_16x16x32_bf16 v[52:55], v[100:103], v[112:115], v[52:55]
    ds_read_b64_tr_b16 v[150:151], v171 offset:34816
    v_mfma_f32_16x16x32_bf16 v[56:59], v[100:103], v[116:119], v[56:59]
    ds_read_b64_tr_b16 v[152:153], v172 offset:32768
    ds_read_b64_tr_b16 v[154:155], v172 offset:34816
    v_mfma_f32_16x16x32_bf16 v[60:63], v[104:107], v[112:115], v[60:63]
    s_add_u32 s58, s58, 128
    s_add_u32 s59, s59, 73728
    v_mfma_f32_16x16x32_bf16 v[64:67], v[104:107], v[116:119], v[64:67]
    s_add_u32 m0, s41, 49152
    s_add_u32 s51, s58, 0
    buffer_load_dwordx4 v0, s[16:19], s51 offen lds
    s_add_u32 m0, s41, 53248
    s_add_u32 s51, s58, 294912
    buffer_load_dwordx4 v0, s[16:19], s51 offen lds
    v_mfma_f32_16x16x32_bf16 v[68:71], v[108:111], v[112:115], v[68:71]
    s_add_u32 m0, s41, 57344
    s_add_u32 s51, s58, 589824
    buffer_load_dwordx4 v0, s[16:19], s51 offen lds
    v_mfma_f32_16x16x32_bf16 v[72:75], v[108:111], v[116:119], v[72:75]
    s_add_u32 m0, s41, 61440
    s_add_u32 s51, s58, 884736
    buffer_load_dwordx4 v0, s[16:19], s51 offen lds
    s_add_u32 m0, s41, 65536
    s_add_u32 s51, s59, 0
    buffer_load_dwordx4 v1, s[20:23], s51 offen lds
    s_waitcnt lgkmcnt(0)
    v_mfma_f32_16x16x32_bf16 v[4:7], v[120:123], v[156:159], v[4:7]
    v_mfma_f32_16x16x32_bf16 v[8:11], v[120:123], v[160:163], v[8:11]
    v_mfma_f32_16x16x32_bf16 v[12:15], v[124:127], v[156:159], v[12:15]
    s_add_u32 m0, s41, 69632
    s_add_u32 s51, s59, 9216
    buffer_load_dwordx4 v2, s[20:23], s51 offen lds
    v_mfma_f32_16x16x32_bf16 v[16:19], v[124:127], v[160:163], v[16:19]
    v_mfma_f32_16x16x32_bf16 v[20:23], v[128:131], v[156:159], v[20:23]
    v_mfma_f32_16x16x32_bf16 v[24:27], v[128:131], v[160:163], v[24:27]
    s_add_u32 m0, s41, 73728
    s_add_u32 s51, s59, 18432
    buffer_load_dwordx4 v1, s[20:23], s51 offen lds
    v_mfma_f32_16x16x32_bf16 v[28:31], v[132:135], v[156:159], v[28:31]
    v_mfma_f32_16x16x32_bf16 v[32:35], v[132:135], v[160:163], v[32:35]
    s_add_u32 m0, s41, 77824
    s_add_u32 s51, s59, 27648
    buffer_load_dwordx4 v2, s[20:23], s51 offen lds
    v_mfma_f32_16x16x32_bf16 v[36:39], v[136:139], v[156:159], v[36:39]
    v_mfma_f32_16x16x32_bf16 v[40:43], v[136:139], v[160:163], v[40:43]
    v_mfma_f32_16x16x32_bf16 v[44:47], v[140:143], v[156:159], v[44:47]
    s_add_u32 m0, s41, 81920
    s_add_u32 s51, s59, 36864
    buffer_load_dwordx4 v1, s[20:23], s51 offen lds
    v_mfma_f32_16x16x32_bf16 v[48:51], v[140:143], v[160:163], v[48:51]
    v_mfma_f32_16x16x32_bf16 v[52:55], v[144:147], v[156:159], v[52:55]
    s_add_u32 m0, s41, 86016
    s_add_u32 s51, s59, 46080
    buffer_load_dwordx4 v2, s[20:23], s51 offen lds
    v_mfma_f32_16x16x32_bf16 v[56:59], v[144:147], v[160:163], v[56:59]
    v_mfma_f32_16x16x32_bf16 v[60:63], v[148:151], v[156:159], v[60:63]
    v_mfma_f32_16x16x32_bf16 v[64:67], v[148:151], v[160:163], v[64:67]
    s_add_u32 m0, s41, 90112
    s_add_u32 s51, s59, 55296
    buffer_load_dwordx4 v1, s[20:23], s51 offen lds
    v_mfma_f32_16x16x32_bf16 v[68:71], v[152:155], v[156:159], v[68:71]
    v_mfma_f32_16x16x32_bf16 v[72:75], v[152:155], v[160:163], v[72:75]
    s_add_u32 m0, s41, 94208
    s_add_u32 s51, s59, 64512
    buffer_load_dwordx4 v2, s[20:23], s51 offen lds
    s_waitcnt vmcnt(12)
    s_barrier
    v_subrev_u32 v164, 98304, v164
    v_subrev_u32 v165, 98304, v165
    v_subrev_u32 v166, 98304, v166
    v_subrev_u32 v167, 98304, v167
    v_subrev_u32 v168, 98304, v168
    v_subrev_u32 v169, 98304, v169
    v_subrev_u32 v170, 98304, v170
    v_subrev_u32 v171, 98304, v171
    v_subrev_u32 v172, 98304, v172
    v_subrev_u32 v173, 98304, v173
    v_subrev_u32 v174, 98304, v174
    ds_read_b128 v[112:115], v173 offset:0
    ds_read_b128 v[116:119], v173 offset:2048
    ds_read_b64_tr_b16 v[76:77], v164 offset:16384
    ds_read_b64_tr_b16 v[78:79], v164 offset:18432
    ds_read_b64_tr_b16 v[80:81], v165 offset:16384
    ds_read_b64_tr_b16 v[82:83], v165 offset:18432
    ds_read_b64_tr_b16 v[84:85], v166 offset:16384
    ds_read_b64_tr_b16 v[86:87], v166 offset:18432
    ds_read_b64_tr_b16 v[88:89], v167 offset:16384
    ds_read_b64_tr_b16 v[90:91], v167 offset:18432
    ds_read_b64_tr_b16 v[92:93], v168 offset:16384
    ds_read_b64_tr_b16 v[94:95], v168 offset:18432
    ds_read_b64_tr_b16 v[96:97], v169 offset:16384
    ds_read_b64_tr_b16 v[98:99], v169 offset:18432
    ds_read_b64_tr_b16 v[100:101], v170 offset:16384
    ds_read_b64_tr_b16 v[102:103], v170 offset:18432
    ds_read_b64_tr_b16 v[104:105], v171 offset:16384
    ds_read_b64_tr_b16 v[106:107], v171 offset:18432
    ds_read_b64_tr_b16 v[108:109], v172 offset:16384
    ds_read_b64_tr_b16 v[110:111], v172 offset:18432
    s_waitcnt lgkmcnt(0)
    v_mfma_f32_16x16x32_bf16 v[4:7], v[76:79], v[112:115], v[4:7]
    ds_read_b128 v[156:159], v174 offset:0
    v_mfma_f32_16x16x32_bf16 v[8:11], v[76:79], v[116:119], v[8:11]
    ds_read_b128 v[160:163], v174 offset:2048
    v_mfma_f32_16x16x32_bf16 v[12:15], v[80:83], v[112:115], v[12:15]
    ds_read_b64_tr_b16 v[120:121], v164 offset:32768
    ds_read_b64_tr_b16 v[122:123], v164 offset:34816
    v_mfma_f32_16x16x32_bf16 v[16:19], v[80:83], v[116:119], v[16:19]
    ds_read_b64_tr_b16 v[124:125], v165 offset:32768
    v_mfma_f32_16x16x32_bf16 v[20:23], v[84:87], v[112:115], v[20:23]
    ds_read_b64_tr_b16 v[126:127], v165 offset:34816
    ds_read_b64_tr_b16 v[128:129], v166 offset:32768
    v_mfma_f32_16x16x32_bf16 v[24:27], v[84:87], v[116:119], v[24:27]
    ds_read_b64_tr_b16 v[130:131], v166 offset:34816
    v_mfma_f32_16x16x32_bf16 v[28:31], v[88:91], v[112:115], v[28:31]
    ds_read_b64_tr_b16 v[132:133], v167 offset:32768
    ds_read_b64_tr_b16 v[134:135], v167 offset:34816
    v_mfma_f32_16x16x32_bf16 v[32:35], v[88:91], v[116:119], v[32:35]
    ds_read_b64_tr_b16 v[136:137], v168 offset:32768
    v_mfma_f32_16x16x32_bf16 v[36:39], v[92:95], v[112:115], v[36:39]
    ds_read_b64_tr_b16 v[138:139], v168 offset:34816
    ds_read_b64_tr_b16 v[140:141], v169 offset:32768
    v_mfma_f32_16x16x32_bf16 v[40:43], v[92:95], v[116:119], v[40:43]
    ds_read_b64_tr_b16 v[142:143], v169 offset:34816
    v_mfma_f32_16x16x32_bf16 v[44:47], v[96:99], v[112:115], v[44:47]
    ds_read_b64_tr_b16 v[144:145], v170 offset:32768
    v_mfma_f32_16x16x32_bf16 v[48:51], v[96:99], v[116:119], v[48:51]
    ds_read_b64_tr_b16 v[146:147], v170 offset:34816
    ds_read_b64_tr_b16 v[148:149], v171 offset:32768
    v_mfma_f32_16x16x32_bf16 v[52:55], v[100:103], v[112:115], v[52:55]
    ds_read_b64_tr_b16 v[150:151], v171 offset:34816
    v_mfma_f32_16x16x32_bf16 v[56:59], v[100:103], v[116:119], v[56:59]
    ds_read_b64_tr_b16 v[152:153], v172 offset:32768
    ds_read_b64_tr_b16 v[154:155], v172 offset:34816
    v_mfma_f32_16x16x32_bf16 v[60:63], v[104:107], v[112:115], v[60:63]
    s_add_u32 s58, s58, 128
    s_add_u32 s59, s59, 73728
    v_mfma_f32_16x16x32_bf16 v[64:67], v[104:107], v[116:119], v[64:67]
    s_add_u32 m0, s41, 98304
    s_add_u32 s51, s58, 0
    buffer_load_dwordx4 v0, s[16:19], s51 offen lds
    s_add_u32 m0, s41, 102400
    s_add_u32 s51, s58, 294912
    buffer_load_dwordx4 v0, s[16:19], s51 offen lds
    v_mfma_f32_16x16x32_bf16 v[68:71], v[108:111], v[112:115], v[68:71]
    s_add_u32 m0, s41, 106496
    s_add_u32 s51, s58, 589824
    buffer_load_dwordx4 v0, s[16:19], s51 offen lds
    v_mfma_f32_16x16x32_bf16 v[72:75], v[108:111], v[116:119], v[72:75]
    s_add_u32 m0, s41, 110592
    s_add_u32 s51, s58, 884736
    buffer_load_dwordx4 v0, s[16:19], s51 offen lds
    s_add_u32 m0, s41, 114688
    s_add_u32 s51, s59, 0
    buffer_load_dwordx4 v1, s[20:23], s51 offen lds
    s_waitcnt lgkmcnt(0)
    v_mfma_f32_16x16x32_bf16 v[4:7], v[120:123], v[156:159], v[4:7]
    v_mfma_f32_16x16x32_bf16 v[8:11], v[120:123], v[160:163], v[8:11]
    v_mfma_f32_16x16x32_bf16 v[12:15], v[124:127], v[156:159], v[12:15]
    s_add_u32 m0, s41, 118784
    s_add_u32 s51, s59, 9216
    buffer_load_dwordx4 v2, s[20:23], s51 offen lds
    v_mfma_f32_16x16x32_bf16 v[16:19], v[124:127], v[160:163], v[16:19]
    v_mfma_f32_16x16x32_bf16 v[20:23], v[128:131], v[156:159], v[20:23]
    v_mfma_f32_16x16x32_bf16 v[24:27], v[128:131], v[160:163], v[24:27]
    s_add_u32 m0, s41, 122880
    s_add_u32 s51, s59, 18432
    buffer_load_dwordx4 v1, s[20:23], s51 offen lds
    v_mfma_f32_16x16x32_bf16 v[28:31], v[132:135], v[156:159], v[28:31]
    v_mfma_f32_16x16x32_bf16 v[32:35], v[132:135], v[160:163], v[32:35]
    s_add_u32 m0, s41, 126976
    s_add_u32 s51, s59, 27648
    buffer_load_dwordx4 v2, s[20:23], s51 offen lds
    v_mfma_f32_16x16x32_bf16 v[36:39], v[136:139], v[156:159], v[36:39]
    v_mfma_f32_16x16x32_bf16 v[40:43], v[136:139], v[160:163], v[40:43]
    v_mfma_f32_16x16x32_bf16 v[44:47], v[140:143], v[156:159], v[44:47]
    s_add_u32 m0, s41, 131072
    s_add_u32 s51, s59, 36864
    buffer_load_dwordx4 v1, s[20:23], s51 offen lds
    v_mfma_f32_16x16x32_bf16 v[48:51], v[140:143], v[160:163], v[48:51]
    v_mfma_f32_16x16x32_bf16 v[52:55], v[144:147], v[156:159], v[52:55]
    s_add_u32 m0, s41, 135168
    s_add_u32 s51, s59, 46080
    buffer_load_dwordx4 v2, s[20:23], s51 offen lds
    v_mfma_f32_16x16x32_bf16 v[56:59], v[144:147], v[160:163], v[56:59]
    v_mfma_f32_16x16x32_bf16 v[60:63], v[148:151], v[156:159], v[60:63]
    v_mfma_f32_16x16x32_bf16 v[64:67], v[148:151], v[160:163], v[64:67]
    s_add_u32 m0, s41, 139264
    s_add_u32 s51, s59, 55296
    buffer_load_dwordx4 v1, s[20:23], s51 offen lds
    v_mfma_f32_16x16x32_bf16 v[68:71], v[152:155], v[156:159], v[68:71]
    v_mfma_f32_16x16x32_bf16 v[72:75], v[152:155], v[160:163], v[72:75]
    s_add_u32 m0, s41, 143360
    s_add_u32 s51, s59, 64512
    buffer_load_dwordx4 v2, s[20:23], s51 offen lds
    s_waitcnt vmcnt(12)
    s_barrier
    v_add_u32 v164, 49152, v164
    v_add_u32 v165, 49152, v165
    v_add_u32 v166, 49152, v166
    v_add_u32 v167, 49152, v167
    v_add_u32 v168, 49152, v168
    v_add_u32 v169, 49152, v169
    v_add_u32 v170, 49152, v170
    v_add_u32 v171, 49152, v171
    v_add_u32 v172, 49152, v172
    v_add_u32 v173, 49152, v173
    v_add_u32 v174, 49152, v174
    ds_read_b128 v[112:115], v173 offset:0
    ds_read_b128 v[116:119], v173 offset:2048
    ds_read_b64_tr_b16 v[76:77], v164 offset:16384
    ds_read_b64_tr_b16 v[78:79], v164 offset:18432
    ds_read_b64_tr_b16 v[80:81], v165 offset:16384
    ds_read_b64_tr_b16 v[82:83], v165 offset:18432
    ds_read_b64_tr_b16 v[84:85], v166 offset:16384
    ds_read_b64_tr_b16 v[86:87], v166 offset:18432
    ds_read_b64_tr_b16 v[88:89], v167 offset:16384
    ds_read_b64_tr_b16 v[90:91], v167 offset:18432
    ds_read_b64_tr_b16 v[92:93], v168 offset:16384
    ds_read_b64_tr_b16 v[94:95], v168 offset:18432
    ds_read_b64_tr_b16 v[96:97], v169 offset:16384
    ds_read_b64_tr_b16 v[98:99], v169 offset:18432
    ds_read_b64_tr_b16 v[100:101], v170 offset:16384
    ds_read_b64_tr_b16 v[102:103], v170 offset:18432
    ds_read_b64_tr_b16 v[104:105], v171 offset:16384
    ds_read_b64_tr_b16 v[106:107], v171 offset:18432
    ds_read_b64_tr_b16 v[108:109], v172 offset:16384
    ds_read_b64_tr_b16 v[110:111], v172 offset:18432
    s_waitcnt lgkmcnt(0)
    v_mfma_f32_16x16x32_bf16 v[4:7], v[76:79], v[112:115], v[4:7]
    ds_read_b128 v[156:159], v174 offset:0
    v_mfma_f32_16x16x32_bf16 v[8:11], v[76:79], v[116:119], v[8:11]
    ds_read_b128 v[160:163], v174 offset:2048
    v_mfma_f32_16x16x32_bf16 v[12:15], v[80:83], v[112:115], v[12:15]
    ds_read_b64_tr_b16 v[120:121], v164 offset:32768
    ds_read_b64_tr_b16 v[122:123], v164 offset:34816
    v_mfma_f32_16x16x32_bf16 v[16:19], v[80:83], v[116:119], v[16:19]
    ds_read_b64_tr_b16 v[124:125], v165 offset:32768
    v_mfma_f32_16x16x32_bf16 v[20:23], v[84:87], v[112:115], v[20:23]
    ds_read_b64_tr_b16 v[126:127], v165 offset:34816
    ds_read_b64_tr_b16 v[128:129], v166 offset:32768
    v_mfma_f32_16x16x32_bf16 v[24:27], v[84:87], v[116:119], v[24:27]
    ds_read_b64_tr_b16 v[130:131], v166 offset:34816
    v_mfma_f32_16x16x32_bf16 v[28:31], v[88:91], v[112:115], v[28:31]
    ds_read_b64_tr_b16 v[132:133], v167 offset:32768
    ds_read_b64_tr_b16 v[134:135], v167 offset:34816
    v_mfma_f32_16x16x32_bf16 v[32:35], v[88:91], v[116:119], v[32:35]
    ds_read_b64_tr_b16 v[136:137], v168 offset:32768
    v_mfma_f32_16x16x32_bf16 v[36:39], v[92:95], v[112:115], v[36:39]
    ds_read_b64_tr_b16 v[138:139], v168 offset:34816
    ds_read_b64_tr_b16 v[140:141], v169 offset:32768
    v_mfma_f32_16x16x32_bf16 v[40:43], v[92:95], v[116:119], v[40:43]
    ds_read_b64_tr_b16 v[142:143], v169 offset:34816
    v_mfma_f32_16x16x32_bf16 v[44:47], v[96:99], v[112:115], v[44:47]
    ds_read_b64_tr_b16 v[144:145], v170 offset:32768
    v_mfma_f32_16x16x32_bf16 v[48:51], v[96:99], v[116:119], v[48:51]
    ds_read_b64_tr_b16 v[146:147], v170 offset:34816
    ds_read_b64_tr_b16 v[148:149], v171 offset:32768
    v_mfma_f32_16x16x32_bf16 v[52:55], v[100:103], v[112:115], v[52:55]
    ds_read_b64_tr_b16 v[150:151], v171 offset:34816
    v_mfma_f32_16x16x32_bf16 v[56:59], v[100:103], v[116:119], v[56:59]
    ds_read_b64_tr_b16 v[152:153], v172 offset:32768
    ds_read_b64_tr_b16 v[154:155], v172 offset:34816
    v_mfma_f32_16x16x32_bf16 v[60:63], v[104:107], v[112:115], v[60:63]
    s_add_u32 s58, s58, 128
    s_add_u32 s59, s59, 73728
    v_mfma_f32_16x16x32_bf16 v[64:67], v[104:107], v[116:119], v[64:67]
    s_add_u32 m0, s41, 0
    s_add_u32 s51, s58, 0
    buffer_load_dwordx4 v0, s[16:19], s51 offen lds
    s_add_u32 m0, s41, 4096
    s_add_u32 s51, s58, 294912
    buffer_load_dwordx4 v0, s[16:19], s51 offen lds
    v_mfma_f32_16x16x32_bf16 v[68:71], v[108:111], v[112:115], v[68:71]
    s_add_u32 m0, s41, 8192
    s_add_u32 s51, s58, 589824
    buffer_load_dwordx4 v0, s[16:19], s51 offen lds
    v_mfma_f32_16x16x32_bf16 v[72:75], v[108:111], v[116:119], v[72:75]
    s_add_u32 m0, s41, 12288
    s_add_u32 s51, s58, 884736
    buffer_load_dwordx4 v0, s[16:19], s51 offen lds
    s_add_u32 m0, s41, 16384
    s_add_u32 s51, s59, 0
    buffer_load_dwordx4 v1, s[20:23], s51 offen lds
    s_waitcnt lgkmcnt(0)
    v_mfma_f32_16x16x32_bf16 v[4:7], v[120:123], v[156:159], v[4:7]
    v_mfma_f32_16x16x32_bf16 v[8:11], v[120:123], v[160:163], v[8:11]
    v_mfma_f32_16x16x32_bf16 v[12:15], v[124:127], v[156:159], v[12:15]
    s_add_u32 m0, s41, 20480
    s_add_u32 s51, s59, 9216
    buffer_load_dwordx4 v2, s[20:23], s51 offen lds
    v_mfma_f32_16x16x32_bf16 v[16:19], v[124:127], v[160:163], v[16:19]
    v_mfma_f32_16x16x32_bf16 v[20:23], v[128:131], v[156:159], v[20:23]
    v_mfma_f32_16x16x32_bf16 v[24:27], v[128:131], v[160:163], v[24:27]
    s_add_u32 m0, s41, 24576
    s_add_u32 s51, s59, 18432
    buffer_load_dwordx4 v1, s[20:23], s51 offen lds
    v_mfma_f32_16x16x32_bf16 v[28:31], v[132:135], v[156:159], v[28:31]
    v_mfma_f32_16x16x32_bf16 v[32:35], v[132:135], v[160:163], v[32:35]
    s_add_u32 m0, s41, 28672
    s_add_u32 s51, s59, 27648
    buffer_load_dwordx4 v2, s[20:23], s51 offen lds
    v_mfma_f32_16x16x32_bf16 v[36:39], v[136:139], v[156:159], v[36:39]
    v_mfma_f32_16x16x32_bf16 v[40:43], v[136:139], v[160:163], v[40:43]
    v_mfma_f32_16x16x32_bf16 v[44:47], v[140:143], v[156:159], v[44:47]
    s_add_u32 m0, s41, 32768
    s_add_u32 s51, s59, 36864
    buffer_load_dwordx4 v1, s[20:23], s51 offen lds
    v_mfma_f32_16x16x32_bf16 v[48:51], v[140:143], v[160:163], v[48:51]
    v_mfma_f32_16x16x32_bf16 v[52:55], v[144:147], v[156:159], v[52:55]
    s_add_u32 m0, s41, 36864
    s_add_u32 s51, s59, 46080
    buffer_load_dwordx4 v2, s[20:23], s51 offen lds
    v_mfma_f32_16x16x32_bf16 v[56:59], v[144:147], v[160:163], v[56:59]
    v_mfma_f32_16x16x32_bf16 v[60:63], v[148:151], v[156:159], v[60:63]
    v_mfma_f32_16x16x32_bf16 v[64:67], v[148:151], v[160:163], v[64:67]
    s_add_u32 m0, s41, 40960
    s_add_u32 s51, s59, 55296
    buffer_load_dwordx4 v1, s[20:23], s51 offen lds
    v_mfma_f32_16x16x32_bf16 v[68:71], v[152:155], v[156:159], v[68:71]
    v_mfma_f32_16x16x32_bf16 v[72:75], v[152:155], v[160:163], v[72:75]
    s_add_u32 m0, s41, 45056
    s_add_u32 s51, s59, 64512
    buffer_load_dwordx4 v2, s[20:23], s51 offen lds
    s_waitcnt vmcnt(12)
    s_barrier
    v_add_u32 v164, 49152, v164
    v_add_u32 v165, 49152, v165
    v_add_u32 v166, 49152, v166
    v_add_u32 v167, 49152, v167
    v_add_u32 v168, 49152, v168
    v_add_u32 v169, 49152, v169
    v_add_u32 v170, 49152, v170
    v_add_u32 v171, 49152, v171
    v_add_u32 v172, 49152, v172
    v_add_u32 v173, 49152, v173
    v_add_u32 v174, 49152, v174
    ds_read_b128 v[112:115], v173 offset:0
    ds_read_b128 v[116:119], v173 offset:2048
    ds_read_b64_tr_b16 v[76:77], v164 offset:16384
    ds_read_b64_tr_b16 v[78:79], v164 offset:18432
    ds_read_b64_tr_b16 v[80:81], v165 offset:16384
    ds_read_b64_tr_b16 v[82:83], v165 offset:18432
    ds_read_b64_tr_b16 v[84:85], v166 offset:16384
    ds_read_b64_tr_b16 v[86:87], v166 offset:18432
    ds_read_b64_tr_b16 v[88:89], v167 offset:16384
    ds_read_b64_tr_b16 v[90:91], v167 offset:18432
    ds_read_b64_tr_b16 v[92:93], v168 offset:16384
    ds_read_b64_tr_b16 v[94:95], v168 offset:18432
    ds_read_b64_tr_b16 v[96:97], v169 offset:16384
    ds_read_b64_tr_b16 v[98:99], v169 offset:18432
    ds_read_b64_tr_b16 v[100:101], v170 offset:16384
    ds_read_b64_tr_b16 v[102:103], v170 offset:18432
    ds_read_b64_tr_b16 v[104:105], v171 offset:16384
    ds_read_b64_tr_b16 v[106:107], v171 offset:18432
    ds_read_b64_tr_b16 v[108:109], v172 offset:16384
    ds_read_b64_tr_b16 v[110:111], v172 offset:18432
    s_waitcnt lgkmcnt(0)
    v_mfma_f32_16x16x32_bf16 v[4:7], v[76:79], v[112:115], v[4:7]
    ds_read_b128 v[156:159], v174 offset:0
    v_mfma_f32_16x16x32_bf16 v[8:11], v[76:79], v[116:119], v[8:11]
    ds_read_b128 v[160:163], v174 offset:2048
    v_mfma_f32_16x16x32_bf16 v[12:15], v[80:83], v[112:115], v[12:15]
    ds_read_b64_tr_b16 v[120:121], v164 offset:32768
    ds_read_b64_tr_b16 v[122:123], v164 offset:34816
    v_mfma_f32_16x16x32_bf16 v[16:19], v[80:83], v[116:119], v[16:19]
    ds_read_b64_tr_b16 v[124:125], v165 offset:32768
    v_mfma_f32_16x16x32_bf16 v[20:23], v[84:87], v[112:115], v[20:23]
    ds_read_b64_tr_b16 v[126:127], v165 offset:34816
    ds_read_b64_tr_b16 v[128:129], v166 offset:32768
    v_mfma_f32_16x16x32_bf16 v[24:27], v[84:87], v[116:119], v[24:27]
    ds_read_b64_tr_b16 v[130:131], v166 offset:34816
    v_mfma_f32_16x16x32_bf16 v[28:31], v[88:91], v[112:115], v[28:31]
    ds_read_b64_tr_b16 v[132:133], v167 offset:32768
    ds_read_b64_tr_b16 v[134:135], v167 offset:34816
    v_mfma_f32_16x16x32_bf16 v[32:35], v[88:91], v[116:119], v[32:35]
    ds_read_b64_tr_b16 v[136:137], v168 offset:32768
    v_mfma_f32_16x16x32_bf16 v[36:39], v[92:95], v[112:115], v[36:39]
    ds_read_b64_tr_b16 v[138:139], v168 offset:34816
    ds_read_b64_tr_b16 v[140:141], v169 offset:32768
    v_mfma_f32_16x16x32_bf16 v[40:43], v[92:95], v[116:119], v[40:43]
    ds_read_b64_tr_b16 v[142:143], v169 offset:34816
    v_mfma_f32_16x16x32_bf16 v[44:47], v[96:99], v[112:115], v[44:47]
    ds_read_b64_tr_b16 v[144:145], v170 offset:32768
    v_mfma_f32_16x16x32_bf16 v[48:51], v[96:99], v[116:119], v[48:51]
    ds_read_b64_tr_b16 v[146:147], v170 offset:34816
    ds_read_b64_tr_b16 v[148:149], v171 offset:32768
    v_mfma_f32_16x16x32_bf16 v[52:55], v[100:103], v[112:115], v[52:55]
    ds_read_b64_tr_b16 v[150:151], v171 offset:34816
    v_mfma_f32_16x16x32_bf16 v[56:59], v[100:103], v[116:119], v[56:59]
    ds_read_b64_tr_b16 v[152:153], v172 offset:32768
    ds_read_b64_tr_b16 v[154:155], v172 offset:34816
    v_mfma_f32_16x16x32_bf16 v[60:63], v[104:107], v[112:115], v[60:63]
    s_add_u32 s58, s58, 128
    s_add_u32 s59, s59, 73728
    v_mfma_f32_16x16x32_bf16 v[64:67], v[104:107], v[116:119], v[64:67]
    s_add_u32 m0, s41, 49152
    s_add_u32 s51, s58, 0
    buffer_load_dwordx4 v0, s[16:19], s51 offen lds
    s_add_u32 m0, s41, 53248
    s_add_u32 s51, s58, 294912
    buffer_load_dwordx4 v0, s[16:19], s51 offen lds
    v_mfma_f32_16x16x32_bf16 v[68:71], v[108:111], v[112:115], v[68:71]
    s_add_u32 m0, s41, 57344
    s_add_u32 s51, s58, 589824
    buffer_load_dwordx4 v0, s[16:19], s51 offen lds
    v_mfma_f32_16x16x32_bf16 v[72:75], v[108:111], v[116:119], v[72:75]
    s_add_u32 m0, s41, 61440
    s_add_u32 s51, s58, 884736
    buffer_load_dwordx4 v0, s[16:19], s51 offen lds
    s_add_u32 m0, s41, 65536
    s_add_u32 s51, s59, 0
    buffer_load_dwordx4 v1, s[20:23], s51 offen lds
    s_waitcnt lgkmcnt(0)
    v_mfma_f32_16x16x32_bf16 v[4:7], v[120:123], v[156:159], v[4:7]
    v_mfma_f32_16x16x32_bf16 v[8:11], v[120:123], v[160:163], v[8:11]
    v_mfma_f32_16x16x32_bf16 v[12:15], v[124:127], v[156:159], v[12:15]
    s_add_u32 m0, s41, 69632
    s_add_u32 s51, s59, 9216
    buffer_load_dwordx4 v2, s[20:23], s51 offen lds
    v_mfma_f32_16x16x32_bf16 v[16:19], v[124:127], v[160:163], v[16:19]
    v_mfma_f32_16x16x32_bf16 v[20:23], v[128:131], v[156:159], v[20:23]
    v_mfma_f32_16x16x32_bf16 v[24:27], v[128:131], v[160:163], v[24:27]
    s_add_u32 m0, s41, 73728
    s_add_u32 s51, s59, 18432
    buffer_load_dwordx4 v1, s[20:23], s51 offen lds
    v_mfma_f32_16x16x32_bf16 v[28:31], v[132:135], v[156:159], v[28:31]
    v_mfma_f32_16x16x32_bf16 v[32:35], v[132:135], v[160:163], v[32:35]
    s_add_u32 m0, s41, 77824
    s_add_u32 s51, s59, 27648
    buffer_load_dwordx4 v2, s[20:23], s51 offen lds
    v_mfma_f32_16x16x32_bf16 v[36:39], v[136:139], v[156:159], v[36:39]
    v_mfma_f32_16x16x32_bf16 v[40:43], v[136:139], v[160:163], v[40:43]
    v_mfma_f32_16x16x32_bf16 v[44:47], v[140:143], v[156:159], v[44:47]
    s_add_u32 m0, s41, 81920
    s_add_u32 s51, s59, 36864
    buffer_load_dwordx4 v1, s[20:23], s51 offen lds
    v_mfma_f32_16x16x32_bf16 v[48:51], v[140:143], v[160:163], v[48:51]
    v_mfma_f32_16x16x32_bf16 v[52:55], v[144:147], v[156:159], v[52:55]
    s_add_u32 m0, s41, 86016
    s_add_u32 s51, s59, 46080
    buffer_load_dwordx4 v2, s[20:23], s51 offen lds
    v_mfma_f32_16x16x32_bf16 v[56:59], v[144:147], v[160:163], v[56:59]
    v_mfma_f32_16x16x32_bf16 v[60:63], v[148:151], v[156:159], v[60:63]
    v_mfma_f32_16x16x32_bf16 v[64:67], v[148:151], v[160:163], v[64:67]
    s_add_u32 m0, s41, 90112
    s_add_u32 s51, s59, 55296
    buffer_load_dwordx4 v1, s[20:23], s51 offen lds
    v_mfma_f32_16x16x32_bf16 v[68:71], v[152:155], v[156:159], v[68:71]
    v_mfma_f32_16x16x32_bf16 v[72:75], v[152:155], v[160:163], v[72:75]
    s_add_u32 m0, s41, 94208
    s_add_u32 s51, s59, 64512
    buffer_load_dwordx4 v2, s[20:23], s51 offen lds
    s_waitcnt vmcnt(12)
    s_barrier
    v_subrev_u32 v164, 98304, v164
    v_subrev_u32 v165, 98304, v165
    v_subrev_u32 v166, 98304, v166
    v_subrev_u32 v167, 98304, v167
    v_subrev_u32 v168, 98304, v168
    v_subrev_u32 v169, 98304, v169
    v_subrev_u32 v170, 98304, v170
    v_subrev_u32 v171, 98304, v171
    v_subrev_u32 v172, 98304, v172
    v_subrev_u32 v173, 98304, v173
    v_subrev_u32 v174, 98304, v174
    ds_read_b128 v[112:115], v173 offset:0
    ds_read_b128 v[116:119], v173 offset:2048
    ds_read_b64_tr_b16 v[76:77], v164 offset:16384
    ds_read_b64_tr_b16 v[78:79], v164 offset:18432
    ds_read_b64_tr_b16 v[80:81], v165 offset:16384
    ds_read_b64_tr_b16 v[82:83], v165 offset:18432
    ds_read_b64_tr_b16 v[84:85], v166 offset:16384
    ds_read_b64_tr_b16 v[86:87], v166 offset:18432
    ds_read_b64_tr_b16 v[88:89], v167 offset:16384
    ds_read_b64_tr_b16 v[90:91], v167 offset:18432
    ds_read_b64_tr_b16 v[92:93], v168 offset:16384
    ds_read_b64_tr_b16 v[94:95], v168 offset:18432
    ds_read_b64_tr_b16 v[96:97], v169 offset:16384
    ds_read_b64_tr_b16 v[98:99], v169 offset:18432
    ds_read_b64_tr_b16 v[100:101], v170 offset:16384
    ds_read_b64_tr_b16 v[102:103], v170 offset:18432
    ds_read_b64_tr_b16 v[104:105], v171 offset:16384
    ds_read_b64_tr_b16 v[106:107], v171 offset:18432
    ds_read_b64_tr_b16 v[108:109], v172 offset:16384
    ds_read_b64_tr_b16 v[110:111], v172 offset:18432
    s_waitcnt lgkmcnt(0)
    v_mfma_f32_16x16x32_bf16 v[4:7], v[76:79], v[112:115], v[4:7]
    ds_read_b128 v[156:159], v174 offset:0
    v_mfma_f32_16x16x32_bf16 v[8:11], v[76:79], v[116:119], v[8:11]
    ds_read_b128 v[160:163], v174 offset:2048
    v_mfma_f32_16x16x32_bf16 v[12:15], v[80:83], v[112:115], v[12:15]
    ds_read_b64_tr_b16 v[120:121], v164 offset:32768
    ds_read_b64_tr_b16 v[122:123], v164 offset:34816
    v_mfma_f32_16x16x32_bf16 v[16:19], v[80:83], v[116:119], v[16:19]
    ds_read_b64_tr_b16 v[124:125], v165 offset:32768
    v_mfma_f32_16x16x32_bf16 v[20:23], v[84:87], v[112:115], v[20:23]
    ds_read_b64_tr_b16 v[126:127], v165 offset:34816
    ds_read_b64_tr_b16 v[128:129], v166 offset:32768
    v_mfma_f32_16x16x32_bf16 v[24:27], v[84:87], v[116:119], v[24:27]
    ds_read_b64_tr_b16 v[130:131], v166 offset:34816
    v_mfma_f32_16x16x32_bf16 v[28:31], v[88:91], v[112:115], v[28:31]
    ds_read_b64_tr_b16 v[132:133], v167 offset:32768
    ds_read_b64_tr_b16 v[134:135], v167 offset:34816
    v_mfma_f32_16x16x32_bf16 v[32:35], v[88:91], v[116:119], v[32:35]
    ds_read_b64_tr_b16 v[136:137], v168 offset:32768
    v_mfma_f32_16x16x32_bf16 v[36:39], v[92:95], v[112:115], v[36:39]
    ds_read_b64_tr_b16 v[138:139], v168 offset:34816
    ds_read_b64_tr_b16 v[140:141], v169 offset:32768
    v_mfma_f32_16x16x32_bf16 v[40:43], v[92:95], v[116:119], v[40:43]
    ds_read_b64_tr_b16 v[142:143], v169 offset:34816
    v_mfma_f32_16x16x32_bf16 v[44:47], v[96:99], v[112:115], v[44:47]
    ds_read_b64_tr_b16 v[144:145], v170 offset:32768
    v_mfma_f32_16x16x32_bf16 v[48:51], v[96:99], v[116:119], v[48:51]
    ds_read_b64_tr_b16 v[146:147], v170 offset:34816
    ds_read_b64_tr_b16 v[148:149], v171 offset:32768
    v_mfma_f32_16x16x32_bf16 v[52:55], v[100:103], v[112:115], v[52:55]
    ds_read_b64_tr_b16 v[150:151], v171 offset:34816
    v_mfma_f32_16x16x32_bf16 v[56:59], v[100:103], v[116:119], v[56:59]
    ds_read_b64_tr_b16 v[152:153], v172 offset:32768
    ds_read_b64_tr_b16 v[154:155], v172 offset:34816
    v_mfma_f32_16x16x32_bf16 v[60:63], v[104:107], v[112:115], v[60:63]
    s_add_u32 s58, s58, 128
    s_add_u32 s59, s59, 73728
    v_mfma_f32_16x16x32_bf16 v[64:67], v[104:107], v[116:119], v[64:67]
    s_add_u32 m0, s41, 98304
    s_add_u32 s51, s58, 0
    buffer_load_dwordx4 v0, s[16:19], s51 offen lds
    s_add_u32 m0, s41, 102400
    s_add_u32 s51, s58, 294912
    buffer_load_dwordx4 v0, s[16:19], s51 offen lds
    v_mfma_f32_16x16x32_bf16 v[68:71], v[108:111], v[112:115], v[68:71]
    s_add_u32 m0, s41, 106496
    s_add_u32 s51, s58, 589824
    buffer_load_dwordx4 v0, s[16:19], s51 offen lds
    v_mfma_f32_16x16x32_bf16 v[72:75], v[108:111], v[116:119], v[72:75]
    s_add_u32 m0, s41, 110592
    s_add_u32 s51, s58, 884736
    buffer_load_dwordx4 v0, s[16:19], s51 offen lds
    s_add_u32 m0, s41, 114688
    s_add_u32 s51, s59, 0
    buffer_load_dwordx4 v1, s[20:23], s51 offen lds
    s_waitcnt lgkmcnt(0)
    v_mfma_f32_16x16x32_bf16 v[4:7], v[120:123], v[156:159], v[4:7]
    v_mfma_f32_16x16x32_bf16 v[8:11], v[120:123], v[160:163], v[8:11]
    v_mfma_f32_16x16x32_bf16 v[12:15], v[124:127], v[156:159], v[12:15]
    s_add_u32 m0, s41, 118784
    s_add_u32 s51, s59, 9216
    buffer_load_dwordx4 v2, s[20:23], s51 offen lds
    v_mfma_f32_16x16x32_bf16 v[16:19], v[124:127], v[160:163], v[16:19]
    v_mfma_f32_16x16x32_bf16 v[20:23], v[128:131], v[156:159], v[20:23]
    v_mfma_f32_16x16x32_bf16 v[24:27], v[128:131], v[160:163], v[24:27]
    s_add_u32 m0, s41, 122880
    s_add_u32 s51, s59, 18432
    buffer_load_dwordx4 v1, s[20:23], s51 offen lds
    v_mfma_f32_16x16x32_bf16 v[28:31], v[132:135], v[156:159], v[28:31]
    v_mfma_f32_16x16x32_bf16 v[32:35], v[132:135], v[160:163], v[32:35]
    s_add_u32 m0, s41, 126976
    s_add_u32 s51, s59, 27648
    buffer_load_dwordx4 v2, s[20:23], s51 offen lds
    v_mfma_f32_16x16x32_bf16 v[36:39], v[136:139], v[156:159], v[36:39]
    v_mfma_f32_16x16x32_bf16 v[40:43], v[136:139], v[160:163], v[40:43]
    v_mfma_f32_16x16x32_bf16 v[44:47], v[140:143], v[156:159], v[44:47]
    s_add_u32 m0, s41, 131072
    s_add_u32 s51, s59, 36864
    buffer_load_dwordx4 v1, s[20:23], s51 offen lds
    v_mfma_f32_16x16x32_bf16 v[48:51], v[140:143], v[160:163], v[48:51]
    v_mfma_f32_16x16x32_bf16 v[52:55], v[144:147], v[156:159], v[52:55]
    s_add_u32 m0, s41, 135168
    s_add_u32 s51, s59, 46080
    buffer_load_dwordx4 v2, s[20:23], s51 offen lds
    v_mfma_f32_16x16x32_bf16 v[56:59], v[144:147], v[160:163], v[56:59]
    v_mfma_f32_16x16x32_bf16 v[60:63], v[148:151], v[156:159], v[60:63]
    v_mfma_f32_16x16x32_bf16 v[64:67], v[148:151], v[160:163], v[64:67]
    s_add_u32 m0, s41, 139264
    s_add_u32 s51, s59, 55296
    buffer_load_dwordx4 v1, s[20:23], s51 offen lds
    v_mfma_f32_16x16x32_bf16 v[68:71], v[152:155], v[156:159], v[68:71]
    v_mfma_f32_16x16x32_bf16 v[72:75], v[152:155], v[160:163], v[72:75]
    s_add_u32 m0, s41, 143360
    s_add_u32 s51, s59, 64512
    buffer_load_dwordx4 v2, s[20:23], s51 offen lds
    s_waitcnt vmcnt(12)
    s_barrier
    v_add_u32 v164, 49152, v164
    v_add_u32 v165, 49152, v165
    v_add_u32 v166, 49152, v166
    v_add_u32 v167, 49152, v167
    v_add_u32 v168, 49152, v168
    v_add_u32 v169, 49152, v169
    v_add_u32 v170, 49152, v170
    v_add_u32 v171, 49152, v171
    v_add_u32 v172, 49152, v172
    v_add_u32 v173, 49152, v173
    v_add_u32 v174, 49152, v174
    ds_read_b128 v[112:115], v173 offset:0
    ds_read_b128 v[116:119], v173 offset:2048
    ds_read_b64_tr_b16 v[76:77], v164 offset:16384
    ds_read_b64_tr_b16 v[78:79], v164 offset:18432
    ds_read_b64_tr_b16 v[80:81], v165 offset:16384
    ds_read_b64_tr_b16 v[82:83], v165 offset:18432
    ds_read_b64_tr_b16 v[84:85], v166 offset:16384
    ds_read_b64_tr_b16 v[86:87], v166 offset:18432
    ds_read_b64_tr_b16 v[88:89], v167 offset:16384
    ds_read_b64_tr_b16 v[90:91], v167 offset:18432
    ds_read_b64_tr_b16 v[92:93], v168 offset:16384
    ds_read_b64_tr_b16 v[94:95], v168 offset:18432
    ds_read_b64_tr_b16 v[96:97], v169 offset:16384
    ds_read_b64_tr_b16 v[98:99], v169 offset:18432
    ds_read_b64_tr_b16 v[100:101], v170 offset:16384
    ds_read_b64_tr_b16 v[102:103], v170 offset:18432
    ds_read_b64_tr_b16 v[104:105], v171 offset:16384
    ds_read_b64_tr_b16 v[106:107], v171 offset:18432
    ds_read_b64_tr_b16 v[108:109], v172 offset:16384
    ds_read_b64_tr_b16 v[110:111], v172 offset:18432
    s_waitcnt lgkmcnt(0)
    v_mfma_f32_16x16x32_bf16 v[4:7], v[76:79], v[112:115], v[4:7]
    ds_read_b128 v[156:159], v174 offset:0
    v_mfma_f32_16x16x32_bf16 v[8:11], v[76:79], v[116:119], v[8:11]
    ds_read_b128 v[160:163], v174 offset:2048
    v_mfma_f32_16x16x32_bf16 v[12:15], v[80:83], v[112:115], v[12:15]
    ds_read_b64_tr_b16 v[120:121], v164 offset:32768
    ds_read_b64_tr_b16 v[122:123], v164 offset:34816
    v_mfma_f32_16x16x32_bf16 v[16:19], v[80:83], v[116:119], v[16:19]
    ds_read_b64_tr_b16 v[124:125], v165 offset:32768
    v_mfma_f32_16x16x32_bf16 v[20:23], v[84:87], v[112:115], v[20:23]
    ds_read_b64_tr_b16 v[126:127], v165 offset:34816
    ds_read_b64_tr_b16 v[128:129], v166 offset:32768
    v_mfma_f32_16x16x32_bf16 v[24:27], v[84:87], v[116:119], v[24:27]
    ds_read_b64_tr_b16 v[130:131], v166 offset:34816
    v_mfma_f32_16x16x32_bf16 v[28:31], v[88:91], v[112:115], v[28:31]
    ds_read_b64_tr_b16 v[132:133], v167 offset:32768
    ds_read_b64_tr_b16 v[134:135], v167 offset:34816
    v_mfma_f32_16x16x32_bf16 v[32:35], v[88:91], v[116:119], v[32:35]
    ds_read_b64_tr_b16 v[136:137], v168 offset:32768
    v_mfma_f32_16x16x32_bf16 v[36:39], v[92:95], v[112:115], v[36:39]
    ds_read_b64_tr_b16 v[138:139], v168 offset:34816
    ds_read_b64_tr_b16 v[140:141], v169 offset:32768
    v_mfma_f32_16x16x32_bf16 v[40:43], v[92:95], v[116:119], v[40:43]
    ds_read_b64_tr_b16 v[142:143], v169 offset:34816
    v_mfma_f32_16x16x32_bf16 v[44:47], v[96:99], v[112:115], v[44:47]
    ds_read_b64_tr_b16 v[144:145], v170 offset:32768
    v_mfma_f32_16x16x32_bf16 v[48:51], v[96:99], v[116:119], v[48:51]
    ds_read_b64_tr_b16 v[146:147], v170 offset:34816
    ds_read_b64_tr_b16 v[148:149], v171 offset:32768
    v_mfma_f32_16x16x32_bf16 v[52:55], v[100:103], v[112:115], v[52:55]
    ds_read_b64_tr_b16 v[150:151], v171 offset:34816
    v_mfma_f32_16x16x32_bf16 v[56:59], v[100:103], v[116:119], v[56:59]
    ds_read_b64_tr_b16 v[152:153], v172 offset:32768
    ds_read_b64_tr_b16 v[154:155], v172 offset:34816
    v_mfma_f32_16x16x32_bf16 v[60:63], v[104:107], v[112:115], v[60:63]
    s_add_u32 s58, s58, 128
    s_add_u32 s59, s59, 73728
    v_mfma_f32_16x16x32_bf16 v[64:67], v[104:107], v[116:119], v[64:67]
    s_add_u32 m0, s41, 0
    s_add_u32 s51, s58, 0
    buffer_load_dwordx4 v0, s[16:19], s51 offen lds
    s_add_u32 m0, s41, 4096
    s_add_u32 s51, s58, 294912
    buffer_load_dwordx4 v0, s[16:19], s51 offen lds
    v_mfma_f32_16x16x32_bf16 v[68:71], v[108:111], v[112:115], v[68:71]
    s_add_u32 m0, s41, 8192
    s_add_u32 s51, s58, 589824
    buffer_load_dwordx4 v0, s[16:19], s51 offen lds
    v_mfma_f32_16x16x32_bf16 v[72:75], v[108:111], v[116:119], v[72:75]
    s_add_u32 m0, s41, 12288
    s_add_u32 s51, s58, 884736
    buffer_load_dwordx4 v0, s[16:19], s51 offen lds
    s_add_u32 m0, s41, 16384
    s_add_u32 s51, s59, 0
    buffer_load_dwordx4 v1, s[20:23], s51 offen lds
    s_waitcnt lgkmcnt(0)
    v_mfma_f32_16x16x32_bf16 v[4:7], v[120:123], v[156:159], v[4:7]
    v_mfma_f32_16x16x32_bf16 v[8:11], v[120:123], v[160:163], v[8:11]
    v_mfma_f32_16x16x32_bf16 v[12:15], v[124:127], v[156:159], v[12:15]
    s_add_u32 m0, s41, 20480
    s_add_u32 s51, s59, 9216
    buffer_load_dwordx4 v2, s[20:23], s51 offen lds
    v_mfma_f32_16x16x32_bf16 v[16:19], v[124:127], v[160:163], v[16:19]
    v_mfma_f32_16x16x32_bf16 v[20:23], v[128:131], v[156:159], v[20:23]
    v_mfma_f32_16x16x32_bf16 v[24:27], v[128:131], v[160:163], v[24:27]
    s_add_u32 m0, s41, 24576
    s_add_u32 s51, s59, 18432
    buffer_load_dwordx4 v1, s[20:23], s51 offen lds
    v_mfma_f32_16x16x32_bf16 v[28:31], v[132:135], v[156:159], v[28:31]
    v_mfma_f32_16x16x32_bf16 v[32:35], v[132:135], v[160:163], v[32:35]
    s_add_u32 m0, s41, 28672
    s_add_u32 s51, s59, 27648
    buffer_load_dwordx4 v2, s[20:23], s51 offen lds
    v_mfma_f32_16x16x32_bf16 v[36:39], v[136:139], v[156:159], v[36:39]
    v_mfma_f32_16x16x32_bf16 v[40:43], v[136:139], v[160:163], v[40:43]
    v_mfma_f32_16x16x32_bf16 v[44:47], v[140:143], v[156:159], v[44:47]
    s_add_u32 m0, s41, 32768
    s_add_u32 s51, s59, 36864
    buffer_load_dwordx4 v1, s[20:23], s51 offen lds
    v_mfma_f32_16x16x32_bf16 v[48:51], v[140:143], v[160:163], v[48:51]
    v_mfma_f32_16x16x32_bf16 v[52:55], v[144:147], v[156:159], v[52:55]
    s_add_u32 m0, s41, 36864
    s_add_u32 s51, s59, 46080
    buffer_load_dwordx4 v2, s[20:23], s51 offen lds
    v_mfma_f32_16x16x32_bf16 v[56:59], v[144:147], v[160:163], v[56:59]
    v_mfma_f32_16x16x32_bf16 v[60:63], v[148:151], v[156:159], v[60:63]
    v_mfma_f32_16x16x32_bf16 v[64:67], v[148:151], v[160:163], v[64:67]
    s_add_u32 m0, s41, 40960
    s_add_u32 s51, s59, 55296
    buffer_load_dwordx4 v1, s[20:23], s51 offen lds
    v_mfma_f32_16x16x32_bf16 v[68:71], v[152:155], v[156:159], v[68:71]
    v_mfma_f32_16x16x32_bf16 v[72:75], v[152:155], v[160:163], v[72:75]
    s_add_u32 m0, s41, 45056
    s_add_u32 s51, s59, 64512
    buffer_load_dwordx4 v2, s[20:23], s51 offen lds
    s_waitcnt vmcnt(12)
    s_barrier
    v_add_u32 v164, 49152, v164
    v_add_u32 v165, 49152, v165
    v_add_u32 v166, 49152, v166
    v_add_u32 v167, 49152, v167
    v_add_u32 v168, 49152, v168
    v_add_u32 v169, 49152, v169
    v_add_u32 v170, 49152, v170
    v_add_u32 v171, 49152, v171
    v_add_u32 v172, 49152, v172
    v_add_u32 v173, 49152, v173
    v_add_u32 v174, 49152, v174
    ds_read_b128 v[112:115], v173 offset:0
    ds_read_b128 v[116:119], v173 offset:2048
    ds_read_b64_tr_b16 v[76:77], v164 offset:16384
    ds_read_b64_tr_b16 v[78:79], v164 offset:18432
    ds_read_b64_tr_b16 v[80:81], v165 offset:16384
    ds_read_b64_tr_b16 v[82:83], v165 offset:18432
    ds_read_b64_tr_b16 v[84:85], v166 offset:16384
    ds_read_b64_tr_b16 v[86:87], v166 offset:18432
    ds_read_b64_tr_b16 v[88:89], v167 offset:16384
    ds_read_b64_tr_b16 v[90:91], v167 offset:18432
    ds_read_b64_tr_b16 v[92:93], v168 offset:16384
    ds_read_b64_tr_b16 v[94:95], v168 offset:18432
    ds_read_b64_tr_b16 v[96:97], v169 offset:16384
    ds_read_b64_tr_b16 v[98:99], v169 offset:18432
    ds_read_b64_tr_b16 v[100:101], v170 offset:16384
    ds_read_b64_tr_b16 v[102:103], v170 offset:18432
    ds_read_b64_tr_b16 v[104:105], v171 offset:16384
    ds_read_b64_tr_b16 v[106:107], v171 offset:18432
    ds_read_b64_tr_b16 v[108:109], v172 offset:16384
    ds_read_b64_tr_b16 v[110:111], v172 offset:18432
    s_waitcnt lgkmcnt(0)
    v_mfma_f32_16x16x32_bf16 v[4:7], v[76:79], v[112:115], v[4:7]
    ds_read_b128 v[156:159], v174 offset:0
    v_mfma_f32_16x16x32_bf16 v[8:11], v[76:79], v[116:119], v[8:11]
    ds_read_b128 v[160:163], v174 offset:2048
    v_mfma_f32_16x16x32_bf16 v[12:15], v[80:83], v[112:115], v[12:15]
    ds_read_b64_tr_b16 v[120:121], v164 offset:32768
    ds_read_b64_tr_b16 v[122:123], v164 offset:34816
    v_mfma_f32_16x16x32_bf16 v[16:19], v[80:83], v[116:119], v[16:19]
    ds_read_b64_tr_b16 v[124:125], v165 offset:32768
    v_mfma_f32_16x16x32_bf16 v[20:23], v[84:87], v[112:115], v[20:23]
    ds_read_b64_tr_b16 v[126:127], v165 offset:34816
    ds_read_b64_tr_b16 v[128:129], v166 offset:32768
    v_mfma_f32_16x16x32_bf16 v[24:27], v[84:87], v[116:119], v[24:27]
    ds_read_b64_tr_b16 v[130:131], v166 offset:34816
    v_mfma_f32_16x16x32_bf16 v[28:31], v[88:91], v[112:115], v[28:31]
    ds_read_b64_tr_b16 v[132:133], v167 offset:32768
    ds_read_b64_tr_b16 v[134:135], v167 offset:34816
    v_mfma_f32_16x16x32_bf16 v[32:35], v[88:91], v[116:119], v[32:35]
    ds_read_b64_tr_b16 v[136:137], v168 offset:32768
    v_mfma_f32_16x16x32_bf16 v[36:39], v[92:95], v[112:115], v[36:39]
    ds_read_b64_tr_b16 v[138:139], v168 offset:34816
    ds_read_b64_tr_b16 v[140:141], v169 offset:32768
    v_mfma_f32_16x16x32_bf16 v[40:43], v[92:95], v[116:119], v[40:43]
    ds_read_b64_tr_b16 v[142:143], v169 offset:34816
    v_mfma_f32_16x16x32_bf16 v[44:47], v[96:99], v[112:115], v[44:47]
    ds_read_b64_tr_b16 v[144:145], v170 offset:32768
    v_mfma_f32_16x16x32_bf16 v[48:51], v[96:99], v[116:119], v[48:51]
    ds_read_b64_tr_b16 v[146:147], v170 offset:34816
    ds_read_b64_tr_b16 v[148:149], v171 offset:32768
    v_mfma_f32_16x16x32_bf16 v[52:55], v[100:103], v[112:115], v[52:55]
    ds_read_b64_tr_b16 v[150:151], v171 offset:34816
    v_mfma_f32_16x16x32_bf16 v[56:59], v[100:103], v[116:119], v[56:59]
    ds_read_b64_tr_b16 v[152:153], v172 offset:32768
    ds_read_b64_tr_b16 v[154:155], v172 offset:34816
    v_mfma_f32_16x16x32_bf16 v[60:63], v[104:107], v[112:115], v[60:63]
    s_add_u32 s58, s58, 128
    s_add_u32 s59, s59, 73728
    v_mfma_f32_16x16x32_bf16 v[64:67], v[104:107], v[116:119], v[64:67]
    s_add_u32 m0, s41, 49152
    s_add_u32 s51, s58, 0
    buffer_load_dwordx4 v0, s[16:19], s51 offen lds
    s_add_u32 m0, s41, 53248
    s_add_u32 s51, s58, 294912
    buffer_load_dwordx4 v0, s[16:19], s51 offen lds
    v_mfma_f32_16x16x32_bf16 v[68:71], v[108:111], v[112:115], v[68:71]
    s_add_u32 m0, s41, 57344
    s_add_u32 s51, s58, 589824
    buffer_load_dwordx4 v0, s[16:19], s51 offen lds
    v_mfma_f32_16x16x32_bf16 v[72:75], v[108:111], v[116:119], v[72:75]
    s_add_u32 m0, s41, 61440
    s_add_u32 s51, s58, 884736
    buffer_load_dwordx4 v0, s[16:19], s51 offen lds
    s_add_u32 m0, s41, 65536
    s_add_u32 s51, s59, 0
    buffer_load_dwordx4 v1, s[20:23], s51 offen lds
    s_waitcnt lgkmcnt(0)
    v_mfma_f32_16x16x32_bf16 v[4:7], v[120:123], v[156:159], v[4:7]
    v_mfma_f32_16x16x32_bf16 v[8:11], v[120:123], v[160:163], v[8:11]
    v_mfma_f32_16x16x32_bf16 v[12:15], v[124:127], v[156:159], v[12:15]
    s_add_u32 m0, s41, 69632
    s_add_u32 s51, s59, 9216
    buffer_load_dwordx4 v2, s[20:23], s51 offen lds
    v_mfma_f32_16x16x32_bf16 v[16:19], v[124:127], v[160:163], v[16:19]
    v_mfma_f32_16x16x32_bf16 v[20:23], v[128:131], v[156:159], v[20:23]
    v_mfma_f32_16x16x32_bf16 v[24:27], v[128:131], v[160:163], v[24:27]
    s_add_u32 m0, s41, 73728
    s_add_u32 s51, s59, 18432
    buffer_load_dwordx4 v1, s[20:23], s51 offen lds
    v_mfma_f32_16x16x32_bf16 v[28:31], v[132:135], v[156:159], v[28:31]
    v_mfma_f32_16x16x32_bf16 v[32:35], v[132:135], v[160:163], v[32:35]
    s_add_u32 m0, s41, 77824
    s_add_u32 s51, s59, 27648
    buffer_load_dwordx4 v2, s[20:23], s51 offen lds
    v_mfma_f32_16x16x32_bf16 v[36:39], v[136:139], v[156:159], v[36:39]
    v_mfma_f32_16x16x32_bf16 v[40:43], v[136:139], v[160:163], v[40:43]
    v_mfma_f32_16x16x32_bf16 v[44:47], v[140:143], v[156:159], v[44:47]
    s_add_u32 m0, s41, 81920
    s_add_u32 s51, s59, 36864
    buffer_load_dwordx4 v1, s[20:23], s51 offen lds
    v_mfma_f32_16x16x32_bf16 v[48:51], v[140:143], v[160:163], v[48:51]
    v_mfma_f32_16x16x32_bf16 v[52:55], v[144:147], v[156:159], v[52:55]
    s_add_u32 m0, s41, 86016
    s_add_u32 s51, s59, 46080
    buffer_load_dwordx4 v2, s[20:23], s51 offen lds
    v_mfma_f32_16x16x32_bf16 v[56:59], v[144:147], v[160:163], v[56:59]
    v_mfma_f32_16x16x32_bf16 v[60:63], v[148:151], v[156:159], v[60:63]
    v_mfma_f32_16x16x32_bf16 v[64:67], v[148:151], v[160:163], v[64:67]
    s_add_u32 m0, s41, 90112
    s_add_u32 s51, s59, 55296
    buffer_load_dwordx4 v1, s[20:23], s51 offen lds
    v_mfma_f32_16x16x32_bf16 v[68:71], v[152:155], v[156:159], v[68:71]
    v_mfma_f32_16x16x32_bf16 v[72:75], v[152:155], v[160:163], v[72:75]
    s_add_u32 m0, s41, 94208
    s_add_u32 s51, s59, 64512
    buffer_load_dwordx4 v2, s[20:23], s51 offen lds
    s_waitcnt vmcnt(12)
    s_barrier
    v_subrev_u32 v164, 98304, v164
    v_subrev_u32 v165, 98304, v165
    v_subrev_u32 v166, 98304, v166
    v_subrev_u32 v167, 98304, v167
    v_subrev_u32 v168, 98304, v168
    v_subrev_u32 v169, 98304, v169
    v_subrev_u32 v170, 98304, v170
    v_subrev_u32 v171, 98304, v171
    v_subrev_u32 v172, 98304, v172
    v_subrev_u32 v173, 98304, v173
    v_subrev_u32 v174, 98304, v174
    ds_read_b128 v[112:115], v173 offset:0
    ds_read_b128 v[116:119], v173 offset:2048
    ds_read_b64_tr_b16 v[76:77], v164 offset:16384
    ds_read_b64_tr_b16 v[78:79], v164 offset:18432
    ds_read_b64_tr_b16 v[80:81], v165 offset:16384
    ds_read_b64_tr_b16 v[82:83], v165 offset:18432
    ds_read_b64_tr_b16 v[84:85], v166 offset:16384
    ds_read_b64_tr_b16 v[86:87], v166 offset:18432
    ds_read_b64_tr_b16 v[88:89], v167 offset:16384
    ds_read_b64_tr_b16 v[90:91], v167 offset:18432
    ds_read_b64_tr_b16 v[92:93], v168 offset:16384
    ds_read_b64_tr_b16 v[94:95], v168 offset:18432
    ds_read_b64_tr_b16 v[96:97], v169 offset:16384
    ds_read_b64_tr_b16 v[98:99], v169 offset:18432
    ds_read_b64_tr_b16 v[100:101], v170 offset:16384
    ds_read_b64_tr_b16 v[102:103], v170 offset:18432
    ds_read_b64_tr_b16 v[104:105], v171 offset:16384
    ds_read_b64_tr_b16 v[106:107], v171 offset:18432
    ds_read_b64_tr_b16 v[108:109], v172 offset:16384
    ds_read_b64_tr_b16 v[110:111], v172 offset:18432
    s_waitcnt lgkmcnt(0)
    v_mfma_f32_16x16x32_bf16 v[4:7], v[76:79], v[112:115], v[4:7]
    ds_read_b128 v[156:159], v174 offset:0
    v_mfma_f32_16x16x32_bf16 v[8:11], v[76:79], v[116:119], v[8:11]
    ds_read_b128 v[160:163], v174 offset:2048
    v_mfma_f32_16x16x32_bf16 v[12:15], v[80:83], v[112:115], v[12:15]
    ds_read_b64_tr_b16 v[120:121], v164 offset:32768
    ds_read_b64_tr_b16 v[122:123], v164 offset:34816
    v_mfma_f32_16x16x32_bf16 v[16:19], v[80:83], v[116:119], v[16:19]
    ds_read_b64_tr_b16 v[124:125], v165 offset:32768
    v_mfma_f32_16x16x32_bf16 v[20:23], v[84:87], v[112:115], v[20:23]
    ds_read_b64_tr_b16 v[126:127], v165 offset:34816
    ds_read_b64_tr_b16 v[128:129], v166 offset:32768
    v_mfma_f32_16x16x32_bf16 v[24:27], v[84:87], v[116:119], v[24:27]
    ds_read_b64_tr_b16 v[130:131], v166 offset:34816
    v_mfma_f32_16x16x32_bf16 v[28:31], v[88:91], v[112:115], v[28:31]
    ds_read_b64_tr_b16 v[132:133], v167 offset:32768
    ds_read_b64_tr_b16 v[134:135], v167 offset:34816
    v_mfma_f32_16x16x32_bf16 v[32:35], v[88:91], v[116:119], v[32:35]
    ds_read_b64_tr_b16 v[136:137], v168 offset:32768
    v_mfma_f32_16x16x32_bf16 v[36:39], v[92:95], v[112:115], v[36:39]
    ds_read_b64_tr_b16 v[138:139], v168 offset:34816
    ds_read_b64_tr_b16 v[140:141], v169 offset:32768
    v_mfma_f32_16x16x32_bf16 v[40:43], v[92:95], v[116:119], v[40:43]
    ds_read_b64_tr_b16 v[142:143], v169 offset:34816
    v_mfma_f32_16x16x32_bf16 v[44:47], v[96:99], v[112:115], v[44:47]
    ds_read_b64_tr_b16 v[144:145], v170 offset:32768
    v_mfma_f32_16x16x32_bf16 v[48:51], v[96:99], v[116:119], v[48:51]
    ds_read_b64_tr_b16 v[146:147], v170 offset:34816
    ds_read_b64_tr_b16 v[148:149], v171 offset:32768
    v_mfma_f32_16x16x32_bf16 v[52:55], v[100:103], v[112:115], v[52:55]
    ds_read_b64_tr_b16 v[150:151], v171 offset:34816
    v_mfma_f32_16x16x32_bf16 v[56:59], v[100:103], v[116:119], v[56:59]
    ds_read_b64_tr_b16 v[152:153], v172 offset:32768
    ds_read_b64_tr_b16 v[154:155], v172 offset:34816
    v_mfma_f32_16x16x32_bf16 v[60:63], v[104:107], v[112:115], v[60:63]
    s_add_u32 s58, s58, 128
    s_add_u32 s59, s59, 73728
    v_mfma_f32_16x16x32_bf16 v[64:67], v[104:107], v[116:119], v[64:67]
    s_add_u32 m0, s41, 98304
    s_add_u32 s51, s58, 0
    buffer_load_dwordx4 v0, s[16:19], s51 offen lds
    s_add_u32 m0, s41, 102400
    s_add_u32 s51, s58, 294912
    buffer_load_dwordx4 v0, s[16:19], s51 offen lds
    v_mfma_f32_16x16x32_bf16 v[68:71], v[108:111], v[112:115], v[68:71]
    s_add_u32 m0, s41, 106496
    s_add_u32 s51, s58, 589824
    buffer_load_dwordx4 v0, s[16:19], s51 offen lds
    v_mfma_f32_16x16x32_bf16 v[72:75], v[108:111], v[116:119], v[72:75]
    s_add_u32 m0, s41, 110592
    s_add_u32 s51, s58, 884736
    buffer_load_dwordx4 v0, s[16:19], s51 offen lds
    s_add_u32 m0, s41, 114688
    s_add_u32 s51, s59, 0
    buffer_load_dwordx4 v1, s[20:23], s51 offen lds
    s_waitcnt lgkmcnt(0)
    v_mfma_f32_16x16x32_bf16 v[4:7], v[120:123], v[156:159], v[4:7]
    v_mfma_f32_16x16x32_bf16 v[8:11], v[120:123], v[160:163], v[8:11]
    v_mfma_f32_16x16x32_bf16 v[12:15], v[124:127], v[156:159], v[12:15]
    s_add_u32 m0, s41, 118784
    s_add_u32 s51, s59, 9216
    buffer_load_dwordx4 v2, s[20:23], s51 offen lds
    v_mfma_f32_16x16x32_bf16 v[16:19], v[124:127], v[160:163], v[16:19]
    v_mfma_f32_16x16x32_bf16 v[20:23], v[128:131], v[156:159], v[20:23]
    v_mfma_f32_16x16x32_bf16 v[24:27], v[128:131], v[160:163], v[24:27]
    s_add_u32 m0, s41, 122880
    s_add_u32 s51, s59, 18432
    buffer_load_dwordx4 v1, s[20:23], s51 offen lds
    v_mfma_f32_16x16x32_bf16 v[28:31], v[132:135], v[156:159], v[28:31]
    v_mfma_f32_16x16x32_bf16 v[32:35], v[132:135], v[160:163], v[32:35]
    s_add_u32 m0, s41, 126976
    s_add_u32 s51, s59, 27648
    buffer_load_dwordx4 v2, s[20:23], s51 offen lds
    v_mfma_f32_16x16x32_bf16 v[36:39], v[136:139], v[156:159], v[36:39]
    v_mfma_f32_16x16x32_bf16 v[40:43], v[136:139], v[160:163], v[40:43]
    v_mfma_f32_16x16x32_bf16 v[44:47], v[140:143], v[156:159], v[44:47]
    s_add_u32 m0, s41, 131072
    s_add_u32 s51, s59, 36864
    buffer_load_dwordx4 v1, s[20:23], s51 offen lds
    v_mfma_f32_16x16x32_bf16 v[48:51], v[140:143], v[160:163], v[48:51]
    v_mfma_f32_16x16x32_bf16 v[52:55], v[144:147], v[156:159], v[52:55]
    s_add_u32 m0, s41, 135168
    s_add_u32 s51, s59, 46080
    buffer_load_dwordx4 v2, s[20:23], s51 offen lds
    v_mfma_f32_16x16x32_bf16 v[56:59], v[144:147], v[160:163], v[56:59]
    v_mfma_f32_16x16x32_bf16 v[60:63], v[148:151], v[156:159], v[60:63]
    v_mfma_f32_16x16x32_bf16 v[64:67], v[148:151], v[160:163], v[64:67]
    s_add_u32 m0, s41, 139264
    s_add_u32 s51, s59, 55296
    buffer_load_dwordx4 v1, s[20:23], s51 offen lds
    v_mfma_f32_16x16x32_bf16 v[68:71], v[152:155], v[156:159], v[68:71]
    v_mfma_f32_16x16x32_bf16 v[72:75], v[152:155], v[160:163], v[72:75]
    s_add_u32 m0, s41, 143360
    s_add_u32 s51, s59, 64512
    buffer_load_dwordx4 v2, s[20:23], s51 offen lds
    s_waitcnt vmcnt(12)
    s_barrier
    v_add_u32 v164, 49152, v164
    v_add_u32 v165, 49152, v165
    v_add_u32 v166, 49152, v166
    v_add_u32 v167, 49152, v167
    v_add_u32 v168, 49152, v168
    v_add_u32 v169, 49152, v169
    v_add_u32 v170, 49152, v170
    v_add_u32 v171, 49152, v171
    v_add_u32 v172, 49152, v172
    v_add_u32 v173, 49152, v173
    v_add_u32 v174, 49152, v174
    ds_read_b128 v[112:115], v173 offset:0
    ds_read_b128 v[116:119], v173 offset:2048
    ds_read_b64_tr_b16 v[76:77], v164 offset:16384
    ds_read_b64_tr_b16 v[78:79], v164 offset:18432
    ds_read_b64_tr_b16 v[80:81], v165 offset:16384
    ds_read_b64_tr_b16 v[82:83], v165 offset:18432
    ds_read_b64_tr_b16 v[84:85], v166 offset:16384
    ds_read_b64_tr_b16 v[86:87], v166 offset:18432
    ds_read_b64_tr_b16 v[88:89], v167 offset:16384
    ds_read_b64_tr_b16 v[90:91], v167 offset:18432
    ds_read_b64_tr_b16 v[92:93], v168 offset:16384
    ds_read_b64_tr_b16 v[94:95], v168 offset:18432
    ds_read_b64_tr_b16 v[96:97], v169 offset:16384
    ds_read_b64_tr_b16 v[98:99], v169 offset:18432
    ds_read_b64_tr_b16 v[100:101], v170 offset:16384
    ds_read_b64_tr_b16 v[102:103], v170 offset:18432
    ds_read_b64_tr_b16 v[104:105], v171 offset:16384
    ds_read_b64_tr_b16 v[106:107], v171 offset:18432
    ds_read_b64_tr_b16 v[108:109], v172 offset:16384
    ds_read_b64_tr_b16 v[110:111], v172 offset:18432
    s_waitcnt lgkmcnt(0)
    v_mfma_f32_16x16x32_bf16 v[4:7], v[76:79], v[112:115], v[4:7]
    ds_read_b128 v[156:159], v174 offset:0
    v_mfma_f32_16x16x32_bf16 v[8:11], v[76:79], v[116:119], v[8:11]
    ds_read_b128 v[160:163], v174 offset:2048
    v_mfma_f32_16x16x32_bf16 v[12:15], v[80:83], v[112:115], v[12:15]
    ds_read_b64_tr_b16 v[120:121], v164 offset:32768
    ds_read_b64_tr_b16 v[122:123], v164 offset:34816
    v_mfma_f32_16x16x32_bf16 v[16:19], v[80:83], v[116:119], v[16:19]
    ds_read_b64_tr_b16 v[124:125], v165 offset:32768
    v_mfma_f32_16x16x32_bf16 v[20:23], v[84:87], v[112:115], v[20:23]
    ds_read_b64_tr_b16 v[126:127], v165 offset:34816
    ds_read_b64_tr_b16 v[128:129], v166 offset:32768
    v_mfma_f32_16x16x32_bf16 v[24:27], v[84:87], v[116:119], v[24:27]
    ds_read_b64_tr_b16 v[130:131], v166 offset:34816
    v_mfma_f32_16x16x32_bf16 v[28:31], v[88:91], v[112:115], v[28:31]
    ds_read_b64_tr_b16 v[132:133], v167 offset:32768
    ds_read_b64_tr_b16 v[134:135], v167 offset:34816
    v_mfma_f32_16x16x32_bf16 v[32:35], v[88:91], v[116:119], v[32:35]
    ds_read_b64_tr_b16 v[136:137], v168 offset:32768
    v_mfma_f32_16x16x32_bf16 v[36:39], v[92:95], v[112:115], v[36:39]
    ds_read_b64_tr_b16 v[138:139], v168 offset:34816
    ds_read_b64_tr_b16 v[140:141], v169 offset:32768
    v_mfma_f32_16x16x32_bf16 v[40:43], v[92:95], v[116:119], v[40:43]
    ds_read_b64_tr_b16 v[142:143], v169 offset:34816
    v_mfma_f32_16x16x32_bf16 v[44:47], v[96:99], v[112:115], v[44:47]
    ds_read_b64_tr_b16 v[144:145], v170 offset:32768
    v_mfma_f32_16x16x32_bf16 v[48:51], v[96:99], v[116:119], v[48:51]
    ds_read_b64_tr_b16 v[146:147], v170 offset:34816
    ds_read_b64_tr_b16 v[148:149], v171 offset:32768
    v_mfma_f32_16x16x32_bf16 v[52:55], v[100:103], v[112:115], v[52:55]
    ds_read_b64_tr_b16 v[150:151], v171 offset:34816
    v_mfma_f32_16x16x32_bf16 v[56:59], v[100:103], v[116:119], v[56:59]
    ds_read_b64_tr_b16 v[152:153], v172 offset:32768
    ds_read_b64_tr_b16 v[154:155], v172 offset:34816
    v_mfma_f32_16x16x32_bf16 v[60:63], v[104:107], v[112:115], v[60:63]
    s_add_u32 s58, s58, 128
    s_add_u32 s59, s59, 73728
    v_mfma_f32_16x16x32_bf16 v[64:67], v[104:107], v[116:119], v[64:67]
    s_add_u32 m0, s41, 0
    s_add_u32 s51, s58, 0
    buffer_load_dwordx4 v0, s[16:19], s51 offen lds
    s_add_u32 m0, s41, 4096
    s_add_u32 s51, s58, 294912
    buffer_load_dwordx4 v0, s[16:19], s51 offen lds
    v_mfma_f32_16x16x32_bf16 v[68:71], v[108:111], v[112:115], v[68:71]
    s_add_u32 m0, s41, 8192
    s_add_u32 s51, s58, 589824
    buffer_load_dwordx4 v0, s[16:19], s51 offen lds
    v_mfma_f32_16x16x32_bf16 v[72:75], v[108:111], v[116:119], v[72:75]
    s_add_u32 m0, s41, 12288
    s_add_u32 s51, s58, 884736
    buffer_load_dwordx4 v0, s[16:19], s51 offen lds
    s_add_u32 m0, s41, 16384
    s_add_u32 s51, s59, 0
    buffer_load_dwordx4 v1, s[20:23], s51 offen lds
    s_waitcnt lgkmcnt(0)
    v_mfma_f32_16x16x32_bf16 v[4:7], v[120:123], v[156:159], v[4:7]
    v_mfma_f32_16x16x32_bf16 v[8:11], v[120:123], v[160:163], v[8:11]
    v_mfma_f32_16x16x32_bf16 v[12:15], v[124:127], v[156:159], v[12:15]
    s_add_u32 m0, s41, 20480
    s_add_u32 s51, s59, 9216
    buffer_load_dwordx4 v2, s[20:23], s51 offen lds
    v_mfma_f32_16x16x32_bf16 v[16:19], v[124:127], v[160:163], v[16:19]
    v_mfma_f32_16x16x32_bf16 v[20:23], v[128:131], v[156:159], v[20:23]
    v_mfma_f32_16x16x32_bf16 v[24:27], v[128:131], v[160:163], v[24:27]
    s_add_u32 m0, s41, 24576
    s_add_u32 s51, s59, 18432
    buffer_load_dwordx4 v1, s[20:23], s51 offen lds
    v_mfma_f32_16x16x32_bf16 v[28:31], v[132:135], v[156:159], v[28:31]
    v_mfma_f32_16x16x32_bf16 v[32:35], v[132:135], v[160:163], v[32:35]
    s_add_u32 m0, s41, 28672
    s_add_u32 s51, s59, 27648
    buffer_load_dwordx4 v2, s[20:23], s51 offen lds
    v_mfma_f32_16x16x32_bf16 v[36:39], v[136:139], v[156:159], v[36:39]
    v_mfma_f32_16x16x32_bf16 v[40:43], v[136:139], v[160:163], v[40:43]
    v_mfma_f32_16x16x32_bf16 v[44:47], v[140:143], v[156:159], v[44:47]
    s_add_u32 m0, s41, 32768
    s_add_u32 s51, s59, 36864
    buffer_load_dwordx4 v1, s[20:23], s51 offen lds
    v_mfma_f32_16x16x32_bf16 v[48:51], v[140:143], v[160:163], v[48:51]
    v_mfma_f32_16x16x32_bf16 v[52:55], v[144:147], v[156:159], v[52:55]
    s_add_u32 m0, s41, 36864
    s_add_u32 s51, s59, 46080
    buffer_load_dwordx4 v2, s[20:23], s51 offen lds
    v_mfma_f32_16x16x32_bf16 v[56:59], v[144:147], v[160:163], v[56:59]
    v_mfma_f32_16x16x32_bf16 v[60:63], v[148:151], v[156:159], v[60:63]
    v_mfma_f32_16x16x32_bf16 v[64:67], v[148:151], v[160:163], v[64:67]
    s_add_u32 m0, s41, 40960
    s_add_u32 s51, s59, 55296
    buffer_load_dwordx4 v1, s[20:23], s51 offen lds
    v_mfma_f32_16x16x32_bf16 v[68:71], v[152:155], v[156:159], v[68:71]
    v_mfma_f32_16x16x32_bf16 v[72:75], v[152:155], v[160:163], v[72:75]
    s_add_u32 m0, s41, 45056
    s_add_u32 s51, s59, 64512
    buffer_load_dwordx4 v2, s[20:23], s51 offen lds
    s_waitcnt vmcnt(12)
    s_barrier
    v_add_u32 v164, 49152, v164
    v_add_u32 v165, 49152, v165
    v_add_u32 v166, 49152, v166
    v_add_u32 v167, 49152, v167
    v_add_u32 v168, 49152, v168
    v_add_u32 v169, 49152, v169
    v_add_u32 v170, 49152, v170
    v_add_u32 v171, 49152, v171
    v_add_u32 v172, 49152, v172
    v_add_u32 v173, 49152, v173
    v_add_u32 v174, 49152, v174
    ds_read_b128 v[112:115], v173 offset:0
    ds_read_b128 v[116:119], v173 offset:2048
    ds_read_b64_tr_b16 v[76:77], v164 offset:16384
    ds_read_b64_tr_b16 v[78:79], v164 offset:18432
    ds_read_b64_tr_b16 v[80:81], v165 offset:16384
    ds_read_b64_tr_b16 v[82:83], v165 offset:18432
    ds_read_b64_tr_b16 v[84:85], v166 offset:16384
    ds_read_b64_tr_b16 v[86:87], v166 offset:18432
    ds_read_b64_tr_b16 v[88:89], v167 offset:16384
    ds_read_b64_tr_b16 v[90:91], v167 offset:18432
    ds_read_b64_tr_b16 v[92:93], v168 offset:16384
    ds_read_b64_tr_b16 v[94:95], v168 offset:18432
    ds_read_b64_tr_b16 v[96:97], v169 offset:16384
    ds_read_b64_tr_b16 v[98:99], v169 offset:18432
    ds_read_b64_tr_b16 v[100:101], v170 offset:16384
    ds_read_b64_tr_b16 v[102:103], v170 offset:18432
    ds_read_b64_tr_b16 v[104:105], v171 offset:16384
    ds_read_b64_tr_b16 v[106:107], v171 offset:18432
    ds_read_b64_tr_b16 v[108:109], v172 offset:16384
    ds_read_b64_tr_b16 v[110:111], v172 offset:18432
    s_waitcnt lgkmcnt(0)
    v_mfma_f32_16x16x32_bf16 v[4:7], v[76:79], v[112:115], v[4:7]
    ds_read_b128 v[156:159], v174 offset:0
    v_mfma_f32_16x16x32_bf16 v[8:11], v[76:79], v[116:119], v[8:11]
    ds_read_b128 v[160:163], v174 offset:2048
    v_mfma_f32_16x16x32_bf16 v[12:15], v[80:83], v[112:115], v[12:15]
    ds_read_b64_tr_b16 v[120:121], v164 offset:32768
    ds_read_b64_tr_b16 v[122:123], v164 offset:34816
    v_mfma_f32_16x16x32_bf16 v[16:19], v[80:83], v[116:119], v[16:19]
    ds_read_b64_tr_b16 v[124:125], v165 offset:32768
    v_mfma_f32_16x16x32_bf16 v[20:23], v[84:87], v[112:115], v[20:23]
    ds_read_b64_tr_b16 v[126:127], v165 offset:34816
    ds_read_b64_tr_b16 v[128:129], v166 offset:32768
    v_mfma_f32_16x16x32_bf16 v[24:27], v[84:87], v[116:119], v[24:27]
    ds_read_b64_tr_b16 v[130:131], v166 offset:34816
    v_mfma_f32_16x16x32_bf16 v[28:31], v[88:91], v[112:115], v[28:31]
    ds_read_b64_tr_b16 v[132:133], v167 offset:32768
    ds_read_b64_tr_b16 v[134:135], v167 offset:34816
    v_mfma_f32_16x16x32_bf16 v[32:35], v[88:91], v[116:119], v[32:35]
    ds_read_b64_tr_b16 v[136:137], v168 offset:32768
    v_mfma_f32_16x16x32_bf16 v[36:39], v[92:95], v[112:115], v[36:39]
    ds_read_b64_tr_b16 v[138:139], v168 offset:34816
    ds_read_b64_tr_b16 v[140:141], v169 offset:32768
    v_mfma_f32_16x16x32_bf16 v[40:43], v[92:95], v[116:119], v[40:43]
    ds_read_b64_tr_b16 v[142:143], v169 offset:34816
    v_mfma_f32_16x16x32_bf16 v[44:47], v[96:99], v[112:115], v[44:47]
    ds_read_b64_tr_b16 v[144:145], v170 offset:32768
    v_mfma_f32_16x16x32_bf16 v[48:51], v[96:99], v[116:119], v[48:51]
    ds_read_b64_tr_b16 v[146:147], v170 offset:34816
    ds_read_b64_tr_b16 v[148:149], v171 offset:32768
    v_mfma_f32_16x16x32_bf16 v[52:55], v[100:103], v[112:115], v[52:55]
    ds_read_b64_tr_b16 v[150:151], v171 offset:34816
    v_mfma_f32_16x16x32_bf16 v[56:59], v[100:103], v[116:119], v[56:59]
    ds_read_b64_tr_b16 v[152:153], v172 offset:32768
    ds_read_b64_tr_b16 v[154:155], v172 offset:34816
    v_mfma_f32_16x16x32_bf16 v[60:63], v[104:107], v[112:115], v[60:63]
    s_add_u32 s58, s58, 128
    s_add_u32 s59, s59, 73728
    v_mfma_f32_16x16x32_bf16 v[64:67], v[104:107], v[116:119], v[64:67]
    s_add_u32 m0, s41, 49152
    s_add_u32 s51, s58, 0
    buffer_load_dwordx4 v0, s[16:19], s51 offen lds
    s_add_u32 m0, s41, 53248
    s_add_u32 s51, s58, 294912
    buffer_load_dwordx4 v0, s[16:19], s51 offen lds
    v_mfma_f32_16x16x32_bf16 v[68:71], v[108:111], v[112:115], v[68:71]
    s_add_u32 m0, s41, 57344
    s_add_u32 s51, s58, 589824
    buffer_load_dwordx4 v0, s[16:19], s51 offen lds
    v_mfma_f32_16x16x32_bf16 v[72:75], v[108:111], v[116:119], v[72:75]
    s_add_u32 m0, s41, 61440
    s_add_u32 s51, s58, 884736
    buffer_load_dwordx4 v0, s[16:19], s51 offen lds
    s_add_u32 m0, s41, 65536
    s_add_u32 s51, s59, 0
    buffer_load_dwordx4 v1, s[20:23], s51 offen lds
    s_waitcnt lgkmcnt(0)
    v_mfma_f32_16x16x32_bf16 v[4:7], v[120:123], v[156:159], v[4:7]
    v_mfma_f32_16x16x32_bf16 v[8:11], v[120:123], v[160:163], v[8:11]
    v_mfma_f32_16x16x32_bf16 v[12:15], v[124:127], v[156:159], v[12:15]
    s_add_u32 m0, s41, 69632
    s_add_u32 s51, s59, 9216
    buffer_load_dwordx4 v2, s[20:23], s51 offen lds
    v_mfma_f32_16x16x32_bf16 v[16:19], v[124:127], v[160:163], v[16:19]
    v_mfma_f32_16x16x32_bf16 v[20:23], v[128:131], v[156:159], v[20:23]
    v_mfma_f32_16x16x32_bf16 v[24:27], v[128:131], v[160:163], v[24:27]
    s_add_u32 m0, s41, 73728
    s_add_u32 s51, s59, 18432
    buffer_load_dwordx4 v1, s[20:23], s51 offen lds
    v_mfma_f32_16x16x32_bf16 v[28:31], v[132:135], v[156:159], v[28:31]
    v_mfma_f32_16x16x32_bf16 v[32:35], v[132:135], v[160:163], v[32:35]
    s_add_u32 m0, s41, 77824
    s_add_u32 s51, s59, 27648
    buffer_load_dwordx4 v2, s[20:23], s51 offen lds
    v_mfma_f32_16x16x32_bf16 v[36:39], v[136:139], v[156:159], v[36:39]
    v_mfma_f32_16x16x32_bf16 v[40:43], v[136:139], v[160:163], v[40:43]
    v_mfma_f32_16x16x32_bf16 v[44:47], v[140:143], v[156:159], v[44:47]
    s_add_u32 m0, s41, 81920
    s_add_u32 s51, s59, 36864
    buffer_load_dwordx4 v1, s[20:23], s51 offen lds
    v_mfma_f32_16x16x32_bf16 v[48:51], v[140:143], v[160:163], v[48:51]
    v_mfma_f32_16x16x32_bf16 v[52:55], v[144:147], v[156:159], v[52:55]
    s_add_u32 m0, s41, 86016
    s_add_u32 s51, s59, 46080
    buffer_load_dwordx4 v2, s[20:23], s51 offen lds
    v_mfma_f32_16x16x32_bf16 v[56:59], v[144:147], v[160:163], v[56:59]
    v_mfma_f32_16x16x32_bf16 v[60:63], v[148:151], v[156:159], v[60:63]
    v_mfma_f32_16x16x32_bf16 v[64:67], v[148:151], v[160:163], v[64:67]
    s_add_u32 m0, s41, 90112
    s_add_u32 s51, s59, 55296
    buffer_load_dwordx4 v1, s[20:23], s51 offen lds
    v_mfma_f32_16x16x32_bf16 v[68:71], v[152:155], v[156:159], v[68:71]
    v_mfma_f32_16x16x32_bf16 v[72:75], v[152:155], v[160:163], v[72:75]
    s_add_u32 m0, s41, 94208
    s_add_u32 s51, s59, 64512
    buffer_load_dwordx4 v2, s[20:23], s51 offen lds
    s_waitcnt vmcnt(12)
    s_barrier
    v_subrev_u32 v164, 98304, v164
    v_subrev_u32 v165, 98304, v165
    v_subrev_u32 v166, 98304, v166
    v_subrev_u32 v167, 98304, v167
    v_subrev_u32 v168, 98304, v168
    v_subrev_u32 v169, 98304, v169
    v_subrev_u32 v170, 98304, v170
    v_subrev_u32 v171, 98304, v171
    v_subrev_u32 v172, 98304, v172
    v_subrev_u32 v173, 98304, v173
    v_subrev_u32 v174, 98304, v174
    ds_read_b128 v[112:115], v173 offset:0
    ds_read_b128 v[116:119], v173 offset:2048
    ds_read_b64_tr_b16 v[76:77], v164 offset:16384
    ds_read_b64_tr_b16 v[78:79], v164 offset:18432
    ds_read_b64_tr_b16 v[80:81], v165 offset:16384
    ds_read_b64_tr_b16 v[82:83], v165 offset:18432
    ds_read_b64_tr_b16 v[84:85], v166 offset:16384
    ds_read_b64_tr_b16 v[86:87], v166 offset:18432
    ds_read_b64_tr_b16 v[88:89], v167 offset:16384
    ds_read_b64_tr_b16 v[90:91], v167 offset:18432
    ds_read_b64_tr_b16 v[92:93], v168 offset:16384
    ds_read_b64_tr_b16 v[94:95], v168 offset:18432
    ds_read_b64_tr_b16 v[96:97], v169 offset:16384
    ds_read_b64_tr_b16 v[98:99], v169 offset:18432
    ds_read_b64_tr_b16 v[100:101], v170 offset:16384
    ds_read_b64_tr_b16 v[102:103], v170 offset:18432
    ds_read_b64_tr_b16 v[104:105], v171 offset:16384
    ds_read_b64_tr_b16 v[106:107], v171 offset:18432
    ds_read_b64_tr_b16 v[108:109], v172 offset:16384
    ds_read_b64_tr_b16 v[110:111], v172 offset:18432
    s_waitcnt lgkmcnt(0)
    v_mfma_f32_16x16x32_bf16 v[4:7], v[76:79], v[112:115], v[4:7]
    ds_read_b128 v[156:159], v174 offset:0
    v_mfma_f32_16x16x32_bf16 v[8:11], v[76:79], v[116:119], v[8:11]
    ds_read_b128 v[160:163], v174 offset:2048
    v_mfma_f32_16x16x32_bf16 v[12:15], v[80:83], v[112:115], v[12:15]
    ds_read_b64_tr_b16 v[120:121], v164 offset:32768
    ds_read_b64_tr_b16 v[122:123], v164 offset:34816
    v_mfma_f32_16x16x32_bf16 v[16:19], v[80:83], v[116:119], v[16:19]
    ds_read_b64_tr_b16 v[124:125], v165 offset:32768
    v_mfma_f32_16x16x32_bf16 v[20:23], v[84:87], v[112:115], v[20:23]
    ds_read_b64_tr_b16 v[126:127], v165 offset:34816
    ds_read_b64_tr_b16 v[128:129], v166 offset:32768
    v_mfma_f32_16x16x32_bf16 v[24:27], v[84:87], v[116:119], v[24:27]
    ds_read_b64_tr_b16 v[130:131], v166 offset:34816
    v_mfma_f32_16x16x32_bf16 v[28:31], v[88:91], v[112:115], v[28:31]
    ds_read_b64_tr_b16 v[132:133], v167 offset:32768
    ds_read_b64_tr_b16 v[134:135], v167 offset:34816
    v_mfma_f32_16x16x32_bf16 v[32:35], v[88:91], v[116:119], v[32:35]
    ds_read_b64_tr_b16 v[136:137], v168 offset:32768
    v_mfma_f32_16x16x32_bf16 v[36:39], v[92:95], v[112:115], v[36:39]
    ds_read_b64_tr_b16 v[138:139], v168 offset:34816
    ds_read_b64_tr_b16 v[140:141], v169 offset:32768
    v_mfma_f32_16x16x32_bf16 v[40:43], v[92:95], v[116:119], v[40:43]
    ds_read_b64_tr_b16 v[142:143], v169 offset:34816
    v_mfma_f32_16x16x32_bf16 v[44:47], v[96:99], v[112:115], v[44:47]
    ds_read_b64_tr_b16 v[144:145], v170 offset:32768
    v_mfma_f32_16x16x32_bf16 v[48:51], v[96:99], v[116:119], v[48:51]
    ds_read_b64_tr_b16 v[146:147], v170 offset:34816
    ds_read_b64_tr_b16 v[148:149], v171 offset:32768
    v_mfma_f32_16x16x32_bf16 v[52:55], v[100:103], v[112:115], v[52:55]
    ds_read_b64_tr_b16 v[150:151], v171 offset:34816
    v_mfma_f32_16x16x32_bf16 v[56:59], v[100:103], v[116:119], v[56:59]
    ds_read_b64_tr_b16 v[152:153], v172 offset:32768
    ds_read_b64_tr_b16 v[154:155], v172 offset:34816
    v_mfma_f32_16x16x32_bf16 v[60:63], v[104:107], v[112:115], v[60:63]
    s_add_u32 s58, s58, 128
    s_add_u32 s59, s59, 73728
    v_mfma_f32_16x16x32_bf16 v[64:67], v[104:107], v[116:119], v[64:67]
    s_add_u32 m0, s41, 98304
    s_add_u32 s51, s58, 0
    buffer_load_dwordx4 v0, s[16:19], s51 offen lds
    s_add_u32 m0, s41, 102400
    s_add_u32 s51, s58, 294912
    buffer_load_dwordx4 v0, s[16:19], s51 offen lds
    v_mfma_f32_16x16x32_bf16 v[68:71], v[108:111], v[112:115], v[68:71]
    s_add_u32 m0, s41, 106496
    s_add_u32 s51, s58, 589824
    buffer_load_dwordx4 v0, s[16:19], s51 offen lds
    v_mfma_f32_16x16x32_bf16 v[72:75], v[108:111], v[116:119], v[72:75]
    s_add_u32 m0, s41, 110592
    s_add_u32 s51, s58, 884736
    buffer_load_dwordx4 v0, s[16:19], s51 offen lds
    s_add_u32 m0, s41, 114688
    s_add_u32 s51, s59, 0
    buffer_load_dwordx4 v1, s[20:23], s51 offen lds
    s_waitcnt lgkmcnt(0)
    v_mfma_f32_16x16x32_bf16 v[4:7], v[120:123], v[156:159], v[4:7]
    v_mfma_f32_16x16x32_bf16 v[8:11], v[120:123], v[160:163], v[8:11]
    v_mfma_f32_16x16x32_bf16 v[12:15], v[124:127], v[156:159], v[12:15]
    s_add_u32 m0, s41, 118784
    s_add_u32 s51, s59, 9216
    buffer_load_dwordx4 v2, s[20:23], s51 offen lds
    v_mfma_f32_16x16x32_bf16 v[16:19], v[124:127], v[160:163], v[16:19]
    v_mfma_f32_16x16x32_bf16 v[20:23], v[128:131], v[156:159], v[20:23]
    v_mfma_f32_16x16x32_bf16 v[24:27], v[128:131], v[160:163], v[24:27]
    s_add_u32 m0, s41, 122880
    s_add_u32 s51, s59, 18432
    buffer_load_dwordx4 v1, s[20:23], s51 offen lds
    v_mfma_f32_16x16x32_bf16 v[28:31], v[132:135], v[156:159], v[28:31]
    v_mfma_f32_16x16x32_bf16 v[32:35], v[132:135], v[160:163], v[32:35]
    s_add_u32 m0, s41, 126976
    s_add_u32 s51, s59, 27648
    buffer_load_dwordx4 v2, s[20:23], s51 offen lds
    v_mfma_f32_16x16x32_bf16 v[36:39], v[136:139], v[156:159], v[36:39]
    v_mfma_f32_16x16x32_bf16 v[40:43], v[136:139], v[160:163], v[40:43]
    v_mfma_f32_16x16x32_bf16 v[44:47], v[140:143], v[156:159], v[44:47]
    s_add_u32 m0, s41, 131072
    s_add_u32 s51, s59, 36864
    buffer_load_dwordx4 v1, s[20:23], s51 offen lds
    v_mfma_f32_16x16x32_bf16 v[48:51], v[140:143], v[160:163], v[48:51]
    v_mfma_f32_16x16x32_bf16 v[52:55], v[144:147], v[156:159], v[52:55]
    s_add_u32 m0, s41, 135168
    s_add_u32 s51, s59, 46080
    buffer_load_dwordx4 v2, s[20:23], s51 offen lds
    v_mfma_f32_16x16x32_bf16 v[56:59], v[144:147], v[160:163], v[56:59]
    v_mfma_f32_16x16x32_bf16 v[60:63], v[148:151], v[156:159], v[60:63]
    v_mfma_f32_16x16x32_bf16 v[64:67], v[148:151], v[160:163], v[64:67]
    s_add_u32 m0, s41, 139264
    s_add_u32 s51, s59, 55296
    buffer_load_dwordx4 v1, s[20:23], s51 offen lds
    v_mfma_f32_16x16x32_bf16 v[68:71], v[152:155], v[156:159], v[68:71]
    v_mfma_f32_16x16x32_bf16 v[72:75], v[152:155], v[160:163], v[72:75]
    s_add_u32 m0, s41, 143360
    s_add_u32 s51, s59, 64512
    buffer_load_dwordx4 v2, s[20:23], s51 offen lds
    s_waitcnt vmcnt(12)
    s_barrier
    v_add_u32 v164, 49152, v164
    v_add_u32 v165, 49152, v165
    v_add_u32 v166, 49152, v166
    v_add_u32 v167, 49152, v167
    v_add_u32 v168, 49152, v168
    v_add_u32 v169, 49152, v169
    v_add_u32 v170, 49152, v170
    v_add_u32 v171, 49152, v171
    v_add_u32 v172, 49152, v172
    v_add_u32 v173, 49152, v173
    v_add_u32 v174, 49152, v174
    ds_read_b128 v[112:115], v173 offset:0
    ds_read_b128 v[116:119], v173 offset:2048
    ds_read_b64_tr_b16 v[76:77], v164 offset:16384
    ds_read_b64_tr_b16 v[78:79], v164 offset:18432
    ds_read_b64_tr_b16 v[80:81], v165 offset:16384
    ds_read_b64_tr_b16 v[82:83], v165 offset:18432
    ds_read_b64_tr_b16 v[84:85], v166 offset:16384
    ds_read_b64_tr_b16 v[86:87], v166 offset:18432
    ds_read_b64_tr_b16 v[88:89], v167 offset:16384
    ds_read_b64_tr_b16 v[90:91], v167 offset:18432
    ds_read_b64_tr_b16 v[92:93], v168 offset:16384
    ds_read_b64_tr_b16 v[94:95], v168 offset:18432
    ds_read_b64_tr_b16 v[96:97], v169 offset:16384
    ds_read_b64_tr_b16 v[98:99], v169 offset:18432
    ds_read_b64_tr_b16 v[100:101], v170 offset:16384
    ds_read_b64_tr_b16 v[102:103], v170 offset:18432
    ds_read_b64_tr_b16 v[104:105], v171 offset:16384
    ds_read_b64_tr_b16 v[106:107], v171 offset:18432
    ds_read_b64_tr_b16 v[108:109], v172 offset:16384
    ds_read_b64_tr_b16 v[110:111], v172 offset:18432
    s_waitcnt lgkmcnt(0)
    v_mfma_f32_16x16x32_bf16 v[4:7], v[76:79], v[112:115], v[4:7]
    ds_read_b128 v[156:159], v174 offset:0
    v_mfma_f32_16x16x32_bf16 v[8:11], v[76:79], v[116:119], v[8:11]
    ds_read_b128 v[160:163], v174 offset:2048
    v_mfma_f32_16x16x32_bf16 v[12:15], v[80:83], v[112:115], v[12:15]
    ds_read_b64_tr_b16 v[120:121], v164 offset:32768
    ds_read_b64_tr_b16 v[122:123], v164 offset:34816
    v_mfma_f32_16x16x32_bf16 v[16:19], v[80:83], v[116:119], v[16:19]
    ds_read_b64_tr_b16 v[124:125], v165 offset:32768
    v_mfma_f32_16x16x32_bf16 v[20:23], v[84:87], v[112:115], v[20:23]
    ds_read_b64_tr_b16 v[126:127], v165 offset:34816
    ds_read_b64_tr_b16 v[128:129], v166 offset:32768
    v_mfma_f32_16x16x32_bf16 v[24:27], v[84:87], v[116:119], v[24:27]
    ds_read_b64_tr_b16 v[130:131], v166 offset:34816
    v_mfma_f32_16x16x32_bf16 v[28:31], v[88:91], v[112:115], v[28:31]
    ds_read_b64_tr_b16 v[132:133], v167 offset:32768
    ds_read_b64_tr_b16 v[134:135], v167 offset:34816
    v_mfma_f32_16x16x32_bf16 v[32:35], v[88:91], v[116:119], v[32:35]
    ds_read_b64_tr_b16 v[136:137], v168 offset:32768
    v_mfma_f32_16x16x32_bf16 v[36:39], v[92:95], v[112:115], v[36:39]
    ds_read_b64_tr_b16 v[138:139], v168 offset:34816
    ds_read_b64_tr_b16 v[140:141], v169 offset:32768
    v_mfma_f32_16x16x32_bf16 v[40:43], v[92:95], v[116:119], v[40:43]
    ds_read_b64_tr_b16 v[142:143], v169 offset:34816
    v_mfma_f32_16x16x32_bf16 v[44:47], v[96:99], v[112:115], v[44:47]
    ds_read_b64_tr_b16 v[144:145], v170 offset:32768
    v_mfma_f32_16x16x32_bf16 v[48:51], v[96:99], v[116:119], v[48:51]
    ds_read_b64_tr_b16 v[146:147], v170 offset:34816
    ds_read_b64_tr_b16 v[148:149], v171 offset:32768
    v_mfma_f32_16x16x32_bf16 v[52:55], v[100:103], v[112:115], v[52:55]
    ds_read_b64_tr_b16 v[150:151], v171 offset:34816
    v_mfma_f32_16x16x32_bf16 v[56:59], v[100:103], v[116:119], v[56:59]
    ds_read_b64_tr_b16 v[152:153], v172 offset:32768
    ds_read_b64_tr_b16 v[154:155], v172 offset:34816
    v_mfma_f32_16x16x32_bf16 v[60:63], v[104:107], v[112:115], v[60:63]
    s_add_u32 s58, s58, 128
    s_add_u32 s59, s59, 73728
    v_mfma_f32_16x16x32_bf16 v[64:67], v[104:107], v[116:119], v[64:67]
    s_add_u32 m0, s41, 0
    s_add_u32 s51, s58, 0
    buffer_load_dwordx4 v0, s[16:19], s51 offen lds
    s_add_u32 m0, s41, 4096
    s_add_u32 s51, s58, 294912
    buffer_load_dwordx4 v0, s[16:19], s51 offen lds
    v_mfma_f32_16x16x32_bf16 v[68:71], v[108:111], v[112:115], v[68:71]
    s_add_u32 m0, s41, 8192
    s_add_u32 s51, s58, 589824
    buffer_load_dwordx4 v0, s[16:19], s51 offen lds
    v_mfma_f32_16x16x32_bf16 v[72:75], v[108:111], v[116:119], v[72:75]
    s_add_u32 m0, s41, 12288
    s_add_u32 s51, s58, 884736
    buffer_load_dwordx4 v0, s[16:19], s51 offen lds
    s_add_u32 m0, s41, 16384
    s_add_u32 s51, s59, 0
    buffer_load_dwordx4 v1, s[20:23], s51 offen lds
    s_waitcnt lgkmcnt(0)
    v_mfma_f32_16x16x32_bf16 v[4:7], v[120:123], v[156:159], v[4:7]
    v_mfma_f32_16x16x32_bf16 v[8:11], v[120:123], v[160:163], v[8:11]
    v_mfma_f32_16x16x32_bf16 v[12:15], v[124:127], v[156:159], v[12:15]
    s_add_u32 m0, s41, 20480
    s_add_u32 s51, s59, 9216
    buffer_load_dwordx4 v2, s[20:23], s51 offen lds
    v_mfma_f32_16x16x32_bf16 v[16:19], v[124:127], v[160:163], v[16:19]
    v_mfma_f32_16x16x32_bf16 v[20:23], v[128:131], v[156:159], v[20:23]
    v_mfma_f32_16x16x32_bf16 v[24:27], v[128:131], v[160:163], v[24:27]
    s_add_u32 m0, s41, 24576
    s_add_u32 s51, s59, 18432
    buffer_load_dwordx4 v1, s[20:23], s51 offen lds
    v_mfma_f32_16x16x32_bf16 v[28:31], v[132:135], v[156:159], v[28:31]
    v_mfma_f32_16x16x32_bf16 v[32:35], v[132:135], v[160:163], v[32:35]
    s_add_u32 m0, s41, 28672
    s_add_u32 s51, s59, 27648
    buffer_load_dwordx4 v2, s[20:23], s51 offen lds
    v_mfma_f32_16x16x32_bf16 v[36:39], v[136:139], v[156:159], v[36:39]
    v_mfma_f32_16x16x32_bf16 v[40:43], v[136:139], v[160:163], v[40:43]
    v_mfma_f32_16x16x32_bf16 v[44:47], v[140:143], v[156:159], v[44:47]
    s_add_u32 m0, s41, 32768
    s_add_u32 s51, s59, 36864
    buffer_load_dwordx4 v1, s[20:23], s51 offen lds
    v_mfma_f32_16x16x32_bf16 v[48:51], v[140:143], v[160:163], v[48:51]
    v_mfma_f32_16x16x32_bf16 v[52:55], v[144:147], v[156:159], v[52:55]
    s_add_u32 m0, s41, 36864
    s_add_u32 s51, s59, 46080
    buffer_load_dwordx4 v2, s[20:23], s51 offen lds
    v_mfma_f32_16x16x32_bf16 v[56:59], v[144:147], v[160:163], v[56:59]
    v_mfma_f32_16x16x32_bf16 v[60:63], v[148:151], v[156:159], v[60:63]
    v_mfma_f32_16x16x32_bf16 v[64:67], v[148:151], v[160:163], v[64:67]
    s_add_u32 m0, s41, 40960
    s_add_u32 s51, s59, 55296
    buffer_load_dwordx4 v1, s[20:23], s51 offen lds
    v_mfma_f32_16x16x32_bf16 v[68:71], v[152:155], v[156:159], v[68:71]
    v_mfma_f32_16x16x32_bf16 v[72:75], v[152:155], v[160:163], v[72:75]
    s_add_u32 m0, s41, 45056
    s_add_u32 s51, s59, 64512
    buffer_load_dwordx4 v2, s[20:23], s51 offen lds
    s_waitcnt vmcnt(12)
    s_barrier
    v_add_u32 v164, 49152, v164
    v_add_u32 v165, 49152, v165
    v_add_u32 v166, 49152, v166
    v_add_u32 v167, 49152, v167
    v_add_u32 v168, 49152, v168
    v_add_u32 v169, 49152, v169
    v_add_u32 v170, 49152, v170
    v_add_u32 v171, 49152, v171
    v_add_u32 v172, 49152, v172
    v_add_u32 v173, 49152, v173
    v_add_u32 v174, 49152, v174
    ds_read_b128 v[112:115], v173 offset:0
    ds_read_b128 v[116:119], v173 offset:2048
    ds_read_b64_tr_b16 v[76:77], v164 offset:16384
    ds_read_b64_tr_b16 v[78:79], v164 offset:18432
    ds_read_b64_tr_b16 v[80:81], v165 offset:16384
    ds_read_b64_tr_b16 v[82:83], v165 offset:18432
    ds_read_b64_tr_b16 v[84:85], v166 offset:16384
    ds_read_b64_tr_b16 v[86:87], v166 offset:18432
    ds_read_b64_tr_b16 v[88:89], v167 offset:16384
    ds_read_b64_tr_b16 v[90:91], v167 offset:18432
    ds_read_b64_tr_b16 v[92:93], v168 offset:16384
    ds_read_b64_tr_b16 v[94:95], v168 offset:18432
    ds_read_b64_tr_b16 v[96:97], v169 offset:16384
    ds_read_b64_tr_b16 v[98:99], v169 offset:18432
    ds_read_b64_tr_b16 v[100:101], v170 offset:16384
    ds_read_b64_tr_b16 v[102:103], v170 offset:18432
    ds_read_b64_tr_b16 v[104:105], v171 offset:16384
    ds_read_b64_tr_b16 v[106:107], v171 offset:18432
    ds_read_b64_tr_b16 v[108:109], v172 offset:16384
    ds_read_b64_tr_b16 v[110:111], v172 offset:18432
    s_waitcnt lgkmcnt(0)
    v_mfma_f32_16x16x32_bf16 v[4:7], v[76:79], v[112:115], v[4:7]
    ds_read_b128 v[156:159], v174 offset:0
    v_mfma_f32_16x16x32_bf16 v[8:11], v[76:79], v[116:119], v[8:11]
    ds_read_b128 v[160:163], v174 offset:2048
    v_mfma_f32_16x16x32_bf16 v[12:15], v[80:83], v[112:115], v[12:15]
    ds_read_b64_tr_b16 v[120:121], v164 offset:32768
    ds_read_b64_tr_b16 v[122:123], v164 offset:34816
    v_mfma_f32_16x16x32_bf16 v[16:19], v[80:83], v[116:119], v[16:19]
    ds_read_b64_tr_b16 v[124:125], v165 offset:32768
    v_mfma_f32_16x16x32_bf16 v[20:23], v[84:87], v[112:115], v[20:23]
    ds_read_b64_tr_b16 v[126:127], v165 offset:34816
    ds_read_b64_tr_b16 v[128:129], v166 offset:32768
    v_mfma_f32_16x16x32_bf16 v[24:27], v[84:87], v[116:119], v[24:27]
    ds_read_b64_tr_b16 v[130:131], v166 offset:34816
    v_mfma_f32_16x16x32_bf16 v[28:31], v[88:91], v[112:115], v[28:31]
    ds_read_b64_tr_b16 v[132:133], v167 offset:32768
    ds_read_b64_tr_b16 v[134:135], v167 offset:34816
    v_mfma_f32_16x16x32_bf16 v[32:35], v[88:91], v[116:119], v[32:35]
    ds_read_b64_tr_b16 v[136:137], v168 offset:32768
    v_mfma_f32_16x16x32_bf16 v[36:39], v[92:95], v[112:115], v[36:39]
    ds_read_b64_tr_b16 v[138:139], v168 offset:34816
    ds_read_b64_tr_b16 v[140:141], v169 offset:32768
    v_mfma_f32_16x16x32_bf16 v[40:43], v[92:95], v[116:119], v[40:43]
    ds_read_b64_tr_b16 v[142:143], v169 offset:34816
    v_mfma_f32_16x16x32_bf16 v[44:47], v[96:99], v[112:115], v[44:47]
    ds_read_b64_tr_b16 v[144:145], v170 offset:32768
    v_mfma_f32_16x16x32_bf16 v[48:51], v[96:99], v[116:119], v[48:51]
    ds_read_b64_tr_b16 v[146:147], v170 offset:34816
    ds_read_b64_tr_b16 v[148:149], v171 offset:32768
    v_mfma_f32_16x16x32_bf16 v[52:55], v[100:103], v[112:115], v[52:55]
    ds_read_b64_tr_b16 v[150:151], v171 offset:34816
    v_mfma_f32_16x16x32_bf16 v[56:59], v[100:103], v[116:119], v[56:59]
    ds_read_b64_tr_b16 v[152:153], v172 offset:32768
    ds_read_b64_tr_b16 v[154:155], v172 offset:34816
    v_mfma_f32_16x16x32_bf16 v[60:63], v[104:107], v[112:115], v[60:63]
    s_add_u32 s58, s58, 128
    s_add_u32 s59, s59, 73728
    v_mfma_f32_16x16x32_bf16 v[64:67], v[104:107], v[116:119], v[64:67]
    s_add_u32 m0, s41, 49152
    s_add_u32 s51, s58, 0
    buffer_load_dwordx4 v0, s[16:19], s51 offen lds
    s_add_u32 m0, s41, 53248
    s_add_u32 s51, s58, 294912
    buffer_load_dwordx4 v0, s[16:19], s51 offen lds
    v_mfma_f32_16x16x32_bf16 v[68:71], v[108:111], v[112:115], v[68:71]
    s_add_u32 m0, s41, 57344
    s_add_u32 s51, s58, 589824
    buffer_load_dwordx4 v0, s[16:19], s51 offen lds
    v_mfma_f32_16x16x32_bf16 v[72:75], v[108:111], v[116:119], v[72:75]
    s_add_u32 m0, s41, 61440
    s_add_u32 s51, s58, 884736
    buffer_load_dwordx4 v0, s[16:19], s51 offen lds
    s_add_u32 m0, s41, 65536
    s_add_u32 s51, s59, 0
    buffer_load_dwordx4 v1, s[20:23], s51 offen lds
    s_waitcnt lgkmcnt(0)
    v_mfma_f32_16x16x32_bf16 v[4:7], v[120:123], v[156:159], v[4:7]
    v_mfma_f32_16x16x32_bf16 v[8:11], v[120:123], v[160:163], v[8:11]
    v_mfma_f32_16x16x32_bf16 v[12:15], v[124:127], v[156:159], v[12:15]
    s_add_u32 m0, s41, 69632
    s_add_u32 s51, s59, 9216
    buffer_load_dwordx4 v2, s[20:23], s51 offen lds
    v_mfma_f32_16x16x32_bf16 v[16:19], v[124:127], v[160:163], v[16:19]
    v_mfma_f32_16x16x32_bf16 v[20:23], v[128:131], v[156:159], v[20:23]
    v_mfma_f32_16x16x32_bf16 v[24:27], v[128:131], v[160:163], v[24:27]
    s_add_u32 m0, s41, 73728
    s_add_u32 s51, s59, 18432
    buffer_load_dwordx4 v1, s[20:23], s51 offen lds
    v_mfma_f32_16x16x32_bf16 v[28:31], v[132:135], v[156:159], v[28:31]
    v_mfma_f32_16x16x32_bf16 v[32:35], v[132:135], v[160:163], v[32:35]
    s_add_u32 m0, s41, 77824
    s_add_u32 s51, s59, 27648
    buffer_load_dwordx4 v2, s[20:23], s51 offen lds
    v_mfma_f32_16x16x32_bf16 v[36:39], v[136:139], v[156:159], v[36:39]
    v_mfma_f32_16x16x32_bf16 v[40:43], v[136:139], v[160:163], v[40:43]
    v_mfma_f32_16x16x32_bf16 v[44:47], v[140:143], v[156:159], v[44:47]
    s_add_u32 m0, s41, 81920
    s_add_u32 s51, s59, 36864
    buffer_load_dwordx4 v1, s[20:23], s51 offen lds
    v_mfma_f32_16x16x32_bf16 v[48:51], v[140:143], v[160:163], v[48:51]
    v_mfma_f32_16x16x32_bf16 v[52:55], v[144:147], v[156:159], v[52:55]
    s_add_u32 m0, s41, 86016
    s_add_u32 s51, s59, 46080
    buffer_load_dwordx4 v2, s[20:23], s51 offen lds
    v_mfma_f32_16x16x32_bf16 v[56:59], v[144:147], v[160:163], v[56:59]
    v_mfma_f32_16x16x32_bf16 v[60:63], v[148:151], v[156:159], v[60:63]
    v_mfma_f32_16x16x32_bf16 v[64:67], v[148:151], v[160:163], v[64:67]
    s_add_u32 m0, s41, 90112
    s_add_u32 s51, s59, 55296
    buffer_load_dwordx4 v1, s[20:23], s51 offen lds
    v_mfma_f32_16x16x32_bf16 v[68:71], v[152:155], v[156:159], v[68:71]
    v_mfma_f32_16x16x32_bf16 v[72:75], v[152:155], v[160:163], v[72:75]
    s_add_u32 m0, s41, 94208
    s_add_u32 s51, s59, 64512
    buffer_load_dwordx4 v2, s[20:23], s51 offen lds
    s_waitcnt vmcnt(12)
    s_barrier
    v_subrev_u32 v164, 98304, v164
    v_subrev_u32 v165, 98304, v165
    v_subrev_u32 v166, 98304, v166
    v_subrev_u32 v167, 98304, v167
    v_subrev_u32 v168, 98304, v168
    v_subrev_u32 v169, 98304, v169
    v_subrev_u32 v170, 98304, v170
    v_subrev_u32 v171, 98304, v171
    v_subrev_u32 v172, 98304, v172
    v_subrev_u32 v173, 98304, v173
    v_subrev_u32 v174, 98304, v174
    ds_read_b128 v[112:115], v173 offset:0
    ds_read_b128 v[116:119], v173 offset:2048
    ds_read_b64_tr_b16 v[76:77], v164 offset:16384
    ds_read_b64_tr_b16 v[78:79], v164 offset:18432
    ds_read_b64_tr_b16 v[80:81], v165 offset:16384
    ds_read_b64_tr_b16 v[82:83], v165 offset:18432
    ds_read_b64_tr_b16 v[84:85], v166 offset:16384
    ds_read_b64_tr_b16 v[86:87], v166 offset:18432
    ds_read_b64_tr_b16 v[88:89], v167 offset:16384
    ds_read_b64_tr_b16 v[90:91], v167 offset:18432
    ds_read_b64_tr_b16 v[92:93], v168 offset:16384
    ds_read_b64_tr_b16 v[94:95], v168 offset:18432
    ds_read_b64_tr_b16 v[96:97], v169 offset:16384
    ds_read_b64_tr_b16 v[98:99], v169 offset:18432
    ds_read_b64_tr_b16 v[100:101], v170 offset:16384
    ds_read_b64_tr_b16 v[102:103], v170 offset:18432
    ds_read_b64_tr_b16 v[104:105], v171 offset:16384
    ds_read_b64_tr_b16 v[106:107], v171 offset:18432
    ds_read_b64_tr_b16 v[108:109], v172 offset:16384
    ds_read_b64_tr_b16 v[110:111], v172 offset:18432
    s_waitcnt lgkmcnt(0)
    v_mfma_f32_16x16x32_bf16 v[4:7], v[76:79], v[112:115], v[4:7]
    ds_read_b128 v[156:159], v174 offset:0
    v_mfma_f32_16x16x32_bf16 v[8:11], v[76:79], v[116:119], v[8:11]
    ds_read_b128 v[160:163], v174 offset:2048
    v_mfma_f32_16x16x32_bf16 v[12:15], v[80:83], v[112:115], v[12:15]
    ds_read_b64_tr_b16 v[120:121], v164 offset:32768
    ds_read_b64_tr_b16 v[122:123], v164 offset:34816
    v_mfma_f32_16x16x32_bf16 v[16:19], v[80:83], v[116:119], v[16:19]
    ds_read_b64_tr_b16 v[124:125], v165 offset:32768
    v_mfma_f32_16x16x32_bf16 v[20:23], v[84:87], v[112:115], v[20:23]
    ds_read_b64_tr_b16 v[126:127], v165 offset:34816
    ds_read_b64_tr_b16 v[128:129], v166 offset:32768
    v_mfma_f32_16x16x32_bf16 v[24:27], v[84:87], v[116:119], v[24:27]
    ds_read_b64_tr_b16 v[130:131], v166 offset:34816
    v_mfma_f32_16x16x32_bf16 v[28:31], v[88:91], v[112:115], v[28:31]
    ds_read_b64_tr_b16 v[132:133], v167 offset:32768
    ds_read_b64_tr_b16 v[134:135], v167 offset:34816
    v_mfma_f32_16x16x32_bf16 v[32:35], v[88:91], v[116:119], v[32:35]
    ds_read_b64_tr_b16 v[136:137], v168 offset:32768
    v_mfma_f32_16x16x32_bf16 v[36:39], v[92:95], v[112:115], v[36:39]
    ds_read_b64_tr_b16 v[138:139], v168 offset:34816
    ds_read_b64_tr_b16 v[140:141], v169 offset:32768
    v_mfma_f32_16x16x32_bf16 v[40:43], v[92:95], v[116:119], v[40:43]
    ds_read_b64_tr_b16 v[142:143], v169 offset:34816
    v_mfma_f32_16x16x32_bf16 v[44:47], v[96:99], v[112:115], v[44:47]
    ds_read_b64_tr_b16 v[144:145], v170 offset:32768
    v_mfma_f32_16x16x32_bf16 v[48:51], v[96:99], v[116:119], v[48:51]
    ds_read_b64_tr_b16 v[146:147], v170 offset:34816
    ds_read_b64_tr_b16 v[148:149], v171 offset:32768
    v_mfma_f32_16x16x32_bf16 v[52:55], v[100:103], v[112:115], v[52:55]
    ds_read_b64_tr_b16 v[150:151], v171 offset:34816
    v_mfma_f32_16x16x32_bf16 v[56:59], v[100:103], v[116:119], v[56:59]
    ds_read_b64_tr_b16 v[152:153], v172 offset:32768
    ds_read_b64_tr_b16 v[154:155], v172 offset:34816
    v_mfma_f32_16x16x32_bf16 v[60:63], v[104:107], v[112:115], v[60:63]
    s_add_u32 s58, s58, 128
    s_add_u32 s59, s59, 73728
    v_mfma_f32_16x16x32_bf16 v[64:67], v[104:107], v[116:119], v[64:67]
    s_add_u32 m0, s41, 98304
    s_add_u32 s51, s58, 0
    buffer_load_dwordx4 v0, s[16:19], s51 offen lds
    s_add_u32 m0, s41, 102400
    s_add_u32 s51, s58, 294912
    buffer_load_dwordx4 v0, s[16:19], s51 offen lds
    v_mfma_f32_16x16x32_bf16 v[68:71], v[108:111], v[112:115], v[68:71]
    s_add_u32 m0, s41, 106496
    s_add_u32 s51, s58, 589824
    buffer_load_dwordx4 v0, s[16:19], s51 offen lds
    v_mfma_f32_16x16x32_bf16 v[72:75], v[108:111], v[116:119], v[72:75]
    s_add_u32 m0, s41, 110592
    s_add_u32 s51, s58, 884736
    buffer_load_dwordx4 v0, s[16:19], s51 offen lds
    s_add_u32 m0, s41, 114688
    s_add_u32 s51, s59, 0
    buffer_load_dwordx4 v1, s[20:23], s51 offen lds
    s_waitcnt lgkmcnt(0)
    v_mfma_f32_16x16x32_bf16 v[4:7], v[120:123], v[156:159], v[4:7]
    v_mfma_f32_16x16x32_bf16 v[8:11], v[120:123], v[160:163], v[8:11]
    v_mfma_f32_16x16x32_bf16 v[12:15], v[124:127], v[156:159], v[12:15]
    s_add_u32 m0, s41, 118784
    s_add_u32 s51, s59, 9216
    buffer_load_dwordx4 v2, s[20:23], s51 offen lds
    v_mfma_f32_16x16x32_bf16 v[16:19], v[124:127], v[160:163], v[16:19]
    v_mfma_f32_16x16x32_bf16 v[20:23], v[128:131], v[156:159], v[20:23]
    v_mfma_f32_16x16x32_bf16 v[24:27], v[128:131], v[160:163], v[24:27]
    s_add_u32 m0, s41, 122880
    s_add_u32 s51, s59, 18432
    buffer_load_dwordx4 v1, s[20:23], s51 offen lds
    v_mfma_f32_16x16x32_bf16 v[28:31], v[132:135], v[156:159], v[28:31]
    v_mfma_f32_16x16x32_bf16 v[32:35], v[132:135], v[160:163], v[32:35]
    s_add_u32 m0, s41, 126976
    s_add_u32 s51, s59, 27648
    buffer_load_dwordx4 v2, s[20:23], s51 offen lds
    v_mfma_f32_16x16x32_bf16 v[36:39], v[136:139], v[156:159], v[36:39]
    v_mfma_f32_16x16x32_bf16 v[40:43], v[136:139], v[160:163], v[40:43]
    v_mfma_f32_16x16x32_bf16 v[44:47], v[140:143], v[156:159], v[44:47]
    s_add_u32 m0, s41, 131072
    s_add_u32 s51, s59, 36864
    buffer_load_dwordx4 v1, s[20:23], s51 offen lds
    v_mfma_f32_16x16x32_bf16 v[48:51], v[140:143], v[160:163], v[48:51]
    v_mfma_f32_16x16x32_bf16 v[52:55], v[144:147], v[156:159], v[52:55]
    s_add_u32 m0, s41, 135168
    s_add_u32 s51, s59, 46080
    buffer_load_dwordx4 v2, s[20:23], s51 offen lds
    v_mfma_f32_16x16x32_bf16 v[56:59], v[144:147], v[160:163], v[56:59]
    v_mfma_f32_16x16x32_bf16 v[60:63], v[148:151], v[156:159], v[60:63]
    v_mfma_f32_16x16x32_bf16 v[64:67], v[148:151], v[160:163], v[64:67]
    s_add_u32 m0, s41, 139264
    s_add_u32 s51, s59, 55296
    buffer_load_dwordx4 v1, s[20:23], s51 offen lds
    v_mfma_f32_16x16x32_bf16 v[68:71], v[152:155], v[156:159], v[68:71]
    v_mfma_f32_16x16x32_bf16 v[72:75], v[152:155], v[160:163], v[72:75]
    s_add_u32 m0, s41, 143360
    s_add_u32 s51, s59, 64512
    buffer_load_dwordx4 v2, s[20:23], s51 offen lds
    s_waitcnt vmcnt(12)
    s_barrier
    v_add_u32 v164, 49152, v164
    v_add_u32 v165, 49152, v165
    v_add_u32 v166, 49152, v166
    v_add_u32 v167, 49152, v167
    v_add_u32 v168, 49152, v168
    v_add_u32 v169, 49152, v169
    v_add_u32 v170, 49152, v170
    v_add_u32 v171, 49152, v171
    v_add_u32 v172, 49152, v172
    v_add_u32 v173, 49152, v173
    v_add_u32 v174, 49152, v174
    ds_read_b128 v[112:115], v173 offset:0
    ds_read_b128 v[116:119], v173 offset:2048
    ds_read_b64_tr_b16 v[76:77], v164 offset:16384
    ds_read_b64_tr_b16 v[78:79], v164 offset:18432
    ds_read_b64_tr_b16 v[80:81], v165 offset:16384
    ds_read_b64_tr_b16 v[82:83], v165 offset:18432
    ds_read_b64_tr_b16 v[84:85], v166 offset:16384
    ds_read_b64_tr_b16 v[86:87], v166 offset:18432
    ds_read_b64_tr_b16 v[88:89], v167 offset:16384
    ds_read_b64_tr_b16 v[90:91], v167 offset:18432
    ds_read_b64_tr_b16 v[92:93], v168 offset:16384
    ds_read_b64_tr_b16 v[94:95], v168 offset:18432
    ds_read_b64_tr_b16 v[96:97], v169 offset:16384
    ds_read_b64_tr_b16 v[98:99], v169 offset:18432
    ds_read_b64_tr_b16 v[100:101], v170 offset:16384
    ds_read_b64_tr_b16 v[102:103], v170 offset:18432
    ds_read_b64_tr_b16 v[104:105], v171 offset:16384
    ds_read_b64_tr_b16 v[106:107], v171 offset:18432
    ds_read_b64_tr_b16 v[108:109], v172 offset:16384
    ds_read_b64_tr_b16 v[110:111], v172 offset:18432
    s_waitcnt lgkmcnt(0)
    v_mfma_f32_16x16x32_bf16 v[4:7], v[76:79], v[112:115], v[4:7]
    ds_read_b128 v[156:159], v174 offset:0
    v_mfma_f32_16x16x32_bf16 v[8:11], v[76:79], v[116:119], v[8:11]
    ds_read_b128 v[160:163], v174 offset:2048
    v_mfma_f32_16x16x32_bf16 v[12:15], v[80:83], v[112:115], v[12:15]
    ds_read_b64_tr_b16 v[120:121], v164 offset:32768
    ds_read_b64_tr_b16 v[122:123], v164 offset:34816
    v_mfma_f32_16x16x32_bf16 v[16:19], v[80:83], v[116:119], v[16:19]
    ds_read_b64_tr_b16 v[124:125], v165 offset:32768
    v_mfma_f32_16x16x32_bf16 v[20:23], v[84:87], v[112:115], v[20:23]
    ds_read_b64_tr_b16 v[126:127], v165 offset:34816
    ds_read_b64_tr_b16 v[128:129], v166 offset:32768
    v_mfma_f32_16x16x32_bf16 v[24:27], v[84:87], v[116:119], v[24:27]
    ds_read_b64_tr_b16 v[130:131], v166 offset:34816
    v_mfma_f32_16x16x32_bf16 v[28:31], v[88:91], v[112:115], v[28:31]
    ds_read_b64_tr_b16 v[132:133], v167 offset:32768
    ds_read_b64_tr_b16 v[134:135], v167 offset:34816
    v_mfma_f32_16x16x32_bf16 v[32:35], v[88:91], v[116:119], v[32:35]
    ds_read_b64_tr_b16 v[136:137], v168 offset:32768
    v_mfma_f32_16x16x32_bf16 v[36:39], v[92:95], v[112:115], v[36:39]
    ds_read_b64_tr_b16 v[138:139], v168 offset:34816
    ds_read_b64_tr_b16 v[140:141], v169 offset:32768
    v_mfma_f32_16x16x32_bf16 v[40:43], v[92:95], v[116:119], v[40:43]
    ds_read_b64_tr_b16 v[142:143], v169 offset:34816
    v_mfma_f32_16x16x32_bf16 v[44:47], v[96:99], v[112:115], v[44:47]
    ds_read_b64_tr_b16 v[144:145], v170 offset:32768
    v_mfma_f32_16x16x32_bf16 v[48:51], v[96:99], v[116:119], v[48:51]
    ds_read_b64_tr_b16 v[146:147], v170 offset:34816
    ds_read_b64_tr_b16 v[148:149], v171 offset:32768
    v_mfma_f32_16x16x32_bf16 v[52:55], v[100:103], v[112:115], v[52:55]
    ds_read_b64_tr_b16 v[150:151], v171 offset:34816
    v_mfma_f32_16x16x32_bf16 v[56:59], v[100:103], v[116:119], v[56:59]
    ds_read_b64_tr_b16 v[152:153], v172 offset:32768
    ds_read_b64_tr_b16 v[154:155], v172 offset:34816
    v_mfma_f32_16x16x32_bf16 v[60:63], v[104:107], v[112:115], v[60:63]
    s_add_u32 s58, s58, 128
    s_add_u32 s59, s59, 73728
    v_mfma_f32_16x16x32_bf16 v[64:67], v[104:107], v[116:119], v[64:67]
    s_add_u32 m0, s41, 0
    s_add_u32 s51, s58, 0
    buffer_load_dwordx4 v0, s[16:19], s51 offen lds
    s_add_u32 m0, s41, 4096
    s_add_u32 s51, s58, 294912
    buffer_load_dwordx4 v0, s[16:19], s51 offen lds
    v_mfma_f32_16x16x32_bf16 v[68:71], v[108:111], v[112:115], v[68:71]
    s_add_u32 m0, s41, 8192
    s_add_u32 s51, s58, 589824
    buffer_load_dwordx4 v0, s[16:19], s51 offen lds
    v_mfma_f32_16x16x32_bf16 v[72:75], v[108:111], v[116:119], v[72:75]
    s_add_u32 m0, s41, 12288
    s_add_u32 s51, s58, 884736
    buffer_load_dwordx4 v0, s[16:19], s51 offen lds
    s_add_u32 m0, s41, 16384
    s_add_u32 s51, s59, 0
    buffer_load_dwordx4 v1, s[20:23], s51 offen lds
    s_waitcnt lgkmcnt(0)
    v_mfma_f32_16x16x32_bf16 v[4:7], v[120:123], v[156:159], v[4:7]
    v_mfma_f32_16x16x32_bf16 v[8:11], v[120:123], v[160:163], v[8:11]
    v_mfma_f32_16x16x32_bf16 v[12:15], v[124:127], v[156:159], v[12:15]
    s_add_u32 m0, s41, 20480
    s_add_u32 s51, s59, 9216
    buffer_load_dwordx4 v2, s[20:23], s51 offen lds
    v_mfma_f32_16x16x32_bf16 v[16:19], v[124:127], v[160:163], v[16:19]
    v_mfma_f32_16x16x32_bf16 v[20:23], v[128:131], v[156:159], v[20:23]
    v_mfma_f32_16x16x32_bf16 v[24:27], v[128:131], v[160:163], v[24:27]
    s_add_u32 m0, s41, 24576
    s_add_u32 s51, s59, 18432
    buffer_load_dwordx4 v1, s[20:23], s51 offen lds
    v_mfma_f32_16x16x32_bf16 v[28:31], v[132:135], v[156:159], v[28:31]
    v_mfma_f32_16x16x32_bf16 v[32:35], v[132:135], v[160:163], v[32:35]
    s_add_u32 m0, s41, 28672
    s_add_u32 s51, s59, 27648
    buffer_load_dwordx4 v2, s[20:23], s51 offen lds
    v_mfma_f32_16x16x32_bf16 v[36:39], v[136:139], v[156:159], v[36:39]
    v_mfma_f32_16x16x32_bf16 v[40:43], v[136:139], v[160:163], v[40:43]
    v_mfma_f32_16x16x32_bf16 v[44:47], v[140:143], v[156:159], v[44:47]
    s_add_u32 m0, s41, 32768
    s_add_u32 s51, s59, 36864
    buffer_load_dwordx4 v1, s[20:23], s51 offen lds
    v_mfma_f32_16x16x32_bf16 v[48:51], v[140:143], v[160:163], v[48:51]
    v_mfma_f32_16x16x32_bf16 v[52:55], v[144:147], v[156:159], v[52:55]
    s_add_u32 m0, s41, 36864
    s_add_u32 s51, s59, 46080
    buffer_load_dwordx4 v2, s[20:23], s51 offen lds
    v_mfma_f32_16x16x32_bf16 v[56:59], v[144:147], v[160:163], v[56:59]
    v_mfma_f32_16x16x32_bf16 v[60:63], v[148:151], v[156:159], v[60:63]
    v_mfma_f32_16x16x32_bf16 v[64:67], v[148:151], v[160:163], v[64:67]
    s_add_u32 m0, s41, 40960
    s_add_u32 s51, s59, 55296
    buffer_load_dwordx4 v1, s[20:23], s51 offen lds
    v_mfma_f32_16x16x32_bf16 v[68:71], v[152:155], v[156:159], v[68:71]
    v_mfma_f32_16x16x32_bf16 v[72:75], v[152:155], v[160:163], v[72:75]
    s_add_u32 m0, s41, 45056
    s_add_u32 s51, s59, 64512
    buffer_load_dwordx4 v2, s[20:23], s51 offen lds
    s_waitcnt vmcnt(12)
    s_barrier
    v_add_u32 v164, 49152, v164
    v_add_u32 v165, 49152, v165
    v_add_u32 v166, 49152, v166
    v_add_u32 v167, 49152, v167
    v_add_u32 v168, 49152, v168
    v_add_u32 v169, 49152, v169
    v_add_u32 v170, 49152, v170
    v_add_u32 v171, 49152, v171
    v_add_u32 v172, 49152, v172
    v_add_u32 v173, 49152, v173
    v_add_u32 v174, 49152, v174
    ds_read_b128 v[112:115], v173 offset:0
    ds_read_b128 v[116:119], v173 offset:2048
    ds_read_b64_tr_b16 v[76:77], v164 offset:16384
    ds_read_b64_tr_b16 v[78:79], v164 offset:18432
    ds_read_b64_tr_b16 v[80:81], v165 offset:16384
    ds_read_b64_tr_b16 v[82:83], v165 offset:18432
    ds_read_b64_tr_b16 v[84:85], v166 offset:16384
    ds_read_b64_tr_b16 v[86:87], v166 offset:18432
    ds_read_b64_tr_b16 v[88:89], v167 offset:16384
    ds_read_b64_tr_b16 v[90:91], v167 offset:18432
    ds_read_b64_tr_b16 v[92:93], v168 offset:16384
    ds_read_b64_tr_b16 v[94:95], v168 offset:18432
    ds_read_b64_tr_b16 v[96:97], v169 offset:16384
    ds_read_b64_tr_b16 v[98:99], v169 offset:18432
    ds_read_b64_tr_b16 v[100:101], v170 offset:16384
    ds_read_b64_tr_b16 v[102:103], v170 offset:18432
    ds_read_b64_tr_b16 v[104:105], v171 offset:16384
    ds_read_b64_tr_b16 v[106:107], v171 offset:18432
    ds_read_b64_tr_b16 v[108:109], v172 offset:16384
    ds_read_b64_tr_b16 v[110:111], v172 offset:18432
    s_waitcnt lgkmcnt(0)
    v_mfma_f32_16x16x32_bf16 v[4:7], v[76:79], v[112:115], v[4:7]
    ds_read_b128 v[156:159], v174 offset:0
    v_mfma_f32_16x16x32_bf16 v[8:11], v[76:79], v[116:119], v[8:11]
    ds_read_b128 v[160:163], v174 offset:2048
    v_mfma_f32_16x16x32_bf16 v[12:15], v[80:83], v[112:115], v[12:15]
    ds_read_b64_tr_b16 v[120:121], v164 offset:32768
    ds_read_b64_tr_b16 v[122:123], v164 offset:34816
    v_mfma_f32_16x16x32_bf16 v[16:19], v[80:83], v[116:119], v[16:19]
    ds_read_b64_tr_b16 v[124:125], v165 offset:32768
    v_mfma_f32_16x16x32_bf16 v[20:23], v[84:87], v[112:115], v[20:23]
    ds_read_b64_tr_b16 v[126:127], v165 offset:34816
    ds_read_b64_tr_b16 v[128:129], v166 offset:32768
    v_mfma_f32_16x16x32_bf16 v[24:27], v[84:87], v[116:119], v[24:27]
    ds_read_b64_tr_b16 v[130:131], v166 offset:34816
    v_mfma_f32_16x16x32_bf16 v[28:31], v[88:91], v[112:115], v[28:31]
    ds_read_b64_tr_b16 v[132:133], v167 offset:32768
    ds_read_b64_tr_b16 v[134:135], v167 offset:34816
    v_mfma_f32_16x16x32_bf16 v[32:35], v[88:91], v[116:119], v[32:35]
    ds_read_b64_tr_b16 v[136:137], v168 offset:32768
    v_mfma_f32_16x16x32_bf16 v[36:39], v[92:95], v[112:115], v[36:39]
    ds_read_b64_tr_b16 v[138:139], v168 offset:34816
    ds_read_b64_tr_b16 v[140:141], v169 offset:32768
    v_mfma_f32_16x16x32_bf16 v[40:43], v[92:95], v[116:119], v[40:43]
    ds_read_b64_tr_b16 v[142:143], v169 offset:34816
    v_mfma_f32_16x16x32_bf16 v[44:47], v[96:99], v[112:115], v[44:47]
    ds_read_b64_tr_b16 v[144:145], v170 offset:32768
    v_mfma_f32_16x16x32_bf16 v[48:51], v[96:99], v[116:119], v[48:51]
    ds_read_b64_tr_b16 v[146:147], v170 offset:34816
    ds_read_b64_tr_b16 v[148:149], v171 offset:32768
    v_mfma_f32_16x16x32_bf16 v[52:55], v[100:103], v[112:115], v[52:55]
    ds_read_b64_tr_b16 v[150:151], v171 offset:34816
    v_mfma_f32_16x16x32_bf16 v[56:59], v[100:103], v[116:119], v[56:59]
    ds_read_b64_tr_b16 v[152:153], v172 offset:32768
    ds_read_b64_tr_b16 v[154:155], v172 offset:34816
    v_mfma_f32_16x16x32_bf16 v[60:63], v[104:107], v[112:115], v[60:63]
    s_add_u32 s58, s58, 128
    s_add_u32 s59, s59, 73728
    v_mfma_f32_16x16x32_bf16 v[64:67], v[104:107], v[116:119], v[64:67]
    s_add_u32 m0, s41, 49152
    s_add_u32 s51, s58, 0
    buffer_load_dwordx4 v0, s[16:19], s51 offen lds
    s_add_u32 m0, s41, 53248
    s_add_u32 s51, s58, 294912
    buffer_load_dwordx4 v0, s[16:19], s51 offen lds
    v_mfma_f32_16x16x32_bf16 v[68:71], v[108:111], v[112:115], v[68:71]
    s_add_u32 m0, s41, 57344
    s_add_u32 s51, s58, 589824
    buffer_load_dwordx4 v0, s[16:19], s51 offen lds
    v_mfma_f32_16x16x32_bf16 v[72:75], v[108:111], v[116:119], v[72:75]
    s_add_u32 m0, s41, 61440
    s_add_u32 s51, s58, 884736
    buffer_load_dwordx4 v0, s[16:19], s51 offen lds
    s_add_u32 m0, s41, 65536
    s_add_u32 s51, s59, 0
    buffer_load_dwordx4 v1, s[20:23], s51 offen lds
    s_waitcnt lgkmcnt(0)
    v_mfma_f32_16x16x32_bf16 v[4:7], v[120:123], v[156:159], v[4:7]
    v_mfma_f32_16x16x32_bf16 v[8:11], v[120:123], v[160:163], v[8:11]
    v_mfma_f32_16x16x32_bf16 v[12:15], v[124:127], v[156:159], v[12:15]
    s_add_u32 m0, s41, 69632
    s_add_u32 s51, s59, 9216
    buffer_load_dwordx4 v2, s[20:23], s51 offen lds
    v_mfma_f32_16x16x32_bf16 v[16:19], v[124:127], v[160:163], v[16:19]
    v_mfma_f32_16x16x32_bf16 v[20:23], v[128:131], v[156:159], v[20:23]
    v_mfma_f32_16x16x32_bf16 v[24:27], v[128:131], v[160:163], v[24:27]
    s_add_u32 m0, s41, 73728
    s_add_u32 s51, s59, 18432
    buffer_load_dwordx4 v1, s[20:23], s51 offen lds
    v_mfma_f32_16x16x32_bf16 v[28:31], v[132:135], v[156:159], v[28:31]
    v_mfma_f32_16x16x32_bf16 v[32:35], v[132:135], v[160:163], v[32:35]
    s_add_u32 m0, s41, 77824
    s_add_u32 s51, s59, 27648
    buffer_load_dwordx4 v2, s[20:23], s51 offen lds
    v_mfma_f32_16x16x32_bf16 v[36:39], v[136:139], v[156:159], v[36:39]
    v_mfma_f32_16x16x32_bf16 v[40:43], v[136:139], v[160:163], v[40:43]
    v_mfma_f32_16x16x32_bf16 v[44:47], v[140:143], v[156:159], v[44:47]
    s_add_u32 m0, s41, 81920
    s_add_u32 s51, s59, 36864
    buffer_load_dwordx4 v1, s[20:23], s51 offen lds
    v_mfma_f32_16x16x32_bf16 v[48:51], v[140:143], v[160:163], v[48:51]
    v_mfma_f32_16x16x32_bf16 v[52:55], v[144:147], v[156:159], v[52:55]
    s_add_u32 m0, s41, 86016
    s_add_u32 s51, s59, 46080
    buffer_load_dwordx4 v2, s[20:23], s51 offen lds
    v_mfma_f32_16x16x32_bf16 v[56:59], v[144:147], v[160:163], v[56:59]
    v_mfma_f32_16x16x32_bf16 v[60:63], v[148:151], v[156:159], v[60:63]
    v_mfma_f32_16x16x32_bf16 v[64:67], v[148:151], v[160:163], v[64:67]
    s_add_u32 m0, s41, 90112
    s_add_u32 s51, s59, 55296
    buffer_load_dwordx4 v1, s[20:23], s51 offen lds
    v_mfma_f32_16x16x32_bf16 v[68:71], v[152:155], v[156:159], v[68:71]
    v_mfma_f32_16x16x32_bf16 v[72:75], v[152:155], v[160:163], v[72:75]
    s_add_u32 m0, s41, 94208
    s_add_u32 s51, s59, 64512
    buffer_load_dwordx4 v2, s[20:23], s51 offen lds
    s_waitcnt vmcnt(12)
    s_barrier
    v_subrev_u32 v164, 98304, v164
    v_subrev_u32 v165, 98304, v165
    v_subrev_u32 v166, 98304, v166
    v_subrev_u32 v167, 98304, v167
    v_subrev_u32 v168, 98304, v168
    v_subrev_u32 v169, 98304, v169
    v_subrev_u32 v170, 98304, v170
    v_subrev_u32 v171, 98304, v171
    v_subrev_u32 v172, 98304, v172
    v_subrev_u32 v173, 98304, v173
    v_subrev_u32 v174, 98304, v174
    ds_read_b128 v[112:115], v173 offset:0
    ds_read_b128 v[116:119], v173 offset:2048
    ds_read_b64_tr_b16 v[76:77], v164 offset:16384
    ds_read_b64_tr_b16 v[78:79], v164 offset:18432
    ds_read_b64_tr_b16 v[80:81], v165 offset:16384
    ds_read_b64_tr_b16 v[82:83], v165 offset:18432
    ds_read_b64_tr_b16 v[84:85], v166 offset:16384
    ds_read_b64_tr_b16 v[86:87], v166 offset:18432
    ds_read_b64_tr_b16 v[88:89], v167 offset:16384
    ds_read_b64_tr_b16 v[90:91], v167 offset:18432
    ds_read_b64_tr_b16 v[92:93], v168 offset:16384
    ds_read_b64_tr_b16 v[94:95], v168 offset:18432
    ds_read_b64_tr_b16 v[96:97], v169 offset:16384
    ds_read_b64_tr_b16 v[98:99], v169 offset:18432
    ds_read_b64_tr_b16 v[100:101], v170 offset:16384
    ds_read_b64_tr_b16 v[102:103], v170 offset:18432
    ds_read_b64_tr_b16 v[104:105], v171 offset:16384
    ds_read_b64_tr_b16 v[106:107], v171 offset:18432
    ds_read_b64_tr_b16 v[108:109], v172 offset:16384
    ds_read_b64_tr_b16 v[110:111], v172 offset:18432
    s_waitcnt lgkmcnt(0)
    v_mfma_f32_16x16x32_bf16 v[4:7], v[76:79], v[112:115], v[4:7]
    ds_read_b128 v[156:159], v174 offset:0
    v_mfma_f32_16x16x32_bf16 v[8:11], v[76:79], v[116:119], v[8:11]
    ds_read_b128 v[160:163], v174 offset:2048
    v_mfma_f32_16x16x32_bf16 v[12:15], v[80:83], v[112:115], v[12:15]
    ds_read_b64_tr_b16 v[120:121], v164 offset:32768
    ds_read_b64_tr_b16 v[122:123], v164 offset:34816
    v_mfma_f32_16x16x32_bf16 v[16:19], v[80:83], v[116:119], v[16:19]
    ds_read_b64_tr_b16 v[124:125], v165 offset:32768
    v_mfma_f32_16x16x32_bf16 v[20:23], v[84:87], v[112:115], v[20:23]
    ds_read_b64_tr_b16 v[126:127], v165 offset:34816
    ds_read_b64_tr_b16 v[128:129], v166 offset:32768
    v_mfma_f32_16x16x32_bf16 v[24:27], v[84:87], v[116:119], v[24:27]
    ds_read_b64_tr_b16 v[130:131], v166 offset:34816
    v_mfma_f32_16x16x32_bf16 v[28:31], v[88:91], v[112:115], v[28:31]
    ds_read_b64_tr_b16 v[132:133], v167 offset:32768
    ds_read_b64_tr_b16 v[134:135], v167 offset:34816
    v_mfma_f32_16x16x32_bf16 v[32:35], v[88:91], v[116:119], v[32:35]
    ds_read_b64_tr_b16 v[136:137], v168 offset:32768
    v_mfma_f32_16x16x32_bf16 v[36:39], v[92:95], v[112:115], v[36:39]
    ds_read_b64_tr_b16 v[138:139], v168 offset:34816
    ds_read_b64_tr_b16 v[140:141], v169 offset:32768
    v_mfma_f32_16x16x32_bf16 v[40:43], v[92:95], v[116:119], v[40:43]
    ds_read_b64_tr_b16 v[142:143], v169 offset:34816
    v_mfma_f32_16x16x32_bf16 v[44:47], v[96:99], v[112:115], v[44:47]
    ds_read_b64_tr_b16 v[144:145], v170 offset:32768
    v_mfma_f32_16x16x32_bf16 v[48:51], v[96:99], v[116:119], v[48:51]
    ds_read_b64_tr_b16 v[146:147], v170 offset:34816
    ds_read_b64_tr_b16 v[148:149], v171 offset:32768
    v_mfma_f32_16x16x32_bf16 v[52:55], v[100:103], v[112:115], v[52:55]
    ds_read_b64_tr_b16 v[150:151], v171 offset:34816
    v_mfma_f32_16x16x32_bf16 v[56:59], v[100:103], v[116:119], v[56:59]
    ds_read_b64_tr_b16 v[152:153], v172 offset:32768
    ds_read_b64_tr_b16 v[154:155], v172 offset:34816
    v_mfma_f32_16x16x32_bf16 v[60:63], v[104:107], v[112:115], v[60:63]
    s_add_u32 s58, s58, 128
    s_add_u32 s59, s59, 73728
    v_mfma_f32_16x16x32_bf16 v[64:67], v[104:107], v[116:119], v[64:67]
    s_add_u32 m0, s41, 98304
    s_add_u32 s51, s58, 0
    buffer_load_dwordx4 v0, s[16:19], s51 offen lds
    s_add_u32 m0, s41, 102400
    s_add_u32 s51, s58, 294912
    buffer_load_dwordx4 v0, s[16:19], s51 offen lds
    v_mfma_f32_16x16x32_bf16 v[68:71], v[108:111], v[112:115], v[68:71]
    s_add_u32 m0, s41, 106496
    s_add_u32 s51, s58, 589824
    buffer_load_dwordx4 v0, s[16:19], s51 offen lds
    v_mfma_f32_16x16x32_bf16 v[72:75], v[108:111], v[116:119], v[72:75]
    s_add_u32 m0, s41, 110592
    s_add_u32 s51, s58, 884736
    buffer_load_dwordx4 v0, s[16:19], s51 offen lds
    s_add_u32 m0, s41, 114688
    s_add_u32 s51, s59, 0
    buffer_load_dwordx4 v1, s[20:23], s51 offen lds
    s_waitcnt lgkmcnt(0)
    v_mfma_f32_16x16x32_bf16 v[4:7], v[120:123], v[156:159], v[4:7]
    v_mfma_f32_16x16x32_bf16 v[8:11], v[120:123], v[160:163], v[8:11]
    v_mfma_f32_16x16x32_bf16 v[12:15], v[124:127], v[156:159], v[12:15]
    s_add_u32 m0, s41, 118784
    s_add_u32 s51, s59, 9216
    buffer_load_dwordx4 v2, s[20:23], s51 offen lds
    v_mfma_f32_16x16x32_bf16 v[16:19], v[124:127], v[160:163], v[16:19]
    v_mfma_f32_16x16x32_bf16 v[20:23], v[128:131], v[156:159], v[20:23]
    v_mfma_f32_16x16x32_bf16 v[24:27], v[128:131], v[160:163], v[24:27]
    s_add_u32 m0, s41, 122880
    s_add_u32 s51, s59, 18432
    buffer_load_dwordx4 v1, s[20:23], s51 offen lds
    v_mfma_f32_16x16x32_bf16 v[28:31], v[132:135], v[156:159], v[28:31]
    v_mfma_f32_16x16x32_bf16 v[32:35], v[132:135], v[160:163], v[32:35]
    s_add_u32 m0, s41, 126976
    s_add_u32 s51, s59, 27648
    buffer_load_dwordx4 v2, s[20:23], s51 offen lds
    v_mfma_f32_16x16x32_bf16 v[36:39], v[136:139], v[156:159], v[36:39]
    v_mfma_f32_16x16x32_bf16 v[40:43], v[136:139], v[160:163], v[40:43]
    v_mfma_f32_16x16x32_bf16 v[44:47], v[140:143], v[156:159], v[44:47]
    s_add_u32 m0, s41, 131072
    s_add_u32 s51, s59, 36864
    buffer_load_dwordx4 v1, s[20:23], s51 offen lds
    v_mfma_f32_16x16x32_bf16 v[48:51], v[140:143], v[160:163], v[48:51]
    v_mfma_f32_16x16x32_bf16 v[52:55], v[144:147], v[156:159], v[52:55]
    s_add_u32 m0, s41, 135168
    s_add_u32 s51, s59, 46080
    buffer_load_dwordx4 v2, s[20:23], s51 offen lds
    v_mfma_f32_16x16x32_bf16 v[56:59], v[144:147], v[160:163], v[56:59]
    v_mfma_f32_16x16x32_bf16 v[60:63], v[148:151], v[156:159], v[60:63]
    v_mfma_f32_16x16x32_bf16 v[64:67], v[148:151], v[160:163], v[64:67]
    s_add_u32 m0, s41, 139264
    s_add_u32 s51, s59, 55296
    buffer_load_dwordx4 v1, s[20:23], s51 offen lds
    v_mfma_f32_16x16x32_bf16 v[68:71], v[152:155], v[156:159], v[68:71]
    v_mfma_f32_16x16x32_bf16 v[72:75], v[152:155], v[160:163], v[72:75]
    s_add_u32 m0, s41, 143360
    s_add_u32 s51, s59, 64512
    buffer_load_dwordx4 v2, s[20:23], s51 offen lds
    s_waitcnt vmcnt(12)
    s_barrier
    v_add_u32 v164, 49152, v164
    v_add_u32 v165, 49152, v165
    v_add_u32 v166, 49152, v166
    v_add_u32 v167, 49152, v167
    v_add_u32 v168, 49152, v168
    v_add_u32 v169, 49152, v169
    v_add_u32 v170, 49152, v170
    v_add_u32 v171, 49152, v171
    v_add_u32 v172, 49152, v172
    v_add_u32 v173, 49152, v173
    v_add_u32 v174, 49152, v174
    ds_read_b128 v[112:115], v173 offset:0
    ds_read_b128 v[116:119], v173 offset:2048
    ds_read_b64_tr_b16 v[76:77], v164 offset:16384
    ds_read_b64_tr_b16 v[78:79], v164 offset:18432
    ds_read_b64_tr_b16 v[80:81], v165 offset:16384
    ds_read_b64_tr_b16 v[82:83], v165 offset:18432
    ds_read_b64_tr_b16 v[84:85], v166 offset:16384
    ds_read_b64_tr_b16 v[86:87], v166 offset:18432
    ds_read_b64_tr_b16 v[88:89], v167 offset:16384
    ds_read_b64_tr_b16 v[90:91], v167 offset:18432
    ds_read_b64_tr_b16 v[92:93], v168 offset:16384
    ds_read_b64_tr_b16 v[94:95], v168 offset:18432
    ds_read_b64_tr_b16 v[96:97], v169 offset:16384
    ds_read_b64_tr_b16 v[98:99], v169 offset:18432
    ds_read_b64_tr_b16 v[100:101], v170 offset:16384
    ds_read_b64_tr_b16 v[102:103], v170 offset:18432
    ds_read_b64_tr_b16 v[104:105], v171 offset:16384
    ds_read_b64_tr_b16 v[106:107], v171 offset:18432
    ds_read_b64_tr_b16 v[108:109], v172 offset:16384
    ds_read_b64_tr_b16 v[110:111], v172 offset:18432
    s_waitcnt lgkmcnt(0)
    v_mfma_f32_16x16x32_bf16 v[4:7], v[76:79], v[112:115], v[4:7]
    ds_read_b128 v[156:159], v174 offset:0
    v_mfma_f32_16x16x32_bf16 v[8:11], v[76:79], v[116:119], v[8:11]
    ds_read_b128 v[160:163], v174 offset:2048
    v_mfma_f32_16x16x32_bf16 v[12:15], v[80:83], v[112:115], v[12:15]
    ds_read_b64_tr_b16 v[120:121], v164 offset:32768
    ds_read_b64_tr_b16 v[122:123], v164 offset:34816
    v_mfma_f32_16x16x32_bf16 v[16:19], v[80:83], v[116:119], v[16:19]
    ds_read_b64_tr_b16 v[124:125], v165 offset:32768
    v_mfma_f32_16x16x32_bf16 v[20:23], v[84:87], v[112:115], v[20:23]
    ds_read_b64_tr_b16 v[126:127], v165 offset:34816
    ds_read_b64_tr_b16 v[128:129], v166 offset:32768
    v_mfma_f32_16x16x32_bf16 v[24:27], v[84:87], v[116:119], v[24:27]
    ds_read_b64_tr_b16 v[130:131], v166 offset:34816
    v_mfma_f32_16x16x32_bf16 v[28:31], v[88:91], v[112:115], v[28:31]
    ds_read_b64_tr_b16 v[132:133], v167 offset:32768
    ds_read_b64_tr_b16 v[134:135], v167 offset:34816
    v_mfma_f32_16x16x32_bf16 v[32:35], v[88:91], v[116:119], v[32:35]
    ds_read_b64_tr_b16 v[136:137], v168 offset:32768
    v_mfma_f32_16x16x32_bf16 v[36:39], v[92:95], v[112:115], v[36:39]
    ds_read_b64_tr_b16 v[138:139], v168 offset:34816
    ds_read_b64_tr_b16 v[140:141], v169 offset:32768
    v_mfma_f32_16x16x32_bf16 v[40:43], v[92:95], v[116:119], v[40:43]
    ds_read_b64_tr_b16 v[142:143], v169 offset:34816
    v_mfma_f32_16x16x32_bf16 v[44:47], v[96:99], v[112:115], v[44:47]
    ds_read_b64_tr_b16 v[144:145], v170 offset:32768
    v_mfma_f32_16x16x32_bf16 v[48:51], v[96:99], v[116:119], v[48:51]
    ds_read_b64_tr_b16 v[146:147], v170 offset:34816
    ds_read_b64_tr_b16 v[148:149], v171 offset:32768
    v_mfma_f32_16x16x32_bf16 v[52:55], v[100:103], v[112:115], v[52:55]
    ds_read_b64_tr_b16 v[150:151], v171 offset:34816
    v_mfma_f32_16x16x32_bf16 v[56:59], v[100:103], v[116:119], v[56:59]
    ds_read_b64_tr_b16 v[152:153], v172 offset:32768
    ds_read_b64_tr_b16 v[154:155], v172 offset:34816
    v_mfma_f32_16x16x32_bf16 v[60:63], v[104:107], v[112:115], v[60:63]
    s_add_u32 s58, s58, 128
    s_add_u32 s59, s59, 73728
    v_mfma_f32_16x16x32_bf16 v[64:67], v[104:107], v[116:119], v[64:67]
    s_add_u32 m0, s41, 0
    s_add_u32 s51, s58, 0
    buffer_load_dwordx4 v0, s[16:19], s51 offen lds
    s_add_u32 m0, s41, 4096
    s_add_u32 s51, s58, 294912
    buffer_load_dwordx4 v0, s[16:19], s51 offen lds
    v_mfma_f32_16x16x32_bf16 v[68:71], v[108:111], v[112:115], v[68:71]
    s_add_u32 m0, s41, 8192
    s_add_u32 s51, s58, 589824
    buffer_load_dwordx4 v0, s[16:19], s51 offen lds
    v_mfma_f32_16x16x32_bf16 v[72:75], v[108:111], v[116:119], v[72:75]
    s_add_u32 m0, s41, 12288
    s_add_u32 s51, s58, 884736
    buffer_load_dwordx4 v0, s[16:19], s51 offen lds
    s_add_u32 m0, s41, 16384
    s_add_u32 s51, s59, 0
    buffer_load_dwordx4 v1, s[20:23], s51 offen lds
    s_waitcnt lgkmcnt(0)
    v_mfma_f32_16x16x32_bf16 v[4:7], v[120:123], v[156:159], v[4:7]
    v_mfma_f32_16x16x32_bf16 v[8:11], v[120:123], v[160:163], v[8:11]
    v_mfma_f32_16x16x32_bf16 v[12:15], v[124:127], v[156:159], v[12:15]
    s_add_u32 m0, s41, 20480
    s_add_u32 s51, s59, 9216
    buffer_load_dwordx4 v2, s[20:23], s51 offen lds
    v_mfma_f32_16x16x32_bf16 v[16:19], v[124:127], v[160:163], v[16:19]
    v_mfma_f32_16x16x32_bf16 v[20:23], v[128:131], v[156:159], v[20:23]
    v_mfma_f32_16x16x32_bf16 v[24:27], v[128:131], v[160:163], v[24:27]
    s_add_u32 m0, s41, 24576
    s_add_u32 s51, s59, 18432
    buffer_load_dwordx4 v1, s[20:23], s51 offen lds
    v_mfma_f32_16x16x32_bf16 v[28:31], v[132:135], v[156:159], v[28:31]
    v_mfma_f32_16x16x32_bf16 v[32:35], v[132:135], v[160:163], v[32:35]
    s_add_u32 m0, s41, 28672
    s_add_u32 s51, s59, 27648
    buffer_load_dwordx4 v2, s[20:23], s51 offen lds
    v_mfma_f32_16x16x32_bf16 v[36:39], v[136:139], v[156:159], v[36:39]
    v_mfma_f32_16x16x32_bf16 v[40:43], v[136:139], v[160:163], v[40:43]
    v_mfma_f32_16x16x32_bf16 v[44:47], v[140:143], v[156:159], v[44:47]
    s_add_u32 m0, s41, 32768
    s_add_u32 s51, s59, 36864
    buffer_load_dwordx4 v1, s[20:23], s51 offen lds
    v_mfma_f32_16x16x32_bf16 v[48:51], v[140:143], v[160:163], v[48:51]
    v_mfma_f32_16x16x32_bf16 v[52:55], v[144:147], v[156:159], v[52:55]
    s_add_u32 m0, s41, 36864
    s_add_u32 s51, s59, 46080
    buffer_load_dwordx4 v2, s[20:23], s51 offen lds
    v_mfma_f32_16x16x32_bf16 v[56:59], v[144:147], v[160:163], v[56:59]
    v_mfma_f32_16x16x32_bf16 v[60:63], v[148:151], v[156:159], v[60:63]
    v_mfma_f32_16x16x32_bf16 v[64:67], v[148:151], v[160:163], v[64:67]
    s_add_u32 m0, s41, 40960
    s_add_u32 s51, s59, 55296
    buffer_load_dwordx4 v1, s[20:23], s51 offen lds
    v_mfma_f32_16x16x32_bf16 v[68:71], v[152:155], v[156:159], v[68:71]
    v_mfma_f32_16x16x32_bf16 v[72:75], v[152:155], v[160:163], v[72:75]
    s_add_u32 m0, s41, 45056
    s_add_u32 s51, s59, 64512
    buffer_load_dwordx4 v2, s[20:23], s51 offen lds
    s_waitcnt vmcnt(12)
    s_barrier
    v_add_u32 v164, 49152, v164
    v_add_u32 v165, 49152, v165
    v_add_u32 v166, 49152, v166
    v_add_u32 v167, 49152, v167
    v_add_u32 v168, 49152, v168
    v_add_u32 v169, 49152, v169
    v_add_u32 v170, 49152, v170
    v_add_u32 v171, 49152, v171
    v_add_u32 v172, 49152, v172
    v_add_u32 v173, 49152, v173
    v_add_u32 v174, 49152, v174
    ds_read_b128 v[112:115], v173 offset:0
    ds_read_b128 v[116:119], v173 offset:2048
    ds_read_b64_tr_b16 v[76:77], v164 offset:16384
    ds_read_b64_tr_b16 v[78:79], v164 offset:18432
    ds_read_b64_tr_b16 v[80:81], v165 offset:16384
    ds_read_b64_tr_b16 v[82:83], v165 offset:18432
    ds_read_b64_tr_b16 v[84:85], v166 offset:16384
    ds_read_b64_tr_b16 v[86:87], v166 offset:18432
    ds_read_b64_tr_b16 v[88:89], v167 offset:16384
    ds_read_b64_tr_b16 v[90:91], v167 offset:18432
    ds_read_b64_tr_b16 v[92:93], v168 offset:16384
    ds_read_b64_tr_b16 v[94:95], v168 offset:18432
    ds_read_b64_tr_b16 v[96:97], v169 offset:16384
    ds_read_b64_tr_b16 v[98:99], v169 offset:18432
    ds_read_b64_tr_b16 v[100:101], v170 offset:16384
    ds_read_b64_tr_b16 v[102:103], v170 offset:18432
    ds_read_b64_tr_b16 v[104:105], v171 offset:16384
    ds_read_b64_tr_b16 v[106:107], v171 offset:18432
    ds_read_b64_tr_b16 v[108:109], v172 offset:16384
    ds_read_b64_tr_b16 v[110:111], v172 offset:18432
    s_waitcnt lgkmcnt(0)
    v_mfma_f32_16x16x32_bf16 v[4:7], v[76:79], v[112:115], v[4:7]
    ds_read_b128 v[156:159], v174 offset:0
    v_mfma_f32_16x16x32_bf16 v[8:11], v[76:79], v[116:119], v[8:11]
    ds_read_b128 v[160:163], v174 offset:2048
    v_mfma_f32_16x16x32_bf16 v[12:15], v[80:83], v[112:115], v[12:15]
    ds_read_b64_tr_b16 v[120:121], v164 offset:32768
    ds_read_b64_tr_b16 v[122:123], v164 offset:34816
    v_mfma_f32_16x16x32_bf16 v[16:19], v[80:83], v[116:119], v[16:19]
    ds_read_b64_tr_b16 v[124:125], v165 offset:32768
    v_mfma_f32_16x16x32_bf16 v[20:23], v[84:87], v[112:115], v[20:23]
    ds_read_b64_tr_b16 v[126:127], v165 offset:34816
    ds_read_b64_tr_b16 v[128:129], v166 offset:32768
    v_mfma_f32_16x16x32_bf16 v[24:27], v[84:87], v[116:119], v[24:27]
    ds_read_b64_tr_b16 v[130:131], v166 offset:34816
    v_mfma_f32_16x16x32_bf16 v[28:31], v[88:91], v[112:115], v[28:31]
    ds_read_b64_tr_b16 v[132:133], v167 offset:32768
    ds_read_b64_tr_b16 v[134:135], v167 offset:34816
    v_mfma_f32_16x16x32_bf16 v[32:35], v[88:91], v[116:119], v[32:35]
    ds_read_b64_tr_b16 v[136:137], v168 offset:32768
    v_mfma_f32_16x16x32_bf16 v[36:39], v[92:95], v[112:115], v[36:39]
    ds_read_b64_tr_b16 v[138:139], v168 offset:34816
    ds_read_b64_tr_b16 v[140:141], v169 offset:32768
    v_mfma_f32_16x16x32_bf16 v[40:43], v[92:95], v[116:119], v[40:43]
    ds_read_b64_tr_b16 v[142:143], v169 offset:34816
    v_mfma_f32_16x16x32_bf16 v[44:47], v[96:99], v[112:115], v[44:47]
    ds_read_b64_tr_b16 v[144:145], v170 offset:32768
    v_mfma_f32_16x16x32_bf16 v[48:51], v[96:99], v[116:119], v[48:51]
    ds_read_b64_tr_b16 v[146:147], v170 offset:34816
    ds_read_b64_tr_b16 v[148:149], v171 offset:32768
    v_mfma_f32_16x16x32_bf16 v[52:55], v[100:103], v[112:115], v[52:55]
    ds_read_b64_tr_b16 v[150:151], v171 offset:34816
    v_mfma_f32_16x16x32_bf16 v[56:59], v[100:103], v[116:119], v[56:59]
    ds_read_b64_tr_b16 v[152:153], v172 offset:32768
    ds_read_b64_tr_b16 v[154:155], v172 offset:34816
    v_mfma_f32_16x16x32_bf16 v[60:63], v[104:107], v[112:115], v[60:63]
    s_add_u32 s58, s58, 128
    s_add_u32 s59, s59, 73728
    v_mfma_f32_16x16x32_bf16 v[64:67], v[104:107], v[116:119], v[64:67]
    s_add_u32 m0, s41, 49152
    s_add_u32 s51, s58, 0
    buffer_load_dwordx4 v0, s[16:19], s51 offen lds
    s_add_u32 m0, s41, 53248
    s_add_u32 s51, s58, 294912
    buffer_load_dwordx4 v0, s[16:19], s51 offen lds
    v_mfma_f32_16x16x32_bf16 v[68:71], v[108:111], v[112:115], v[68:71]
    s_add_u32 m0, s41, 57344
    s_add_u32 s51, s58, 589824
    buffer_load_dwordx4 v0, s[16:19], s51 offen lds
    v_mfma_f32_16x16x32_bf16 v[72:75], v[108:111], v[116:119], v[72:75]
    s_add_u32 m0, s41, 61440
    s_add_u32 s51, s58, 884736
    buffer_load_dwordx4 v0, s[16:19], s51 offen lds
    s_add_u32 m0, s41, 65536
    s_add_u32 s51, s59, 0
    buffer_load_dwordx4 v1, s[20:23], s51 offen lds
    s_waitcnt lgkmcnt(0)
    v_mfma_f32_16x16x32_bf16 v[4:7], v[120:123], v[156:159], v[4:7]
    v_mfma_f32_16x16x32_bf16 v[8:11], v[120:123], v[160:163], v[8:11]
    v_mfma_f32_16x16x32_bf16 v[12:15], v[124:127], v[156:159], v[12:15]
    s_add_u32 m0, s41, 69632
    s_add_u32 s51, s59, 9216
    buffer_load_dwordx4 v2, s[20:23], s51 offen lds
    v_mfma_f32_16x16x32_bf16 v[16:19], v[124:127], v[160:163], v[16:19]
    v_mfma_f32_16x16x32_bf16 v[20:23], v[128:131], v[156:159], v[20:23]
    v_mfma_f32_16x16x32_bf16 v[24:27], v[128:131], v[160:163], v[24:27]
    s_add_u32 m0, s41, 73728
    s_add_u32 s51, s59, 18432
    buffer_load_dwordx4 v1, s[20:23], s51 offen lds
    v_mfma_f32_16x16x32_bf16 v[28:31], v[132:135], v[156:159], v[28:31]
    v_mfma_f32_16x16x32_bf16 v[32:35], v[132:135], v[160:163], v[32:35]
    s_add_u32 m0, s41, 77824
    s_add_u32 s51, s59, 27648
    buffer_load_dwordx4 v2, s[20:23], s51 offen lds
    v_mfma_f32_16x16x32_bf16 v[36:39], v[136:139], v[156:159], v[36:39]
    v_mfma_f32_16x16x32_bf16 v[40:43], v[136:139], v[160:163], v[40:43]
    v_mfma_f32_16x16x32_bf16 v[44:47], v[140:143], v[156:159], v[44:47]
    s_add_u32 m0, s41, 81920
    s_add_u32 s51, s59, 36864
    buffer_load_dwordx4 v1, s[20:23], s51 offen lds
    v_mfma_f32_16x16x32_bf16 v[48:51], v[140:143], v[160:163], v[48:51]
    v_mfma_f32_16x16x32_bf16 v[52:55], v[144:147], v[156:159], v[52:55]
    s_add_u32 m0, s41, 86016
    s_add_u32 s51, s59, 46080
    buffer_load_dwordx4 v2, s[20:23], s51 offen lds
    v_mfma_f32_16x16x32_bf16 v[56:59], v[144:147], v[160:163], v[56:59]
    v_mfma_f32_16x16x32_bf16 v[60:63], v[148:151], v[156:159], v[60:63]
    v_mfma_f32_16x16x32_bf16 v[64:67], v[148:151], v[160:163], v[64:67]
    s_add_u32 m0, s41, 90112
    s_add_u32 s51, s59, 55296
    buffer_load_dwordx4 v1, s[20:23], s51 offen lds
    v_mfma_f32_16x16x32_bf16 v[68:71], v[152:155], v[156:159], v[68:71]
    v_mfma_f32_16x16x32_bf16 v[72:75], v[152:155], v[160:163], v[72:75]
    s_add_u32 m0, s41, 94208
    s_add_u32 s51, s59, 64512
    buffer_load_dwordx4 v2, s[20:23], s51 offen lds
    s_waitcnt vmcnt(12)
    s_barrier
    v_subrev_u32 v164, 98304, v164
    v_subrev_u32 v165, 98304, v165
    v_subrev_u32 v166, 98304, v166
    v_subrev_u32 v167, 98304, v167
    v_subrev_u32 v168, 98304, v168
    v_subrev_u32 v169, 98304, v169
    v_subrev_u32 v170, 98304, v170
    v_subrev_u32 v171, 98304, v171
    v_subrev_u32 v172, 98304, v172
    v_subrev_u32 v173, 98304, v173
    v_subrev_u32 v174, 98304, v174
    ds_read_b128 v[112:115], v173 offset:0
    ds_read_b128 v[116:119], v173 offset:2048
    ds_read_b64_tr_b16 v[76:77], v164 offset:16384
    ds_read_b64_tr_b16 v[78:79], v164 offset:18432
    ds_read_b64_tr_b16 v[80:81], v165 offset:16384
    ds_read_b64_tr_b16 v[82:83], v165 offset:18432
    ds_read_b64_tr_b16 v[84:85], v166 offset:16384
    ds_read_b64_tr_b16 v[86:87], v166 offset:18432
    ds_read_b64_tr_b16 v[88:89], v167 offset:16384
    ds_read_b64_tr_b16 v[90:91], v167 offset:18432
    ds_read_b64_tr_b16 v[92:93], v168 offset:16384
    ds_read_b64_tr_b16 v[94:95], v168 offset:18432
    ds_read_b64_tr_b16 v[96:97], v169 offset:16384
    ds_read_b64_tr_b16 v[98:99], v169 offset:18432
    ds_read_b64_tr_b16 v[100:101], v170 offset:16384
    ds_read_b64_tr_b16 v[102:103], v170 offset:18432
    ds_read_b64_tr_b16 v[104:105], v171 offset:16384
    ds_read_b64_tr_b16 v[106:107], v171 offset:18432
    ds_read_b64_tr_b16 v[108:109], v172 offset:16384
    ds_read_b64_tr_b16 v[110:111], v172 offset:18432
    s_waitcnt lgkmcnt(0)
    v_mfma_f32_16x16x32_bf16 v[4:7], v[76:79], v[112:115], v[4:7]
    ds_read_b128 v[156:159], v174 offset:0
    v_mfma_f32_16x16x32_bf16 v[8:11], v[76:79], v[116:119], v[8:11]
    ds_read_b128 v[160:163], v174 offset:2048
    v_mfma_f32_16x16x32_bf16 v[12:15], v[80:83], v[112:115], v[12:15]
    ds_read_b64_tr_b16 v[120:121], v164 offset:32768
    ds_read_b64_tr_b16 v[122:123], v164 offset:34816
    v_mfma_f32_16x16x32_bf16 v[16:19], v[80:83], v[116:119], v[16:19]
    ds_read_b64_tr_b16 v[124:125], v165 offset:32768
    v_mfma_f32_16x16x32_bf16 v[20:23], v[84:87], v[112:115], v[20:23]
    ds_read_b64_tr_b16 v[126:127], v165 offset:34816
    ds_read_b64_tr_b16 v[128:129], v166 offset:32768
    v_mfma_f32_16x16x32_bf16 v[24:27], v[84:87], v[116:119], v[24:27]
    ds_read_b64_tr_b16 v[130:131], v166 offset:34816
    v_mfma_f32_16x16x32_bf16 v[28:31], v[88:91], v[112:115], v[28:31]
    ds_read_b64_tr_b16 v[132:133], v167 offset:32768
    ds_read_b64_tr_b16 v[134:135], v167 offset:34816
    v_mfma_f32_16x16x32_bf16 v[32:35], v[88:91], v[116:119], v[32:35]
    ds_read_b64_tr_b16 v[136:137], v168 offset:32768
    v_mfma_f32_16x16x32_bf16 v[36:39], v[92:95], v[112:115], v[36:39]
    ds_read_b64_tr_b16 v[138:139], v168 offset:34816
    ds_read_b64_tr_b16 v[140:141], v169 offset:32768
    v_mfma_f32_16x16x32_bf16 v[40:43], v[92:95], v[116:119], v[40:43]
    ds_read_b64_tr_b16 v[142:143], v169 offset:34816
    v_mfma_f32_16x16x32_bf16 v[44:47], v[96:99], v[112:115], v[44:47]
    ds_read_b64_tr_b16 v[144:145], v170 offset:32768
    v_mfma_f32_16x16x32_bf16 v[48:51], v[96:99], v[116:119], v[48:51]
    ds_read_b64_tr_b16 v[146:147], v170 offset:34816
    ds_read_b64_tr_b16 v[148:149], v171 offset:32768
    v_mfma_f32_16x16x32_bf16 v[52:55], v[100:103], v[112:115], v[52:55]
    ds_read_b64_tr_b16 v[150:151], v171 offset:34816
    v_mfma_f32_16x16x32_bf16 v[56:59], v[100:103], v[116:119], v[56:59]
    ds_read_b64_tr_b16 v[152:153], v172 offset:32768
    ds_read_b64_tr_b16 v[154:155], v172 offset:34816
    v_mfma_f32_16x16x32_bf16 v[60:63], v[104:107], v[112:115], v[60:63]
    s_add_u32 s58, s58, 128
    s_add_u32 s59, s59, 73728
    v_mfma_f32_16x16x32_bf16 v[64:67], v[104:107], v[116:119], v[64:67]
    s_add_u32 m0, s41, 98304
    s_add_u32 s51, s58, 0
    buffer_load_dwordx4 v0, s[16:19], s51 offen lds
    s_add_u32 m0, s41, 102400
    s_add_u32 s51, s58, 294912
    buffer_load_dwordx4 v0, s[16:19], s51 offen lds
    v_mfma_f32_16x16x32_bf16 v[68:71], v[108:111], v[112:115], v[68:71]
    s_add_u32 m0, s41, 106496
    s_add_u32 s51, s58, 589824
    buffer_load_dwordx4 v0, s[16:19], s51 offen lds
    v_mfma_f32_16x16x32_bf16 v[72:75], v[108:111], v[116:119], v[72:75]
    s_add_u32 m0, s41, 110592
    s_add_u32 s51, s58, 884736
    buffer_load_dwordx4 v0, s[16:19], s51 offen lds
    s_add_u32 m0, s41, 114688
    s_add_u32 s51, s59, 0
    buffer_load_dwordx4 v1, s[20:23], s51 offen lds
    s_waitcnt lgkmcnt(0)
    v_mfma_f32_16x16x32_bf16 v[4:7], v[120:123], v[156:159], v[4:7]
    v_mfma_f32_16x16x32_bf16 v[8:11], v[120:123], v[160:163], v[8:11]
    v_mfma_f32_16x16x32_bf16 v[12:15], v[124:127], v[156:159], v[12:15]
    s_add_u32 m0, s41, 118784
    s_add_u32 s51, s59, 9216
    buffer_load_dwordx4 v2, s[20:23], s51 offen lds
    v_mfma_f32_16x16x32_bf16 v[16:19], v[124:127], v[160:163], v[16:19]
    v_mfma_f32_16x16x32_bf16 v[20:23], v[128:131], v[156:159], v[20:23]
    v_mfma_f32_16x16x32_bf16 v[24:27], v[128:131], v[160:163], v[24:27]
    s_add_u32 m0, s41, 122880
    s_add_u32 s51, s59, 18432
    buffer_load_dwordx4 v1, s[20:23], s51 offen lds
    v_mfma_f32_16x16x32_bf16 v[28:31], v[132:135], v[156:159], v[28:31]
    v_mfma_f32_16x16x32_bf16 v[32:35], v[132:135], v[160:163], v[32:35]
    s_add_u32 m0, s41, 126976
    s_add_u32 s51, s59, 27648
    buffer_load_dwordx4 v2, s[20:23], s51 offen lds
    v_mfma_f32_16x16x32_bf16 v[36:39], v[136:139], v[156:159], v[36:39]
    v_mfma_f32_16x16x32_bf16 v[40:43], v[136:139], v[160:163], v[40:43]
    v_mfma_f32_16x16x32_bf16 v[44:47], v[140:143], v[156:159], v[44:47]
    s_add_u32 m0, s41, 131072
    s_add_u32 s51, s59, 36864
    buffer_load_dwordx4 v1, s[20:23], s51 offen lds
    v_mfma_f32_16x16x32_bf16 v[48:51], v[140:143], v[160:163], v[48:51]
    v_mfma_f32_16x16x32_bf16 v[52:55], v[144:147], v[156:159], v[52:55]
    s_add_u32 m0, s41, 135168
    s_add_u32 s51, s59, 46080
    buffer_load_dwordx4 v2, s[20:23], s51 offen lds
    v_mfma_f32_16x16x32_bf16 v[56:59], v[144:147], v[160:163], v[56:59]
    v_mfma_f32_16x16x32_bf16 v[60:63], v[148:151], v[156:159], v[60:63]
    v_mfma_f32_16x16x32_bf16 v[64:67], v[148:151], v[160:163], v[64:67]
    s_add_u32 m0, s41, 139264
    s_add_u32 s51, s59, 55296
    buffer_load_dwordx4 v1, s[20:23], s51 offen lds
    v_mfma_f32_16x16x32_bf16 v[68:71], v[152:155], v[156:159], v[68:71]
    v_mfma_f32_16x16x32_bf16 v[72:75], v[152:155], v[160:163], v[72:75]
    s_add_u32 m0, s41, 143360
    s_add_u32 s51, s59, 64512
    buffer_load_dwordx4 v2, s[20:23], s51 offen lds
    s_waitcnt vmcnt(12)
    s_barrier
    v_add_u32 v164, 49152, v164
    v_add_u32 v165, 49152, v165
    v_add_u32 v166, 49152, v166
    v_add_u32 v167, 49152, v167
    v_add_u32 v168, 49152, v168
    v_add_u32 v169, 49152, v169
    v_add_u32 v170, 49152, v170
    v_add_u32 v171, 49152, v171
    v_add_u32 v172, 49152, v172
    v_add_u32 v173, 49152, v173
    v_add_u32 v174, 49152, v174
    ds_read_b128 v[112:115], v173 offset:0
    ds_read_b128 v[116:119], v173 offset:2048
    ds_read_b64_tr_b16 v[76:77], v164 offset:16384
    ds_read_b64_tr_b16 v[78:79], v164 offset:18432
    ds_read_b64_tr_b16 v[80:81], v165 offset:16384
    ds_read_b64_tr_b16 v[82:83], v165 offset:18432
    ds_read_b64_tr_b16 v[84:85], v166 offset:16384
    ds_read_b64_tr_b16 v[86:87], v166 offset:18432
    ds_read_b64_tr_b16 v[88:89], v167 offset:16384
    ds_read_b64_tr_b16 v[90:91], v167 offset:18432
    ds_read_b64_tr_b16 v[92:93], v168 offset:16384
    ds_read_b64_tr_b16 v[94:95], v168 offset:18432
    ds_read_b64_tr_b16 v[96:97], v169 offset:16384
    ds_read_b64_tr_b16 v[98:99], v169 offset:18432
    ds_read_b64_tr_b16 v[100:101], v170 offset:16384
    ds_read_b64_tr_b16 v[102:103], v170 offset:18432
    ds_read_b64_tr_b16 v[104:105], v171 offset:16384
    ds_read_b64_tr_b16 v[106:107], v171 offset:18432
    ds_read_b64_tr_b16 v[108:109], v172 offset:16384
    ds_read_b64_tr_b16 v[110:111], v172 offset:18432
    s_waitcnt lgkmcnt(0)
    v_mfma_f32_16x16x32_bf16 v[4:7], v[76:79], v[112:115], v[4:7]
    ds_read_b128 v[156:159], v174 offset:0
    v_mfma_f32_16x16x32_bf16 v[8:11], v[76:79], v[116:119], v[8:11]
    ds_read_b128 v[160:163], v174 offset:2048
    v_mfma_f32_16x16x32_bf16 v[12:15], v[80:83], v[112:115], v[12:15]
    ds_read_b64_tr_b16 v[120:121], v164 offset:32768
    ds_read_b64_tr_b16 v[122:123], v164 offset:34816
    v_mfma_f32_16x16x32_bf16 v[16:19], v[80:83], v[116:119], v[16:19]
    ds_read_b64_tr_b16 v[124:125], v165 offset:32768
    v_mfma_f32_16x16x32_bf16 v[20:23], v[84:87], v[112:115], v[20:23]
    ds_read_b64_tr_b16 v[126:127], v165 offset:34816
    ds_read_b64_tr_b16 v[128:129], v166 offset:32768
    v_mfma_f32_16x16x32_bf16 v[24:27], v[84:87], v[116:119], v[24:27]
    ds_read_b64_tr_b16 v[130:131], v166 offset:34816
    v_mfma_f32_16x16x32_bf16 v[28:31], v[88:91], v[112:115], v[28:31]
    ds_read_b64_tr_b16 v[132:133], v167 offset:32768
    ds_read_b64_tr_b16 v[134:135], v167 offset:34816
    v_mfma_f32_16x16x32_bf16 v[32:35], v[88:91], v[116:119], v[32:35]
    ds_read_b64_tr_b16 v[136:137], v168 offset:32768
    v_mfma_f32_16x16x32_bf16 v[36:39], v[92:95], v[112:115], v[36:39]
    ds_read_b64_tr_b16 v[138:139], v168 offset:34816
    ds_read_b64_tr_b16 v[140:141], v169 offset:32768
    v_mfma_f32_16x16x32_bf16 v[40:43], v[92:95], v[116:119], v[40:43]
    ds_read_b64_tr_b16 v[142:143], v169 offset:34816
    v_mfma_f32_16x16x32_bf16 v[44:47], v[96:99], v[112:115], v[44:47]
    ds_read_b64_tr_b16 v[144:145], v170 offset:32768
    v_mfma_f32_16x16x32_bf16 v[48:51], v[96:99], v[116:119], v[48:51]
    ds_read_b64_tr_b16 v[146:147], v170 offset:34816
    ds_read_b64_tr_b16 v[148:149], v171 offset:32768
    v_mfma_f32_16x16x32_bf16 v[52:55], v[100:103], v[112:115], v[52:55]
    ds_read_b64_tr_b16 v[150:151], v171 offset:34816
    v_mfma_f32_16x16x32_bf16 v[56:59], v[100:103], v[116:119], v[56:59]
    ds_read_b64_tr_b16 v[152:153], v172 offset:32768
    ds_read_b64_tr_b16 v[154:155], v172 offset:34816
    v_mfma_f32_16x16x32_bf16 v[60:63], v[104:107], v[112:115], v[60:63]
    s_add_u32 s58, s58, 128
    s_add_u32 s59, s59, 73728
    v_mfma_f32_16x16x32_bf16 v[64:67], v[104:107], v[116:119], v[64:67]
    s_add_u32 m0, s41, 0
    s_add_u32 s51, s58, 0
    buffer_load_dwordx4 v0, s[16:19], s51 offen lds
    s_add_u32 m0, s41, 4096
    s_add_u32 s51, s58, 294912
    buffer_load_dwordx4 v0, s[16:19], s51 offen lds
    v_mfma_f32_16x16x32_bf16 v[68:71], v[108:111], v[112:115], v[68:71]
    s_add_u32 m0, s41, 8192
    s_add_u32 s51, s58, 589824
    buffer_load_dwordx4 v0, s[16:19], s51 offen lds
    v_mfma_f32_16x16x32_bf16 v[72:75], v[108:111], v[116:119], v[72:75]
    s_add_u32 m0, s41, 12288
    s_add_u32 s51, s58, 884736
    buffer_load_dwordx4 v0, s[16:19], s51 offen lds
    s_add_u32 m0, s41, 16384
    s_add_u32 s51, s59, 0
    buffer_load_dwordx4 v1, s[20:23], s51 offen lds
    s_waitcnt lgkmcnt(0)
    v_mfma_f32_16x16x32_bf16 v[4:7], v[120:123], v[156:159], v[4:7]
    v_mfma_f32_16x16x32_bf16 v[8:11], v[120:123], v[160:163], v[8:11]
    v_mfma_f32_16x16x32_bf16 v[12:15], v[124:127], v[156:159], v[12:15]
    s_add_u32 m0, s41, 20480
    s_add_u32 s51, s59, 9216
    buffer_load_dwordx4 v2, s[20:23], s51 offen lds
    v_mfma_f32_16x16x32_bf16 v[16:19], v[124:127], v[160:163], v[16:19]
    v_mfma_f32_16x16x32_bf16 v[20:23], v[128:131], v[156:159], v[20:23]
    v_mfma_f32_16x16x32_bf16 v[24:27], v[128:131], v[160:163], v[24:27]
    s_add_u32 m0, s41, 24576
    s_add_u32 s51, s59, 18432
    buffer_load_dwordx4 v1, s[20:23], s51 offen lds
    v_mfma_f32_16x16x32_bf16 v[28:31], v[132:135], v[156:159], v[28:31]
    v_mfma_f32_16x16x32_bf16 v[32:35], v[132:135], v[160:163], v[32:35]
    s_add_u32 m0, s41, 28672
    s_add_u32 s51, s59, 27648
    buffer_load_dwordx4 v2, s[20:23], s51 offen lds
    v_mfma_f32_16x16x32_bf16 v[36:39], v[136:139], v[156:159], v[36:39]
    v_mfma_f32_16x16x32_bf16 v[40:43], v[136:139], v[160:163], v[40:43]
    v_mfma_f32_16x16x32_bf16 v[44:47], v[140:143], v[156:159], v[44:47]
    s_add_u32 m0, s41, 32768
    s_add_u32 s51, s59, 36864
    buffer_load_dwordx4 v1, s[20:23], s51 offen lds
    v_mfma_f32_16x16x32_bf16 v[48:51], v[140:143], v[160:163], v[48:51]
    v_mfma_f32_16x16x32_bf16 v[52:55], v[144:147], v[156:159], v[52:55]
    s_add_u32 m0, s41, 36864
    s_add_u32 s51, s59, 46080
    buffer_load_dwordx4 v2, s[20:23], s51 offen lds
    v_mfma_f32_16x16x32_bf16 v[56:59], v[144:147], v[160:163], v[56:59]
    v_mfma_f32_16x16x32_bf16 v[60:63], v[148:151], v[156:159], v[60:63]
    v_mfma_f32_16x16x32_bf16 v[64:67], v[148:151], v[160:163], v[64:67]
    s_add_u32 m0, s41, 40960
    s_add_u32 s51, s59, 55296
    buffer_load_dwordx4 v1, s[20:23], s51 offen lds
    v_mfma_f32_16x16x32_bf16 v[68:71], v[152:155], v[156:159], v[68:71]
    v_mfma_f32_16x16x32_bf16 v[72:75], v[152:155], v[160:163], v[72:75]
    s_add_u32 m0, s41, 45056
    s_add_u32 s51, s59, 64512
    buffer_load_dwordx4 v2, s[20:23], s51 offen lds
    s_waitcnt vmcnt(12)
    s_barrier
    v_add_u32 v164, 49152, v164
    v_add_u32 v165, 49152, v165
    v_add_u32 v166, 49152, v166
    v_add_u32 v167, 49152, v167
    v_add_u32 v168, 49152, v168
    v_add_u32 v169, 49152, v169
    v_add_u32 v170, 49152, v170
    v_add_u32 v171, 49152, v171
    v_add_u32 v172, 49152, v172
    v_add_u32 v173, 49152, v173
    v_add_u32 v174, 49152, v174
    ds_read_b128 v[112:115], v173 offset:0
    ds_read_b128 v[116:119], v173 offset:2048
    ds_read_b64_tr_b16 v[76:77], v164 offset:16384
    ds_read_b64_tr_b16 v[78:79], v164 offset:18432
    ds_read_b64_tr_b16 v[80:81], v165 offset:16384
    ds_read_b64_tr_b16 v[82:83], v165 offset:18432
    ds_read_b64_tr_b16 v[84:85], v166 offset:16384
    ds_read_b64_tr_b16 v[86:87], v166 offset:18432
    ds_read_b64_tr_b16 v[88:89], v167 offset:16384
    ds_read_b64_tr_b16 v[90:91], v167 offset:18432
    ds_read_b64_tr_b16 v[92:93], v168 offset:16384
    ds_read_b64_tr_b16 v[94:95], v168 offset:18432
    ds_read_b64_tr_b16 v[96:97], v169 offset:16384
    ds_read_b64_tr_b16 v[98:99], v169 offset:18432
    ds_read_b64_tr_b16 v[100:101], v170 offset:16384
    ds_read_b64_tr_b16 v[102:103], v170 offset:18432
    ds_read_b64_tr_b16 v[104:105], v171 offset:16384
    ds_read_b64_tr_b16 v[106:107], v171 offset:18432
    ds_read_b64_tr_b16 v[108:109], v172 offset:16384
    ds_read_b64_tr_b16 v[110:111], v172 offset:18432
    s_waitcnt lgkmcnt(0)
    v_mfma_f32_16x16x32_bf16 v[4:7], v[76:79], v[112:115], v[4:7]
    ds_read_b128 v[156:159], v174 offset:0
    v_mfma_f32_16x16x32_bf16 v[8:11], v[76:79], v[116:119], v[8:11]
    ds_read_b128 v[160:163], v174 offset:2048
    v_mfma_f32_16x16x32_bf16 v[12:15], v[80:83], v[112:115], v[12:15]
    ds_read_b64_tr_b16 v[120:121], v164 offset:32768
    ds_read_b64_tr_b16 v[122:123], v164 offset:34816
    v_mfma_f32_16x16x32_bf16 v[16:19], v[80:83], v[116:119], v[16:19]
    ds_read_b64_tr_b16 v[124:125], v165 offset:32768
    v_mfma_f32_16x16x32_bf16 v[20:23], v[84:87], v[112:115], v[20:23]
    ds_read_b64_tr_b16 v[126:127], v165 offset:34816
    ds_read_b64_tr_b16 v[128:129], v166 offset:32768
    v_mfma_f32_16x16x32_bf16 v[24:27], v[84:87], v[116:119], v[24:27]
    ds_read_b64_tr_b16 v[130:131], v166 offset:34816
    v_mfma_f32_16x16x32_bf16 v[28:31], v[88:91], v[112:115], v[28:31]
    ds_read_b64_tr_b16 v[132:133], v167 offset:32768
    ds_read_b64_tr_b16 v[134:135], v167 offset:34816
    v_mfma_f32_16x16x32_bf16 v[32:35], v[88:91], v[116:119], v[32:35]
    ds_read_b64_tr_b16 v[136:137], v168 offset:32768
    v_mfma_f32_16x16x32_bf16 v[36:39], v[92:95], v[112:115], v[36:39]
    ds_read_b64_tr_b16 v[138:139], v168 offset:34816
    ds_read_b64_tr_b16 v[140:141], v169 offset:32768
    v_mfma_f32_16x16x32_bf16 v[40:43], v[92:95], v[116:119], v[40:43]
    ds_read_b64_tr_b16 v[142:143], v169 offset:34816
    v_mfma_f32_16x16x32_bf16 v[44:47], v[96:99], v[112:115], v[44:47]
    ds_read_b64_tr_b16 v[144:145], v170 offset:32768
    v_mfma_f32_16x16x32_bf16 v[48:51], v[96:99], v[116:119], v[48:51]
    ds_read_b64_tr_b16 v[146:147], v170 offset:34816
    ds_read_b64_tr_b16 v[148:149], v171 offset:32768
    v_mfma_f32_16x16x32_bf16 v[52:55], v[100:103], v[112:115], v[52:55]
    ds_read_b64_tr_b16 v[150:151], v171 offset:34816
    v_mfma_f32_16x16x32_bf16 v[56:59], v[100:103], v[116:119], v[56:59]
    ds_read_b64_tr_b16 v[152:153], v172 offset:32768
    ds_read_b64_tr_b16 v[154:155], v172 offset:34816
    v_mfma_f32_16x16x32_bf16 v[60:63], v[104:107], v[112:115], v[60:63]
    s_add_u32 s58, s58, 128
    s_add_u32 s59, s59, 73728
    v_mfma_f32_16x16x32_bf16 v[64:67], v[104:107], v[116:119], v[64:67]
    s_add_u32 m0, s41, 49152
    s_add_u32 s51, s58, 0
    buffer_load_dwordx4 v0, s[16:19], s51 offen lds
    s_add_u32 m0, s41, 53248
    s_add_u32 s51, s58, 294912
    buffer_load_dwordx4 v0, s[16:19], s51 offen lds
    v_mfma_f32_16x16x32_bf16 v[68:71], v[108:111], v[112:115], v[68:71]
    s_add_u32 m0, s41, 57344
    s_add_u32 s51, s58, 589824
    buffer_load_dwordx4 v0, s[16:19], s51 offen lds
    v_mfma_f32_16x16x32_bf16 v[72:75], v[108:111], v[116:119], v[72:75]
    s_add_u32 m0, s41, 61440
    s_add_u32 s51, s58, 884736
    buffer_load_dwordx4 v0, s[16:19], s51 offen lds
    s_add_u32 m0, s41, 65536
    s_add_u32 s51, s59, 0
    buffer_load_dwordx4 v1, s[20:23], s51 offen lds
    s_waitcnt lgkmcnt(0)
    v_mfma_f32_16x16x32_bf16 v[4:7], v[120:123], v[156:159], v[4:7]
    v_mfma_f32_16x16x32_bf16 v[8:11], v[120:123], v[160:163], v[8:11]
    v_mfma_f32_16x16x32_bf16 v[12:15], v[124:127], v[156:159], v[12:15]
    s_add_u32 m0, s41, 69632
    s_add_u32 s51, s59, 9216
    buffer_load_dwordx4 v2, s[20:23], s51 offen lds
    v_mfma_f32_16x16x32_bf16 v[16:19], v[124:127], v[160:163], v[16:19]
    v_mfma_f32_16x16x32_bf16 v[20:23], v[128:131], v[156:159], v[20:23]
    v_mfma_f32_16x16x32_bf16 v[24:27], v[128:131], v[160:163], v[24:27]
    s_add_u32 m0, s41, 73728
    s_add_u32 s51, s59, 18432
    buffer_load_dwordx4 v1, s[20:23], s51 offen lds
    v_mfma_f32_16x16x32_bf16 v[28:31], v[132:135], v[156:159], v[28:31]
    v_mfma_f32_16x16x32_bf16 v[32:35], v[132:135], v[160:163], v[32:35]
    s_add_u32 m0, s41, 77824
    s_add_u32 s51, s59, 27648
    buffer_load_dwordx4 v2, s[20:23], s51 offen lds
    v_mfma_f32_16x16x32_bf16 v[36:39], v[136:139], v[156:159], v[36:39]
    v_mfma_f32_16x16x32_bf16 v[40:43], v[136:139], v[160:163], v[40:43]
    v_mfma_f32_16x16x32_bf16 v[44:47], v[140:143], v[156:159], v[44:47]
    s_add_u32 m0, s41, 81920
    s_add_u32 s51, s59, 36864
    buffer_load_dwordx4 v1, s[20:23], s51 offen lds
    v_mfma_f32_16x16x32_bf16 v[48:51], v[140:143], v[160:163], v[48:51]
    v_mfma_f32_16x16x32_bf16 v[52:55], v[144:147], v[156:159], v[52:55]
    s_add_u32 m0, s41, 86016
    s_add_u32 s51, s59, 46080
    buffer_load_dwordx4 v2, s[20:23], s51 offen lds
    v_mfma_f32_16x16x32_bf16 v[56:59], v[144:147], v[160:163], v[56:59]
    v_mfma_f32_16x16x32_bf16 v[60:63], v[148:151], v[156:159], v[60:63]
    v_mfma_f32_16x16x32_bf16 v[64:67], v[148:151], v[160:163], v[64:67]
    s_add_u32 m0, s41, 90112
    s_add_u32 s51, s59, 55296
    buffer_load_dwordx4 v1, s[20:23], s51 offen lds
    v_mfma_f32_16x16x32_bf16 v[68:71], v[152:155], v[156:159], v[68:71]
    v_mfma_f32_16x16x32_bf16 v[72:75], v[152:155], v[160:163], v[72:75]
    s_add_u32 m0, s41, 94208
    s_add_u32 s51, s59, 64512
    buffer_load_dwordx4 v2, s[20:23], s51 offen lds
    s_waitcnt vmcnt(12)
    s_barrier
    v_subrev_u32 v164, 98304, v164
    v_subrev_u32 v165, 98304, v165
    v_subrev_u32 v166, 98304, v166
    v_subrev_u32 v167, 98304, v167
    v_subrev_u32 v168, 98304, v168
    v_subrev_u32 v169, 98304, v169
    v_subrev_u32 v170, 98304, v170
    v_subrev_u32 v171, 98304, v171
    v_subrev_u32 v172, 98304, v172
    v_subrev_u32 v173, 98304, v173
    v_subrev_u32 v174, 98304, v174
    ds_read_b128 v[112:115], v173 offset:0
    ds_read_b128 v[116:119], v173 offset:2048
    ds_read_b64_tr_b16 v[76:77], v164 offset:16384
    ds_read_b64_tr_b16 v[78:79], v164 offset:18432
    ds_read_b64_tr_b16 v[80:81], v165 offset:16384
    ds_read_b64_tr_b16 v[82:83], v165 offset:18432
    ds_read_b64_tr_b16 v[84:85], v166 offset:16384
    ds_read_b64_tr_b16 v[86:87], v166 offset:18432
    ds_read_b64_tr_b16 v[88:89], v167 offset:16384
    ds_read_b64_tr_b16 v[90:91], v167 offset:18432
    ds_read_b64_tr_b16 v[92:93], v168 offset:16384
    ds_read_b64_tr_b16 v[94:95], v168 offset:18432
    ds_read_b64_tr_b16 v[96:97], v169 offset:16384
    ds_read_b64_tr_b16 v[98:99], v169 offset:18432
    ds_read_b64_tr_b16 v[100:101], v170 offset:16384
    ds_read_b64_tr_b16 v[102:103], v170 offset:18432
    ds_read_b64_tr_b16 v[104:105], v171 offset:16384
    ds_read_b64_tr_b16 v[106:107], v171 offset:18432
    ds_read_b64_tr_b16 v[108:109], v172 offset:16384
    ds_read_b64_tr_b16 v[110:111], v172 offset:18432
    s_waitcnt lgkmcnt(0)
    v_mfma_f32_16x16x32_bf16 v[4:7], v[76:79], v[112:115], v[4:7]
    ds_read_b128 v[156:159], v174 offset:0
    v_mfma_f32_16x16x32_bf16 v[8:11], v[76:79], v[116:119], v[8:11]
    ds_read_b128 v[160:163], v174 offset:2048
    v_mfma_f32_16x16x32_bf16 v[12:15], v[80:83], v[112:115], v[12:15]
    ds_read_b64_tr_b16 v[120:121], v164 offset:32768
    ds_read_b64_tr_b16 v[122:123], v164 offset:34816
    v_mfma_f32_16x16x32_bf16 v[16:19], v[80:83], v[116:119], v[16:19]
    ds_read_b64_tr_b16 v[124:125], v165 offset:32768
    v_mfma_f32_16x16x32_bf16 v[20:23], v[84:87], v[112:115], v[20:23]
    ds_read_b64_tr_b16 v[126:127], v165 offset:34816
    ds_read_b64_tr_b16 v[128:129], v166 offset:32768
    v_mfma_f32_16x16x32_bf16 v[24:27], v[84:87], v[116:119], v[24:27]
    ds_read_b64_tr_b16 v[130:131], v166 offset:34816
    v_mfma_f32_16x16x32_bf16 v[28:31], v[88:91], v[112:115], v[28:31]
    ds_read_b64_tr_b16 v[132:133], v167 offset:32768
    ds_read_b64_tr_b16 v[134:135], v167 offset:34816
    v_mfma_f32_16x16x32_bf16 v[32:35], v[88:91], v[116:119], v[32:35]
    ds_read_b64_tr_b16 v[136:137], v168 offset:32768
    v_mfma_f32_16x16x32_bf16 v[36:39], v[92:95], v[112:115], v[36:39]
    ds_read_b64_tr_b16 v[138:139], v168 offset:34816
    ds_read_b64_tr_b16 v[140:141], v169 offset:32768
    v_mfma_f32_16x16x32_bf16 v[40:43], v[92:95], v[116:119], v[40:43]
    ds_read_b64_tr_b16 v[142:143], v169 offset:34816
    v_mfma_f32_16x16x32_bf16 v[44:47], v[96:99], v[112:115], v[44:47]
    ds_read_b64_tr_b16 v[144:145], v170 offset:32768
    v_mfma_f32_16x16x32_bf16 v[48:51], v[96:99], v[116:119], v[48:51]
    ds_read_b64_tr_b16 v[146:147], v170 offset:34816
    ds_read_b64_tr_b16 v[148:149], v171 offset:32768
    v_mfma_f32_16x16x32_bf16 v[52:55], v[100:103], v[112:115], v[52:55]
    ds_read_b64_tr_b16 v[150:151], v171 offset:34816
    v_mfma_f32_16x16x32_bf16 v[56:59], v[100:103], v[116:119], v[56:59]
    ds_read_b64_tr_b16 v[152:153], v172 offset:32768
    ds_read_b64_tr_b16 v[154:155], v172 offset:34816
    v_mfma_f32_16x16x32_bf16 v[60:63], v[104:107], v[112:115], v[60:63]
    s_add_u32 s58, s58, 128
    s_add_u32 s59, s59, 73728
    v_mfma_f32_16x16x32_bf16 v[64:67], v[104:107], v[116:119], v[64:67]
    s_add_u32 m0, s41, 98304
    s_add_u32 s51, s58, 0
    buffer_load_dwordx4 v0, s[16:19], s51 offen lds
    s_add_u32 m0, s41, 102400
    s_add_u32 s51, s58, 294912
    buffer_load_dwordx4 v0, s[16:19], s51 offen lds
    v_mfma_f32_16x16x32_bf16 v[68:71], v[108:111], v[112:115], v[68:71]
    s_add_u32 m0, s41, 106496
    s_add_u32 s51, s58, 589824
    buffer_load_dwordx4 v0, s[16:19], s51 offen lds
    v_mfma_f32_16x16x32_bf16 v[72:75], v[108:111], v[116:119], v[72:75]
    s_add_u32 m0, s41, 110592
    s_add_u32 s51, s58, 884736
    buffer_load_dwordx4 v0, s[16:19], s51 offen lds
    s_add_u32 m0, s41, 114688
    s_add_u32 s51, s59, 0
    buffer_load_dwordx4 v1, s[20:23], s51 offen lds
    s_waitcnt lgkmcnt(0)
    v_mfma_f32_16x16x32_bf16 v[4:7], v[120:123], v[156:159], v[4:7]
    v_mfma_f32_16x16x32_bf16 v[8:11], v[120:123], v[160:163], v[8:11]
    v_mfma_f32_16x16x32_bf16 v[12:15], v[124:127], v[156:159], v[12:15]
    s_add_u32 m0, s41, 118784
    s_add_u32 s51, s59, 9216
    buffer_load_dwordx4 v2, s[20:23], s51 offen lds
    v_mfma_f32_16x16x32_bf16 v[16:19], v[124:127], v[160:163], v[16:19]
    v_mfma_f32_16x16x32_bf16 v[20:23], v[128:131], v[156:159], v[20:23]
    v_mfma_f32_16x16x32_bf16 v[24:27], v[128:131], v[160:163], v[24:27]
    s_add_u32 m0, s41, 122880
    s_add_u32 s51, s59, 18432
    buffer_load_dwordx4 v1, s[20:23], s51 offen lds
    v_mfma_f32_16x16x32_bf16 v[28:31], v[132:135], v[156:159], v[28:31]
    v_mfma_f32_16x16x32_bf16 v[32:35], v[132:135], v[160:163], v[32:35]
    s_add_u32 m0, s41, 126976
    s_add_u32 s51, s59, 27648
    buffer_load_dwordx4 v2, s[20:23], s51 offen lds
    v_mfma_f32_16x16x32_bf16 v[36:39], v[136:139], v[156:159], v[36:39]
    v_mfma_f32_16x16x32_bf16 v[40:43], v[136:139], v[160:163], v[40:43]
    v_mfma_f32_16x16x32_bf16 v[44:47], v[140:143], v[156:159], v[44:47]
    s_add_u32 m0, s41, 131072
    s_add_u32 s51, s59, 36864
    buffer_load_dwordx4 v1, s[20:23], s51 offen lds
    v_mfma_f32_16x16x32_bf16 v[48:51], v[140:143], v[160:163], v[48:51]
    v_mfma_f32_16x16x32_bf16 v[52:55], v[144:147], v[156:159], v[52:55]
    s_add_u32 m0, s41, 135168
    s_add_u32 s51, s59, 46080
    buffer_load_dwordx4 v2, s[20:23], s51 offen lds
    v_mfma_f32_16x16x32_bf16 v[56:59], v[144:147], v[160:163], v[56:59]
    v_mfma_f32_16x16x32_bf16 v[60:63], v[148:151], v[156:159], v[60:63]
    v_mfma_f32_16x16x32_bf16 v[64:67], v[148:151], v[160:163], v[64:67]
    s_add_u32 m0, s41, 139264
    s_add_u32 s51, s59, 55296
    buffer_load_dwordx4 v1, s[20:23], s51 offen lds
    v_mfma_f32_16x16x32_bf16 v[68:71], v[152:155], v[156:159], v[68:71]
    v_mfma_f32_16x16x32_bf16 v[72:75], v[152:155], v[160:163], v[72:75]
    s_add_u32 m0, s41, 143360
    s_add_u32 s51, s59, 64512
    buffer_load_dwordx4 v2, s[20:23], s51 offen lds
    s_waitcnt vmcnt(12)
    s_barrier
    v_add_u32 v164, 49152, v164
    v_add_u32 v165, 49152, v165
    v_add_u32 v166, 49152, v166
    v_add_u32 v167, 49152, v167
    v_add_u32 v168, 49152, v168
    v_add_u32 v169, 49152, v169
    v_add_u32 v170, 49152, v170
    v_add_u32 v171, 49152, v171
    v_add_u32 v172, 49152, v172
    v_add_u32 v173, 49152, v173
    v_add_u32 v174, 49152, v174
    ds_read_b128 v[112:115], v173 offset:0
    ds_read_b128 v[116:119], v173 offset:2048
    ds_read_b64_tr_b16 v[76:77], v164 offset:16384
    ds_read_b64_tr_b16 v[78:79], v164 offset:18432
    ds_read_b64_tr_b16 v[80:81], v165 offset:16384
    ds_read_b64_tr_b16 v[82:83], v165 offset:18432
    ds_read_b64_tr_b16 v[84:85], v166 offset:16384
    ds_read_b64_tr_b16 v[86:87], v166 offset:18432
    ds_read_b64_tr_b16 v[88:89], v167 offset:16384
    ds_read_b64_tr_b16 v[90:91], v167 offset:18432
    ds_read_b64_tr_b16 v[92:93], v168 offset:16384
    ds_read_b64_tr_b16 v[94:95], v168 offset:18432
    ds_read_b64_tr_b16 v[96:97], v169 offset:16384
    ds_read_b64_tr_b16 v[98:99], v169 offset:18432
    ds_read_b64_tr_b16 v[100:101], v170 offset:16384
    ds_read_b64_tr_b16 v[102:103], v170 offset:18432
    ds_read_b64_tr_b16 v[104:105], v171 offset:16384
    ds_read_b64_tr_b16 v[106:107], v171 offset:18432
    ds_read_b64_tr_b16 v[108:109], v172 offset:16384
    ds_read_b64_tr_b16 v[110:111], v172 offset:18432
    s_waitcnt lgkmcnt(0)
    v_mfma_f32_16x16x32_bf16 v[4:7], v[76:79], v[112:115], v[4:7]
    ds_read_b128 v[156:159], v174 offset:0
    v_mfma_f32_16x16x32_bf16 v[8:11], v[76:79], v[116:119], v[8:11]
    ds_read_b128 v[160:163], v174 offset:2048
    v_mfma_f32_16x16x32_bf16 v[12:15], v[80:83], v[112:115], v[12:15]
    ds_read_b64_tr_b16 v[120:121], v164 offset:32768
    v_mfma_f32_16x16x32_bf16 v[16:19], v[80:83], v[116:119], v[16:19]
    ds_read_b64_tr_b16 v[122:123], v164 offset:34816
    v_mfma_f32_16x16x32_bf16 v[20:23], v[84:87], v[112:115], v[20:23]
    ds_read_b64_tr_b16 v[124:125], v165 offset:32768
    v_mfma_f32_16x16x32_bf16 v[24:27], v[84:87], v[116:119], v[24:27]
    ds_read_b64_tr_b16 v[126:127], v165 offset:34816
    v_mfma_f32_16x16x32_bf16 v[28:31], v[88:91], v[112:115], v[28:31]
    ds_read_b64_tr_b16 v[128:129], v166 offset:32768
    v_mfma_f32_16x16x32_bf16 v[32:35], v[88:91], v[116:119], v[32:35]
    ds_read_b64_tr_b16 v[130:131], v166 offset:34816
    v_mfma_f32_16x16x32_bf16 v[36:39], v[92:95], v[112:115], v[36:39]
    ds_read_b64_tr_b16 v[132:133], v167 offset:32768
    ds_read_b64_tr_b16 v[134:135], v167 offset:34816
    v_mfma_f32_16x16x32_bf16 v[40:43], v[92:95], v[116:119], v[40:43]
    ds_read_b64_tr_b16 v[136:137], v168 offset:32768
    v_mfma_f32_16x16x32_bf16 v[44:47], v[96:99], v[112:115], v[44:47]
    ds_read_b64_tr_b16 v[138:139], v168 offset:34816
    v_mfma_f32_16x16x32_bf16 v[48:51], v[96:99], v[116:119], v[48:51]
    ds_read_b64_tr_b16 v[140:141], v169 offset:32768
    v_mfma_f32_16x16x32_bf16 v[52:55], v[100:103], v[112:115], v[52:55]
    ds_read_b64_tr_b16 v[142:143], v169 offset:34816
    v_mfma_f32_16x16x32_bf16 v[56:59], v[100:103], v[116:119], v[56:59]
    ds_read_b64_tr_b16 v[144:145], v170 offset:32768
    v_mfma_f32_16x16x32_bf16 v[60:63], v[104:107], v[112:115], v[60:63]
    ds_read_b64_tr_b16 v[146:147], v170 offset:34816
    v_mfma_f32_16x16x32_bf16 v[64:67], v[104:107], v[116:119], v[64:67]
    ds_read_b64_tr_b16 v[148:149], v171 offset:32768
    v_mfma_f32_16x16x32_bf16 v[68:71], v[108:111], v[112:115], v[68:71]
    ds_read_b64_tr_b16 v[150:151], v171 offset:34816
    v_mfma_f32_16x16x32_bf16 v[72:75], v[108:111], v[116:119], v[72:75]
    ds_read_b64_tr_b16 v[152:153], v172 offset:32768
    ds_read_b64_tr_b16 v[154:155], v172 offset:34816
    s_waitcnt lgkmcnt(0)
    v_mfma_f32_16x16x32_bf16 v[4:7], v[120:123], v[156:159], v[4:7]
    v_mfma_f32_16x16x32_bf16 v[8:11], v[120:123], v[160:163], v[8:11]
    v_mfma_f32_16x16x32_bf16 v[12:15], v[124:127], v[156:159], v[12:15]
    v_mfma_f32_16x16x32_bf16 v[16:19], v[124:127], v[160:163], v[16:19]
    v_mfma_f32_16x16x32_bf16 v[20:23], v[128:131], v[156:159], v[20:23]
    v_mfma_f32_16x16x32_bf16 v[24:27], v[128:131], v[160:163], v[24:27]
    v_mfma_f32_16x16x32_bf16 v[28:31], v[132:135], v[156:159], v[28:31]
    v_mfma_f32_16x16x32_bf16 v[32:35], v[132:135], v[160:163], v[32:35]
    v_mfma_f32_16x16x32_bf16 v[36:39], v[136:139], v[156:159], v[36:39]
    v_mfma_f32_16x16x32_bf16 v[40:43], v[136:139], v[160:163], v[40:43]
    v_mfma_f32_16x16x32_bf16 v[44:47], v[140:143], v[156:159], v[44:47]
    v_mfma_f32_16x16x32_bf16 v[48:51], v[140:143], v[160:163], v[48:51]
    v_mfma_f32_16x16x32_bf16 v[52:55], v[144:147], v[156:159], v[52:55]
    v_mfma_f32_16x16x32_bf16 v[56:59], v[144:147], v[160:163], v[56:59]
    v_mfma_f32_16x16x32_bf16 v[60:63], v[148:151], v[156:159], v[60:63]
    v_mfma_f32_16x16x32_bf16 v[64:67], v[148:151], v[160:163], v[64:67]
    v_mfma_f32_16x16x32_bf16 v[68:71], v[152:155], v[156:159], v[68:71]
    v_mfma_f32_16x16x32_bf16 v[72:75], v[152:155], v[160:163], v[72:75]
    s_waitcnt vmcnt(0)
    s_barrier
    v_add_u32 v164, 49152, v164
    v_add_u32 v165, 49152, v165
    v_add_u32 v166, 49152, v166
    v_add_u32 v167, 49152, v167
    v_add_u32 v168, 49152, v168
    v_add_u32 v169, 49152, v169
    v_add_u32 v170, 49152, v170
    v_add_u32 v171, 49152, v171
    v_add_u32 v172, 49152, v172
    v_add_u32 v173, 49152, v173
    v_add_u32 v174, 49152, v174
    ds_read_b128 v[112:115], v173 offset:0
    ds_read_b128 v[116:119], v173 offset:2048
    ds_read_b64_tr_b16 v[76:77], v164 offset:16384
    ds_read_b64_tr_b16 v[78:79], v164 offset:18432
    ds_read_b64_tr_b16 v[80:81], v165 offset:16384
    ds_read_b64_tr_b16 v[82:83], v165 offset:18432
    ds_read_b64_tr_b16 v[84:85], v166 offset:16384
    ds_read_b64_tr_b16 v[86:87], v166 offset:18432
    ds_read_b64_tr_b16 v[88:89], v167 offset:16384
    ds_read_b64_tr_b16 v[90:91], v167 offset:18432
    ds_read_b64_tr_b16 v[92:93], v168 offset:16384
    ds_read_b64_tr_b16 v[94:95], v168 offset:18432
    ds_read_b64_tr_b16 v[96:97], v169 offset:16384
    ds_read_b64_tr_b16 v[98:99], v169 offset:18432
    ds_read_b64_tr_b16 v[100:101], v170 offset:16384
    ds_read_b64_tr_b16 v[102:103], v170 offset:18432
    ds_read_b64_tr_b16 v[104:105], v171 offset:16384
    ds_read_b64_tr_b16 v[106:107], v171 offset:18432
    ds_read_b64_tr_b16 v[108:109], v172 offset:16384
    ds_read_b64_tr_b16 v[110:111], v172 offset:18432
    s_waitcnt lgkmcnt(0)
    v_mfma_f32_16x16x32_bf16 v[4:7], v[76:79], v[112:115], v[4:7]
    ds_read_b128 v[156:159], v174 offset:0
    v_mfma_f32_16x16x32_bf16 v[8:11], v[76:79], v[116:119], v[8:11]
    ds_read_b128 v[160:163], v174 offset:2048
    v_mfma_f32_16x16x32_bf16 v[12:15], v[80:83], v[112:115], v[12:15]
    ds_read_b64_tr_b16 v[120:121], v164 offset:32768
    v_mfma_f32_16x16x32_bf16 v[16:19], v[80:83], v[116:119], v[16:19]
    ds_read_b64_tr_b16 v[122:123], v164 offset:34816
    v_mfma_f32_16x16x32_bf16 v[20:23], v[84:87], v[112:115], v[20:23]
    ds_read_b64_tr_b16 v[124:125], v165 offset:32768
    v_mfma_f32_16x16x32_bf16 v[24:27], v[84:87], v[116:119], v[24:27]
    ds_read_b64_tr_b16 v[126:127], v165 offset:34816
    v_mfma_f32_16x16x32_bf16 v[28:31], v[88:91], v[112:115], v[28:31]
    ds_read_b64_tr_b16 v[128:129], v166 offset:32768
    v_mfma_f32_16x16x32_bf16 v[32:35], v[88:91], v[116:119], v[32:35]
    ds_read_b64_tr_b16 v[130:131], v166 offset:34816
    v_mfma_f32_16x16x32_bf16 v[36:39], v[92:95], v[112:115], v[36:39]
    ds_read_b64_tr_b16 v[132:133], v167 offset:32768
    ds_read_b64_tr_b16 v[134:135], v167 offset:34816
    v_mfma_f32_16x16x32_bf16 v[40:43], v[92:95], v[116:119], v[40:43]
    ds_read_b64_tr_b16 v[136:137], v168 offset:32768
    v_mfma_f32_16x16x32_bf16 v[44:47], v[96:99], v[112:115], v[44:47]
    ds_read_b64_tr_b16 v[138:139], v168 offset:34816
    v_mfma_f32_16x16x32_bf16 v[48:51], v[96:99], v[116:119], v[48:51]
    ds_read_b64_tr_b16 v[140:141], v169 offset:32768
    v_mfma_f32_16x16x32_bf16 v[52:55], v[100:103], v[112:115], v[52:55]
    ds_read_b64_tr_b16 v[142:143], v169 offset:34816
    v_mfma_f32_16x16x32_bf16 v[56:59], v[100:103], v[116:119], v[56:59]
    ds_read_b64_tr_b16 v[144:145], v170 offset:32768
    v_mfma_f32_16x16x32_bf16 v[60:63], v[104:107], v[112:115], v[60:63]
    ds_read_b64_tr_b16 v[146:147], v170 offset:34816
    v_mfma_f32_16x16x32_bf16 v[64:67], v[104:107], v[116:119], v[64:67]
    ds_read_b64_tr_b16 v[148:149], v171 offset:32768
    v_mfma_f32_16x16x32_bf16 v[68:71], v[108:111], v[112:115], v[68:71]
    ds_read_b64_tr_b16 v[150:151], v171 offset:34816
    v_mfma_f32_16x16x32_bf16 v[72:75], v[108:111], v[116:119], v[72:75]
    ds_read_b64_tr_b16 v[152:153], v172 offset:32768
    ds_read_b64_tr_b16 v[154:155], v172 offset:34816
    s_waitcnt lgkmcnt(0)
    v_mfma_f32_16x16x32_bf16 v[4:7], v[120:123], v[156:159], v[4:7]
    v_mfma_f32_16x16x32_bf16 v[8:11], v[120:123], v[160:163], v[8:11]
    v_mfma_f32_16x16x32_bf16 v[12:15], v[124:127], v[156:159], v[12:15]
    v_mfma_f32_16x16x32_bf16 v[16:19], v[124:127], v[160:163], v[16:19]
    v_mfma_f32_16x16x32_bf16 v[20:23], v[128:131], v[156:159], v[20:23]
    v_mfma_f32_16x16x32_bf16 v[24:27], v[128:131], v[160:163], v[24:27]
    v_mfma_f32_16x16x32_bf16 v[28:31], v[132:135], v[156:159], v[28:31]
    v_mfma_f32_16x16x32_bf16 v[32:35], v[132:135], v[160:163], v[32:35]
    v_mfma_f32_16x16x32_bf16 v[36:39], v[136:139], v[156:159], v[36:39]
    v_mfma_f32_16x16x32_bf16 v[40:43], v[136:139], v[160:163], v[40:43]
    v_mfma_f32_16x16x32_bf16 v[44:47], v[140:143], v[156:159], v[44:47]
    v_mfma_f32_16x16x32_bf16 v[48:51], v[140:143], v[160:163], v[48:51]
    v_mfma_f32_16x16x32_bf16 v[52:55], v[144:147], v[156:159], v[52:55]
    v_mfma_f32_16x16x32_bf16 v[56:59], v[144:147], v[160:163], v[56:59]
    v_mfma_f32_16x16x32_bf16 v[60:63], v[148:151], v[156:159], v[60:63]
    v_mfma_f32_16x16x32_bf16 v[64:67], v[148:151], v[160:163], v[64:67]
    v_mfma_f32_16x16x32_bf16 v[68:71], v[152:155], v[156:159], v[68:71]
    v_mfma_f32_16x16x32_bf16 v[72:75], v[152:155], v[160:163], v[72:75]
    s_waitcnt vmcnt(0)
    s_barrier
    s_nop 7
    s_nop 7
    v_and_b32 v249, 15, v250
    s_lshl_b32 s55, s45, 7
    s_lshl_b32 s56, s40, 5
    s_add_u32 s55, s55, s56
    v_add_u32 v249, s55, v249
    s_movk_i32 s56, 2304
    v_mul_lo_u32 v249, v249, s56
    v_lshrrev_b32 v248, 4, v250
    v_lshlrev_b32 v248, 4, v248
    v_add_u32 v249, v249, v248
    s_mul_i32 s55, s44, 576
    v_add_u32 v249, s55, v249
    s_mov_b32 s55, 0
    buffer_store_dwordx4 v[4:7], v249, s[28:31], s55 offen offset:0
    s_mov_b32 s55, 36864
    buffer_store_dwordx4 v[8:11], v249, s[28:31], s55 offen offset:0
    s_mov_b32 s55, 0
    buffer_store_dwordx4 v[12:15], v249, s[28:31], s55 offen offset:64
    s_mov_b32 s55, 36864
    buffer_store_dwordx4 v[16:19], v249, s[28:31], s55 offen offset:64
    s_mov_b32 s55, 0
    buffer_store_dwordx4 v[20:23], v249, s[28:31], s55 offen offset:128
    s_mov_b32 s55, 36864
    buffer_store_dwordx4 v[24:27], v249, s[28:31], s55 offen offset:128
    s_mov_b32 s55, 0
    buffer_store_dwordx4 v[28:31], v249, s[28:31], s55 offen offset:192
    s_mov_b32 s55, 36864
    buffer_store_dwordx4 v[32:35], v249, s[28:31], s55 offen offset:192
    s_mov_b32 s55, 0
    buffer_store_dwordx4 v[36:39], v249, s[28:31], s55 offen offset:256
    s_mov_b32 s55, 36864
    buffer_store_dwordx4 v[40:43], v249, s[28:31], s55 offen offset:256
    s_mov_b32 s55, 0
    buffer_store_dwordx4 v[44:47], v249, s[28:31], s55 offen offset:320
    s_mov_b32 s55, 36864
    buffer_store_dwordx4 v[48:51], v249, s[28:31], s55 offen offset:320
    s_mov_b32 s55, 0
    buffer_store_dwordx4 v[52:55], v249, s[28:31], s55 offen offset:384
    s_mov_b32 s55, 36864
    buffer_store_dwordx4 v[56:59], v249, s[28:31], s55 offen offset:384
    s_mov_b32 s55, 0
    buffer_store_dwordx4 v[60:63], v249, s[28:31], s55 offen offset:448
    s_mov_b32 s55, 36864
    buffer_store_dwordx4 v[64:67], v249, s[28:31], s55 offen offset:448
    s_mov_b32 s55, 0
    buffer_store_dwordx4 v[68:71], v249, s[28:31], s55 offen offset:512
    s_mov_b32 s55, 36864
    buffer_store_dwordx4 v[72:75], v249, s[28:31], s55 offen offset:512
K2_END:
    s_endpgm
.globl final_kernel
.p2align 8
.type final_kernel,@function
final_kernel:
    s_cmp_ge_u32 s2, 1152
    s_cbranch_scc1 K3_END
    s_load_dwordx2 s[4:5], s[0:1], 0
    s_load_dwordx2 s[6:7], s[0:1], 72
    s_load_dwordx2 s[12:13], s[0:1], 88
    s_lshl_b32 s3, s2, 8
    v_add_u32 v1, s3, v0
    v_lshlrev_b32 v2, 3, v1
    v_lshlrev_b32 v3, 4, v1
    s_waitcnt lgkmcnt(0)
    s_mov_b32 s16, s4
    s_mov_b32 s17, s5
    s_mov_b32 s18, 0x240000
    s_mov_b32 s19, 0x00020000
    s_mov_b32 s20, s6
    s_mov_b32 s21, s7
    s_mov_b32 s22, 0x240000
    s_mov_b32 s23, 0x00020000
    s_add_u32 s24, s12, 0x1a00000
    s_addc_u32 s25, s13, 0
    s_mov_b32 s26, 0x240000
    s_mov_b32 s27, 0x00020000
    s_add_u32 s28, s12, 0x1d00000
    s_addc_u32 s29, s13, 0
    s_mov_b32 s30, 0x240000
    s_mov_b32 s31, 0x00020000
    s_add_u32 s32, s12, 0x2000000
    s_addc_u32 s33, s13, 0
    s_mov_b32 s34, 0x480000
    s_mov_b32 s35, 0x00020000
    s_add_u32 s36, s12, 0x2480000
    s_addc_u32 s37, s13, 0
    s_mov_b32 s38, 0x480000
    s_mov_b32 s39, 0x00020000
    buffer_load_dwordx2 v[4:5], v2, s[16:19], 0 offen
    buffer_load_dwordx2 v[6:7], v2, s[24:27], 0 offen
    buffer_load_dwordx2 v[8:9], v2, s[28:31], 0 offen
    buffer_load_dwordx4 v[12:15], v3, s[32:35], 0 offen
    buffer_load_dwordx4 v[16:19], v3, s[36:39], 0 offen
    s_waitcnt vmcnt(0)
    v_lshlrev_b32 v20, 16, v4
    v_lshlrev_b32 v21, 16, v6
    v_lshlrev_b32 v22, 16, v8
    v_sub_f32 v21, v21, v22
    v_cvt_pk_bf16_f32 v23, v21, v21
    v_lshlrev_b32 v21, 16, v23
    v_add_f32 v22, v12, v16
    v_cvt_pk_bf16_f32 v23, v22, v22
    v_lshlrev_b32 v22, 16, v23
    v_mul_f32 v23, 0xbfb8aa3b, v22
    v_exp_f32 v23, v23
    s_nop 0
    v_add_f32 v23, 1.0, v23
    v_rcp_f32 v24, v23
    s_nop 0
    v_mul_f32 v22, v22, v24
    v_cvt_pk_bf16_f32 v23, v22, v22
    v_lshlrev_b32 v22, 16, v23
    v_mul_f32 v21, v21, v22
    v_cvt_pk_bf16_f32 v23, v21, v21
    v_lshlrev_b32 v21, 16, v23
    v_add_f32 v26, v20, v21
    v_and_b32 v20, 0xffff0000, v4
    v_and_b32 v21, 0xffff0000, v6
    v_and_b32 v22, 0xffff0000, v8
    v_sub_f32 v21, v21, v22
    v_cvt_pk_bf16_f32 v23, v21, v21
    v_lshlrev_b32 v21, 16, v23
    v_add_f32 v22, v13, v17
    v_cvt_pk_bf16_f32 v23, v22, v22
    v_lshlrev_b32 v22, 16, v23
    v_mul_f32 v23, 0xbfb8aa3b, v22
    v_exp_f32 v23, v23
    s_nop 0
    v_add_f32 v23, 1.0, v23
    v_rcp_f32 v24, v23
    s_nop 0
    v_mul_f32 v22, v22, v24
    v_cvt_pk_bf16_f32 v23, v22, v22
    v_lshlrev_b32 v22, 16, v23
    v_mul_f32 v21, v21, v22
    v_cvt_pk_bf16_f32 v23, v21, v21
    v_lshlrev_b32 v21, 16, v23
    v_add_f32 v27, v20, v21
    v_lshlrev_b32 v20, 16, v5
    v_lshlrev_b32 v21, 16, v7
    v_lshlrev_b32 v22, 16, v9
    v_sub_f32 v21, v21, v22
    v_cvt_pk_bf16_f32 v23, v21, v21
    v_lshlrev_b32 v21, 16, v23
    v_add_f32 v22, v14, v18
    v_cvt_pk_bf16_f32 v23, v22, v22
    v_lshlrev_b32 v22, 16, v23
    v_mul_f32 v23, 0xbfb8aa3b, v22
    v_exp_f32 v23, v23
    s_nop 0
    v_add_f32 v23, 1.0, v23
    v_rcp_f32 v24, v23
    s_nop 0
    v_mul_f32 v22, v22, v24
    v_cvt_pk_bf16_f32 v23, v22, v22
    v_lshlrev_b32 v22, 16, v23
    v_mul_f32 v21, v21, v22
    v_cvt_pk_bf16_f32 v23, v21, v21
    v_lshlrev_b32 v21, 16, v23
    v_add_f32 v28, v20, v21
    v_and_b32 v20, 0xffff0000, v5
    v_and_b32 v21, 0xffff0000, v7
    v_and_b32 v22, 0xffff0000, v9
    v_sub_f32 v21, v21, v22
    v_cvt_pk_bf16_f32 v23, v21, v21
    v_lshlrev_b32 v21, 16, v23
    v_add_f32 v22, v15, v19
    v_cvt_pk_bf16_f32 v23, v22, v22
    v_lshlrev_b32 v22, 16, v23
    v_mul_f32 v23, 0xbfb8aa3b, v22
    v_exp_f32 v23, v23
    s_nop 0
    v_add_f32 v23, 1.0, v23
    v_rcp_f32 v24, v23
    s_nop 0
    v_mul_f32 v22, v22, v24
    v_cvt_pk_bf16_f32 v23, v22, v22
    v_lshlrev_b32 v22, 16, v23
    v_mul_f32 v21, v21, v22
    v_cvt_pk_bf16_f32 v23, v21, v21
    v_lshlrev_b32 v21, 16, v23
    v_add_f32 v29, v20, v21
    v_cvt_pk_bf16_f32 v30, v26, v27
    v_cvt_pk_bf16_f32 v31, v28, v29
    buffer_store_dwordx2 v[30:31], v2, s[20:23], 0 offen
K3_END:
    s_endpgm
.section .rodata,"a"
.p2align 6
.amdhsa_kernel ln_kernel
  .amdhsa_next_free_vgpr 64
  .amdhsa_next_free_sgpr 102
  .amdhsa_accum_offset 64
  .amdhsa_group_segment_fixed_size 0
  .amdhsa_kernarg_size 96
  .amdhsa_user_sgpr_count 2
  .amdhsa_user_sgpr_kernarg_segment_ptr 1
  .amdhsa_system_sgpr_workgroup_id_x 1
.end_amdhsa_kernel
.section .rodata,"a"
.p2align 6
.amdhsa_kernel stagea_kernel
  .amdhsa_next_free_vgpr 256
  .amdhsa_next_free_sgpr 102
  .amdhsa_accum_offset 256
  .amdhsa_group_segment_fixed_size 0
  .amdhsa_kernarg_size 96
  .amdhsa_user_sgpr_count 2
  .amdhsa_user_sgpr_kernarg_segment_ptr 1
  .amdhsa_system_sgpr_workgroup_id_x 1
.end_amdhsa_kernel
.section .rodata,"a"
.p2align 6
.amdhsa_kernel stageb_kernel
  .amdhsa_next_free_vgpr 256
  .amdhsa_next_free_sgpr 102
  .amdhsa_accum_offset 256
  .amdhsa_group_segment_fixed_size 0
  .amdhsa_kernarg_size 96
  .amdhsa_user_sgpr_count 2
  .amdhsa_user_sgpr_kernarg_segment_ptr 1
  .amdhsa_system_sgpr_workgroup_id_x 1
.end_amdhsa_kernel
.section .rodata,"a"
.p2align 6
.amdhsa_kernel final_kernel
  .amdhsa_next_free_vgpr 64
  .amdhsa_next_free_sgpr 102
  .amdhsa_accum_offset 64
  .amdhsa_group_segment_fixed_size 0
  .amdhsa_kernarg_size 96
  .amdhsa_user_sgpr_count 2
  .amdhsa_user_sgpr_kernarg_segment_ptr 1
  .amdhsa_system_sgpr_workgroup_id_x 1
.end_amdhsa_kernel
```
